```python
import torch

def _softmax(x, axis=-1):
    return torch.softmax(x, dim=axis)
def _gelu(x):
    return torch.nn.functional.gelu(x, approximate="tanh")
def _silu(x):
    return torch.nn.functional.silu(x)
def _sigmoid(x):
    return torch.sigmoid(x)
def _layernorm(x, axis=-1, eps=1e-5):
    m = x.mean(dim=axis, keepdim=True)
    v = x.var(dim=axis, keepdim=True, unbiased=False)
    return (x - m) / torch.sqrt(v + eps)
def _scatter_add(tgt, idx, src, axis=0):
    return tgt.clone().index_add_(axis, idx, src)
def _segment_sum(src, seg, n):
    out = torch.zeros((n,) + src.shape[1:], dtype=src.dtype)
    return out.index_add_(0, seg, src)
def _pad(x, pw):
    flat = tuple(v for pair in reversed(pw) for v in pair)
    return torch.nn.functional.pad(x, flat)

kernel_name = 'recurrent_scan__sliding_block_cached__glu_gated_bilinear__prompt'

def setup_inputs():

    _w = (lambda a: (lambda t: t.to(torch.bfloat16) if t.is_floating_point() else t)(torch.as_tensor(a)))
    def _A_setup():
        B, Sq, D = 1, 2048, 1024
        Hq, Hkv, Sk, Dh = 32, 4, 2048, 128
        assert Hq % Hkv == 0, (Hq, Hkv)
        return {
            "x": _w((lambda *s: torch.randn(*s, dtype=torch.bfloat16) * 0.05)(B, Sq, D)),
            "k_cache": _w((lambda *s: torch.randn(*s, dtype=torch.bfloat16) * 1.6)(B, Hkv, Sk, Dh)),
            "v_cache": _w((lambda *s: torch.randn(*s, dtype=torch.bfloat16) * 1.6)(B, Hkv, Sk, Dh)),
            "wq": _w((lambda *s: torch.randn(*s, dtype=torch.bfloat16) * 1.6)(D, Hq * Dh) * (D ** -0.5)),
            "wo": _w((lambda *s: torch.randn(*s, dtype=torch.bfloat16) * 1.6)(Hq * Dh, D) * ((Hq * Dh) ** -0.5)),
        }
    _A_in = _A_setup()

    def _B_setup():
        B, S, D, F = 1, 2048, 1024, 3584
        return {
            "x": _w((lambda *s: torch.randn(*s, dtype=torch.bfloat16) * 0.05)(B, S, D)),
            "w_gate": _w((lambda *s: torch.randn(*s, dtype=torch.bfloat16) * 0.2)(D, F) * (D ** -0.5)),
            "w_up": _w((lambda *s: torch.randn(*s, dtype=torch.bfloat16) * 0.2)(D, F) * (D ** -0.5)),
            "w_down": _w((lambda *s: torch.randn(*s, dtype=torch.bfloat16) * 0.2)(F, D) * (F ** -0.5)),
        }
    _B_in = _B_setup()

    return {
        "A_x": _A_in["x"],
        "A_k_cache": _A_in["k_cache"],
        "A_v_cache": _A_in["v_cache"],
        "A_wq": _A_in["wq"],
        "A_wo": _A_in["wo"],
        "B_x": _B_in["x"],
        "B_w_gate": _B_in["w_gate"],
        "B_w_up": _B_in["w_up"],
        "B_w_down": _B_in["w_down"],
    }

def reference(A_x, A_k_cache, A_v_cache, A_wq, A_wo, B_x, B_w_gate, B_w_up, B_w_down):
    def _A_ref(x, k_cache, v_cache, wq, wo):
        B, Sq, D = x.shape
        Hq, Dh = 32, 128
        Hkv, Sk = k_cache.shape[1], k_cache.shape[2]
        W = min(4096, max(256, Sk // 4))
        rep = Hq // Hkv
        q = (lambda x, *d: x.permute(*d))((x @ wq).reshape(B, Sq, Hq, Dh), 0, 2, 1, 3)
        k = (lambda x, n, axis: torch.repeat_interleave(x, n, dim=axis))(k_cache[:, :, Sk - W:, :], rep, axis=1)
        v = (lambda x, n, axis: torch.repeat_interleave(x, n, dim=axis))(v_cache[:, :, Sk - W:, :], rep, axis=1)
        scores = torch.einsum("bhqd,bhkd->bhqk", q, k) * (Dh ** -0.5)
        p = _softmax(scores, axis=-1)
        o = torch.einsum("bhqk,bhkd->bhqd", p, v)
        return (lambda x, *d: x.permute(*d))(o, 0, 2, 1, 3).reshape(B, Sq, Hq * Dh) @ wo

    def _B_ref(x, w_gate, w_up, w_down):
        g = torch.einsum("bsd,df->bsf", x, w_gate)
        u = torch.einsum("bsd,df->bsf", x, w_up)
        h = g * u
        return torch.einsum("bsf,fd->bsd", h, w_down)

    x = A_x
    xn = _layernorm(x, axis=-1)
    s = _A_ref(xn, A_k_cache, A_v_cache, A_wq, A_wo)
    g = _silu(_B_ref(xn, B_w_gate, B_w_up, B_w_down))
    return x + s * g
```

```asm
; @launch grid=(256,1,1) block=(256,1,1) lds=163840
.amdgcn_target "amdgcn-amd-amdhsa--gfx950"
.text
.globl recurrent_scan__sliding_block_cached__glu_gated_bilinear__prompt_kernel
.p2align 8
.type recurrent_scan__sliding_block_cached__glu_gated_bilinear__prompt_kernel,@function
recurrent_scan__sliding_block_cached__glu_gated_bilinear__prompt_kernel:
  s_cmp_ge_u32 s2, 256
  s_cbranch_scc1 L_end
  s_load_dwordx2 s[92:93], s[0:1], 0
  s_load_dwordx4 s[48:51], s[0:1], 8
  s_load_dwordx4 s[52:55], s[0:1], 24
  s_load_dwordx4 s[56:59], s[0:1], 48
  s_load_dwordx4 s[72:75], s[0:1], 64
  s_load_dwordx4 s[60:63], s[0:1], 80
  v_and_b32 v1, 63, v0
  v_lshrrev_b32 v16, 6, v0
  s_nop 0
  v_readfirstlane_b32 s33, v16
  s_lshr_b32 s34, s2, 3
  s_and_b32 s35, s2, 1
  s_lshl_b32 s35, s35, 2
  s_and_b32 s32, s34, 3
  s_add_u32 s32, s32, s35
  s_bfe_u32 s35, s2, 0x20001
  s_lshr_b32 s34, s34, 2
  s_lshl_b32 s3, s35, 3
  s_add_u32 s34, s34, s3
  s_lshl_b32 s3, s32, 5
  s_add_u32 s3, s3, s34
  s_lshl_b32 s4, s3, 3
  v_and_b32 v32, 7, v1
  v_add_u32 v33, s4, v32
  v_lshlrev_b32 v34, 11, v33
  v_lshrrev_b32 v35, 3, v1
  s_lshl_b32 s4, s33, 3
  v_add_u32 v35, s4, v35
  v_lshl_add_u32 v34, v35, 6, v34
  s_mov_b32 s94, 0x400000
  s_mov_b32 s95, 0x20000
  s_waitcnt lgkmcnt(0)
  buffer_load_dwordx4 v[64:67], v34, s[92:95], 0 offen offset:0
  buffer_load_dwordx4 v[68:71], v34, s[92:95], 0 offen offset:16
  buffer_load_dwordx4 v[72:75], v34, s[92:95], 0 offen offset:32
  buffer_load_dwordx4 v[76:79], v34, s[92:95], 0 offen offset:48
  s_mov_b32 s44, s60
  s_mov_b32 s45, s61
  s_mov_b32 s46, 256
  s_mov_b32 s47, 0x20000
  s_mov_b32 s60, s62
  s_mov_b32 s61, s63
  s_lshl_b32 s62, s34, 8
  v_bfe_u32 v36, v1, 2, 3
  s_and_b32 s63, s33, 1
  s_lshl_b32 s63, s63, 5
  v_add_u32 v36, s63, v36
  s_mov_b32 s63, 8192
  v_mul_lo_u32 v7, v36, s63
  v_lshrrev_b32 v36, 5, v1
  v_lshl_add_u32 v7, v36, 6, v7
  v_bfe_u32 v36, v1, 4, 1
  v_lshlrev_b32 v36, 1, v36
  v_and_b32 v37, 3, v1
  v_xor_b32 v36, v36, v37
  v_lshl_add_u32 v7, v36, 4, v7
  s_lshr_b32 s63, s33, 1
  s_lshl_b32 s63, s63, 7
  s_add_u32 s63, s63, s62
  v_add_u32 v7, s63, v7
  v_add_u32 v8, 0xfc00, v7
  v_add_u32 v9, 0x1f800, v7
  v_add_u32 v10, 0x2f400, v7
  s_lshr_b32 s62, s34, 1
  s_mul_i32 s62, s62, 448
  s_and_b32 s63, s34, 1
  s_lshl_b32 s70, s63, 8
  s_add_u32 s70, s70, s62
  s_lshl_b32 s71, s63, 5
  s_add_u32 s71, s71, s62
  s_add_u32 s71, s71, 192
  v_lshrrev_b32 v36, 5, v1
  v_lshlrev_b32 v36, 3, v36
  v_bfe_u32 v37, v1, 2, 3
  v_add_u32 v36, v36, v37
  s_lshl_b32 s62, s33, 4
  v_add_u32 v36, s62, v36
  s_movk_i32 s62, 7168
  v_mul_lo_u32 v11, v36, s62
  v_bfe_u32 v36, v1, 4, 1
  v_lshlrev_b32 v36, 1, v36
  v_and_b32 v37, 3, v1
  v_xor_b32 v36, v36, v37
  v_lshl_add_u32 v11, v36, 4, v11
  s_add_u32 s70, s70, 4096
  v_add_u32 v11, s70, v11
  v_subrev_u32 v12, 960, v11
  v_subrev_u32 v13, 1920, v11
  v_lshrrev_b32 v36, 1, v1
  s_and_b32 s63, s33, 1
  s_lshl_b32 s63, s63, 5
  v_add_u32 v36, s63, v36
  v_mul_lo_u32 v14, v36, s62
  v_and_b32 v37, 1, v1
  v_lshl_add_u32 v14, v37, 4, v14
  s_add_u32 s71, s71, 4096
  v_add_u32 v14, s71, v14
  s_lshl_b32 s5, s33, 12
  s_mul_i32 s6, s33, 3072
  s_lshl_b32 s7, s33, 10
  s_mov_b32 s8, s52
  s_mov_b32 s9, s53
  s_mov_b32 s10, 0x800000
  s_mov_b32 s11, 0x20000
  s_sub_u32 s12, s56, 0x1000
  s_subb_u32 s13, s57, 0
  s_mov_b32 s14, 0x701000
  s_mov_b32 s15, 0x20000
  s_sub_u32 s16, s58, 0x1000
  s_subb_u32 s17, s59, 0
  s_mov_b32 s18, 0x701000
  s_mov_b32 s19, 0x20000
  s_cmp_lt_u32 s33, 2
  s_cselect_b32 s20, s12, s16
  s_cselect_b32 s21, s13, s17
  s_mov_b32 s22, 0x701000
  s_mov_b32 s23, 0x20000
  s_mov_b32 s76, s54
  s_mov_b32 s77, s55
  s_mov_b32 s78, 0x800000
  s_mov_b32 s79, 0x20000
  s_mov_b32 s80, s72
  s_mov_b32 s81, s73
  s_mov_b32 s82, 0x700000
  s_mov_b32 s83, 0x20000
  s_mov_b32 s96, s74
  s_mov_b32 s97, s75
  s_mov_b32 s98, 0x400000
  s_mov_b32 s99, 0x20000
  s_mov_b32 s52, 0
  s_mov_b32 s53, 0
  s_mov_b32 s54, 0
  s_mov_b32 s90, 0
  s_mov_b32 s88, 90112
  s_mov_b32 s89, 45056
  s_add_u32 m0, s5, s90
  s_nop 0
  buffer_load_dwordx4 v7, s[8:11], s52 offen offset:0 lds
  buffer_load_dwordx4 v8, s[8:11], s52 offen offset:1024 lds
  buffer_load_dwordx4 v9, s[8:11], s52 offen offset:2048 lds
  buffer_load_dwordx4 v10, s[8:11], s52 offen offset:3072 lds
  s_add_u32 s100, s6, s90
  s_add_u32 m0, s100, 16384
  s_nop 0
  buffer_load_dwordx4 v11, s[12:15], s53 offen offset:0 lds
  buffer_load_dwordx4 v12, s[12:15], s53 offen offset:1024 lds
  buffer_load_dwordx4 v13, s[12:15], s53 offen offset:2048 lds
  s_add_u32 m0, s100, 28672
  s_nop 0
  buffer_load_dwordx4 v11, s[16:19], s53 offen offset:0 lds
  buffer_load_dwordx4 v12, s[16:19], s53 offen offset:1024 lds
  buffer_load_dwordx4 v13, s[16:19], s53 offen offset:2048 lds
  s_add_u32 s100, s7, s90
  s_add_u32 m0, s100, 40960
  s_nop 0
  buffer_load_dwordx4 v14, s[20:23], s53 offen lds
  s_add_u32 s52, s52, 0x80000
  s_add_u32 s53, s53, 0x70000
  s_mov_b32 s100, s90
  s_mov_b32 s90, s88
  s_mov_b32 s88, s89
  s_mov_b32 s89, s100
  s_lshl_b32 s62, s2, 2
  s_add_u32 s62, s62, s33
  s_lshl_b32 s63, s62, 12
  v_lshlrev_b32 v31, 6, v1
  v_add_u32 v31, s63, v31
  s_lshl_b32 s63, s62, 10
  v_and_b32 v30, 15, v1
  v_lshlrev_b32 v30, 6, v30
  v_add_u32 v30, s63, v30
  s_mul_i32 s63, s62, 1280
  v_min_u32 v31, 9, v1
  v_lshlrev_b32 v31, 7, v31
  v_add_u32 v31, s63, v31
  s_add_u32 s64, s60, 0x2400000
  s_addc_u32 s65, s61, 0
  s_mov_b32 s66, 0x2000000
  s_mov_b32 s67, 0x20000
  s_lshl_b32 s62, s3, 17
  s_add_u32 s62, s62, 0x0
  v_and_b32 v36, 31, v1
  v_add_u32 v28, s62, v1
  s_lshl_b32 s62, s32, 22
  s_add_u32 s62, s62, s34
  s_add_u32 s62, s62, 0x0
  v_lshl_add_u32 v29, v36, 17, s62
  v_mov_b32 v37, 0x7fff0000
  v_lshrrev_b32 v38, 5, v1
  v_or_b32 v38, s33, v38
  v_cmp_eq_u32 vcc, 0, v38
  v_mov_b32 v126, 0
  s_nop 0
  v_cndmask_b32 v29, v37, v29, vcc
  s_cmp_eq_u32 s33, 0
  s_cselect_b32 s70, 0, 0x40000000
  v_or_b32 v38, s33, v1
  v_cmp_eq_u32 vcc, 0, v38
  v_mov_b32 v36, s3
  s_lshl_b32 s62, s32, 5
  v_cndmask_b32 v27, v37, v36, vcc
  v_and_b32 v26, 31, v1
  v_add_u32 v26, s62, v26
  s_mov_b32 s62, 0xffff0000
  s_waitcnt vmcnt(11)
  v_lshlrev_b32 v80, 16, v64
  v_and_b32 v81, s62, v64
  v_lshlrev_b32 v82, 16, v65
  v_and_b32 v83, s62, v65
  v_lshlrev_b32 v84, 16, v66
  v_and_b32 v85, s62, v66
  v_lshlrev_b32 v86, 16, v67
  v_and_b32 v87, s62, v67
  v_lshlrev_b32 v88, 16, v68
  v_and_b32 v89, s62, v68
  v_lshlrev_b32 v90, 16, v69
  v_and_b32 v91, s62, v69
  v_lshlrev_b32 v92, 16, v70
  v_and_b32 v93, s62, v70
  v_lshlrev_b32 v94, 16, v71
  v_and_b32 v95, s62, v71
  v_lshlrev_b32 v96, 16, v72
  v_and_b32 v97, s62, v72
  v_lshlrev_b32 v98, 16, v73
  v_and_b32 v99, s62, v73
  v_lshlrev_b32 v100, 16, v74
  v_and_b32 v101, s62, v74
  v_lshlrev_b32 v102, 16, v75
  v_and_b32 v103, s62, v75
  v_lshlrev_b32 v104, 16, v76
  v_and_b32 v105, s62, v76
  v_lshlrev_b32 v106, 16, v77
  v_and_b32 v107, s62, v77
  v_lshlrev_b32 v108, 16, v78
  v_and_b32 v109, s62, v78
  v_lshlrev_b32 v110, 16, v79
  v_and_b32 v111, s62, v79
  v_pk_add_f32 v[36:37], v[80:81], v[82:83]
  v_pk_add_f32 v[38:39], v[84:85], v[86:87]
  v_pk_add_f32 v[36:37], v[36:37], v[88:89]
  v_pk_add_f32 v[38:39], v[38:39], v[90:91]
  v_pk_add_f32 v[36:37], v[36:37], v[92:93]
  v_pk_add_f32 v[38:39], v[38:39], v[94:95]
  v_pk_add_f32 v[36:37], v[36:37], v[96:97]
  v_pk_add_f32 v[38:39], v[38:39], v[98:99]
  v_pk_add_f32 v[36:37], v[36:37], v[100:101]
  v_pk_add_f32 v[38:39], v[38:39], v[102:103]
  v_pk_add_f32 v[36:37], v[36:37], v[104:105]
  v_pk_add_f32 v[38:39], v[38:39], v[106:107]
  v_pk_add_f32 v[36:37], v[36:37], v[108:109]
  v_pk_add_f32 v[38:39], v[38:39], v[110:111]
  v_pk_add_f32 v[36:37], v[36:37], v[38:39]
  v_add_f32 v36, v36, v37
  s_nop 1
  v_add_f32_dpp v36, v36, v36 row_ror:8 row_mask:0xf bank_mask:0xf
  v_mov_b32 v40, v36
  s_nop 1
  v_permlane16_swap_b32 v36, v40
  v_add_f32 v36, v36, v40
  v_mov_b32 v40, v36
  s_nop 1
  v_permlane32_swap_b32 v36, v40
  v_add_f32 v36, v36, v40
  v_mul_f32 v36, 0x3b800000, v36
  v_mov_b32 v52, 0
  v_mov_b32 v53, 0
  v_mov_b32 v54, 0
  v_mov_b32 v55, 0
  v_pk_add_f32 v[44:45], v[80:81], v[36:37] op_sel_hi:[1,0] neg_lo:[0,1] neg_hi:[0,1]
  v_pk_add_f32 v[46:47], v[82:83], v[36:37] op_sel_hi:[1,0] neg_lo:[0,1] neg_hi:[0,1]
  v_pk_fma_f32 v[52:53], v[44:45], v[44:45], v[52:53]
  v_pk_fma_f32 v[54:55], v[46:47], v[46:47], v[54:55]
  v_pk_add_f32 v[44:45], v[84:85], v[36:37] op_sel_hi:[1,0] neg_lo:[0,1] neg_hi:[0,1]
  v_pk_add_f32 v[46:47], v[86:87], v[36:37] op_sel_hi:[1,0] neg_lo:[0,1] neg_hi:[0,1]
  v_pk_fma_f32 v[52:53], v[44:45], v[44:45], v[52:53]
  v_pk_fma_f32 v[54:55], v[46:47], v[46:47], v[54:55]
  v_pk_add_f32 v[44:45], v[88:89], v[36:37] op_sel_hi:[1,0] neg_lo:[0,1] neg_hi:[0,1]
  v_pk_add_f32 v[46:47], v[90:91], v[36:37] op_sel_hi:[1,0] neg_lo:[0,1] neg_hi:[0,1]
  v_pk_fma_f32 v[52:53], v[44:45], v[44:45], v[52:53]
  v_pk_fma_f32 v[54:55], v[46:47], v[46:47], v[54:55]
  v_pk_add_f32 v[44:45], v[92:93], v[36:37] op_sel_hi:[1,0] neg_lo:[0,1] neg_hi:[0,1]
  v_pk_add_f32 v[46:47], v[94:95], v[36:37] op_sel_hi:[1,0] neg_lo:[0,1] neg_hi:[0,1]
  v_pk_fma_f32 v[52:53], v[44:45], v[44:45], v[52:53]
  v_pk_fma_f32 v[54:55], v[46:47], v[46:47], v[54:55]
  v_pk_add_f32 v[44:45], v[96:97], v[36:37] op_sel_hi:[1,0] neg_lo:[0,1] neg_hi:[0,1]
  v_pk_add_f32 v[46:47], v[98:99], v[36:37] op_sel_hi:[1,0] neg_lo:[0,1] neg_hi:[0,1]
  v_pk_fma_f32 v[52:53], v[44:45], v[44:45], v[52:53]
  v_pk_fma_f32 v[54:55], v[46:47], v[46:47], v[54:55]
  v_pk_add_f32 v[44:45], v[100:101], v[36:37] op_sel_hi:[1,0] neg_lo:[0,1] neg_hi:[0,1]
  v_pk_add_f32 v[46:47], v[102:103], v[36:37] op_sel_hi:[1,0] neg_lo:[0,1] neg_hi:[0,1]
  v_pk_fma_f32 v[52:53], v[44:45], v[44:45], v[52:53]
  v_pk_fma_f32 v[54:55], v[46:47], v[46:47], v[54:55]
  v_pk_add_f32 v[44:45], v[104:105], v[36:37] op_sel_hi:[1,0] neg_lo:[0,1] neg_hi:[0,1]
  v_pk_add_f32 v[46:47], v[106:107], v[36:37] op_sel_hi:[1,0] neg_lo:[0,1] neg_hi:[0,1]
  v_pk_fma_f32 v[52:53], v[44:45], v[44:45], v[52:53]
  v_pk_fma_f32 v[54:55], v[46:47], v[46:47], v[54:55]
  v_pk_add_f32 v[44:45], v[108:109], v[36:37] op_sel_hi:[1,0] neg_lo:[0,1] neg_hi:[0,1]
  v_pk_add_f32 v[46:47], v[110:111], v[36:37] op_sel_hi:[1,0] neg_lo:[0,1] neg_hi:[0,1]
  v_pk_fma_f32 v[52:53], v[44:45], v[44:45], v[52:53]
  v_pk_fma_f32 v[54:55], v[46:47], v[46:47], v[54:55]
  v_pk_add_f32 v[52:53], v[52:53], v[54:55]
  v_add_f32 v37, v52, v53
  s_nop 1
  v_add_f32_dpp v37, v37, v37 row_ror:8 row_mask:0xf bank_mask:0xf
  v_mov_b32 v40, v37
  s_nop 1
  v_permlane16_swap_b32 v37, v40
  v_add_f32 v37, v37, v40
  v_mov_b32 v40, v37
  s_nop 1
  v_permlane32_swap_b32 v37, v40
  v_add_f32 v37, v37, v40
  v_lshlrev_b32 v38, 5, v32
  v_add_u32 v38, 0x27e00, v38
  s_lshl_b32 s63, s33, 3
  v_add_u32 v39, s63, v38
  ds_write_b64 v39, v[36:37]
  s_waitcnt lgkmcnt(0)
  s_barrier
  ds_read_b128 v[44:47], v38
  ds_read_b128 v[48:51], v38 offset:16
  v_lshrrev_b32 v42, 6, v33
  v_lshlrev_b32 v42, 17, v42
  v_lshl_add_u32 v42, v35, 12, v42
  v_bfe_u32 v43, v33, 4, 2
  v_lshl_add_u32 v42, v43, 10, v42
  v_and_b32 v43, 15, v33
  v_lshl_add_u32 v42, v43, 4, v42
  s_mov_b32 s24, s60
  s_mov_b32 s25, s61
  s_mov_b32 s26, 0x400000
  s_mov_b32 s27, 0x20000
  s_waitcnt lgkmcnt(0)
  v_add_f32 v36, v44, v46
  v_add_f32 v37, v48, v50
  v_add_f32 v36, v36, v37
  v_mul_f32 v36, 0.25, v36
  v_add_f32 v37, v45, v47
  v_add_f32 v38, v49, v51
  v_add_f32 v37, v37, v38
  v_sub_f32 v44, v44, v36
  v_sub_f32 v46, v46, v36
  v_sub_f32 v48, v48, v36
  v_sub_f32 v50, v50, v36
  v_mul_f32 v38, v44, v44
  v_fmac_f32 v38, v46, v46
  v_fmac_f32 v38, v48, v48
  v_fmac_f32 v38, v50, v50
  v_fmac_f32 v37, 0x43800000, v38
  v_mul_f32 v37, 0x3a800000, v37
  v_cvt_pk_bf16_f32 v38, v36, v37
  v_lshlrev_b32 v36, 16, v38
  v_and_b32 v37, s62, v38
  v_add_f32 v37, 0x3727c5ac, v37
  v_cvt_pk_bf16_f32 v37, v37, v37
  v_and_b32 v37, s62, v37
  v_sqrt_f32 v37, v37
  s_nop 0
  v_cvt_pk_bf16_f32 v37, v37, v37
  v_and_b32 v37, s62, v37
  v_rcp_f32 v37, v37
  s_nop 0
  v_pk_add_f32 v[80:81], v[80:81], v[36:37] op_sel_hi:[1,0] neg_lo:[0,1] neg_hi:[0,1]
  v_pk_add_f32 v[82:83], v[82:83], v[36:37] op_sel_hi:[1,0] neg_lo:[0,1] neg_hi:[0,1]
  v_pk_add_f32 v[84:85], v[84:85], v[36:37] op_sel_hi:[1,0] neg_lo:[0,1] neg_hi:[0,1]
  v_pk_add_f32 v[86:87], v[86:87], v[36:37] op_sel_hi:[1,0] neg_lo:[0,1] neg_hi:[0,1]
  v_pk_add_f32 v[88:89], v[88:89], v[36:37] op_sel_hi:[1,0] neg_lo:[0,1] neg_hi:[0,1]
  v_pk_add_f32 v[90:91], v[90:91], v[36:37] op_sel_hi:[1,0] neg_lo:[0,1] neg_hi:[0,1]
  v_pk_add_f32 v[92:93], v[92:93], v[36:37] op_sel_hi:[1,0] neg_lo:[0,1] neg_hi:[0,1]
  v_pk_add_f32 v[94:95], v[94:95], v[36:37] op_sel_hi:[1,0] neg_lo:[0,1] neg_hi:[0,1]
  v_pk_add_f32 v[96:97], v[96:97], v[36:37] op_sel_hi:[1,0] neg_lo:[0,1] neg_hi:[0,1]
  v_pk_add_f32 v[98:99], v[98:99], v[36:37] op_sel_hi:[1,0] neg_lo:[0,1] neg_hi:[0,1]
  v_pk_add_f32 v[100:101], v[100:101], v[36:37] op_sel_hi:[1,0] neg_lo:[0,1] neg_hi:[0,1]
  v_pk_add_f32 v[102:103], v[102:103], v[36:37] op_sel_hi:[1,0] neg_lo:[0,1] neg_hi:[0,1]
  v_pk_add_f32 v[104:105], v[104:105], v[36:37] op_sel_hi:[1,0] neg_lo:[0,1] neg_hi:[0,1]
  v_pk_add_f32 v[106:107], v[106:107], v[36:37] op_sel_hi:[1,0] neg_lo:[0,1] neg_hi:[0,1]
  v_pk_add_f32 v[108:109], v[108:109], v[36:37] op_sel_hi:[1,0] neg_lo:[0,1] neg_hi:[0,1]
  v_pk_add_f32 v[110:111], v[110:111], v[36:37] op_sel_hi:[1,0] neg_lo:[0,1] neg_hi:[0,1]
  v_cvt_pk_bf16_f32 v64, v80, v81
  v_cvt_pk_bf16_f32 v65, v82, v83
  v_cvt_pk_bf16_f32 v66, v84, v85
  v_cvt_pk_bf16_f32 v67, v86, v87
  v_cvt_pk_bf16_f32 v68, v88, v89
  v_cvt_pk_bf16_f32 v69, v90, v91
  v_cvt_pk_bf16_f32 v70, v92, v93
  v_cvt_pk_bf16_f32 v71, v94, v95
  v_cvt_pk_bf16_f32 v72, v96, v97
  v_cvt_pk_bf16_f32 v73, v98, v99
  v_cvt_pk_bf16_f32 v74, v100, v101
  v_cvt_pk_bf16_f32 v75, v102, v103
  v_cvt_pk_bf16_f32 v76, v104, v105
  v_cvt_pk_bf16_f32 v77, v106, v107
  v_cvt_pk_bf16_f32 v78, v108, v109
  v_cvt_pk_bf16_f32 v79, v110, v111
  v_lshlrev_b32 v80, 16, v64
  v_and_b32 v81, s62, v64
  v_lshlrev_b32 v82, 16, v65
  v_and_b32 v83, s62, v65
  v_lshlrev_b32 v84, 16, v66
  v_and_b32 v85, s62, v66
  v_lshlrev_b32 v86, 16, v67
  v_and_b32 v87, s62, v67
  v_lshlrev_b32 v88, 16, v68
  v_and_b32 v89, s62, v68
  v_lshlrev_b32 v90, 16, v69
  v_and_b32 v91, s62, v69
  v_lshlrev_b32 v92, 16, v70
  v_and_b32 v93, s62, v70
  v_lshlrev_b32 v94, 16, v71
  v_and_b32 v95, s62, v71
  v_lshlrev_b32 v96, 16, v72
  v_and_b32 v97, s62, v72
  v_lshlrev_b32 v98, 16, v73
  v_and_b32 v99, s62, v73
  v_lshlrev_b32 v100, 16, v74
  v_and_b32 v101, s62, v74
  v_lshlrev_b32 v102, 16, v75
  v_and_b32 v103, s62, v75
  v_lshlrev_b32 v104, 16, v76
  v_and_b32 v105, s62, v76
  v_lshlrev_b32 v106, 16, v77
  v_and_b32 v107, s62, v77
  v_lshlrev_b32 v108, 16, v78
  v_and_b32 v109, s62, v78
  v_lshlrev_b32 v110, 16, v79
  v_and_b32 v111, s62, v79
  v_pk_mul_f32 v[80:81], v[80:81], v[36:37] op_sel:[0,1]
  v_pk_mul_f32 v[82:83], v[82:83], v[36:37] op_sel:[0,1]
  v_pk_mul_f32 v[84:85], v[84:85], v[36:37] op_sel:[0,1]
  v_pk_mul_f32 v[86:87], v[86:87], v[36:37] op_sel:[0,1]
  v_pk_mul_f32 v[88:89], v[88:89], v[36:37] op_sel:[0,1]
  v_pk_mul_f32 v[90:91], v[90:91], v[36:37] op_sel:[0,1]
  v_pk_mul_f32 v[92:93], v[92:93], v[36:37] op_sel:[0,1]
  v_pk_mul_f32 v[94:95], v[94:95], v[36:37] op_sel:[0,1]
  v_pk_mul_f32 v[96:97], v[96:97], v[36:37] op_sel:[0,1]
  v_pk_mul_f32 v[98:99], v[98:99], v[36:37] op_sel:[0,1]
  v_pk_mul_f32 v[100:101], v[100:101], v[36:37] op_sel:[0,1]
  v_pk_mul_f32 v[102:103], v[102:103], v[36:37] op_sel:[0,1]
  v_pk_mul_f32 v[104:105], v[104:105], v[36:37] op_sel:[0,1]
  v_pk_mul_f32 v[106:107], v[106:107], v[36:37] op_sel:[0,1]
  v_pk_mul_f32 v[108:109], v[108:109], v[36:37] op_sel:[0,1]
  v_pk_mul_f32 v[110:111], v[110:111], v[36:37] op_sel:[0,1]
  v_cvt_pk_bf16_f32 v64, v80, v81
  v_cvt_pk_bf16_f32 v65, v82, v83
  v_cvt_pk_bf16_f32 v66, v96, v97
  v_cvt_pk_bf16_f32 v67, v98, v99
  buffer_store_dwordx4 v[64:67], v42, s[24:27], 0 offen offset:0 sc1
  v_cvt_pk_bf16_f32 v68, v84, v85
  v_cvt_pk_bf16_f32 v69, v86, v87
  v_cvt_pk_bf16_f32 v70, v100, v101
  v_cvt_pk_bf16_f32 v71, v102, v103
  buffer_store_dwordx4 v[68:71], v42, s[24:27], 0 offen offset:256 sc1
  v_cvt_pk_bf16_f32 v72, v88, v89
  v_cvt_pk_bf16_f32 v73, v90, v91
  v_cvt_pk_bf16_f32 v74, v104, v105
  v_cvt_pk_bf16_f32 v75, v106, v107
  buffer_store_dwordx4 v[72:75], v42, s[24:27], 0 offen offset:512 sc1
  v_cvt_pk_bf16_f32 v76, v92, v93
  v_cvt_pk_bf16_f32 v77, v94, v95
  v_cvt_pk_bf16_f32 v78, v108, v109
  v_cvt_pk_bf16_f32 v79, v110, v111
  buffer_store_dwordx4 v[76:79], v42, s[24:27], 0 offen offset:768 sc1
  buffer_store_byte v126, v28, s[64:67], s70 offen sc1
  s_nop 0
  v_mov_b32 v126, 1
  v_lshrrev_b32 v36, 5, v1
  v_lshlrev_b32 v96, 10, v36
  v_bfe_u32 v36, v1, 2, 3
  v_lshl_add_u32 v96, v36, 6, v96
  v_bfe_u32 v36, v1, 4, 1
  v_and_b32 v37, 3, v1
  v_lshlrev_b32 v36, 1, v36
  v_xor_b32 v36, v36, v37
  v_lshl_add_u32 v96, v36, 4, v96
  v_lshrrev_b32 v37, 1, v37
  v_xor_b32 v37, 0, v37
  v_lshl_add_u32 v96, v37, 3, v96
  v_lshrrev_b32 v36, 5, v1
  v_lshlrev_b32 v97, 10, v36
  v_bfe_u32 v36, v1, 2, 3
  v_lshl_add_u32 v97, v36, 6, v97
  v_bfe_u32 v36, v1, 4, 1
  v_and_b32 v37, 3, v1
  v_lshlrev_b32 v36, 1, v36
  v_xor_b32 v36, v36, v37
  v_lshl_add_u32 v97, v36, 4, v97
  v_lshrrev_b32 v37, 1, v37
  v_xor_b32 v37, 1, v37
  v_lshl_add_u32 v97, v37, 3, v97
  v_lshrrev_b32 v36, 5, v1
  v_lshlrev_b32 v98, 9, v36
  v_bfe_u32 v36, v1, 2, 3
  v_lshl_add_u32 v98, v36, 6, v98
  v_bfe_u32 v36, v1, 4, 1
  v_and_b32 v37, 3, v1
  v_xor_b32 v36, 0, v36
  v_lshl_add_u32 v98, v36, 5, v98
  v_lshl_add_u32 v98, v37, 3, v98
  v_lshrrev_b32 v36, 5, v1
  v_lshlrev_b32 v99, 9, v36
  v_bfe_u32 v36, v1, 2, 3
  v_lshl_add_u32 v99, v36, 6, v99
  v_bfe_u32 v36, v1, 4, 1
  v_and_b32 v37, 3, v1
  v_xor_b32 v36, 1, v36
  v_lshl_add_u32 v99, v36, 5, v99
  v_lshl_add_u32 v99, v37, 3, v99
  v_lshlrev_b32 v100, 3, v1
  v_mov_b32 v2, v96
  v_mov_b32 v3, v97
  v_mov_b32 v4, v98
  v_mov_b32 v5, v99
  v_mov_b32 v6, v100
  v_and_b32 v27, 0xffffffe0, v27
  v_mov_b32 v125, 1
  s_waitcnt vmcnt(0)
  s_barrier
  buffer_atomic_add v125, v27, s[44:47], 0 offen sc0 sc1
  s_waitcnt vmcnt(0)
  v_readfirstlane_b32 s70, v125
  s_sub_u32 s63, 48, s34
  s_and_b32 s70, s70, 31
  s_cmp_eq_u32 s70, 31
  s_cselect_b32 s62, s63, 0x40000000
  buffer_store_byte v126, v29, s[64:67], s62 offen sc1
  s_add_u32 m0, s5, s90
  s_nop 0
  buffer_load_dwordx4 v7, s[8:11], s52 offen offset:0 lds
  buffer_load_dwordx4 v8, s[8:11], s52 offen offset:1024 lds
  buffer_load_dwordx4 v9, s[8:11], s52 offen offset:2048 lds
  buffer_load_dwordx4 v10, s[8:11], s52 offen offset:3072 lds
  s_add_u32 s100, s6, s90
  s_add_u32 m0, s100, 16384
  s_nop 0
  buffer_load_dwordx4 v11, s[12:15], s53 offen offset:0 lds
  buffer_load_dwordx4 v12, s[12:15], s53 offen offset:1024 lds
  buffer_load_dwordx4 v13, s[12:15], s53 offen offset:2048 lds
  s_add_u32 m0, s100, 28672
  s_nop 0
  buffer_load_dwordx4 v11, s[16:19], s53 offen offset:0 lds
  buffer_load_dwordx4 v12, s[16:19], s53 offen offset:1024 lds
  buffer_load_dwordx4 v13, s[16:19], s53 offen offset:2048 lds
  s_add_u32 s100, s7, s90
  s_add_u32 m0, s100, 40960
  s_nop 0
  buffer_load_dwordx4 v14, s[20:23], s53 offen lds
  s_add_u32 s52, s52, 0x80000
  s_add_u32 s53, s53, 0x70000
  s_mov_b32 s100, s90
  s_mov_b32 s90, s88
  s_mov_b32 s88, s89
  s_mov_b32 s89, s100
  s_getpc_b64 s[84:85]
L_pc:
  s_sub_u32 s84, s84, L_pc-recurrent_scan__sliding_block_cached__glu_gated_bilinear__prompt_kernel
  s_subb_u32 s85, s85, 0
  s_lshr_b32 s86, s2, 3
  s_lshl_b32 s86, s86, 2
  s_add_u32 s86, s86, s33
  s_and_b32 s86, s86, 31
  s_lshl_b32 s86, s86, 12
  v_lshl_add_u32 v124, v1, 6, s86
  s_mov_b32 s87, L_code_end-recurrent_scan__sliding_block_cached__glu_gated_bilinear__prompt_kernel-4
  v_min_u32 v124, s87, v124
  global_load_dword v124, v124, s[84:85]
  s_lshl_b32 s62, s32, 2
  s_add_u32 s62, s62, s33
  s_lshl_b32 s63, s62, 17
  v_lshlrev_b32 v25, 4, v1
  v_add_u32 v15, s63, v25
  v_add_u32 v16, 0x1000, v15
  s_lshl_b32 s62, s35, 19
  s_add_u32 s62, s62, 0x60000
  s_add_u32 s28, s48, s62
  s_addc_u32 s29, s49, 0
  s_mov_b32 s30, 0x20000
  s_mov_b32 s31, 0x20000
  s_add_u32 s36, s50, s62
  s_addc_u32 s37, s51, 0
  s_mov_b32 s38, 0x20000
  s_mov_b32 s39, 0x20000
  v_lshrrev_b32 v36, 4, v1
  v_and_b32 v37, 15, v1
  v_lshl_add_u32 v38, v36, 8, s5
  s_add_u32 s40, s60, 0x400000
  s_addc_u32 s41, s61, 0
  s_mov_b32 s42, 0x1000000
  s_mov_b32 s43, 0x20000
  v_add_u32 v39, 0, v36
  v_xor_b32 v39, v39, v37
  v_lshl_add_u32 v17, v39, 4, v38
  v_add_u32 v39, 4, v36
  v_xor_b32 v39, v39, v37
  v_lshl_add_u32 v18, v39, 4, v38
  v_add_u32 v39, 8, v36
  v_xor_b32 v39, v39, v37
  v_lshl_add_u32 v19, v39, 4, v38
  v_add_u32 v39, 12, v36
  v_xor_b32 v39, v39, v37
  v_lshl_add_u32 v20, v39, 4, v38
  v_bfe_u32 v40, v1, 2, 3
  s_and_b32 s63, s33, 1
  s_lshl_b32 s63, s63, 5
  v_add_u32 v40, s63, v40
  s_mov_b32 s63, 256
  v_mul_lo_u32 v21, v40, s63
  v_lshrrev_b32 v40, 5, v1
  v_lshl_add_u32 v21, v40, 6, v21
  v_bfe_u32 v40, v1, 4, 1
  v_lshlrev_b32 v40, 1, v40
  v_and_b32 v41, 3, v1
  v_xor_b32 v40, v40, v41
  v_lshl_add_u32 v21, v40, 4, v21
  s_lshr_b32 s63, s33, 1
  s_lshl_b32 s63, s63, 7
  s_add_u32 s63, s63, 0
  v_add_u32 v21, s63, v21
  v_add_u32 v22, 0x400, v21
  v_add_u32 v23, 0x800, v21
  v_add_u32 v24, 0xc00, v21
  s_mov_b32 s55, 0
  s_mov_b32 s56, 0
  s_mov_b32 s57, -1
  s_mov_b32 s91, 6
  s_mov_b32 s58, 0
  v_accvgpr_write_b32 a0, 0
  v_accvgpr_write_b32 a1, 0
  v_accvgpr_write_b32 a2, 0
  v_accvgpr_write_b32 a3, 0
  v_accvgpr_write_b32 a4, 0
  v_accvgpr_write_b32 a5, 0
  v_accvgpr_write_b32 a6, 0
  v_accvgpr_write_b32 a7, 0
  v_accvgpr_write_b32 a8, 0
  v_accvgpr_write_b32 a9, 0
  v_accvgpr_write_b32 a10, 0
  v_accvgpr_write_b32 a11, 0
  v_accvgpr_write_b32 a12, 0
  v_accvgpr_write_b32 a13, 0
  v_accvgpr_write_b32 a14, 0
  v_accvgpr_write_b32 a15, 0
  v_accvgpr_write_b32 a16, 0
  v_accvgpr_write_b32 a17, 0
  v_accvgpr_write_b32 a18, 0
  v_accvgpr_write_b32 a19, 0
  v_accvgpr_write_b32 a20, 0
  v_accvgpr_write_b32 a21, 0
  v_accvgpr_write_b32 a22, 0
  v_accvgpr_write_b32 a23, 0
  v_accvgpr_write_b32 a24, 0
  v_accvgpr_write_b32 a25, 0
  v_accvgpr_write_b32 a26, 0
  v_accvgpr_write_b32 a27, 0
  v_accvgpr_write_b32 a28, 0
  v_accvgpr_write_b32 a29, 0
  v_accvgpr_write_b32 a30, 0
  v_accvgpr_write_b32 a31, 0
  v_accvgpr_write_b32 a32, 0
  v_accvgpr_write_b32 a33, 0
  v_accvgpr_write_b32 a34, 0
  v_accvgpr_write_b32 a35, 0
  v_accvgpr_write_b32 a36, 0
  v_accvgpr_write_b32 a37, 0
  v_accvgpr_write_b32 a38, 0
  v_accvgpr_write_b32 a39, 0
  v_accvgpr_write_b32 a40, 0
  v_accvgpr_write_b32 a41, 0
  v_accvgpr_write_b32 a42, 0
  v_accvgpr_write_b32 a43, 0
  v_accvgpr_write_b32 a44, 0
  v_accvgpr_write_b32 a45, 0
  v_accvgpr_write_b32 a46, 0
  v_accvgpr_write_b32 a47, 0
  v_accvgpr_write_b32 a48, 0
  v_accvgpr_write_b32 a49, 0
  v_accvgpr_write_b32 a50, 0
  v_accvgpr_write_b32 a51, 0
  v_accvgpr_write_b32 a52, 0
  v_accvgpr_write_b32 a53, 0
  v_accvgpr_write_b32 a54, 0
  v_accvgpr_write_b32 a55, 0
  v_accvgpr_write_b32 a56, 0
  v_accvgpr_write_b32 a57, 0
  v_accvgpr_write_b32 a58, 0
  v_accvgpr_write_b32 a59, 0
  v_accvgpr_write_b32 a60, 0
  v_accvgpr_write_b32 a61, 0
  v_accvgpr_write_b32 a62, 0
  v_accvgpr_write_b32 a63, 0
  v_accvgpr_write_b32 a64, 0
  v_accvgpr_write_b32 a65, 0
  v_accvgpr_write_b32 a66, 0
  v_accvgpr_write_b32 a67, 0
  v_accvgpr_write_b32 a68, 0
  v_accvgpr_write_b32 a69, 0
  v_accvgpr_write_b32 a70, 0
  v_accvgpr_write_b32 a71, 0
  v_accvgpr_write_b32 a72, 0
  v_accvgpr_write_b32 a73, 0
  v_accvgpr_write_b32 a74, 0
  v_accvgpr_write_b32 a75, 0
  v_accvgpr_write_b32 a76, 0
  v_accvgpr_write_b32 a77, 0
  v_accvgpr_write_b32 a78, 0
  v_accvgpr_write_b32 a79, 0
  v_accvgpr_write_b32 a80, 0
  v_accvgpr_write_b32 a81, 0
  v_accvgpr_write_b32 a82, 0
  v_accvgpr_write_b32 a83, 0
  v_accvgpr_write_b32 a84, 0
  v_accvgpr_write_b32 a85, 0
  v_accvgpr_write_b32 a86, 0
  v_accvgpr_write_b32 a87, 0
  v_accvgpr_write_b32 a88, 0
  v_accvgpr_write_b32 a89, 0
  v_accvgpr_write_b32 a90, 0
  v_accvgpr_write_b32 a91, 0
  v_accvgpr_write_b32 a92, 0
  v_accvgpr_write_b32 a93, 0
  v_accvgpr_write_b32 a94, 0
  v_accvgpr_write_b32 a95, 0
  v_accvgpr_write_b32 a96, 0
  v_accvgpr_write_b32 a97, 0
  v_accvgpr_write_b32 a98, 0
  v_accvgpr_write_b32 a99, 0
  v_accvgpr_write_b32 a100, 0
  v_accvgpr_write_b32 a101, 0
  v_accvgpr_write_b32 a102, 0
  v_accvgpr_write_b32 a103, 0
  v_accvgpr_write_b32 a104, 0
  v_accvgpr_write_b32 a105, 0
  v_accvgpr_write_b32 a106, 0
  v_accvgpr_write_b32 a107, 0
  v_accvgpr_write_b32 a108, 0
  v_accvgpr_write_b32 a109, 0
  v_accvgpr_write_b32 a110, 0
  v_accvgpr_write_b32 a111, 0
  v_accvgpr_write_b32 a112, 0
  v_accvgpr_write_b32 a113, 0
  v_accvgpr_write_b32 a114, 0
  v_accvgpr_write_b32 a115, 0
  v_accvgpr_write_b32 a116, 0
  v_accvgpr_write_b32 a117, 0
  v_accvgpr_write_b32 a118, 0
  v_accvgpr_write_b32 a119, 0
  v_accvgpr_write_b32 a120, 0
  v_accvgpr_write_b32 a121, 0
  v_accvgpr_write_b32 a122, 0
  v_accvgpr_write_b32 a123, 0
  v_accvgpr_write_b32 a124, 0
  v_accvgpr_write_b32 a125, 0
  v_accvgpr_write_b32 a126, 0
  v_accvgpr_write_b32 a127, 0
  v_accvgpr_write_b32 a128, 0
  v_accvgpr_write_b32 a129, 0
  v_accvgpr_write_b32 a130, 0
  v_accvgpr_write_b32 a131, 0
  v_accvgpr_write_b32 a132, 0
  v_accvgpr_write_b32 a133, 0
  v_accvgpr_write_b32 a134, 0
  v_accvgpr_write_b32 a135, 0
  v_accvgpr_write_b32 a136, 0
  v_accvgpr_write_b32 a137, 0
  v_accvgpr_write_b32 a138, 0
  v_accvgpr_write_b32 a139, 0
  v_accvgpr_write_b32 a140, 0
  v_accvgpr_write_b32 a141, 0
  v_accvgpr_write_b32 a142, 0
  v_accvgpr_write_b32 a143, 0
  v_accvgpr_write_b32 a144, 0
  v_accvgpr_write_b32 a145, 0
  v_accvgpr_write_b32 a146, 0
  v_accvgpr_write_b32 a147, 0
  v_accvgpr_write_b32 a148, 0
  v_accvgpr_write_b32 a149, 0
  v_accvgpr_write_b32 a150, 0
  v_accvgpr_write_b32 a151, 0
  v_accvgpr_write_b32 a152, 0
  v_accvgpr_write_b32 a153, 0
  v_accvgpr_write_b32 a154, 0
  v_accvgpr_write_b32 a155, 0
  v_accvgpr_write_b32 a156, 0
  v_accvgpr_write_b32 a157, 0
  v_accvgpr_write_b32 a158, 0
  v_accvgpr_write_b32 a159, 0
  v_accvgpr_write_b32 a160, 0
  v_accvgpr_write_b32 a161, 0
  v_accvgpr_write_b32 a162, 0
  v_accvgpr_write_b32 a163, 0
  v_accvgpr_write_b32 a164, 0
  v_accvgpr_write_b32 a165, 0
  v_accvgpr_write_b32 a166, 0
  v_accvgpr_write_b32 a167, 0
  v_accvgpr_write_b32 a168, 0
  v_accvgpr_write_b32 a169, 0
  v_accvgpr_write_b32 a170, 0
  v_accvgpr_write_b32 a171, 0
  v_accvgpr_write_b32 a172, 0
  v_accvgpr_write_b32 a173, 0
  v_accvgpr_write_b32 a174, 0
  v_accvgpr_write_b32 a175, 0
  v_accvgpr_write_b32 a176, 0
  v_accvgpr_write_b32 a177, 0
  v_accvgpr_write_b32 a178, 0
  v_accvgpr_write_b32 a179, 0
  v_accvgpr_write_b32 a180, 0
  v_accvgpr_write_b32 a181, 0
  v_accvgpr_write_b32 a182, 0
  v_accvgpr_write_b32 a183, 0
  v_accvgpr_write_b32 a184, 0
  v_accvgpr_write_b32 a185, 0
  v_accvgpr_write_b32 a186, 0
  v_accvgpr_write_b32 a187, 0
  v_accvgpr_write_b32 a188, 0
  v_accvgpr_write_b32 a189, 0
  v_accvgpr_write_b32 a190, 0
  v_accvgpr_write_b32 a191, 0
  v_accvgpr_write_b32 a192, 0
  v_accvgpr_write_b32 a193, 0
  v_accvgpr_write_b32 a194, 0
  v_accvgpr_write_b32 a195, 0
  v_accvgpr_write_b32 a196, 0
  v_accvgpr_write_b32 a197, 0
  v_accvgpr_write_b32 a198, 0
  v_accvgpr_write_b32 a199, 0
  v_accvgpr_write_b32 a200, 0
  v_accvgpr_write_b32 a201, 0
  v_accvgpr_write_b32 a202, 0
  v_accvgpr_write_b32 a203, 0
  v_accvgpr_write_b32 a204, 0
  v_accvgpr_write_b32 a205, 0
  v_accvgpr_write_b32 a206, 0
  v_accvgpr_write_b32 a207, 0
  v_accvgpr_write_b32 a208, 0
  v_accvgpr_write_b32 a209, 0
  v_accvgpr_write_b32 a210, 0
  v_accvgpr_write_b32 a211, 0
  v_accvgpr_write_b32 a212, 0
  v_accvgpr_write_b32 a213, 0
  v_accvgpr_write_b32 a214, 0
  v_accvgpr_write_b32 a215, 0
  v_accvgpr_write_b32 a216, 0
  v_accvgpr_write_b32 a217, 0
  v_accvgpr_write_b32 a218, 0
  v_accvgpr_write_b32 a219, 0
  v_accvgpr_write_b32 a220, 0
  v_accvgpr_write_b32 a221, 0
  v_accvgpr_write_b32 a222, 0
  v_accvgpr_write_b32 a223, 0
  v_mov_b64 v[128:129], 0
  v_mov_b64 v[130:131], 0
  v_mov_b64 v[132:133], 0
  v_mov_b64 v[134:135], 0
  v_mov_b64 v[136:137], 0
  v_mov_b64 v[138:139], 0
  v_mov_b64 v[140:141], 0
  v_mov_b64 v[142:143], 0
  v_mov_b64 v[144:145], 0
  v_mov_b64 v[146:147], 0
  v_mov_b64 v[148:149], 0
  v_mov_b64 v[150:151], 0
  v_mov_b64 v[152:153], 0
  v_mov_b64 v[154:155], 0
  v_mov_b64 v[156:157], 0
  v_mov_b64 v[158:159], 0
  v_mov_b64 v[160:161], 0
  v_mov_b64 v[162:163], 0
  v_mov_b64 v[164:165], 0
  v_mov_b64 v[166:167], 0
  v_mov_b64 v[168:169], 0
  v_mov_b64 v[170:171], 0
  v_mov_b64 v[172:173], 0
  v_mov_b64 v[174:175], 0
  v_mov_b64 v[176:177], 0
  v_mov_b64 v[178:179], 0
  v_mov_b64 v[180:181], 0
  v_mov_b64 v[182:183], 0
  v_mov_b64 v[184:185], 0
  v_mov_b64 v[186:187], 0
  v_mov_b64 v[188:189], 0
  v_mov_b64 v[190:191], 0
  v_mov_b64 v[192:193], 0
  v_mov_b64 v[194:195], 0
  v_mov_b64 v[196:197], 0
  v_mov_b64 v[198:199], 0
  v_mov_b64 v[200:201], 0
  v_mov_b64 v[202:203], 0
  v_mov_b64 v[204:205], 0
  v_mov_b64 v[206:207], 0
  v_mov_b64 v[208:209], 0
  v_mov_b64 v[210:211], 0
  v_mov_b64 v[212:213], 0
  v_mov_b64 v[214:215], 0
  v_mov_b64 v[216:217], 0
  v_mov_b64 v[218:219], 0
  v_mov_b64 v[220:221], 0
  v_mov_b64 v[222:223], 0
  v_mov_b64 v[224:225], 0
  v_mov_b64 v[226:227], 0
  v_mov_b64 v[228:229], 0
  v_mov_b64 v[230:231], 0
  v_mov_b64 v[232:233], 0
  v_mov_b64 v[234:235], 0
  v_mov_b64 v[236:237], 0
  v_mov_b64 v[238:239], 0
  v_mov_b64 v[240:241], 0
  v_mov_b64 v[242:243], 0
  v_mov_b64 v[244:245], 0
  v_mov_b64 v[246:247], 0
  v_mov_b64 v[248:249], 0
  v_mov_b64 v[250:251], 0
  v_mov_b64 v[252:253], 0
  v_mov_b64 v[254:255], 0
  s_cmp_lg_u32 s33, 0
  s_cbranch_scc1 L_x_go
  s_mov_b32 s70, 0x40000
L_x_poll:
  buffer_load_ubyte v125, v28, s[64:67], 0 offen sc1
  s_waitcnt vmcnt(0)
  v_readlane_b32 s62, v125, 48
  s_sub_u32 s70, s70, 1
  s_cbranch_scc1 L_x_go
  s_cmp_eq_u32 s62, 0
  s_cbranch_scc1 L_x_poll
L_x_go:
  s_barrier
  buffer_load_dwordx4 v[64:67], v15, s[24:27], s54 offen offset:0 sc1
  buffer_load_dwordx4 v[80:83], v16, s[24:27], s54 offen offset:0 sc1
  buffer_load_dwordx4 v[68:71], v15, s[24:27], s54 offen offset:1024 sc1
  buffer_load_dwordx4 v[84:87], v16, s[24:27], s54 offen offset:1024 sc1
  buffer_load_dwordx4 v[72:75], v15, s[24:27], s54 offen offset:2048 sc1
  buffer_load_dwordx4 v[88:91], v16, s[24:27], s54 offen offset:2048 sc1
  buffer_load_dwordx4 v[76:79], v15, s[24:27], s54 offen offset:3072 sc1
  buffer_load_dwordx4 v[92:95], v16, s[24:27], s54 offen offset:3072 sc1
  s_add_u32 s54, s54, 0x2000
  buffer_load_dwordx4 a[224:227], v15, s[24:27], s54 offen offset:0 sc1
  buffer_load_dwordx4 a[240:243], v16, s[24:27], s54 offen offset:0 sc1
  buffer_load_dwordx4 a[228:231], v15, s[24:27], s54 offen offset:1024 sc1
  buffer_load_dwordx4 a[244:247], v16, s[24:27], s54 offen offset:1024 sc1
  buffer_load_dwordx4 a[232:235], v15, s[24:27], s54 offen offset:2048 sc1
  buffer_load_dwordx4 a[248:251], v16, s[24:27], s54 offen offset:2048 sc1
  buffer_load_dwordx4 a[236:239], v15, s[24:27], s54 offen offset:3072 sc1
  buffer_load_dwordx4 a[252:255], v16, s[24:27], s54 offen offset:3072 sc1
  s_add_u32 s54, s54, 0x2000
  s_add_u32 s44, s60, 0x1400000
  s_addc_u32 s45, s61, 0
  s_mov_b32 s46, 0xe00000
  s_mov_b32 s47, 0x20000
  ds_read_b64_tr_b16 v[32:33], v4 offset:16384
  ds_read_b64_tr_b16 v[34:35], v4 offset:19456
  ds_read_b64_tr_b16 v[36:37], v4 offset:22528
  ds_read_b64_tr_b16 v[38:39], v4 offset:25600
  ds_read_b64_tr_b16 v[40:41], v4 offset:28672
  ds_read_b64_tr_b16 v[42:43], v4 offset:31744
  ds_read_b64_tr_b16 v[44:45], v4 offset:34816
  ds_read_b64_tr_b16 v[46:47], v4 offset:37888
  s_waitcnt vmcnt(14)
  s_waitcnt lgkmcnt(4)
  v_mfma_f32_16x16x32_bf16 a[0:3], v[32:35], v[64:67], a[0:3]
  ds_read_b64_tr_b16 v[48:49], v5 offset:16384
  v_mfma_f32_16x16x32_bf16 a[0:3], v[36:39], v[80:83], a[0:3]
  ds_read_b64_tr_b16 v[50:51], v5 offset:19456
  s_waitcnt vmcnt(12)
  v_mfma_f32_16x16x32_bf16 a[4:7], v[32:35], v[68:71], a[4:7]
  ds_read_b64_tr_b16 v[52:53], v5 offset:22528
  v_mfma_f32_16x16x32_bf16 a[4:7], v[36:39], v[84:87], a[4:7]
  ds_read_b64_tr_b16 v[54:55], v5 offset:25600
  s_waitcnt vmcnt(10)
  v_mfma_f32_16x16x32_bf16 a[8:11], v[32:35], v[72:75], a[8:11]
  s_lshl_b32 s62, s32, 2
  v_mfma_f32_16x16x32_bf16 a[8:11], v[36:39], v[88:91], a[8:11]
  s_add_u32 s62, s62, s33
  s_waitcnt vmcnt(8)
  v_mfma_f32_16x16x32_bf16 a[12:15], v[32:35], v[76:79], a[12:15]
  s_mul_i32 s63, s62, 458752
  v_mfma_f32_16x16x32_bf16 a[12:15], v[36:39], v[92:95], a[12:15]
  ds_read_b64_tr_b16 v[56:57], v5 offset:28672
  s_waitcnt lgkmcnt(5)
  v_mfma_f32_16x16x32_bf16 a[16:19], v[40:43], v[64:67], a[16:19]
  ds_read_b64_tr_b16 v[58:59], v5 offset:31744
  s_lshr_b32 s59, s34, 1
  v_mfma_f32_16x16x32_bf16 a[16:19], v[44:47], v[80:83], a[16:19]
  ds_read_b64_tr_b16 v[60:61], v5 offset:34816
  s_mul_i32 s59, s59, 7
  v_mfma_f32_16x16x32_bf16 a[20:23], v[40:43], v[68:71], a[20:23]
  ds_read_b64_tr_b16 v[62:63], v5 offset:37888
  s_and_b32 s4, s34, 1
  v_mfma_f32_16x16x32_bf16 a[20:23], v[44:47], v[84:87], a[20:23]
  s_lshl_b32 s73, s4, 2
  s_add_u32 s73, s73, s59
  v_mfma_f32_16x16x32_bf16 a[24:27], v[40:43], v[72:75], a[24:27]
  s_lshl_b32 s73, s73, 12
  s_add_u32 s73, s73, s63
  v_mfma_f32_16x16x32_bf16 a[24:27], v[44:47], v[88:91], a[24:27]
  s_add_u32 s59, s59, 3
  s_lshl_b32 s59, s59, 12
  v_mfma_f32_16x16x32_bf16 a[28:31], v[40:43], v[76:79], a[28:31]
  s_add_u32 s59, s59, s63
  s_lshl_b32 s4, s4, 3
  v_mfma_f32_16x16x32_bf16 a[28:31], v[44:47], v[92:95], a[28:31]
  ds_read_b64_tr_b16 v[32:33], v4 offset:17408
  s_waitcnt lgkmcnt(5)
  v_mfma_f32_16x16x32_bf16 a[32:35], v[48:51], v[64:67], a[32:35]
  ds_read_b64_tr_b16 v[34:35], v4 offset:20480
  s_add_u32 s59, s59, s4
  v_mfma_f32_16x16x32_bf16 a[32:35], v[52:55], v[80:83], a[32:35]
  ds_read_b64_tr_b16 v[36:37], v4 offset:23552
  s_lshr_b32 s48, s34, 3
  v_mfma_f32_16x16x32_bf16 a[36:39], v[48:51], v[68:71], a[36:39]
  ds_read_b64_tr_b16 v[38:39], v4 offset:26624
  s_and_b32 s49, s34, 7
  v_mfma_f32_16x16x32_bf16 a[36:39], v[52:55], v[84:87], a[36:39]
  s_lshl_b32 s49, s49, 8
  s_mul_i32 s50, s48, 1835008
  v_mfma_f32_16x16x32_bf16 a[40:43], v[48:51], v[72:75], a[40:43]
  s_mul_i32 s72, s48, 114688
  s_add_u32 s72, s72, s63
  v_mfma_f32_16x16x32_bf16 a[40:43], v[52:55], v[88:91], a[40:43]
  s_lshl_b32 s74, s48, 21
  s_lshl_b32 s75, s62, 19
  v_mfma_f32_16x16x32_bf16 a[44:47], v[48:51], v[76:79], a[44:47]
  s_lshl_b32 s51, s34, 14
  s_add_u32 s51, s51, s75
  v_mfma_f32_16x16x32_bf16 a[44:47], v[52:55], v[92:95], a[44:47]
  ds_read_b64_tr_b16 v[40:41], v4 offset:29696
  s_waitcnt lgkmcnt(5)
  v_mfma_f32_16x16x32_bf16 a[48:51], v[56:59], v[64:67], a[48:51]
  ds_read_b64_tr_b16 v[42:43], v4 offset:32768
  s_lshl_b32 s4, s48, 17
  v_mfma_f32_16x16x32_bf16 a[48:51], v[60:63], v[80:83], a[48:51]
  ds_read_b64_tr_b16 v[44:45], v4 offset:35840
  s_add_u32 s75, s75, s4
  v_mfma_f32_16x16x32_bf16 a[52:55], v[56:59], v[68:71], a[52:55]
  ds_read_b64_tr_b16 v[46:47], v4 offset:38912
  v_bfe_u32 v109, v1, 2, 3
  v_mfma_f32_16x16x32_bf16 a[52:55], v[60:63], v[84:87], a[52:55]
  s_and_b32 s63, s33, 1
  s_lshl_b32 s63, s63, 5
  v_mfma_f32_16x16x32_bf16 a[56:59], v[56:59], v[72:75], a[56:59]
  v_add_u32 v109, s63, v109
  s_mov_b32 s63, 2048
  v_mfma_f32_16x16x32_bf16 a[56:59], v[60:63], v[88:91], a[56:59]
  v_mul_lo_u32 v101, v109, s63
  v_lshrrev_b32 v109, 5, v1
  v_mfma_f32_16x16x32_bf16 a[60:63], v[56:59], v[76:79], a[60:63]
  v_lshl_add_u32 v101, v109, 6, v101
  v_bfe_u32 v109, v1, 4, 1
  v_mfma_f32_16x16x32_bf16 a[60:63], v[60:63], v[92:95], a[60:63]
  ds_read_b64_tr_b16 v[48:49], v5 offset:17408
  s_waitcnt lgkmcnt(5)
  v_mfma_f32_16x16x32_bf16 a[64:67], v[32:35], v[64:67], a[64:67]
  ds_read_b64_tr_b16 v[50:51], v5 offset:20480
  v_lshlrev_b32 v109, 1, v109
  v_mfma_f32_16x16x32_bf16 a[64:67], v[36:39], v[80:83], a[64:67]
  ds_read_b64_tr_b16 v[52:53], v5 offset:23552
  v_and_b32 v110, 3, v1
  v_mfma_f32_16x16x32_bf16 a[68:71], v[32:35], v[68:71], a[68:71]
  ds_read_b64_tr_b16 v[54:55], v5 offset:26624
  v_xor_b32 v109, v109, v110
  v_mfma_f32_16x16x32_bf16 a[68:71], v[36:39], v[84:87], a[68:71]
  v_lshl_add_u32 v101, v109, 4, v101
  s_lshr_b32 s63, s33, 1
  v_mfma_f32_16x16x32_bf16 a[72:75], v[32:35], v[72:75], a[72:75]
  s_lshl_b32 s63, s63, 7
  s_add_u32 s63, s63, 0
  v_mfma_f32_16x16x32_bf16 a[72:75], v[36:39], v[88:91], a[72:75]
  v_add_u32 v101, s63, v101
  v_add_u32 v102, 0x3c00, v101
  v_mfma_f32_16x16x32_bf16 a[76:79], v[32:35], v[76:79], a[76:79]
  v_add_u32 v103, 0x7800, v101
  v_add_u32 v104, 0xb400, v101
  v_mfma_f32_16x16x32_bf16 a[76:79], v[36:39], v[92:95], a[76:79]
  ds_read_b64_tr_b16 v[56:57], v5 offset:29696
  s_waitcnt lgkmcnt(5)
  v_mfma_f32_16x16x32_bf16 a[80:83], v[40:43], v[64:67], a[80:83]
  ds_read_b64_tr_b16 v[58:59], v5 offset:32768
  s_lshl_b32 s63, s48, 6
  v_mfma_f32_16x16x32_bf16 a[80:83], v[44:47], v[80:83], a[80:83]
  ds_read_b64_tr_b16 v[60:61], v5 offset:35840
  v_xor_b32 v101, s63, v101
  v_mfma_f32_16x16x32_bf16 a[84:87], v[40:43], v[68:71], a[84:87]
  ds_read_b64_tr_b16 v[62:63], v5 offset:38912
  v_add_u32 v101, s49, v101
  v_mfma_f32_16x16x32_bf16 a[84:87], v[44:47], v[84:87], a[84:87]
  v_xor_b32 v102, s63, v102
  v_add_u32 v102, s49, v102
  v_mfma_f32_16x16x32_bf16 a[88:91], v[40:43], v[72:75], a[88:91]
  v_xor_b32 v103, s63, v103
  v_add_u32 v103, s49, v103
  v_mfma_f32_16x16x32_bf16 a[88:91], v[44:47], v[88:91], a[88:91]
  v_xor_b32 v104, s63, v104
  v_add_u32 v104, s49, v104
  v_mfma_f32_16x16x32_bf16 a[92:95], v[40:43], v[76:79], a[92:95]
  v_lshrrev_b32 v109, 4, v1
  v_and_b32 v110, 15, v1
  v_mfma_f32_16x16x32_bf16 a[92:95], v[44:47], v[92:95], a[92:95]
  ds_read_b64_tr_b16 v[32:33], v4 offset:18432
  s_waitcnt lgkmcnt(5)
  v_mfma_f32_16x16x32_bf16 a[96:99], v[48:51], v[64:67], a[96:99]
  ds_read_b64_tr_b16 v[34:35], v4 offset:21504
  v_xor_b32 v109, v109, v110
  v_mfma_f32_16x16x32_bf16 a[96:99], v[52:55], v[80:83], a[96:99]
  ds_read_b64_tr_b16 v[36:37], v4 offset:24576
  v_lshlrev_b32 v109, 4, v109
  v_mfma_f32_16x16x32_bf16 a[100:103], v[48:51], v[68:71], a[100:103]
  ds_read_b64_tr_b16 v[38:39], v4 offset:27648
  v_lshl_add_u32 v105, v110, 8, v109
  v_mfma_f32_16x16x32_bf16 a[100:103], v[52:55], v[84:87], a[100:103]
  v_add_u32 v105, 0x20000, v105
  v_lshrrev_b32 v109, 5, v1
  v_mfma_f32_16x16x32_bf16 a[104:107], v[48:51], v[72:75], a[104:107]
  v_lshl_add_u32 v106, v109, 9, v98
  v_lshl_add_u32 v107, v109, 9, v99
  v_mfma_f32_16x16x32_bf16 a[104:107], v[52:55], v[88:91], a[104:107]
  v_add_u32 v106, 0x2c000, v106
  v_add_u32 v107, 0x2c000, v107
  v_mfma_f32_16x16x32_bf16 a[108:111], v[48:51], v[76:79], a[108:111]
  s_lshr_b32 s62, s2, 3
  s_lshl_b32 s62, s62, 2
  s_add_u32 s62, s62, s33
  s_and_b32 s62, s62, 31
  s_lshl_b32 s62, s62, 12
  v_lshl_add_u32 v108, v1, 6, s62
  s_mov_b32 s63, L_code_end-recurrent_scan__sliding_block_cached__glu_gated_bilinear__prompt_kernel-4
  v_min_u32 v108, s63, v108
  s_getpc_b64 s[68:69]
L_pc2:
  s_sub_u32 s68, s68, L_pc2-recurrent_scan__sliding_block_cached__glu_gated_bilinear__prompt_kernel
  s_subb_u32 s69, s69, 0
  v_mfma_f32_16x16x32_bf16 a[108:111], v[52:55], v[92:95], a[108:111]
L_G:
  s_waitcnt lgkmcnt(4)
  v_mfma_f32_16x16x32_bf16 a[112:115], v[56:59], v[64:67], a[112:115]
  ds_read_b64_tr_b16 v[40:41], v4 offset:30720
  ds_read_b64_tr_b16 v[42:43], v4 offset:33792
  v_mfma_f32_16x16x32_bf16 a[112:115], v[60:63], v[80:83], a[112:115]
  ds_read_b64_tr_b16 v[44:45], v4 offset:36864
  s_add_u32 m0, s5, s90
  v_mfma_f32_16x16x32_bf16 a[116:119], v[56:59], v[68:71], a[116:119]
  ds_read_b64_tr_b16 v[46:47], v4 offset:39936
  v_mfma_f32_16x16x32_bf16 a[116:119], v[60:63], v[84:87], a[116:119]
  buffer_load_dwordx4 v7, s[8:11], s52 offen offset:0 lds
  v_mfma_f32_16x16x32_bf16 a[120:123], v[56:59], v[72:75], a[120:123]
  v_mfma_f32_16x16x32_bf16 a[120:123], v[60:63], v[88:91], a[120:123]
  v_mfma_f32_16x16x32_bf16 a[124:127], v[56:59], v[76:79], a[124:127]
  v_mfma_f32_16x16x32_bf16 a[124:127], v[60:63], v[92:95], a[124:127]
  ds_read_b64_tr_b16 v[48:49], v5 offset:18432
  s_waitcnt lgkmcnt(5)
  v_mfma_f32_16x16x32_bf16 a[128:131], v[32:35], v[64:67], a[128:131]
  ds_read_b64_tr_b16 v[50:51], v5 offset:21504
  v_mfma_f32_16x16x32_bf16 a[128:131], v[36:39], v[80:83], a[128:131]
  ds_read_b64_tr_b16 v[52:53], v5 offset:24576
  v_mfma_f32_16x16x32_bf16 a[132:135], v[32:35], v[68:71], a[132:135]
  ds_read_b64_tr_b16 v[54:55], v5 offset:27648
  v_mfma_f32_16x16x32_bf16 a[132:135], v[36:39], v[84:87], a[132:135]
  buffer_load_dwordx4 v8, s[8:11], s52 offen offset:1024 lds
  v_mfma_f32_16x16x32_bf16 a[136:139], v[32:35], v[72:75], a[136:139]
  v_mfma_f32_16x16x32_bf16 a[136:139], v[36:39], v[88:91], a[136:139]
  v_mfma_f32_16x16x32_bf16 a[140:143], v[32:35], v[76:79], a[140:143]
  v_mfma_f32_16x16x32_bf16 a[140:143], v[36:39], v[92:95], a[140:143]
  ds_read_b64_tr_b16 v[56:57], v5 offset:30720
  s_waitcnt lgkmcnt(5)
  v_mfma_f32_16x16x32_bf16 a[144:147], v[40:43], v[64:67], a[144:147]
  ds_read_b64_tr_b16 v[58:59], v5 offset:33792
  v_mfma_f32_16x16x32_bf16 a[144:147], v[44:47], v[80:83], a[144:147]
  ds_read_b64_tr_b16 v[60:61], v5 offset:36864
  v_mfma_f32_16x16x32_bf16 a[148:151], v[40:43], v[68:71], a[148:151]
  ds_read_b64_tr_b16 v[62:63], v5 offset:39936
  v_mfma_f32_16x16x32_bf16 a[148:151], v[44:47], v[84:87], a[148:151]
  buffer_load_dwordx4 v9, s[8:11], s52 offen offset:2048 lds
  v_mfma_f32_16x16x32_bf16 a[152:155], v[40:43], v[72:75], a[152:155]
  v_mfma_f32_16x16x32_bf16 a[152:155], v[44:47], v[88:91], a[152:155]
  v_mfma_f32_16x16x32_bf16 a[156:159], v[40:43], v[76:79], a[156:159]
  v_mfma_f32_16x16x32_bf16 a[156:159], v[44:47], v[92:95], a[156:159]
  ds_read_b64_tr_b16 v[32:33], v6 offset:40960
  s_waitcnt lgkmcnt(5)
  v_mfma_f32_16x16x32_bf16 a[160:163], v[48:51], v[64:67], a[160:163]
  ds_read_b64_tr_b16 v[34:35], v6 offset:41472
  v_mfma_f32_16x16x32_bf16 a[160:163], v[52:55], v[80:83], a[160:163]
  ds_read_b64_tr_b16 v[36:37], v6 offset:41984
  v_mfma_f32_16x16x32_bf16 a[164:167], v[48:51], v[68:71], a[164:167]
  ds_read_b64_tr_b16 v[38:39], v6 offset:42496
  v_mfma_f32_16x16x32_bf16 a[164:167], v[52:55], v[84:87], a[164:167]
  buffer_load_dwordx4 v10, s[8:11], s52 offen offset:3072 lds
  v_mfma_f32_16x16x32_bf16 a[168:171], v[48:51], v[72:75], a[168:171]
  v_mfma_f32_16x16x32_bf16 a[168:171], v[52:55], v[88:91], a[168:171]
  v_mfma_f32_16x16x32_bf16 a[172:175], v[48:51], v[76:79], a[172:175]
  v_mfma_f32_16x16x32_bf16 a[172:175], v[52:55], v[92:95], a[172:175]
  ds_read_b64_tr_b16 v[40:41], v6 offset:43008
  s_waitcnt lgkmcnt(5)
  v_mfma_f32_16x16x32_bf16 a[176:179], v[56:59], v[64:67], a[176:179]
  ds_read_b64_tr_b16 v[42:43], v6 offset:43520
  s_add_u32 s100, s6, s90
  v_mfma_f32_16x16x32_bf16 a[176:179], v[60:63], v[80:83], a[176:179]
  ds_read_b64_tr_b16 v[44:45], v6 offset:44032
  s_add_u32 m0, s100, 16384
  v_mfma_f32_16x16x32_bf16 a[180:183], v[56:59], v[68:71], a[180:183]
  ds_read_b64_tr_b16 v[46:47], v6 offset:44544
  v_mfma_f32_16x16x32_bf16 a[180:183], v[60:63], v[84:87], a[180:183]
  buffer_load_dwordx4 v11, s[12:15], s53 offen offset:0 lds
  v_mfma_f32_16x16x32_bf16 a[184:187], v[56:59], v[72:75], a[184:187]
  v_mfma_f32_16x16x32_bf16 a[184:187], v[60:63], v[88:91], a[184:187]
  v_mfma_f32_16x16x32_bf16 a[188:191], v[56:59], v[76:79], a[188:191]
  v_mfma_f32_16x16x32_bf16 a[188:191], v[60:63], v[92:95], a[188:191]
  ds_read_b64_tr_b16 v[48:49], v2 offset:0
  s_waitcnt lgkmcnt(5)
  v_mfma_f32_16x16x32_bf16 a[192:195], v[32:35], v[64:67], a[192:195]
  ds_read_b64_tr_b16 v[50:51], v2 offset:2048
  v_mfma_f32_16x16x32_bf16 a[192:195], v[36:39], v[80:83], a[192:195]
  ds_read_b64_tr_b16 v[52:53], v2 offset:4096
  v_mfma_f32_16x16x32_bf16 a[196:199], v[32:35], v[68:71], a[196:199]
  ds_read_b64_tr_b16 v[54:55], v2 offset:6144
  v_mfma_f32_16x16x32_bf16 a[196:199], v[36:39], v[84:87], a[196:199]
  buffer_load_dwordx4 v12, s[12:15], s53 offen offset:1024 lds
  v_mfma_f32_16x16x32_bf16 a[200:203], v[32:35], v[72:75], a[200:203]
  v_mfma_f32_16x16x32_bf16 a[200:203], v[36:39], v[88:91], a[200:203]
  v_mfma_f32_16x16x32_bf16 a[204:207], v[32:35], v[76:79], a[204:207]
  v_mfma_f32_16x16x32_bf16 a[204:207], v[36:39], v[92:95], a[204:207]
  ds_read_b64_tr_b16 v[56:57], v3 offset:0
  s_waitcnt lgkmcnt(5)
  v_mfma_f32_16x16x32_bf16 a[208:211], v[40:43], v[64:67], a[208:211]
  ds_read_b64_tr_b16 v[58:59], v3 offset:2048
  v_mfma_f32_16x16x32_bf16 a[208:211], v[44:47], v[80:83], a[208:211]
  ds_read_b64_tr_b16 v[60:61], v3 offset:4096
  v_mfma_f32_16x16x32_bf16 a[212:215], v[40:43], v[68:71], a[212:215]
  ds_read_b64_tr_b16 v[62:63], v3 offset:6144
  v_mfma_f32_16x16x32_bf16 a[212:215], v[44:47], v[84:87], a[212:215]
  buffer_load_dwordx4 v13, s[12:15], s53 offen offset:2048 lds
  v_mfma_f32_16x16x32_bf16 a[216:219], v[40:43], v[72:75], a[216:219]
  v_mfma_f32_16x16x32_bf16 a[216:219], v[44:47], v[88:91], a[216:219]
  v_mfma_f32_16x16x32_bf16 a[220:223], v[40:43], v[76:79], a[220:223]
  v_mfma_f32_16x16x32_bf16 a[220:223], v[44:47], v[92:95], a[220:223]
  ds_read_b64_tr_b16 v[32:33], v2 offset:512
  s_waitcnt lgkmcnt(5)
  v_mfma_f32_16x16x32_bf16 v[128:131], v[48:51], v[64:67], v[128:131]
  ds_read_b64_tr_b16 v[34:35], v2 offset:2560
  s_add_u32 m0, s100, 28672
  v_mfma_f32_16x16x32_bf16 v[128:131], v[52:55], v[80:83], v[128:131]
  ds_read_b64_tr_b16 v[36:37], v2 offset:4608
  v_mfma_f32_16x16x32_bf16 v[132:135], v[48:51], v[68:71], v[132:135]
  ds_read_b64_tr_b16 v[38:39], v2 offset:6656
  v_mfma_f32_16x16x32_bf16 v[132:135], v[52:55], v[84:87], v[132:135]
  buffer_load_dwordx4 v11, s[16:19], s53 offen offset:0 lds
  v_mfma_f32_16x16x32_bf16 v[136:139], v[48:51], v[72:75], v[136:139]
  v_mfma_f32_16x16x32_bf16 v[136:139], v[52:55], v[88:91], v[136:139]
  v_mfma_f32_16x16x32_bf16 v[140:143], v[48:51], v[76:79], v[140:143]
  v_mfma_f32_16x16x32_bf16 v[140:143], v[52:55], v[92:95], v[140:143]
  ds_read_b64_tr_b16 v[40:41], v3 offset:512
  s_waitcnt lgkmcnt(5)
  v_mfma_f32_16x16x32_bf16 v[144:147], v[56:59], v[64:67], v[144:147]
  ds_read_b64_tr_b16 v[42:43], v3 offset:2560
  v_mfma_f32_16x16x32_bf16 v[144:147], v[60:63], v[80:83], v[144:147]
  ds_read_b64_tr_b16 v[44:45], v3 offset:4608
  v_mfma_f32_16x16x32_bf16 v[148:151], v[56:59], v[68:71], v[148:151]
  ds_read_b64_tr_b16 v[46:47], v3 offset:6656
  v_mfma_f32_16x16x32_bf16 v[148:151], v[60:63], v[84:87], v[148:151]
  buffer_load_dwordx4 v12, s[16:19], s53 offen offset:1024 lds
  v_mfma_f32_16x16x32_bf16 v[152:155], v[56:59], v[72:75], v[152:155]
  v_mfma_f32_16x16x32_bf16 v[152:155], v[60:63], v[88:91], v[152:155]
  v_mfma_f32_16x16x32_bf16 v[156:159], v[56:59], v[76:79], v[156:159]
  v_mfma_f32_16x16x32_bf16 v[156:159], v[60:63], v[92:95], v[156:159]
  ds_read_b64_tr_b16 v[48:49], v2 offset:8192
  s_waitcnt lgkmcnt(5)
  v_mfma_f32_16x16x32_bf16 v[160:163], v[32:35], v[64:67], v[160:163]
  ds_read_b64_tr_b16 v[50:51], v2 offset:10240
  v_mfma_f32_16x16x32_bf16 v[160:163], v[36:39], v[80:83], v[160:163]
  ds_read_b64_tr_b16 v[52:53], v2 offset:12288
  v_mfma_f32_16x16x32_bf16 v[164:167], v[32:35], v[68:71], v[164:167]
  ds_read_b64_tr_b16 v[54:55], v2 offset:14336
  v_mfma_f32_16x16x32_bf16 v[164:167], v[36:39], v[84:87], v[164:167]
  buffer_load_dwordx4 v13, s[16:19], s53 offen offset:2048 lds
  v_mfma_f32_16x16x32_bf16 v[168:171], v[32:35], v[72:75], v[168:171]
  v_mfma_f32_16x16x32_bf16 v[168:171], v[36:39], v[88:91], v[168:171]
  v_mfma_f32_16x16x32_bf16 v[172:175], v[32:35], v[76:79], v[172:175]
  v_mfma_f32_16x16x32_bf16 v[172:175], v[36:39], v[92:95], v[172:175]
  ds_read_b64_tr_b16 v[56:57], v3 offset:8192
  s_waitcnt lgkmcnt(5)
  v_mfma_f32_16x16x32_bf16 v[176:179], v[40:43], v[64:67], v[176:179]
  ds_read_b64_tr_b16 v[58:59], v3 offset:10240
  s_add_u32 s100, s7, s90
  v_mfma_f32_16x16x32_bf16 v[176:179], v[44:47], v[80:83], v[176:179]
  ds_read_b64_tr_b16 v[60:61], v3 offset:12288
  s_add_u32 m0, s100, 40960
  v_mfma_f32_16x16x32_bf16 v[180:183], v[40:43], v[68:71], v[180:183]
  ds_read_b64_tr_b16 v[62:63], v3 offset:14336
  v_mfma_f32_16x16x32_bf16 v[180:183], v[44:47], v[84:87], v[180:183]
  buffer_load_dwordx4 v14, s[20:23], s53 offen lds
  v_mfma_f32_16x16x32_bf16 v[184:187], v[40:43], v[72:75], v[184:187]
  v_mfma_f32_16x16x32_bf16 v[184:187], v[44:47], v[88:91], v[184:187]
  v_mfma_f32_16x16x32_bf16 v[188:191], v[40:43], v[76:79], v[188:191]
  v_mfma_f32_16x16x32_bf16 v[188:191], v[44:47], v[92:95], v[188:191]
  ds_read_b64_tr_b16 v[32:33], v2 offset:8704
  s_waitcnt lgkmcnt(5)
  v_mfma_f32_16x16x32_bf16 v[192:195], v[48:51], v[64:67], v[192:195]
  ds_read_b64_tr_b16 v[34:35], v2 offset:10752
  s_add_u32 s52, s52, 0x80000
  v_mfma_f32_16x16x32_bf16 v[192:195], v[52:55], v[80:83], v[192:195]
  ds_read_b64_tr_b16 v[36:37], v2 offset:12800
  s_add_u32 s53, s53, 0x70000
  v_mfma_f32_16x16x32_bf16 v[196:199], v[48:51], v[68:71], v[196:199]
  ds_read_b64_tr_b16 v[38:39], v2 offset:14848
  s_mov_b32 s100, s90
  v_mfma_f32_16x16x32_bf16 v[196:199], v[52:55], v[84:87], v[196:199]
  s_mov_b32 s90, s88
  s_mov_b32 s88, s89
  v_mfma_f32_16x16x32_bf16 v[200:203], v[48:51], v[72:75], v[200:203]
  s_mov_b32 s89, s100
  v_mfma_f32_16x16x32_bf16 v[200:203], v[52:55], v[88:91], v[200:203]
  v_mfma_f32_16x16x32_bf16 v[204:207], v[48:51], v[76:79], v[204:207]
  v_mfma_f32_16x16x32_bf16 v[204:207], v[52:55], v[92:95], v[204:207]
  ds_read_b64_tr_b16 v[40:41], v3 offset:8704
  s_waitcnt lgkmcnt(5)
  v_mfma_f32_16x16x32_bf16 v[208:211], v[56:59], v[64:67], v[208:211]
  ds_read_b64_tr_b16 v[42:43], v3 offset:10752
  v_mfma_f32_16x16x32_bf16 v[208:211], v[60:63], v[80:83], v[208:211]
  ds_read_b64_tr_b16 v[44:45], v3 offset:12800
  v_mfma_f32_16x16x32_bf16 v[212:215], v[56:59], v[68:71], v[212:215]
  ds_read_b64_tr_b16 v[46:47], v3 offset:14848
  v_mfma_f32_16x16x32_bf16 v[212:215], v[60:63], v[84:87], v[212:215]
  v_mfma_f32_16x16x32_bf16 v[216:219], v[56:59], v[72:75], v[216:219]
  v_add_u32 v2, s88, v96
  v_add_u32 v3, s88, v97
  v_mfma_f32_16x16x32_bf16 v[216:219], v[60:63], v[88:91], v[216:219]
  v_add_u32 v4, s88, v98
  v_add_u32 v5, s88, v99
  v_mfma_f32_16x16x32_bf16 v[220:223], v[56:59], v[76:79], v[220:223]
  v_add_u32 v6, s88, v100
  v_mfma_f32_16x16x32_bf16 v[220:223], v[60:63], v[92:95], v[220:223]
  s_waitcnt vmcnt(19)
  s_barrier
  s_waitcnt lgkmcnt(4)
  v_mfma_f32_16x16x32_bf16 v[224:227], v[32:35], v[64:67], v[224:227]
  ds_read_b64_tr_b16 v[48:49], v4 offset:16384
  ds_read_b64_tr_b16 v[50:51], v4 offset:19456
  v_mfma_f32_16x16x32_bf16 v[224:227], v[36:39], v[80:83], v[224:227]
  ds_read_b64_tr_b16 v[52:53], v4 offset:22528
  v_mfma_f32_16x16x32_bf16 v[228:231], v[32:35], v[68:71], v[228:231]
  ds_read_b64_tr_b16 v[54:55], v4 offset:25600
  v_mfma_f32_16x16x32_bf16 v[228:231], v[36:39], v[84:87], v[228:231]
  v_mfma_f32_16x16x32_bf16 v[232:235], v[32:35], v[72:75], v[232:235]
  v_mfma_f32_16x16x32_bf16 v[232:235], v[36:39], v[88:91], v[232:235]
  v_mfma_f32_16x16x32_bf16 v[236:239], v[32:35], v[76:79], v[236:239]
  v_mfma_f32_16x16x32_bf16 v[236:239], v[36:39], v[92:95], v[236:239]
  ds_read_b64_tr_b16 v[56:57], v4 offset:28672
  s_waitcnt lgkmcnt(5)
  v_mfma_f32_16x16x32_bf16 v[240:243], v[40:43], v[64:67], v[240:243]
  ds_read_b64_tr_b16 v[58:59], v4 offset:31744
  v_mfma_f32_16x16x32_bf16 v[240:243], v[44:47], v[80:83], v[240:243]
  ds_read_b64_tr_b16 v[60:61], v4 offset:34816
  v_mfma_f32_16x16x32_bf16 v[244:247], v[40:43], v[68:71], v[244:247]
  ds_read_b64_tr_b16 v[62:63], v4 offset:37888
  v_mfma_f32_16x16x32_bf16 v[244:247], v[44:47], v[84:87], v[244:247]
  v_mfma_f32_16x16x32_bf16 v[248:251], v[40:43], v[72:75], v[248:251]
  v_mfma_f32_16x16x32_bf16 v[248:251], v[44:47], v[88:91], v[248:251]
  v_mfma_f32_16x16x32_bf16 v[252:255], v[40:43], v[76:79], v[252:255]
  v_mfma_f32_16x16x32_bf16 v[252:255], v[44:47], v[92:95], v[252:255]
  s_waitcnt vmcnt(11)
  s_waitcnt lgkmcnt(4)
  v_mfma_f32_16x16x32_bf16 a[0:3], v[48:51], a[224:227], a[0:3]
  ds_read_b64_tr_b16 v[32:33], v5 offset:16384
  ds_read_b64_tr_b16 v[34:35], v5 offset:19456
  v_mfma_f32_16x16x32_bf16 a[0:3], v[52:55], a[240:243], a[0:3]
  s_barrier
  ds_read_b64_tr_b16 v[36:37], v5 offset:22528
  v_mfma_f32_16x16x32_bf16 a[4:7], v[48:51], a[228:231], a[4:7]
  ds_read_b64_tr_b16 v[38:39], v5 offset:25600
  v_mfma_f32_16x16x32_bf16 a[4:7], v[52:55], a[244:247], a[4:7]
  buffer_load_dwordx4 v[64:67], v15, s[24:27], s54 offen offset:0 sc1
  v_mfma_f32_16x16x32_bf16 a[8:11], v[48:51], a[232:235], a[8:11]
  v_mfma_f32_16x16x32_bf16 a[8:11], v[52:55], a[248:251], a[8:11]
  v_mfma_f32_16x16x32_bf16 a[12:15], v[48:51], a[236:239], a[12:15]
  buffer_load_dwordx4 v[80:83], v16, s[24:27], s54 offen offset:0 sc1
  v_mfma_f32_16x16x32_bf16 a[12:15], v[52:55], a[252:255], a[12:15]
  ds_read_b64_tr_b16 v[40:41], v5 offset:28672
  s_waitcnt lgkmcnt(5)
  v_mfma_f32_16x16x32_bf16 a[16:19], v[56:59], a[224:227], a[16:19]
  ds_read_b64_tr_b16 v[42:43], v5 offset:31744
  v_mfma_f32_16x16x32_bf16 a[16:19], v[60:63], a[240:243], a[16:19]
  ds_read_b64_tr_b16 v[44:45], v5 offset:34816
  v_mfma_f32_16x16x32_bf16 a[20:23], v[56:59], a[228:231], a[20:23]
  ds_read_b64_tr_b16 v[46:47], v5 offset:37888
  v_mfma_f32_16x16x32_bf16 a[20:23], v[60:63], a[244:247], a[20:23]
  buffer_load_dwordx4 v[68:71], v15, s[24:27], s54 offen offset:1024 sc1
  v_mfma_f32_16x16x32_bf16 a[24:27], v[56:59], a[232:235], a[24:27]
  v_mfma_f32_16x16x32_bf16 a[24:27], v[60:63], a[248:251], a[24:27]
  v_mfma_f32_16x16x32_bf16 a[28:31], v[56:59], a[236:239], a[28:31]
  buffer_load_dwordx4 v[84:87], v16, s[24:27], s54 offen offset:1024 sc1
  v_mfma_f32_16x16x32_bf16 a[28:31], v[60:63], a[252:255], a[28:31]
  ds_read_b64_tr_b16 v[48:49], v4 offset:17408
  s_waitcnt lgkmcnt(5)
  v_mfma_f32_16x16x32_bf16 a[32:35], v[32:35], a[224:227], a[32:35]
  ds_read_b64_tr_b16 v[50:51], v4 offset:20480
  v_mfma_f32_16x16x32_bf16 a[32:35], v[36:39], a[240:243], a[32:35]
  ds_read_b64_tr_b16 v[52:53], v4 offset:23552
  v_mfma_f32_16x16x32_bf16 a[36:39], v[32:35], a[228:231], a[36:39]
  ds_read_b64_tr_b16 v[54:55], v4 offset:26624
  v_mfma_f32_16x16x32_bf16 a[36:39], v[36:39], a[244:247], a[36:39]
  buffer_load_dwordx4 v[72:75], v15, s[24:27], s54 offen offset:2048 sc1
  v_mfma_f32_16x16x32_bf16 a[40:43], v[32:35], a[232:235], a[40:43]
  v_mfma_f32_16x16x32_bf16 a[40:43], v[36:39], a[248:251], a[40:43]
  v_mfma_f32_16x16x32_bf16 a[44:47], v[32:35], a[236:239], a[44:47]
  buffer_load_dwordx4 v[88:91], v16, s[24:27], s54 offen offset:2048 sc1
  v_mfma_f32_16x16x32_bf16 a[44:47], v[36:39], a[252:255], a[44:47]
  ds_read_b64_tr_b16 v[56:57], v4 offset:29696
  s_waitcnt lgkmcnt(5)
  v_mfma_f32_16x16x32_bf16 a[48:51], v[40:43], a[224:227], a[48:51]
  ds_read_b64_tr_b16 v[58:59], v4 offset:32768
  v_mfma_f32_16x16x32_bf16 a[48:51], v[44:47], a[240:243], a[48:51]
  ds_read_b64_tr_b16 v[60:61], v4 offset:35840
  v_mfma_f32_16x16x32_bf16 a[52:55], v[40:43], a[228:231], a[52:55]
  ds_read_b64_tr_b16 v[62:63], v4 offset:38912
  v_mfma_f32_16x16x32_bf16 a[52:55], v[44:47], a[244:247], a[52:55]
  buffer_load_dwordx4 v[76:79], v15, s[24:27], s54 offen offset:3072 sc1
  v_mfma_f32_16x16x32_bf16 a[56:59], v[40:43], a[232:235], a[56:59]
  v_mfma_f32_16x16x32_bf16 a[56:59], v[44:47], a[248:251], a[56:59]
  v_mfma_f32_16x16x32_bf16 a[60:63], v[40:43], a[236:239], a[60:63]
  buffer_load_dwordx4 v[92:95], v16, s[24:27], s54 offen offset:3072 sc1
  v_mfma_f32_16x16x32_bf16 a[60:63], v[44:47], a[252:255], a[60:63]
  ds_read_b64_tr_b16 v[32:33], v5 offset:17408
  s_waitcnt lgkmcnt(5)
  v_mfma_f32_16x16x32_bf16 a[64:67], v[48:51], a[224:227], a[64:67]
  ds_read_b64_tr_b16 v[34:35], v5 offset:20480
  v_mfma_f32_16x16x32_bf16 a[64:67], v[52:55], a[240:243], a[64:67]
  ds_read_b64_tr_b16 v[36:37], v5 offset:23552
  s_add_u32 s54, s54, 0x2000
  v_mfma_f32_16x16x32_bf16 a[68:71], v[48:51], a[228:231], a[68:71]
  ds_read_b64_tr_b16 v[38:39], v5 offset:26624
  v_mfma_f32_16x16x32_bf16 a[68:71], v[52:55], a[244:247], a[68:71]
  buffer_load_dword v127, v31, s[80:83], s58 offen
  v_mfma_f32_16x16x32_bf16 a[72:75], v[48:51], a[232:235], a[72:75]
  v_mfma_f32_16x16x32_bf16 a[72:75], v[52:55], a[248:251], a[72:75]
  v_mfma_f32_16x16x32_bf16 a[76:79], v[48:51], a[236:239], a[76:79]
  buffer_load_dword v127, v31, s[76:79], s58 offen
  v_mfma_f32_16x16x32_bf16 a[76:79], v[52:55], a[252:255], a[76:79]
  ds_read_b64_tr_b16 v[40:41], v5 offset:29696
  s_waitcnt lgkmcnt(5)
  v_mfma_f32_16x16x32_bf16 a[80:83], v[56:59], a[224:227], a[80:83]
  ds_read_b64_tr_b16 v[42:43], v5 offset:32768
  v_mfma_f32_16x16x32_bf16 a[80:83], v[60:63], a[240:243], a[80:83]
  ds_read_b64_tr_b16 v[44:45], v5 offset:35840
  s_add_u32 s58, s58, 0x140000
  v_mfma_f32_16x16x32_bf16 a[84:87], v[56:59], a[228:231], a[84:87]
  ds_read_b64_tr_b16 v[46:47], v5 offset:38912
  v_mfma_f32_16x16x32_bf16 a[84:87], v[60:63], a[244:247], a[84:87]
  v_mfma_f32_16x16x32_bf16 a[88:91], v[56:59], a[232:235], a[88:91]
  v_mfma_f32_16x16x32_bf16 a[88:91], v[60:63], a[248:251], a[88:91]
  v_mfma_f32_16x16x32_bf16 a[92:95], v[56:59], a[236:239], a[92:95]
  v_mfma_f32_16x16x32_bf16 a[92:95], v[60:63], a[252:255], a[92:95]
  ds_read_b64_tr_b16 v[48:49], v4 offset:18432
  s_waitcnt lgkmcnt(5)
  v_mfma_f32_16x16x32_bf16 a[96:99], v[32:35], a[224:227], a[96:99]
  ds_read_b64_tr_b16 v[50:51], v4 offset:21504
  v_mfma_f32_16x16x32_bf16 a[96:99], v[36:39], a[240:243], a[96:99]
  ds_read_b64_tr_b16 v[52:53], v4 offset:24576
  v_mfma_f32_16x16x32_bf16 a[100:103], v[32:35], a[228:231], a[100:103]
  ds_read_b64_tr_b16 v[54:55], v4 offset:27648
  v_mfma_f32_16x16x32_bf16 a[100:103], v[36:39], a[244:247], a[100:103]
  v_mfma_f32_16x16x32_bf16 a[104:107], v[32:35], a[232:235], a[104:107]
  v_mfma_f32_16x16x32_bf16 a[104:107], v[36:39], a[248:251], a[104:107]
  v_mfma_f32_16x16x32_bf16 a[108:111], v[32:35], a[236:239], a[108:111]
  v_mfma_f32_16x16x32_bf16 a[108:111], v[36:39], a[252:255], a[108:111]
  ds_read_b64_tr_b16 v[56:57], v4 offset:30720
  s_waitcnt lgkmcnt(5)
  v_mfma_f32_16x16x32_bf16 a[112:115], v[40:43], a[224:227], a[112:115]
  ds_read_b64_tr_b16 v[58:59], v4 offset:33792
  s_add_u32 m0, s5, s90
  v_mfma_f32_16x16x32_bf16 a[112:115], v[44:47], a[240:243], a[112:115]
  ds_read_b64_tr_b16 v[60:61], v4 offset:36864
  v_mfma_f32_16x16x32_bf16 a[116:119], v[40:43], a[228:231], a[116:119]
  ds_read_b64_tr_b16 v[62:63], v4 offset:39936
  v_mfma_f32_16x16x32_bf16 a[116:119], v[44:47], a[244:247], a[116:119]
  buffer_load_dwordx4 v7, s[8:11], s52 offen offset:0 lds
  v_mfma_f32_16x16x32_bf16 a[120:123], v[40:43], a[232:235], a[120:123]
  v_mfma_f32_16x16x32_bf16 a[120:123], v[44:47], a[248:251], a[120:123]
  v_mfma_f32_16x16x32_bf16 a[124:127], v[40:43], a[236:239], a[124:127]
  v_mfma_f32_16x16x32_bf16 a[124:127], v[44:47], a[252:255], a[124:127]
  ds_read_b64_tr_b16 v[32:33], v5 offset:18432
  s_waitcnt lgkmcnt(5)
  v_mfma_f32_16x16x32_bf16 a[128:131], v[48:51], a[224:227], a[128:131]
  ds_read_b64_tr_b16 v[34:35], v5 offset:21504
  v_mfma_f32_16x16x32_bf16 a[128:131], v[52:55], a[240:243], a[128:131]
  ds_read_b64_tr_b16 v[36:37], v5 offset:24576
  v_mfma_f32_16x16x32_bf16 a[132:135], v[48:51], a[228:231], a[132:135]
  ds_read_b64_tr_b16 v[38:39], v5 offset:27648
  v_mfma_f32_16x16x32_bf16 a[132:135], v[52:55], a[244:247], a[132:135]
  buffer_load_dwordx4 v8, s[8:11], s52 offen offset:1024 lds
  v_mfma_f32_16x16x32_bf16 a[136:139], v[48:51], a[232:235], a[136:139]
  v_mfma_f32_16x16x32_bf16 a[136:139], v[52:55], a[248:251], a[136:139]
  v_mfma_f32_16x16x32_bf16 a[140:143], v[48:51], a[236:239], a[140:143]
  v_mfma_f32_16x16x32_bf16 a[140:143], v[52:55], a[252:255], a[140:143]
  ds_read_b64_tr_b16 v[40:41], v5 offset:30720
  s_waitcnt lgkmcnt(5)
  v_mfma_f32_16x16x32_bf16 a[144:147], v[56:59], a[224:227], a[144:147]
  ds_read_b64_tr_b16 v[42:43], v5 offset:33792
  v_mfma_f32_16x16x32_bf16 a[144:147], v[60:63], a[240:243], a[144:147]
  ds_read_b64_tr_b16 v[44:45], v5 offset:36864
  v_mfma_f32_16x16x32_bf16 a[148:151], v[56:59], a[228:231], a[148:151]
  ds_read_b64_tr_b16 v[46:47], v5 offset:39936
  v_mfma_f32_16x16x32_bf16 a[148:151], v[60:63], a[244:247], a[148:151]
  buffer_load_dwordx4 v9, s[8:11], s52 offen offset:2048 lds
  v_mfma_f32_16x16x32_bf16 a[152:155], v[56:59], a[232:235], a[152:155]
  v_mfma_f32_16x16x32_bf16 a[152:155], v[60:63], a[248:251], a[152:155]
  v_mfma_f32_16x16x32_bf16 a[156:159], v[56:59], a[236:239], a[156:159]
  v_mfma_f32_16x16x32_bf16 a[156:159], v[60:63], a[252:255], a[156:159]
  ds_read_b64_tr_b16 v[48:49], v6 offset:40960
  s_waitcnt lgkmcnt(5)
  v_mfma_f32_16x16x32_bf16 a[160:163], v[32:35], a[224:227], a[160:163]
  ds_read_b64_tr_b16 v[50:51], v6 offset:41472
  v_mfma_f32_16x16x32_bf16 a[160:163], v[36:39], a[240:243], a[160:163]
  ds_read_b64_tr_b16 v[52:53], v6 offset:41984
  v_mfma_f32_16x16x32_bf16 a[164:167], v[32:35], a[228:231], a[164:167]
  ds_read_b64_tr_b16 v[54:55], v6 offset:42496
  v_mfma_f32_16x16x32_bf16 a[164:167], v[36:39], a[244:247], a[164:167]
  buffer_load_dwordx4 v10, s[8:11], s52 offen offset:3072 lds
  v_mfma_f32_16x16x32_bf16 a[168:171], v[32:35], a[232:235], a[168:171]
  v_mfma_f32_16x16x32_bf16 a[168:171], v[36:39], a[248:251], a[168:171]
  v_mfma_f32_16x16x32_bf16 a[172:175], v[32:35], a[236:239], a[172:175]
  v_mfma_f32_16x16x32_bf16 a[172:175], v[36:39], a[252:255], a[172:175]
  ds_read_b64_tr_b16 v[56:57], v6 offset:43008
  s_waitcnt lgkmcnt(5)
  v_mfma_f32_16x16x32_bf16 a[176:179], v[40:43], a[224:227], a[176:179]
  ds_read_b64_tr_b16 v[58:59], v6 offset:43520
  s_add_u32 s100, s6, s90
  v_mfma_f32_16x16x32_bf16 a[176:179], v[44:47], a[240:243], a[176:179]
  ds_read_b64_tr_b16 v[60:61], v6 offset:44032
  s_add_u32 m0, s100, 16384
  v_mfma_f32_16x16x32_bf16 a[180:183], v[40:43], a[228:231], a[180:183]
  ds_read_b64_tr_b16 v[62:63], v6 offset:44544
  v_mfma_f32_16x16x32_bf16 a[180:183], v[44:47], a[244:247], a[180:183]
  buffer_load_dwordx4 v11, s[12:15], s53 offen offset:0 lds
  v_mfma_f32_16x16x32_bf16 a[184:187], v[40:43], a[232:235], a[184:187]
  v_mfma_f32_16x16x32_bf16 a[184:187], v[44:47], a[248:251], a[184:187]
  v_mfma_f32_16x16x32_bf16 a[188:191], v[40:43], a[236:239], a[188:191]
  v_mfma_f32_16x16x32_bf16 a[188:191], v[44:47], a[252:255], a[188:191]
  ds_read_b64_tr_b16 v[32:33], v2 offset:0
  s_waitcnt lgkmcnt(5)
  v_mfma_f32_16x16x32_bf16 a[192:195], v[48:51], a[224:227], a[192:195]
  ds_read_b64_tr_b16 v[34:35], v2 offset:2048
  v_mfma_f32_16x16x32_bf16 a[192:195], v[52:55], a[240:243], a[192:195]
  ds_read_b64_tr_b16 v[36:37], v2 offset:4096
  v_mfma_f32_16x16x32_bf16 a[196:199], v[48:51], a[228:231], a[196:199]
  ds_read_b64_tr_b16 v[38:39], v2 offset:6144
  v_mfma_f32_16x16x32_bf16 a[196:199], v[52:55], a[244:247], a[196:199]
  buffer_load_dwordx4 v12, s[12:15], s53 offen offset:1024 lds
  v_mfma_f32_16x16x32_bf16 a[200:203], v[48:51], a[232:235], a[200:203]
  v_mfma_f32_16x16x32_bf16 a[200:203], v[52:55], a[248:251], a[200:203]
  v_mfma_f32_16x16x32_bf16 a[204:207], v[48:51], a[236:239], a[204:207]
  v_mfma_f32_16x16x32_bf16 a[204:207], v[52:55], a[252:255], a[204:207]
  ds_read_b64_tr_b16 v[40:41], v3 offset:0
  s_waitcnt lgkmcnt(5)
  v_mfma_f32_16x16x32_bf16 a[208:211], v[56:59], a[224:227], a[208:211]
  ds_read_b64_tr_b16 v[42:43], v3 offset:2048
  v_mfma_f32_16x16x32_bf16 a[208:211], v[60:63], a[240:243], a[208:211]
  ds_read_b64_tr_b16 v[44:45], v3 offset:4096
  v_mfma_f32_16x16x32_bf16 a[212:215], v[56:59], a[228:231], a[212:215]
  ds_read_b64_tr_b16 v[46:47], v3 offset:6144
  v_mfma_f32_16x16x32_bf16 a[212:215], v[60:63], a[244:247], a[212:215]
  buffer_load_dwordx4 v13, s[12:15], s53 offen offset:2048 lds
  v_mfma_f32_16x16x32_bf16 a[216:219], v[56:59], a[232:235], a[216:219]
  v_mfma_f32_16x16x32_bf16 a[216:219], v[60:63], a[248:251], a[216:219]
  v_mfma_f32_16x16x32_bf16 a[220:223], v[56:59], a[236:239], a[220:223]
  v_mfma_f32_16x16x32_bf16 a[220:223], v[60:63], a[252:255], a[220:223]
  ds_read_b64_tr_b16 v[48:49], v2 offset:512
  s_waitcnt lgkmcnt(5)
  v_mfma_f32_16x16x32_bf16 v[128:131], v[32:35], a[224:227], v[128:131]
  ds_read_b64_tr_b16 v[50:51], v2 offset:2560
  s_add_u32 m0, s100, 28672
  v_mfma_f32_16x16x32_bf16 v[128:131], v[36:39], a[240:243], v[128:131]
  ds_read_b64_tr_b16 v[52:53], v2 offset:4608
  v_mfma_f32_16x16x32_bf16 v[132:135], v[32:35], a[228:231], v[132:135]
  ds_read_b64_tr_b16 v[54:55], v2 offset:6656
  v_mfma_f32_16x16x32_bf16 v[132:135], v[36:39], a[244:247], v[132:135]
  buffer_load_dwordx4 v11, s[16:19], s53 offen offset:0 lds
  v_mfma_f32_16x16x32_bf16 v[136:139], v[32:35], a[232:235], v[136:139]
  v_mfma_f32_16x16x32_bf16 v[136:139], v[36:39], a[248:251], v[136:139]
  v_mfma_f32_16x16x32_bf16 v[140:143], v[32:35], a[236:239], v[140:143]
  v_mfma_f32_16x16x32_bf16 v[140:143], v[36:39], a[252:255], v[140:143]
  ds_read_b64_tr_b16 v[56:57], v3 offset:512
  s_waitcnt lgkmcnt(5)
  v_mfma_f32_16x16x32_bf16 v[144:147], v[40:43], a[224:227], v[144:147]
  ds_read_b64_tr_b16 v[58:59], v3 offset:2560
  v_mfma_f32_16x16x32_bf16 v[144:147], v[44:47], a[240:243], v[144:147]
  ds_read_b64_tr_b16 v[60:61], v3 offset:4608
  v_mfma_f32_16x16x32_bf16 v[148:151], v[40:43], a[228:231], v[148:151]
  ds_read_b64_tr_b16 v[62:63], v3 offset:6656
  v_mfma_f32_16x16x32_bf16 v[148:151], v[44:47], a[244:247], v[148:151]
  buffer_load_dwordx4 v12, s[16:19], s53 offen offset:1024 lds
  v_mfma_f32_16x16x32_bf16 v[152:155], v[40:43], a[232:235], v[152:155]
  v_mfma_f32_16x16x32_bf16 v[152:155], v[44:47], a[248:251], v[152:155]
  v_mfma_f32_16x16x32_bf16 v[156:159], v[40:43], a[236:239], v[156:159]
  v_mfma_f32_16x16x32_bf16 v[156:159], v[44:47], a[252:255], v[156:159]
  ds_read_b64_tr_b16 v[32:33], v2 offset:8192
  s_waitcnt lgkmcnt(5)
  v_mfma_f32_16x16x32_bf16 v[160:163], v[48:51], a[224:227], v[160:163]
  ds_read_b64_tr_b16 v[34:35], v2 offset:10240
  v_mfma_f32_16x16x32_bf16 v[160:163], v[52:55], a[240:243], v[160:163]
  ds_read_b64_tr_b16 v[36:37], v2 offset:12288
  v_mfma_f32_16x16x32_bf16 v[164:167], v[48:51], a[228:231], v[164:167]
  ds_read_b64_tr_b16 v[38:39], v2 offset:14336
  v_mfma_f32_16x16x32_bf16 v[164:167], v[52:55], a[244:247], v[164:167]
  buffer_load_dwordx4 v13, s[16:19], s53 offen offset:2048 lds
  v_mfma_f32_16x16x32_bf16 v[168:171], v[48:51], a[232:235], v[168:171]
  v_mfma_f32_16x16x32_bf16 v[168:171], v[52:55], a[248:251], v[168:171]
  v_mfma_f32_16x16x32_bf16 v[172:175], v[48:51], a[236:239], v[172:175]
  v_mfma_f32_16x16x32_bf16 v[172:175], v[52:55], a[252:255], v[172:175]
  ds_read_b64_tr_b16 v[40:41], v3 offset:8192
  s_waitcnt lgkmcnt(5)
  v_mfma_f32_16x16x32_bf16 v[176:179], v[56:59], a[224:227], v[176:179]
  ds_read_b64_tr_b16 v[42:43], v3 offset:10240
  s_add_u32 s100, s7, s90
  v_mfma_f32_16x16x32_bf16 v[176:179], v[60:63], a[240:243], v[176:179]
  ds_read_b64_tr_b16 v[44:45], v3 offset:12288
  s_add_u32 m0, s100, 40960
  v_mfma_f32_16x16x32_bf16 v[180:183], v[56:59], a[228:231], v[180:183]
  ds_read_b64_tr_b16 v[46:47], v3 offset:14336
  v_mfma_f32_16x16x32_bf16 v[180:183], v[60:63], a[244:247], v[180:183]
  buffer_load_dwordx4 v14, s[20:23], s53 offen lds
  v_mfma_f32_16x16x32_bf16 v[184:187], v[56:59], a[232:235], v[184:187]
  v_mfma_f32_16x16x32_bf16 v[184:187], v[60:63], a[248:251], v[184:187]
  v_mfma_f32_16x16x32_bf16 v[188:191], v[56:59], a[236:239], v[188:191]
  v_mfma_f32_16x16x32_bf16 v[188:191], v[60:63], a[252:255], v[188:191]
  ds_read_b64_tr_b16 v[48:49], v2 offset:8704
  s_waitcnt lgkmcnt(5)
  v_mfma_f32_16x16x32_bf16 v[192:195], v[32:35], a[224:227], v[192:195]
  ds_read_b64_tr_b16 v[50:51], v2 offset:10752
  s_add_u32 s52, s52, 0x80000
  v_mfma_f32_16x16x32_bf16 v[192:195], v[36:39], a[240:243], v[192:195]
  ds_read_b64_tr_b16 v[52:53], v2 offset:12800
  s_add_u32 s53, s53, 0x70000
  v_mfma_f32_16x16x32_bf16 v[196:199], v[32:35], a[228:231], v[196:199]
  ds_read_b64_tr_b16 v[54:55], v2 offset:14848
  s_mov_b32 s100, s90
  v_mfma_f32_16x16x32_bf16 v[196:199], v[36:39], a[244:247], v[196:199]
  s_mov_b32 s90, s88
  s_mov_b32 s88, s89
  v_mfma_f32_16x16x32_bf16 v[200:203], v[32:35], a[232:235], v[200:203]
  s_mov_b32 s89, s100
  v_mfma_f32_16x16x32_bf16 v[200:203], v[36:39], a[248:251], v[200:203]
  v_mfma_f32_16x16x32_bf16 v[204:207], v[32:35], a[236:239], v[204:207]
  v_mfma_f32_16x16x32_bf16 v[204:207], v[36:39], a[252:255], v[204:207]
  ds_read_b64_tr_b16 v[56:57], v3 offset:8704
  s_waitcnt lgkmcnt(5)
  v_mfma_f32_16x16x32_bf16 v[208:211], v[40:43], a[224:227], v[208:211]
  ds_read_b64_tr_b16 v[58:59], v3 offset:10752
  v_mfma_f32_16x16x32_bf16 v[208:211], v[44:47], a[240:243], v[208:211]
  ds_read_b64_tr_b16 v[60:61], v3 offset:12800
  v_mfma_f32_16x16x32_bf16 v[212:215], v[40:43], a[228:231], v[212:215]
  ds_read_b64_tr_b16 v[62:63], v3 offset:14848
  v_mfma_f32_16x16x32_bf16 v[212:215], v[44:47], a[244:247], v[212:215]
  v_mfma_f32_16x16x32_bf16 v[216:219], v[40:43], a[232:235], v[216:219]
  v_add_u32 v2, s88, v96
  v_add_u32 v3, s88, v97
  v_mfma_f32_16x16x32_bf16 v[216:219], v[44:47], a[248:251], v[216:219]
  v_add_u32 v4, s88, v98
  v_add_u32 v5, s88, v99
  v_mfma_f32_16x16x32_bf16 v[220:223], v[40:43], a[236:239], v[220:223]
  v_add_u32 v6, s88, v100
  v_mfma_f32_16x16x32_bf16 v[220:223], v[44:47], a[252:255], v[220:223]
  s_waitcnt vmcnt(21)
  s_barrier
  s_waitcnt lgkmcnt(4)
  v_mfma_f32_16x16x32_bf16 v[224:227], v[48:51], a[224:227], v[224:227]
  ds_read_b64_tr_b16 v[32:33], v4 offset:16384
  ds_read_b64_tr_b16 v[34:35], v4 offset:19456
  v_mfma_f32_16x16x32_bf16 v[224:227], v[52:55], a[240:243], v[224:227]
  ds_read_b64_tr_b16 v[36:37], v4 offset:22528
  v_mfma_f32_16x16x32_bf16 v[228:231], v[48:51], a[228:231], v[228:231]
  ds_read_b64_tr_b16 v[38:39], v4 offset:25600
  v_mfma_f32_16x16x32_bf16 v[228:231], v[52:55], a[244:247], v[228:231]
  v_mfma_f32_16x16x32_bf16 v[232:235], v[48:51], a[232:235], v[232:235]
  v_mfma_f32_16x16x32_bf16 v[232:235], v[52:55], a[248:251], v[232:235]
  v_mfma_f32_16x16x32_bf16 v[236:239], v[48:51], a[236:239], v[236:239]
  v_mfma_f32_16x16x32_bf16 v[236:239], v[52:55], a[252:255], v[236:239]
  ds_read_b64_tr_b16 v[40:41], v4 offset:28672
  s_waitcnt lgkmcnt(5)
  v_mfma_f32_16x16x32_bf16 v[240:243], v[56:59], a[224:227], v[240:243]
  ds_read_b64_tr_b16 v[42:43], v4 offset:31744
  v_mfma_f32_16x16x32_bf16 v[240:243], v[60:63], a[240:243], v[240:243]
  ds_read_b64_tr_b16 v[44:45], v4 offset:34816
  v_mfma_f32_16x16x32_bf16 v[244:247], v[56:59], a[228:231], v[244:247]
  ds_read_b64_tr_b16 v[46:47], v4 offset:37888
  v_mfma_f32_16x16x32_bf16 v[244:247], v[60:63], a[244:247], v[244:247]
  v_mfma_f32_16x16x32_bf16 v[248:251], v[56:59], a[232:235], v[248:251]
  v_mfma_f32_16x16x32_bf16 v[248:251], v[60:63], a[248:251], v[248:251]
  v_mfma_f32_16x16x32_bf16 v[252:255], v[56:59], a[236:239], v[252:255]
  v_mfma_f32_16x16x32_bf16 v[252:255], v[60:63], a[252:255], v[252:255]
  s_waitcnt vmcnt(13)
  s_waitcnt lgkmcnt(4)
  v_mfma_f32_16x16x32_bf16 a[0:3], v[32:35], v[64:67], a[0:3]
  ds_read_b64_tr_b16 v[48:49], v5 offset:16384
  ds_read_b64_tr_b16 v[50:51], v5 offset:19456
  v_mfma_f32_16x16x32_bf16 a[0:3], v[36:39], v[80:83], a[0:3]
  s_barrier
  ds_read_b64_tr_b16 v[52:53], v5 offset:22528
  v_mfma_f32_16x16x32_bf16 a[4:7], v[32:35], v[68:71], a[4:7]
  ds_read_b64_tr_b16 v[54:55], v5 offset:25600
  v_mfma_f32_16x16x32_bf16 a[4:7], v[36:39], v[84:87], a[4:7]
  buffer_load_dwordx4 a[224:227], v15, s[24:27], s54 offen offset:0 sc1
  v_mfma_f32_16x16x32_bf16 a[8:11], v[32:35], v[72:75], a[8:11]
  v_mfma_f32_16x16x32_bf16 a[8:11], v[36:39], v[88:91], a[8:11]
  v_mfma_f32_16x16x32_bf16 a[12:15], v[32:35], v[76:79], a[12:15]
  buffer_load_dwordx4 a[240:243], v16, s[24:27], s54 offen offset:0 sc1
  v_mfma_f32_16x16x32_bf16 a[12:15], v[36:39], v[92:95], a[12:15]
  ds_read_b64_tr_b16 v[56:57], v5 offset:28672
  s_waitcnt lgkmcnt(5)
  v_mfma_f32_16x16x32_bf16 a[16:19], v[40:43], v[64:67], a[16:19]
  ds_read_b64_tr_b16 v[58:59], v5 offset:31744
  v_mfma_f32_16x16x32_bf16 a[16:19], v[44:47], v[80:83], a[16:19]
  ds_read_b64_tr_b16 v[60:61], v5 offset:34816
  v_mfma_f32_16x16x32_bf16 a[20:23], v[40:43], v[68:71], a[20:23]
  ds_read_b64_tr_b16 v[62:63], v5 offset:37888
  v_mfma_f32_16x16x32_bf16 a[20:23], v[44:47], v[84:87], a[20:23]
  buffer_load_dwordx4 a[228:231], v15, s[24:27], s54 offen offset:1024 sc1
  v_mfma_f32_16x16x32_bf16 a[24:27], v[40:43], v[72:75], a[24:27]
  v_mfma_f32_16x16x32_bf16 a[24:27], v[44:47], v[88:91], a[24:27]
  v_mfma_f32_16x16x32_bf16 a[28:31], v[40:43], v[76:79], a[28:31]
  buffer_load_dwordx4 a[244:247], v16, s[24:27], s54 offen offset:1024 sc1
  v_mfma_f32_16x16x32_bf16 a[28:31], v[44:47], v[92:95], a[28:31]
  ds_read_b64_tr_b16 v[32:33], v4 offset:17408
  s_waitcnt lgkmcnt(5)
  v_mfma_f32_16x16x32_bf16 a[32:35], v[48:51], v[64:67], a[32:35]
  ds_read_b64_tr_b16 v[34:35], v4 offset:20480
  v_mfma_f32_16x16x32_bf16 a[32:35], v[52:55], v[80:83], a[32:35]
  ds_read_b64_tr_b16 v[36:37], v4 offset:23552
  v_mfma_f32_16x16x32_bf16 a[36:39], v[48:51], v[68:71], a[36:39]
  ds_read_b64_tr_b16 v[38:39], v4 offset:26624
  v_mfma_f32_16x16x32_bf16 a[36:39], v[52:55], v[84:87], a[36:39]
  buffer_load_dwordx4 a[232:235], v15, s[24:27], s54 offen offset:2048 sc1
  v_mfma_f32_16x16x32_bf16 a[40:43], v[48:51], v[72:75], a[40:43]
  v_mfma_f32_16x16x32_bf16 a[40:43], v[52:55], v[88:91], a[40:43]
  v_mfma_f32_16x16x32_bf16 a[44:47], v[48:51], v[76:79], a[44:47]
  buffer_load_dwordx4 a[248:251], v16, s[24:27], s54 offen offset:2048 sc1
  v_mfma_f32_16x16x32_bf16 a[44:47], v[52:55], v[92:95], a[44:47]
  ds_read_b64_tr_b16 v[40:41], v4 offset:29696
  s_waitcnt lgkmcnt(5)
  v_mfma_f32_16x16x32_bf16 a[48:51], v[56:59], v[64:67], a[48:51]
  ds_read_b64_tr_b16 v[42:43], v4 offset:32768
  v_mfma_f32_16x16x32_bf16 a[48:51], v[60:63], v[80:83], a[48:51]
  ds_read_b64_tr_b16 v[44:45], v4 offset:35840
  v_mfma_f32_16x16x32_bf16 a[52:55], v[56:59], v[68:71], a[52:55]
  ds_read_b64_tr_b16 v[46:47], v4 offset:38912
  v_mfma_f32_16x16x32_bf16 a[52:55], v[60:63], v[84:87], a[52:55]
  buffer_load_dwordx4 a[236:239], v15, s[24:27], s54 offen offset:3072 sc1
  v_mfma_f32_16x16x32_bf16 a[56:59], v[56:59], v[72:75], a[56:59]
  v_mfma_f32_16x16x32_bf16 a[56:59], v[60:63], v[88:91], a[56:59]
  v_mfma_f32_16x16x32_bf16 a[60:63], v[56:59], v[76:79], a[60:63]
  buffer_load_dwordx4 a[252:255], v16, s[24:27], s54 offen offset:3072 sc1
  v_mfma_f32_16x16x32_bf16 a[60:63], v[60:63], v[92:95], a[60:63]
  ds_read_b64_tr_b16 v[48:49], v5 offset:17408
  s_waitcnt lgkmcnt(5)
  v_mfma_f32_16x16x32_bf16 a[64:67], v[32:35], v[64:67], a[64:67]
  ds_read_b64_tr_b16 v[50:51], v5 offset:20480
  v_mfma_f32_16x16x32_bf16 a[64:67], v[36:39], v[80:83], a[64:67]
  ds_read_b64_tr_b16 v[52:53], v5 offset:23552
  s_add_u32 s54, s54, 0x2000
  v_mfma_f32_16x16x32_bf16 a[68:71], v[32:35], v[68:71], a[68:71]
  ds_read_b64_tr_b16 v[54:55], v5 offset:26624
  v_mfma_f32_16x16x32_bf16 a[68:71], v[36:39], v[84:87], a[68:71]
  v_mfma_f32_16x16x32_bf16 a[72:75], v[32:35], v[72:75], a[72:75]
  v_mfma_f32_16x16x32_bf16 a[72:75], v[36:39], v[88:91], a[72:75]
  v_mfma_f32_16x16x32_bf16 a[76:79], v[32:35], v[76:79], a[76:79]
  v_mfma_f32_16x16x32_bf16 a[76:79], v[36:39], v[92:95], a[76:79]
  ds_read_b64_tr_b16 v[56:57], v5 offset:29696
  s_waitcnt lgkmcnt(5)
  v_mfma_f32_16x16x32_bf16 a[80:83], v[40:43], v[64:67], a[80:83]
  ds_read_b64_tr_b16 v[58:59], v5 offset:32768
  v_mfma_f32_16x16x32_bf16 a[80:83], v[44:47], v[80:83], a[80:83]
  ds_read_b64_tr_b16 v[60:61], v5 offset:35840
  v_mfma_f32_16x16x32_bf16 a[84:87], v[40:43], v[68:71], a[84:87]
  ds_read_b64_tr_b16 v[62:63], v5 offset:38912
  v_mfma_f32_16x16x32_bf16 a[84:87], v[44:47], v[84:87], a[84:87]
  v_mfma_f32_16x16x32_bf16 a[88:91], v[40:43], v[72:75], a[88:91]
  v_mfma_f32_16x16x32_bf16 a[88:91], v[44:47], v[88:91], a[88:91]
  v_mfma_f32_16x16x32_bf16 a[92:95], v[40:43], v[76:79], a[92:95]
  v_mfma_f32_16x16x32_bf16 a[92:95], v[44:47], v[92:95], a[92:95]
  ds_read_b64_tr_b16 v[32:33], v4 offset:18432
  s_waitcnt lgkmcnt(5)
  v_mfma_f32_16x16x32_bf16 a[96:99], v[48:51], v[64:67], a[96:99]
  ds_read_b64_tr_b16 v[34:35], v4 offset:21504
  v_mfma_f32_16x16x32_bf16 a[96:99], v[52:55], v[80:83], a[96:99]
  ds_read_b64_tr_b16 v[36:37], v4 offset:24576
  v_mfma_f32_16x16x32_bf16 a[100:103], v[48:51], v[68:71], a[100:103]
  ds_read_b64_tr_b16 v[38:39], v4 offset:27648
  v_mfma_f32_16x16x32_bf16 a[100:103], v[52:55], v[84:87], a[100:103]
  v_mfma_f32_16x16x32_bf16 a[104:107], v[48:51], v[72:75], a[104:107]
  v_mfma_f32_16x16x32_bf16 a[104:107], v[52:55], v[88:91], a[104:107]
  v_mfma_f32_16x16x32_bf16 a[108:111], v[48:51], v[76:79], a[108:111]
  v_mfma_f32_16x16x32_bf16 a[108:111], v[52:55], v[92:95], a[108:111]
  s_sub_u32 s91, s91, 1
  s_cbranch_scc0 L_G
  s_waitcnt lgkmcnt(4)
  v_mfma_f32_16x16x32_bf16 a[112:115], v[56:59], v[64:67], a[112:115]
  ds_read_b64_tr_b16 v[40:41], v4 offset:30720
  ds_read_b64_tr_b16 v[42:43], v4 offset:33792
  v_mfma_f32_16x16x32_bf16 a[112:115], v[60:63], v[80:83], a[112:115]
  ds_read_b64_tr_b16 v[44:45], v4 offset:36864
  s_add_u32 m0, s5, 0x20000
  v_mfma_f32_16x16x32_bf16 a[116:119], v[56:59], v[68:71], a[116:119]
  ds_read_b64_tr_b16 v[46:47], v4 offset:39936
  s_mov_b32 s52, s73
  v_mfma_f32_16x16x32_bf16 a[116:119], v[60:63], v[84:87], a[116:119]
  buffer_load_dwordx4 v17, s[28:31], s55 offen offset:0 lds
  v_mfma_f32_16x16x32_bf16 a[120:123], v[56:59], v[72:75], a[120:123]
  s_add_u32 s53, s73, 4096
  s_add_u32 s54, s73, 8192
  v_mfma_f32_16x16x32_bf16 a[120:123], v[60:63], v[88:91], a[120:123]
  s_mov_b32 s3, s59
  s_mov_b32 s70, 0x3e0293ee
  v_mfma_f32_16x16x32_bf16 a[124:127], v[56:59], v[76:79], a[124:127]
  buffer_load_dwordx4 v18, s[28:31], s55 offen offset:1024 lds
  v_mfma_f32_16x16x32_bf16 a[124:127], v[60:63], v[92:95], a[124:127]
  ds_read_b64_tr_b16 v[48:49], v5 offset:18432
  s_waitcnt lgkmcnt(5)
  v_mfma_f32_16x16x32_bf16 a[128:131], v[32:35], v[64:67], a[128:131]
  ds_read_b64_tr_b16 v[50:51], v5 offset:21504
  s_mov_b32 s71, s70
  v_mfma_f32_16x16x32_bf16 a[128:131], v[36:39], v[80:83], a[128:131]
  ds_read_b64_tr_b16 v[52:53], v5 offset:24576
  v_mfma_f32_16x16x32_bf16 a[132:135], v[32:35], v[68:71], a[132:135]
  ds_read_b64_tr_b16 v[54:55], v5 offset:27648
  v_mfma_f32_16x16x32_bf16 a[132:135], v[36:39], v[84:87], a[132:135]
  buffer_load_dwordx4 v19, s[28:31], s55 offen offset:2048 lds
  v_mfma_f32_16x16x32_bf16 a[136:139], v[32:35], v[72:75], a[136:139]
  v_mfma_f32_16x16x32_bf16 a[136:139], v[36:39], v[88:91], a[136:139]
  v_mfma_f32_16x16x32_bf16 a[140:143], v[32:35], v[76:79], a[140:143]
  buffer_load_dwordx4 v20, s[28:31], s55 offen offset:3072 lds
  v_mfma_f32_16x16x32_bf16 a[140:143], v[36:39], v[92:95], a[140:143]
  ds_read_b64_tr_b16 v[56:57], v5 offset:30720
  s_waitcnt lgkmcnt(5)
  v_mfma_f32_16x16x32_bf16 a[144:147], v[40:43], v[64:67], a[144:147]
  ds_read_b64_tr_b16 v[58:59], v5 offset:33792
  v_mfma_f32_16x16x32_bf16 a[144:147], v[44:47], v[80:83], a[144:147]
  ds_read_b64_tr_b16 v[60:61], v5 offset:36864
  s_add_u32 m0, s5, 0x24000
  v_mfma_f32_16x16x32_bf16 a[148:151], v[40:43], v[68:71], a[148:151]
  ds_read_b64_tr_b16 v[62:63], v5 offset:39936
  v_mfma_f32_16x16x32_bf16 a[148:151], v[44:47], v[84:87], a[148:151]
  buffer_load_dwordx4 v21, s[36:39], s55 offen offset:0 lds
  v_mfma_f32_16x16x32_bf16 a[152:155], v[40:43], v[72:75], a[152:155]
  v_mfma_f32_16x16x32_bf16 a[152:155], v[44:47], v[88:91], a[152:155]
  v_mfma_f32_16x16x32_bf16 a[156:159], v[40:43], v[76:79], a[156:159]
  buffer_load_dwordx4 v22, s[36:39], s55 offen offset:1024 lds
  v_mfma_f32_16x16x32_bf16 a[156:159], v[44:47], v[92:95], a[156:159]
  ds_read_b64_tr_b16 v[32:33], v6 offset:40960
  s_waitcnt lgkmcnt(5)
  v_mfma_f32_16x16x32_bf16 a[160:163], v[48:51], v[64:67], a[160:163]
  ds_read_b64_tr_b16 v[34:35], v6 offset:41472
  v_mfma_f32_16x16x32_bf16 a[160:163], v[52:55], v[80:83], a[160:163]
  ds_read_b64_tr_b16 v[36:37], v6 offset:41984
  v_mfma_f32_16x16x32_bf16 a[164:167], v[48:51], v[68:71], a[164:167]
  ds_read_b64_tr_b16 v[38:39], v6 offset:42496
  v_mfma_f32_16x16x32_bf16 a[164:167], v[52:55], v[84:87], a[164:167]
  buffer_load_dwordx4 v23, s[36:39], s55 offen offset:2048 lds
  v_mfma_f32_16x16x32_bf16 a[168:171], v[48:51], v[72:75], a[168:171]
  v_mfma_f32_16x16x32_bf16 a[168:171], v[52:55], v[88:91], a[168:171]
  v_mfma_f32_16x16x32_bf16 a[172:175], v[48:51], v[76:79], a[172:175]
  buffer_load_dwordx4 v24, s[36:39], s55 offen offset:3072 lds
  v_mfma_f32_16x16x32_bf16 a[172:175], v[52:55], v[92:95], a[172:175]
  ds_read_b64_tr_b16 v[40:41], v6 offset:43008
  s_waitcnt lgkmcnt(5)
  v_mfma_f32_16x16x32_bf16 a[176:179], v[56:59], v[64:67], a[176:179]
  ds_read_b64_tr_b16 v[42:43], v6 offset:43520
  v_mfma_f32_16x16x32_bf16 a[176:179], v[60:63], v[80:83], a[176:179]
  ds_read_b64_tr_b16 v[44:45], v6 offset:44032
  s_add_u32 s55, s55, 0x4000
  v_mfma_f32_16x16x32_bf16 a[180:183], v[56:59], v[68:71], a[180:183]
  ds_read_b64_tr_b16 v[46:47], v6 offset:44544
  s_add_u32 m0, s5, 0x18000
  v_mfma_f32_16x16x32_bf16 a[180:183], v[60:63], v[84:87], a[180:183]
  buffer_load_dwordx4 v17, s[28:31], s55 offen offset:0 lds
  v_mfma_f32_16x16x32_bf16 a[184:187], v[56:59], v[72:75], a[184:187]
  v_subrev_u32 v4, 0xb000, v4
  v_subrev_u32 v5, 0xb000, v5
  v_mfma_f32_16x16x32_bf16 a[184:187], v[60:63], v[88:91], a[184:187]
  v_subrev_u32 v6, 0xb000, v6
  v_mfma_f32_16x16x32_bf16 a[188:191], v[56:59], v[76:79], a[188:191]
  buffer_load_dwordx4 v18, s[28:31], s55 offen offset:1024 lds
  v_mfma_f32_16x16x32_bf16 a[188:191], v[60:63], v[92:95], a[188:191]
  s_waitcnt vmcnt(18)
  s_barrier
  s_waitcnt lgkmcnt(4)
  v_mfma_f32_16x16x32_bf16 a[192:195], v[32:35], v[64:67], a[192:195]
  ds_read_b64_tr_b16 v[48:49], v4 offset:16384
  ds_read_b64_tr_b16 v[50:51], v4 offset:19456
  v_mfma_f32_16x16x32_bf16 a[192:195], v[36:39], v[80:83], a[192:195]
  ds_read_b64_tr_b16 v[52:53], v4 offset:22528
  v_mfma_f32_16x16x32_bf16 a[196:199], v[32:35], v[68:71], a[196:199]
  ds_read_b64_tr_b16 v[54:55], v4 offset:25600
  v_mfma_f32_16x16x32_bf16 a[196:199], v[36:39], v[84:87], a[196:199]
  buffer_load_dwordx4 v19, s[28:31], s55 offen offset:2048 lds
  v_mfma_f32_16x16x32_bf16 a[200:203], v[32:35], v[72:75], a[200:203]
  v_mfma_f32_16x16x32_bf16 a[200:203], v[36:39], v[88:91], a[200:203]
  v_mfma_f32_16x16x32_bf16 a[204:207], v[32:35], v[76:79], a[204:207]
  buffer_load_dwordx4 v20, s[28:31], s55 offen offset:3072 lds
  v_mfma_f32_16x16x32_bf16 a[204:207], v[36:39], v[92:95], a[204:207]
  ds_read_b64_tr_b16 v[56:57], v4 offset:28672
  s_waitcnt lgkmcnt(5)
  v_mfma_f32_16x16x32_bf16 a[208:211], v[40:43], v[64:67], a[208:211]
  ds_read_b64_tr_b16 v[58:59], v4 offset:31744
  v_mfma_f32_16x16x32_bf16 a[208:211], v[44:47], v[80:83], a[208:211]
  ds_read_b64_tr_b16 v[60:61], v4 offset:34816
  s_add_u32 m0, s5, 0x1c000
  v_mfma_f32_16x16x32_bf16 a[212:215], v[40:43], v[68:71], a[212:215]
  ds_read_b64_tr_b16 v[62:63], v4 offset:37888
  v_mfma_f32_16x16x32_bf16 a[212:215], v[44:47], v[84:87], a[212:215]
  buffer_load_dwordx4 v21, s[36:39], s55 offen offset:0 lds
  v_mfma_f32_16x16x32_bf16 a[216:219], v[40:43], v[72:75], a[216:219]
  v_mfma_f32_16x16x32_bf16 a[216:219], v[44:47], v[88:91], a[216:219]
  v_mfma_f32_16x16x32_bf16 a[220:223], v[40:43], v[76:79], a[220:223]
  buffer_load_dwordx4 v22, s[36:39], s55 offen offset:1024 lds
  v_mfma_f32_16x16x32_bf16 a[220:223], v[44:47], v[92:95], a[220:223]
  s_waitcnt vmcnt(14)
  s_waitcnt lgkmcnt(4)
  v_mfma_f32_16x16x32_bf16 a[0:3], v[48:51], a[224:227], a[0:3]
  ds_read_b64_tr_b16 v[32:33], v5 offset:16384
  ds_read_b64_tr_b16 v[34:35], v5 offset:19456
  v_mfma_f32_16x16x32_bf16 a[0:3], v[52:55], a[240:243], a[0:3]
  ds_read_b64_tr_b16 v[36:37], v5 offset:22528
  v_mfma_f32_16x16x32_bf16 a[4:7], v[48:51], a[228:231], a[4:7]
  ds_read_b64_tr_b16 v[38:39], v5 offset:25600
  v_mfma_f32_16x16x32_bf16 a[4:7], v[52:55], a[244:247], a[4:7]
  buffer_load_dwordx4 v23, s[36:39], s55 offen offset:2048 lds
  v_mfma_f32_16x16x32_bf16 a[8:11], v[48:51], a[232:235], a[8:11]
  v_mfma_f32_16x16x32_bf16 a[8:11], v[52:55], a[248:251], a[8:11]
  v_mfma_f32_16x16x32_bf16 a[12:15], v[48:51], a[236:239], a[12:15]
  buffer_load_dwordx4 v24, s[36:39], s55 offen offset:3072 lds
  v_mfma_f32_16x16x32_bf16 a[12:15], v[52:55], a[252:255], a[12:15]
  ds_read_b64_tr_b16 v[40:41], v5 offset:28672
  s_waitcnt lgkmcnt(5)
  v_mfma_f32_16x16x32_bf16 a[16:19], v[56:59], a[224:227], a[16:19]
  ds_read_b64_tr_b16 v[42:43], v5 offset:31744
  v_mfma_f32_16x16x32_bf16 a[16:19], v[60:63], a[240:243], a[16:19]
  ds_read_b64_tr_b16 v[44:45], v5 offset:34816
  s_add_u32 s55, s55, 0x4000
  v_mfma_f32_16x16x32_bf16 a[20:23], v[56:59], a[228:231], a[20:23]
  ds_read_b64_tr_b16 v[46:47], v5 offset:37888
  v_mfma_f32_16x16x32_bf16 a[20:23], v[60:63], a[244:247], a[20:23]
  v_mfma_f32_16x16x32_bf16 a[24:27], v[56:59], a[232:235], a[24:27]
  v_mfma_f32_16x16x32_bf16 a[24:27], v[60:63], a[248:251], a[24:27]
  v_mfma_f32_16x16x32_bf16 a[28:31], v[56:59], a[236:239], a[28:31]
  v_mfma_f32_16x16x32_bf16 a[28:31], v[60:63], a[252:255], a[28:31]
  ds_read_b64_tr_b16 v[48:49], v4 offset:17408
  s_waitcnt lgkmcnt(5)
  v_mfma_f32_16x16x32_bf16 a[32:35], v[32:35], a[224:227], a[32:35]
  ds_read_b64_tr_b16 v[50:51], v4 offset:20480
  v_mfma_f32_16x16x32_bf16 a[32:35], v[36:39], a[240:243], a[32:35]
  ds_read_b64_tr_b16 v[52:53], v4 offset:23552
  v_mfma_f32_16x16x32_bf16 a[36:39], v[32:35], a[228:231], a[36:39]
  ds_read_b64_tr_b16 v[54:55], v4 offset:26624
  v_mfma_f32_16x16x32_bf16 a[36:39], v[36:39], a[244:247], a[36:39]
  v_mfma_f32_16x16x32_bf16 a[40:43], v[32:35], a[232:235], a[40:43]
  v_mfma_f32_16x16x32_bf16 a[40:43], v[36:39], a[248:251], a[40:43]
  v_mfma_f32_16x16x32_bf16 a[44:47], v[32:35], a[236:239], a[44:47]
  v_mfma_f32_16x16x32_bf16 a[44:47], v[36:39], a[252:255], a[44:47]
  ds_read_b64_tr_b16 v[56:57], v4 offset:29696
  s_waitcnt lgkmcnt(5)
  v_mfma_f32_16x16x32_bf16 a[48:51], v[40:43], a[224:227], a[48:51]
  ds_read_b64_tr_b16 v[58:59], v4 offset:32768
  v_mfma_f32_16x16x32_bf16 a[48:51], v[44:47], a[240:243], a[48:51]
  ds_read_b64_tr_b16 v[60:61], v4 offset:35840
  v_mfma_f32_16x16x32_bf16 a[52:55], v[40:43], a[228:231], a[52:55]
  ds_read_b64_tr_b16 v[62:63], v4 offset:38912
  v_mfma_f32_16x16x32_bf16 a[52:55], v[44:47], a[244:247], a[52:55]
  v_mfma_f32_16x16x32_bf16 a[56:59], v[40:43], a[232:235], a[56:59]
  v_mfma_f32_16x16x32_bf16 a[56:59], v[44:47], a[248:251], a[56:59]
  v_mfma_f32_16x16x32_bf16 a[60:63], v[40:43], a[236:239], a[60:63]
  v_accvgpr_read_b32 v110, a0
  v_accvgpr_read_b32 v114, a16
  v_mfma_f32_16x16x32_bf16 a[60:63], v[44:47], a[252:255], a[60:63]
  ds_read_b64_tr_b16 v[32:33], v5 offset:17408
  s_waitcnt lgkmcnt(5)
  v_mfma_f32_16x16x32_bf16 a[64:67], v[48:51], a[224:227], a[64:67]
  ds_read_b64_tr_b16 v[34:35], v5 offset:20480
  v_accvgpr_read_b32 v111, a1
  v_mfma_f32_16x16x32_bf16 a[64:67], v[52:55], a[240:243], a[64:67]
  ds_read_b64_tr_b16 v[36:37], v5 offset:23552
  v_accvgpr_read_b32 v115, a17
  v_mfma_f32_16x16x32_bf16 a[68:71], v[48:51], a[228:231], a[68:71]
  ds_read_b64_tr_b16 v[38:39], v5 offset:26624
  v_accvgpr_read_b32 v112, a2
  v_mfma_f32_16x16x32_bf16 a[68:71], v[52:55], a[244:247], a[68:71]
  v_accvgpr_read_b32 v116, a18
  v_accvgpr_read_b32 v113, a3
  v_mfma_f32_16x16x32_bf16 a[72:75], v[48:51], a[232:235], a[72:75]
  v_accvgpr_read_b32 v117, a19
  v_mul_f32 v110, v110, v114
  v_mfma_f32_16x16x32_bf16 a[72:75], v[52:55], a[248:251], a[72:75]
  v_mul_f32 v111, v111, v115
  v_mul_f32 v112, v112, v116
  v_mfma_f32_16x16x32_bf16 a[76:79], v[48:51], a[236:239], a[76:79]
  v_mul_f32 v113, v113, v117
  v_cvt_pk_bf16_f32 v118, v110, v111
  v_mfma_f32_16x16x32_bf16 a[76:79], v[52:55], a[252:255], a[76:79]
  ds_read_b64_tr_b16 v[40:41], v5 offset:29696
  s_waitcnt lgkmcnt(5)
  v_mfma_f32_16x16x32_bf16 a[80:83], v[56:59], a[224:227], a[80:83]
  ds_read_b64_tr_b16 v[42:43], v5 offset:32768
  v_cvt_pk_bf16_f32 v119, v112, v113
  v_mfma_f32_16x16x32_bf16 a[80:83], v[60:63], a[240:243], a[80:83]
  ds_read_b64_tr_b16 v[44:45], v5 offset:35840
  v_accvgpr_read_b32 v110, a32
  v_mfma_f32_16x16x32_bf16 a[84:87], v[56:59], a[228:231], a[84:87]
  ds_read_b64_tr_b16 v[46:47], v5 offset:38912
  v_accvgpr_read_b32 v114, a48
  v_mfma_f32_16x16x32_bf16 a[84:87], v[60:63], a[244:247], a[84:87]
  v_accvgpr_read_b32 v111, a33
  v_accvgpr_read_b32 v115, a49
  v_mfma_f32_16x16x32_bf16 a[88:91], v[56:59], a[232:235], a[88:91]
  v_accvgpr_read_b32 v112, a34
  v_accvgpr_read_b32 v116, a50
  v_mfma_f32_16x16x32_bf16 a[88:91], v[60:63], a[248:251], a[88:91]
  v_accvgpr_read_b32 v113, a35
  v_accvgpr_read_b32 v117, a51
  v_mfma_f32_16x16x32_bf16 a[92:95], v[56:59], a[236:239], a[92:95]
  v_mul_f32 v110, v110, v114
  v_mul_f32 v111, v111, v115
  v_mfma_f32_16x16x32_bf16 a[92:95], v[60:63], a[252:255], a[92:95]
  ds_read_b64_tr_b16 v[48:49], v4 offset:18432
  s_waitcnt lgkmcnt(5)
  v_mfma_f32_16x16x32_bf16 a[96:99], v[32:35], a[224:227], a[96:99]
  ds_read_b64_tr_b16 v[50:51], v4 offset:21504
  v_mul_f32 v112, v112, v116
  v_mfma_f32_16x16x32_bf16 a[96:99], v[36:39], a[240:243], a[96:99]
  ds_read_b64_tr_b16 v[52:53], v4 offset:24576
  v_mul_f32 v113, v113, v117
  v_mfma_f32_16x16x32_bf16 a[100:103], v[32:35], a[228:231], a[100:103]
  ds_read_b64_tr_b16 v[54:55], v4 offset:27648
  v_cvt_pk_bf16_f32 v120, v110, v111
  v_mfma_f32_16x16x32_bf16 a[100:103], v[36:39], a[244:247], a[100:103]
  v_cvt_pk_bf16_f32 v121, v112, v113
  buffer_store_dwordx4 v[118:121], v25, s[44:47], s52 offen offset:0 sc1
  v_mfma_f32_16x16x32_bf16 a[104:107], v[32:35], a[232:235], a[104:107]
  v_accvgpr_read_b32 v110, a4
  v_accvgpr_read_b32 v114, a20
  v_mfma_f32_16x16x32_bf16 a[104:107], v[36:39], a[248:251], a[104:107]
  v_accvgpr_read_b32 v111, a5
  v_accvgpr_read_b32 v115, a21
  v_mfma_f32_16x16x32_bf16 a[108:111], v[32:35], a[236:239], a[108:111]
  v_accvgpr_read_b32 v112, a6
  v_accvgpr_read_b32 v116, a22
  v_mfma_f32_16x16x32_bf16 a[108:111], v[36:39], a[252:255], a[108:111]
  ds_read_b64_tr_b16 v[56:57], v4 offset:30720
  s_waitcnt lgkmcnt(5)
  v_mfma_f32_16x16x32_bf16 a[112:115], v[40:43], a[224:227], a[112:115]
  ds_read_b64_tr_b16 v[58:59], v4 offset:33792
  v_accvgpr_read_b32 v113, a7
  v_mfma_f32_16x16x32_bf16 a[112:115], v[44:47], a[240:243], a[112:115]
  ds_read_b64_tr_b16 v[60:61], v4 offset:36864
  v_accvgpr_read_b32 v117, a23
  v_mfma_f32_16x16x32_bf16 a[116:119], v[40:43], a[228:231], a[116:119]
  ds_read_b64_tr_b16 v[62:63], v4 offset:39936
  v_mul_f32 v110, v110, v114
  v_mfma_f32_16x16x32_bf16 a[116:119], v[44:47], a[244:247], a[116:119]
  v_mul_f32 v111, v111, v115
  v_mul_f32 v112, v112, v116
  v_mfma_f32_16x16x32_bf16 a[120:123], v[40:43], a[232:235], a[120:123]
  v_mul_f32 v113, v113, v117
  v_cvt_pk_bf16_f32 v122, v110, v111
  v_mfma_f32_16x16x32_bf16 a[120:123], v[44:47], a[248:251], a[120:123]
  v_cvt_pk_bf16_f32 v123, v112, v113
  v_accvgpr_read_b32 v110, a36
  v_mfma_f32_16x16x32_bf16 a[124:127], v[40:43], a[236:239], a[124:127]
  v_accvgpr_read_b32 v114, a52
  v_accvgpr_read_b32 v111, a37
  v_mfma_f32_16x16x32_bf16 a[124:127], v[44:47], a[252:255], a[124:127]
  ds_read_b64_tr_b16 v[32:33], v5 offset:18432
  s_waitcnt lgkmcnt(5)
  v_mfma_f32_16x16x32_bf16 a[128:131], v[48:51], a[224:227], a[128:131]
  ds_read_b64_tr_b16 v[34:35], v5 offset:21504
  v_accvgpr_read_b32 v115, a53
  v_mfma_f32_16x16x32_bf16 a[128:131], v[52:55], a[240:243], a[128:131]
  ds_read_b64_tr_b16 v[36:37], v5 offset:24576
  v_accvgpr_read_b32 v112, a38
  v_mfma_f32_16x16x32_bf16 a[132:135], v[48:51], a[228:231], a[132:135]
  ds_read_b64_tr_b16 v[38:39], v5 offset:27648
  v_accvgpr_read_b32 v116, a54
  v_mfma_f32_16x16x32_bf16 a[132:135], v[52:55], a[244:247], a[132:135]
  v_accvgpr_read_b32 v113, a39
  v_accvgpr_read_b32 v117, a55
  v_mfma_f32_16x16x32_bf16 a[136:139], v[48:51], a[232:235], a[136:139]
  v_mul_f32 v110, v110, v114
  v_mul_f32 v111, v111, v115
  v_mfma_f32_16x16x32_bf16 a[136:139], v[52:55], a[248:251], a[136:139]
  v_mul_f32 v112, v112, v116
  v_mul_f32 v113, v113, v117
  v_mfma_f32_16x16x32_bf16 a[140:143], v[48:51], a[236:239], a[140:143]
  v_cvt_pk_bf16_f32 v124, v110, v111
  v_cvt_pk_bf16_f32 v125, v112, v113
  v_mfma_f32_16x16x32_bf16 a[140:143], v[52:55], a[252:255], a[140:143]
  ds_read_b64_tr_b16 v[40:41], v5 offset:30720
  s_waitcnt lgkmcnt(5)
  v_mfma_f32_16x16x32_bf16 a[144:147], v[56:59], a[224:227], a[144:147]
  ds_read_b64_tr_b16 v[42:43], v5 offset:33792
  buffer_store_dwordx4 v[122:125], v25, s[44:47], s52 offen offset:1024 sc1
  v_mfma_f32_16x16x32_bf16 a[144:147], v[60:63], a[240:243], a[144:147]
  ds_read_b64_tr_b16 v[44:45], v5 offset:36864
  v_accvgpr_read_b32 v110, a8
  v_mfma_f32_16x16x32_bf16 a[148:151], v[56:59], a[228:231], a[148:151]
  ds_read_b64_tr_b16 v[46:47], v5 offset:39936
  v_accvgpr_read_b32 v114, a24
  v_mfma_f32_16x16x32_bf16 a[148:151], v[60:63], a[244:247], a[148:151]
  v_accvgpr_read_b32 v111, a9
  v_accvgpr_read_b32 v115, a25
  v_mfma_f32_16x16x32_bf16 a[152:155], v[56:59], a[232:235], a[152:155]
  v_accvgpr_read_b32 v112, a10
  v_accvgpr_read_b32 v116, a26
  v_mfma_f32_16x16x32_bf16 a[152:155], v[60:63], a[248:251], a[152:155]
  v_accvgpr_read_b32 v113, a11
  v_accvgpr_read_b32 v117, a27
  v_mfma_f32_16x16x32_bf16 a[156:159], v[56:59], a[236:239], a[156:159]
  v_mul_f32 v110, v110, v114
  v_mul_f32 v111, v111, v115
  v_mfma_f32_16x16x32_bf16 a[156:159], v[60:63], a[252:255], a[156:159]
  ds_read_b64_tr_b16 v[48:49], v6 offset:40960
  s_waitcnt lgkmcnt(5)
  v_mfma_f32_16x16x32_bf16 a[160:163], v[32:35], a[224:227], a[160:163]
  ds_read_b64_tr_b16 v[50:51], v6 offset:41472
  v_mul_f32 v112, v112, v116
  v_mfma_f32_16x16x32_bf16 a[160:163], v[36:39], a[240:243], a[160:163]
  ds_read_b64_tr_b16 v[52:53], v6 offset:41984
  v_mul_f32 v113, v113, v117
  v_mfma_f32_16x16x32_bf16 a[164:167], v[32:35], a[228:231], a[164:167]
  ds_read_b64_tr_b16 v[54:55], v6 offset:42496
  v_cvt_pk_bf16_f32 v96, v110, v111
  v_mfma_f32_16x16x32_bf16 a[164:167], v[36:39], a[244:247], a[164:167]
  v_cvt_pk_bf16_f32 v97, v112, v113
  v_accvgpr_read_b32 v110, a40
  v_mfma_f32_16x16x32_bf16 a[168:171], v[32:35], a[232:235], a[168:171]
  v_accvgpr_read_b32 v114, a56
  v_accvgpr_read_b32 v111, a41
  v_mfma_f32_16x16x32_bf16 a[168:171], v[36:39], a[248:251], a[168:171]
  v_accvgpr_read_b32 v115, a57
  v_accvgpr_read_b32 v112, a42
  v_mfma_f32_16x16x32_bf16 a[172:175], v[32:35], a[236:239], a[172:175]
  v_accvgpr_read_b32 v116, a58
  v_accvgpr_read_b32 v113, a43
  v_mfma_f32_16x16x32_bf16 a[172:175], v[36:39], a[252:255], a[172:175]
  ds_read_b64_tr_b16 v[56:57], v6 offset:43008
  s_waitcnt lgkmcnt(5)
  v_mfma_f32_16x16x32_bf16 a[176:179], v[40:43], a[224:227], a[176:179]
  ds_read_b64_tr_b16 v[58:59], v6 offset:43520
  v_accvgpr_read_b32 v117, a59
  v_mfma_f32_16x16x32_bf16 a[176:179], v[44:47], a[240:243], a[176:179]
  ds_read_b64_tr_b16 v[60:61], v6 offset:44032
  v_mul_f32 v110, v110, v114
  v_mfma_f32_16x16x32_bf16 a[180:183], v[40:43], a[228:231], a[180:183]
  ds_read_b64_tr_b16 v[62:63], v6 offset:44544
  v_mul_f32 v111, v111, v115
  v_mfma_f32_16x16x32_bf16 a[180:183], v[44:47], a[244:247], a[180:183]
  v_mul_f32 v112, v112, v116
  v_mul_f32 v113, v113, v117
  v_mfma_f32_16x16x32_bf16 a[184:187], v[40:43], a[232:235], a[184:187]
  v_cvt_pk_bf16_f32 v98, v110, v111
  v_cvt_pk_bf16_f32 v99, v112, v113
  v_mfma_f32_16x16x32_bf16 a[184:187], v[44:47], a[248:251], a[184:187]
  buffer_store_dwordx4 v[96:99], v25, s[44:47], s52 offen offset:2048 sc1
  v_accvgpr_read_b32 v110, a12
  v_mfma_f32_16x16x32_bf16 a[188:191], v[40:43], a[236:239], a[188:191]
  v_accvgpr_read_b32 v114, a28
  v_accvgpr_read_b32 v111, a13
  v_mfma_f32_16x16x32_bf16 a[188:191], v[44:47], a[252:255], a[188:191]
  ds_read_b64_tr_b16 v[32:33], v2 offset:0
  s_waitcnt lgkmcnt(5)
  v_mfma_f32_16x16x32_bf16 a[192:195], v[48:51], a[224:227], a[192:195]
  ds_read_b64_tr_b16 v[34:35], v2 offset:2048
  v_accvgpr_read_b32 v115, a29
  v_mfma_f32_16x16x32_bf16 a[192:195], v[52:55], a[240:243], a[192:195]
  ds_read_b64_tr_b16 v[36:37], v2 offset:4096
  v_accvgpr_read_b32 v112, a14
  v_mfma_f32_16x16x32_bf16 a[196:199], v[48:51], a[228:231], a[196:199]
  ds_read_b64_tr_b16 v[38:39], v2 offset:6144
  v_accvgpr_read_b32 v116, a30
  v_mfma_f32_16x16x32_bf16 a[196:199], v[52:55], a[244:247], a[196:199]
  v_accvgpr_read_b32 v113, a15
  v_accvgpr_read_b32 v117, a31
  v_mfma_f32_16x16x32_bf16 a[200:203], v[48:51], a[232:235], a[200:203]
  v_mul_f32 v110, v110, v114
  v_mul_f32 v111, v111, v115
  v_mfma_f32_16x16x32_bf16 a[200:203], v[52:55], a[248:251], a[200:203]
  v_mul_f32 v112, v112, v116
  v_mul_f32 v113, v113, v117
  v_mfma_f32_16x16x32_bf16 a[204:207], v[48:51], a[236:239], a[204:207]
  v_cvt_pk_bf16_f32 v118, v110, v111
  v_cvt_pk_bf16_f32 v119, v112, v113
  v_mfma_f32_16x16x32_bf16 a[204:207], v[52:55], a[252:255], a[204:207]
  ds_read_b64_tr_b16 v[40:41], v3 offset:0
  s_waitcnt lgkmcnt(5)
  v_mfma_f32_16x16x32_bf16 a[208:211], v[56:59], a[224:227], a[208:211]
  ds_read_b64_tr_b16 v[42:43], v3 offset:2048
  v_accvgpr_read_b32 v110, a44
  v_mfma_f32_16x16x32_bf16 a[208:211], v[60:63], a[240:243], a[208:211]
  ds_read_b64_tr_b16 v[44:45], v3 offset:4096
  v_accvgpr_read_b32 v114, a60
  v_mfma_f32_16x16x32_bf16 a[212:215], v[56:59], a[228:231], a[212:215]
  ds_read_b64_tr_b16 v[46:47], v3 offset:6144
  v_accvgpr_read_b32 v111, a45
  v_mfma_f32_16x16x32_bf16 a[212:215], v[60:63], a[244:247], a[212:215]
  v_accvgpr_read_b32 v115, a61
  v_accvgpr_read_b32 v112, a46
  v_mfma_f32_16x16x32_bf16 a[216:219], v[56:59], a[232:235], a[216:219]
  v_accvgpr_read_b32 v116, a62
  v_accvgpr_read_b32 v113, a47
  v_mfma_f32_16x16x32_bf16 a[216:219], v[60:63], a[248:251], a[216:219]
  v_accvgpr_read_b32 v117, a63
  v_mul_f32 v110, v110, v114
  v_mfma_f32_16x16x32_bf16 a[220:223], v[56:59], a[236:239], a[220:223]
  v_mul_f32 v111, v111, v115
  v_mul_f32 v112, v112, v116
  v_mfma_f32_16x16x32_bf16 a[220:223], v[60:63], a[252:255], a[220:223]
  ds_read_b64_tr_b16 v[48:49], v2 offset:512
  s_waitcnt lgkmcnt(5)
  v_mfma_f32_16x16x32_bf16 v[128:131], v[32:35], v[64:67], v[128:131]
  ds_read_b64_tr_b16 v[50:51], v2 offset:2560
  v_mul_f32 v113, v113, v117
  v_mfma_f32_16x16x32_bf16 v[128:131], v[36:39], v[80:83], v[128:131]
  ds_read_b64_tr_b16 v[52:53], v2 offset:4608
  v_cvt_pk_bf16_f32 v120, v110, v111
  v_mfma_f32_16x16x32_bf16 v[132:135], v[32:35], v[68:71], v[132:135]
  ds_read_b64_tr_b16 v[54:55], v2 offset:6656
  v_cvt_pk_bf16_f32 v121, v112, v113
  v_mfma_f32_16x16x32_bf16 v[132:135], v[36:39], v[84:87], v[132:135]
  buffer_store_dwordx4 v[118:121], v25, s[44:47], s52 offen offset:3072 sc1
  v_accvgpr_read_b32 v110, a64
  v_mfma_f32_16x16x32_bf16 v[136:139], v[32:35], v[72:75], v[136:139]
  v_accvgpr_read_b32 v114, a80
  v_accvgpr_read_b32 v111, a65
  v_mfma_f32_16x16x32_bf16 v[136:139], v[36:39], v[88:91], v[136:139]
  v_accvgpr_read_b32 v115, a81
  v_accvgpr_read_b32 v112, a66
  v_mfma_f32_16x16x32_bf16 v[140:143], v[32:35], v[76:79], v[140:143]
  v_accvgpr_read_b32 v116, a82
  v_accvgpr_read_b32 v113, a67
  v_mfma_f32_16x16x32_bf16 v[140:143], v[36:39], v[92:95], v[140:143]
  ds_read_b64_tr_b16 v[56:57], v3 offset:512
  s_waitcnt lgkmcnt(5)
  v_mfma_f32_16x16x32_bf16 v[144:147], v[40:43], v[64:67], v[144:147]
  ds_read_b64_tr_b16 v[58:59], v3 offset:2560
  v_accvgpr_read_b32 v117, a83
  v_mfma_f32_16x16x32_bf16 v[144:147], v[44:47], v[80:83], v[144:147]
  ds_read_b64_tr_b16 v[60:61], v3 offset:4608
  v_mul_f32 v110, v110, v114
  v_mfma_f32_16x16x32_bf16 v[148:151], v[40:43], v[68:71], v[148:151]
  ds_read_b64_tr_b16 v[62:63], v3 offset:6656
  v_mul_f32 v111, v111, v115
  v_mfma_f32_16x16x32_bf16 v[148:151], v[44:47], v[84:87], v[148:151]
  v_mul_f32 v112, v112, v116
  v_mul_f32 v113, v113, v117
  v_mfma_f32_16x16x32_bf16 v[152:155], v[40:43], v[72:75], v[152:155]
  v_cvt_pk_bf16_f32 v122, v110, v111
  v_cvt_pk_bf16_f32 v123, v112, v113
  v_mfma_f32_16x16x32_bf16 v[152:155], v[44:47], v[88:91], v[152:155]
  v_accvgpr_read_b32 v110, a96
  v_accvgpr_read_b32 v114, a112
  v_mfma_f32_16x16x32_bf16 v[156:159], v[40:43], v[76:79], v[156:159]
  v_accvgpr_read_b32 v111, a97
  v_accvgpr_read_b32 v115, a113
  v_mfma_f32_16x16x32_bf16 v[156:159], v[44:47], v[92:95], v[156:159]
  ds_read_b64_tr_b16 v[32:33], v2 offset:8192
  s_waitcnt lgkmcnt(5)
  v_mfma_f32_16x16x32_bf16 v[160:163], v[48:51], v[64:67], v[160:163]
  ds_read_b64_tr_b16 v[34:35], v2 offset:10240
  v_accvgpr_read_b32 v112, a98
  v_mfma_f32_16x16x32_bf16 v[160:163], v[52:55], v[80:83], v[160:163]
  ds_read_b64_tr_b16 v[36:37], v2 offset:12288
  v_accvgpr_read_b32 v116, a114
  v_mfma_f32_16x16x32_bf16 v[164:167], v[48:51], v[68:71], v[164:167]
  ds_read_b64_tr_b16 v[38:39], v2 offset:14336
  v_accvgpr_read_b32 v113, a99
  v_mfma_f32_16x16x32_bf16 v[164:167], v[52:55], v[84:87], v[164:167]
  v_accvgpr_read_b32 v117, a115
  v_mul_f32 v110, v110, v114
  v_mfma_f32_16x16x32_bf16 v[168:171], v[48:51], v[72:75], v[168:171]
  v_mul_f32 v111, v111, v115
  v_mul_f32 v112, v112, v116
  v_mfma_f32_16x16x32_bf16 v[168:171], v[52:55], v[88:91], v[168:171]
  v_mul_f32 v113, v113, v117
  v_cvt_pk_bf16_f32 v124, v110, v111
  v_mfma_f32_16x16x32_bf16 v[172:175], v[48:51], v[76:79], v[172:175]
  v_cvt_pk_bf16_f32 v125, v112, v113
  buffer_store_dwordx4 v[122:125], v25, s[44:47], s53 offen offset:0 sc1
  v_mfma_f32_16x16x32_bf16 v[172:175], v[52:55], v[92:95], v[172:175]
  ds_read_b64_tr_b16 v[40:41], v3 offset:8192
  s_waitcnt lgkmcnt(5)
  v_mfma_f32_16x16x32_bf16 v[176:179], v[56:59], v[64:67], v[176:179]
  ds_read_b64_tr_b16 v[42:43], v3 offset:10240
  v_accvgpr_read_b32 v110, a68
  v_mfma_f32_16x16x32_bf16 v[176:179], v[60:63], v[80:83], v[176:179]
  ds_read_b64_tr_b16 v[44:45], v3 offset:12288
  v_accvgpr_read_b32 v114, a84
  v_mfma_f32_16x16x32_bf16 v[180:183], v[56:59], v[68:71], v[180:183]
  ds_read_b64_tr_b16 v[46:47], v3 offset:14336
  v_accvgpr_read_b32 v111, a69
  v_mfma_f32_16x16x32_bf16 v[180:183], v[60:63], v[84:87], v[180:183]
  v_accvgpr_read_b32 v115, a85
  v_accvgpr_read_b32 v112, a70
  v_mfma_f32_16x16x32_bf16 v[184:187], v[56:59], v[72:75], v[184:187]
  v_accvgpr_read_b32 v116, a86
  v_accvgpr_read_b32 v113, a71
  v_mfma_f32_16x16x32_bf16 v[184:187], v[60:63], v[88:91], v[184:187]
  v_accvgpr_read_b32 v117, a87
  v_mul_f32 v110, v110, v114
  v_mfma_f32_16x16x32_bf16 v[188:191], v[56:59], v[76:79], v[188:191]
  v_mul_f32 v111, v111, v115
  v_mul_f32 v112, v112, v116
  v_mfma_f32_16x16x32_bf16 v[188:191], v[60:63], v[92:95], v[188:191]
  ds_read_b64_tr_b16 v[48:49], v2 offset:8704
  s_waitcnt lgkmcnt(5)
  v_mfma_f32_16x16x32_bf16 v[192:195], v[32:35], v[64:67], v[192:195]
  ds_read_b64_tr_b16 v[50:51], v2 offset:10752
  v_mul_f32 v113, v113, v117
  v_mfma_f32_16x16x32_bf16 v[192:195], v[36:39], v[80:83], v[192:195]
  ds_read_b64_tr_b16 v[52:53], v2 offset:12800
  v_cvt_pk_bf16_f32 v96, v110, v111
  v_mfma_f32_16x16x32_bf16 v[196:199], v[32:35], v[68:71], v[196:199]
  ds_read_b64_tr_b16 v[54:55], v2 offset:14848
  v_cvt_pk_bf16_f32 v97, v112, v113
  v_mfma_f32_16x16x32_bf16 v[196:199], v[36:39], v[84:87], v[196:199]
  v_accvgpr_read_b32 v110, a100
  v_accvgpr_read_b32 v114, a116
  v_mfma_f32_16x16x32_bf16 v[200:203], v[32:35], v[72:75], v[200:203]
  v_accvgpr_read_b32 v111, a101
  v_accvgpr_read_b32 v115, a117
  v_mfma_f32_16x16x32_bf16 v[200:203], v[36:39], v[88:91], v[200:203]
  v_accvgpr_read_b32 v112, a102
  v_accvgpr_read_b32 v116, a118
  v_mfma_f32_16x16x32_bf16 v[204:207], v[32:35], v[76:79], v[204:207]
  v_accvgpr_read_b32 v113, a103
  v_accvgpr_read_b32 v117, a119
  v_mfma_f32_16x16x32_bf16 v[204:207], v[36:39], v[92:95], v[204:207]
  ds_read_b64_tr_b16 v[56:57], v3 offset:8704
  s_waitcnt lgkmcnt(5)
  v_mfma_f32_16x16x32_bf16 v[208:211], v[40:43], v[64:67], v[208:211]
  ds_read_b64_tr_b16 v[58:59], v3 offset:10752
  v_mul_f32 v110, v110, v114
  v_mfma_f32_16x16x32_bf16 v[208:211], v[44:47], v[80:83], v[208:211]
  ds_read_b64_tr_b16 v[60:61], v3 offset:12800
  v_mul_f32 v111, v111, v115
  v_mfma_f32_16x16x32_bf16 v[212:215], v[40:43], v[68:71], v[212:215]
  ds_read_b64_tr_b16 v[62:63], v3 offset:14848
  v_mul_f32 v112, v112, v116
  v_mfma_f32_16x16x32_bf16 v[212:215], v[44:47], v[84:87], v[212:215]
  v_mul_f32 v113, v113, v117
  v_cvt_pk_bf16_f32 v98, v110, v111
  v_mfma_f32_16x16x32_bf16 v[216:219], v[40:43], v[72:75], v[216:219]
  v_subrev_u32 v2, 0xb000, v2
  v_subrev_u32 v3, 0xb000, v3
  v_mfma_f32_16x16x32_bf16 v[216:219], v[44:47], v[88:91], v[216:219]
  v_cvt_pk_bf16_f32 v99, v112, v113
  buffer_store_dwordx4 v[96:99], v25, s[44:47], s53 offen offset:1024 sc1
  v_mfma_f32_16x16x32_bf16 v[220:223], v[40:43], v[76:79], v[220:223]
  v_accvgpr_read_b32 v110, a72
  v_accvgpr_read_b32 v114, a88
  v_mfma_f32_16x16x32_bf16 v[220:223], v[44:47], v[92:95], v[220:223]
  ds_read_b64_tr_b16 v[32:33], v2 offset:0
  s_waitcnt lgkmcnt(5)
  v_mfma_f32_16x16x32_bf16 v[224:227], v[48:51], v[64:67], v[224:227]
  ds_read_b64_tr_b16 v[34:35], v2 offset:2048
  v_accvgpr_read_b32 v111, a73
  v_mfma_f32_16x16x32_bf16 v[224:227], v[52:55], v[80:83], v[224:227]
  ds_read_b64_tr_b16 v[36:37], v2 offset:4096
  v_accvgpr_read_b32 v115, a89
  v_mfma_f32_16x16x32_bf16 v[228:231], v[48:51], v[68:71], v[228:231]
  ds_read_b64_tr_b16 v[38:39], v2 offset:6144
  v_accvgpr_read_b32 v112, a74
  v_mfma_f32_16x16x32_bf16 v[228:231], v[52:55], v[84:87], v[228:231]
  v_accvgpr_read_b32 v116, a90
  v_accvgpr_read_b32 v113, a75
  v_mfma_f32_16x16x32_bf16 v[232:235], v[48:51], v[72:75], v[232:235]
  v_accvgpr_read_b32 v117, a91
  v_mul_f32 v110, v110, v114
  v_mfma_f32_16x16x32_bf16 v[232:235], v[52:55], v[88:91], v[232:235]
  v_mul_f32 v111, v111, v115
  v_mul_f32 v112, v112, v116
  v_mfma_f32_16x16x32_bf16 v[236:239], v[48:51], v[76:79], v[236:239]
  v_mul_f32 v113, v113, v117
  v_cvt_pk_bf16_f32 v118, v110, v111
  v_mfma_f32_16x16x32_bf16 v[236:239], v[52:55], v[92:95], v[236:239]
  ds_read_b64_tr_b16 v[40:41], v3 offset:0
  s_waitcnt lgkmcnt(5)
  v_mfma_f32_16x16x32_bf16 v[240:243], v[56:59], v[64:67], v[240:243]
  ds_read_b64_tr_b16 v[42:43], v3 offset:2048
  v_cvt_pk_bf16_f32 v119, v112, v113
  v_mfma_f32_16x16x32_bf16 v[240:243], v[60:63], v[80:83], v[240:243]
  ds_read_b64_tr_b16 v[44:45], v3 offset:4096
  v_accvgpr_read_b32 v110, a104
  v_mfma_f32_16x16x32_bf16 v[244:247], v[56:59], v[68:71], v[244:247]
  ds_read_b64_tr_b16 v[46:47], v3 offset:6144
  v_accvgpr_read_b32 v114, a120
  v_mfma_f32_16x16x32_bf16 v[244:247], v[60:63], v[84:87], v[244:247]
  v_accvgpr_read_b32 v111, a105
  v_accvgpr_read_b32 v115, a121
  v_mfma_f32_16x16x32_bf16 v[248:251], v[56:59], v[72:75], v[248:251]
  v_accvgpr_read_b32 v112, a106
  v_accvgpr_read_b32 v116, a122
  v_mfma_f32_16x16x32_bf16 v[248:251], v[60:63], v[88:91], v[248:251]
  v_accvgpr_read_b32 v113, a107
  v_accvgpr_read_b32 v117, a123
  v_mfma_f32_16x16x32_bf16 v[252:255], v[56:59], v[76:79], v[252:255]
  v_mul_f32 v110, v110, v114
  v_mul_f32 v111, v111, v115
  v_mfma_f32_16x16x32_bf16 v[252:255], v[60:63], v[92:95], v[252:255]
  ds_read_b64_tr_b16 v[48:49], v2 offset:512
  s_waitcnt lgkmcnt(5)
  v_mfma_f32_16x16x32_bf16 v[128:131], v[32:35], a[224:227], v[128:131]
  ds_read_b64_tr_b16 v[50:51], v2 offset:2560
  v_mul_f32 v112, v112, v116
  v_mfma_f32_16x16x32_bf16 v[128:131], v[36:39], a[240:243], v[128:131]
  ds_read_b64_tr_b16 v[52:53], v2 offset:4608
  v_mul_f32 v113, v113, v117
  v_mfma_f32_16x16x32_bf16 v[132:135], v[32:35], a[228:231], v[132:135]
  ds_read_b64_tr_b16 v[54:55], v2 offset:6656
  v_cvt_pk_bf16_f32 v120, v110, v111
  v_mfma_f32_16x16x32_bf16 v[132:135], v[36:39], a[244:247], v[132:135]
  v_cvt_pk_bf16_f32 v121, v112, v113
  buffer_store_dwordx4 v[118:121], v25, s[44:47], s53 offen offset:2048 sc1
  v_mfma_f32_16x16x32_bf16 v[136:139], v[32:35], a[232:235], v[136:139]
  v_accvgpr_read_b32 v110, a76
  v_accvgpr_read_b32 v114, a92
  v_mfma_f32_16x16x32_bf16 v[136:139], v[36:39], a[248:251], v[136:139]
  v_accvgpr_read_b32 v111, a77
  v_accvgpr_read_b32 v115, a93
  v_mfma_f32_16x16x32_bf16 v[140:143], v[32:35], a[236:239], v[140:143]
  v_accvgpr_read_b32 v112, a78
  v_accvgpr_read_b32 v116, a94
  v_mfma_f32_16x16x32_bf16 v[140:143], v[36:39], a[252:255], v[140:143]
  ds_read_b64_tr_b16 v[56:57], v3 offset:512
  s_waitcnt lgkmcnt(5)
  v_mfma_f32_16x16x32_bf16 v[144:147], v[40:43], a[224:227], v[144:147]
  ds_read_b64_tr_b16 v[58:59], v3 offset:2560
  v_accvgpr_read_b32 v113, a79
  v_mfma_f32_16x16x32_bf16 v[144:147], v[44:47], a[240:243], v[144:147]
  ds_read_b64_tr_b16 v[60:61], v3 offset:4608
  v_accvgpr_read_b32 v117, a95
  v_mfma_f32_16x16x32_bf16 v[148:151], v[40:43], a[228:231], v[148:151]
  ds_read_b64_tr_b16 v[62:63], v3 offset:6656
  v_mul_f32 v110, v110, v114
  v_mfma_f32_16x16x32_bf16 v[148:151], v[44:47], a[244:247], v[148:151]
  v_mul_f32 v111, v111, v115
  v_mul_f32 v112, v112, v116
  v_mfma_f32_16x16x32_bf16 v[152:155], v[40:43], a[232:235], v[152:155]
  v_mul_f32 v113, v113, v117
  v_cvt_pk_bf16_f32 v122, v110, v111
  v_mfma_f32_16x16x32_bf16 v[152:155], v[44:47], a[248:251], v[152:155]
  v_cvt_pk_bf16_f32 v123, v112, v113
  v_accvgpr_read_b32 v110, a108
  v_mfma_f32_16x16x32_bf16 v[156:159], v[40:43], a[236:239], v[156:159]
  v_accvgpr_read_b32 v114, a124
  v_accvgpr_read_b32 v111, a109
  v_mfma_f32_16x16x32_bf16 v[156:159], v[44:47], a[252:255], v[156:159]
  ds_read_b64_tr_b16 v[32:33], v2 offset:8192
  s_waitcnt lgkmcnt(5)
  v_mfma_f32_16x16x32_bf16 v[160:163], v[48:51], a[224:227], v[160:163]
  ds_read_b64_tr_b16 v[34:35], v2 offset:10240
  v_accvgpr_read_b32 v115, a125
  v_mfma_f32_16x16x32_bf16 v[160:163], v[52:55], a[240:243], v[160:163]
  ds_read_b64_tr_b16 v[36:37], v2 offset:12288
  v_accvgpr_read_b32 v112, a110
  v_mfma_f32_16x16x32_bf16 v[164:167], v[48:51], a[228:231], v[164:167]
  ds_read_b64_tr_b16 v[38:39], v2 offset:14336
  v_accvgpr_read_b32 v116, a126
  v_mfma_f32_16x16x32_bf16 v[164:167], v[52:55], a[244:247], v[164:167]
  v_accvgpr_read_b32 v113, a111
  v_accvgpr_read_b32 v117, a127
  v_mfma_f32_16x16x32_bf16 v[168:171], v[48:51], a[232:235], v[168:171]
  v_mul_f32 v110, v110, v114
  v_mul_f32 v111, v111, v115
  v_mfma_f32_16x16x32_bf16 v[168:171], v[52:55], a[248:251], v[168:171]
  v_mul_f32 v112, v112, v116
  v_mul_f32 v113, v113, v117
  v_mfma_f32_16x16x32_bf16 v[172:175], v[48:51], a[236:239], v[172:175]
  v_cvt_pk_bf16_f32 v124, v110, v111
  v_cvt_pk_bf16_f32 v125, v112, v113
  v_mfma_f32_16x16x32_bf16 v[172:175], v[52:55], a[252:255], v[172:175]
  ds_read_b64_tr_b16 v[40:41], v3 offset:8192
  s_waitcnt lgkmcnt(5)
  v_mfma_f32_16x16x32_bf16 v[176:179], v[56:59], a[224:227], v[176:179]
  ds_read_b64_tr_b16 v[42:43], v3 offset:10240
  buffer_store_dwordx4 v[122:125], v25, s[44:47], s53 offen offset:3072 sc1
  v_mfma_f32_16x16x32_bf16 v[176:179], v[60:63], a[240:243], v[176:179]
  ds_read_b64_tr_b16 v[44:45], v3 offset:12288
  v_accvgpr_read_b32 v110, a128
  v_mfma_f32_16x16x32_bf16 v[180:183], v[56:59], a[228:231], v[180:183]
  ds_read_b64_tr_b16 v[46:47], v3 offset:14336
  v_accvgpr_read_b32 v114, a144
  v_mfma_f32_16x16x32_bf16 v[180:183], v[60:63], a[244:247], v[180:183]
  v_accvgpr_read_b32 v111, a129
  v_accvgpr_read_b32 v115, a145
  v_mfma_f32_16x16x32_bf16 v[184:187], v[56:59], a[232:235], v[184:187]
  v_accvgpr_read_b32 v112, a130
  v_accvgpr_read_b32 v116, a146
  v_mfma_f32_16x16x32_bf16 v[184:187], v[60:63], a[248:251], v[184:187]
  v_accvgpr_read_b32 v113, a131
  v_accvgpr_read_b32 v117, a147
  v_mfma_f32_16x16x32_bf16 v[188:191], v[56:59], a[236:239], v[188:191]
  v_mul_f32 v110, v110, v114
  v_mul_f32 v111, v111, v115
  v_mfma_f32_16x16x32_bf16 v[188:191], v[60:63], a[252:255], v[188:191]
  ds_read_b64_tr_b16 v[48:49], v2 offset:8704
  s_waitcnt lgkmcnt(5)
  v_mfma_f32_16x16x32_bf16 v[192:195], v[32:35], a[224:227], v[192:195]
  ds_read_b64_tr_b16 v[50:51], v2 offset:10752
  v_mul_f32 v112, v112, v116
  v_mfma_f32_16x16x32_bf16 v[192:195], v[36:39], a[240:243], v[192:195]
  ds_read_b64_tr_b16 v[52:53], v2 offset:12800
  v_mul_f32 v113, v113, v117
  v_mfma_f32_16x16x32_bf16 v[196:199], v[32:35], a[228:231], v[196:199]
  ds_read_b64_tr_b16 v[54:55], v2 offset:14848
  v_cvt_pk_bf16_f32 v96, v110, v111
  v_mfma_f32_16x16x32_bf16 v[196:199], v[36:39], a[244:247], v[196:199]
  v_cvt_pk_bf16_f32 v97, v112, v113
  v_accvgpr_read_b32 v110, a160
  v_mfma_f32_16x16x32_bf16 v[200:203], v[32:35], a[232:235], v[200:203]
  v_accvgpr_read_b32 v114, a176
  v_accvgpr_read_b32 v111, a161
  v_mfma_f32_16x16x32_bf16 v[200:203], v[36:39], a[248:251], v[200:203]
  v_accvgpr_read_b32 v115, a177
  v_accvgpr_read_b32 v112, a162
  v_mfma_f32_16x16x32_bf16 v[204:207], v[32:35], a[236:239], v[204:207]
  v_accvgpr_read_b32 v116, a178
  v_accvgpr_read_b32 v113, a163
  v_mfma_f32_16x16x32_bf16 v[204:207], v[36:39], a[252:255], v[204:207]
  ds_read_b64_tr_b16 v[56:57], v3 offset:8704
  s_waitcnt lgkmcnt(5)
  v_mfma_f32_16x16x32_bf16 v[208:211], v[40:43], a[224:227], v[208:211]
  ds_read_b64_tr_b16 v[58:59], v3 offset:10752
  v_accvgpr_read_b32 v117, a179
  v_mfma_f32_16x16x32_bf16 v[208:211], v[44:47], a[240:243], v[208:211]
  ds_read_b64_tr_b16 v[60:61], v3 offset:12800
  v_mul_f32 v110, v110, v114
  v_mfma_f32_16x16x32_bf16 v[212:215], v[40:43], a[228:231], v[212:215]
  ds_read_b64_tr_b16 v[62:63], v3 offset:14848
  v_mul_f32 v111, v111, v115
  v_mfma_f32_16x16x32_bf16 v[212:215], v[44:47], a[244:247], v[212:215]
  v_mul_f32 v112, v112, v116
  v_mul_f32 v113, v113, v117
  v_mfma_f32_16x16x32_bf16 v[216:219], v[40:43], a[232:235], v[216:219]
  v_cvt_pk_bf16_f32 v98, v110, v111
  v_cvt_pk_bf16_f32 v99, v112, v113
  v_mfma_f32_16x16x32_bf16 v[216:219], v[44:47], a[248:251], v[216:219]
  buffer_store_dwordx4 v[96:99], v25, s[44:47], s54 offen offset:0 sc1
  v_accvgpr_read_b32 v110, a132
  v_mfma_f32_16x16x32_bf16 v[220:223], v[40:43], a[236:239], v[220:223]
  v_accvgpr_read_b32 v114, a148
  v_accvgpr_read_b32 v111, a133
  v_mfma_f32_16x16x32_bf16 v[220:223], v[44:47], a[252:255], v[220:223]
  v_accvgpr_read_b32 v115, a149
  s_waitcnt lgkmcnt(4)
  v_mfma_f32_16x16x32_bf16 v[224:227], v[48:51], a[224:227], v[224:227]
  v_accvgpr_read_b32 v112, a134
  v_accvgpr_read_b32 v116, a150
  v_mfma_f32_16x16x32_bf16 v[224:227], v[52:55], a[240:243], v[224:227]
  v_accvgpr_read_b32 v113, a135
  v_accvgpr_read_b32 v117, a151
  v_mfma_f32_16x16x32_bf16 v[228:231], v[48:51], a[228:231], v[228:231]
  v_mul_f32 v110, v110, v114
  v_mul_f32 v111, v111, v115
  v_mfma_f32_16x16x32_bf16 v[228:231], v[52:55], a[244:247], v[228:231]
  v_mul_f32 v112, v112, v116
  v_mul_f32 v113, v113, v117
  v_mfma_f32_16x16x32_bf16 v[232:235], v[48:51], a[232:235], v[232:235]
  v_cvt_pk_bf16_f32 v118, v110, v111
  v_cvt_pk_bf16_f32 v119, v112, v113
  v_mfma_f32_16x16x32_bf16 v[232:235], v[52:55], a[248:251], v[232:235]
  v_accvgpr_read_b32 v110, a164
  v_accvgpr_read_b32 v114, a180
  v_mfma_f32_16x16x32_bf16 v[236:239], v[48:51], a[236:239], v[236:239]
  v_accvgpr_read_b32 v111, a165
  v_accvgpr_read_b32 v115, a181
  v_mfma_f32_16x16x32_bf16 v[236:239], v[52:55], a[252:255], v[236:239]
  v_accvgpr_read_b32 v112, a166
  s_waitcnt lgkmcnt(0)
  v_mfma_f32_16x16x32_bf16 v[240:243], v[56:59], a[224:227], v[240:243]
  v_accvgpr_read_b32 v116, a182
  v_accvgpr_read_b32 v113, a167
  v_mfma_f32_16x16x32_bf16 v[240:243], v[60:63], a[240:243], v[240:243]
  v_accvgpr_read_b32 v117, a183
  v_mul_f32 v110, v110, v114
  v_mfma_f32_16x16x32_bf16 v[244:247], v[56:59], a[228:231], v[244:247]
  v_mul_f32 v111, v111, v115
  v_mul_f32 v112, v112, v116
  v_mfma_f32_16x16x32_bf16 v[244:247], v[60:63], a[244:247], v[244:247]
  v_mul_f32 v113, v113, v117
  v_cvt_pk_bf16_f32 v120, v110, v111
  v_mfma_f32_16x16x32_bf16 v[248:251], v[56:59], a[232:235], v[248:251]
  v_cvt_pk_bf16_f32 v121, v112, v113
  buffer_store_dwordx4 v[118:121], v25, s[44:47], s54 offen offset:1024 sc1
  v_mfma_f32_16x16x32_bf16 v[248:251], v[60:63], a[248:251], v[248:251]
  v_accvgpr_read_b32 v110, a136
  v_accvgpr_read_b32 v114, a152
  v_mfma_f32_16x16x32_bf16 v[252:255], v[56:59], a[236:239], v[252:255]
  v_accvgpr_read_b32 v111, a137
  v_accvgpr_read_b32 v115, a153
  v_mfma_f32_16x16x32_bf16 v[252:255], v[60:63], a[252:255], v[252:255]
  s_nop 7
  v_accvgpr_read_b32 v112, a138
  v_accvgpr_read_b32 v116, a154
  v_accvgpr_read_b32 v113, a139
  v_accvgpr_read_b32 v117, a155
  v_pk_mul_f32 v[110:111], v[110:111], v[114:115]
  v_pk_mul_f32 v[112:113], v[112:113], v[116:117]
  v_cvt_pk_bf16_f32 v122, v110, v111
  v_cvt_pk_bf16_f32 v123, v112, v113
  v_accvgpr_read_b32 v110, a168
  v_accvgpr_read_b32 v114, a184
  v_accvgpr_read_b32 v111, a169
  v_accvgpr_read_b32 v115, a185
  v_accvgpr_read_b32 v112, a170
  v_accvgpr_read_b32 v116, a186
  v_accvgpr_read_b32 v113, a171
  v_accvgpr_read_b32 v117, a187
  v_pk_mul_f32 v[110:111], v[110:111], v[114:115]
  v_pk_mul_f32 v[112:113], v[112:113], v[116:117]
  v_cvt_pk_bf16_f32 v124, v110, v111
  v_cvt_pk_bf16_f32 v125, v112, v113
  buffer_store_dwordx4 v[122:125], v25, s[44:47], s54 offen offset:2048 sc1
  v_accvgpr_read_b32 v110, a140
  v_accvgpr_read_b32 v114, a156
  v_accvgpr_read_b32 v111, a141
  v_accvgpr_read_b32 v115, a157
  v_accvgpr_read_b32 v112, a142
  v_accvgpr_read_b32 v116, a158
  v_accvgpr_read_b32 v113, a143
  v_accvgpr_read_b32 v117, a159
  v_pk_mul_f32 v[110:111], v[110:111], v[114:115]
  v_pk_mul_f32 v[112:113], v[112:113], v[116:117]
  v_cvt_pk_bf16_f32 v96, v110, v111
  v_cvt_pk_bf16_f32 v97, v112, v113
  v_accvgpr_read_b32 v110, a172
  v_accvgpr_read_b32 v114, a188
  v_accvgpr_read_b32 v111, a173
  v_accvgpr_read_b32 v115, a189
  v_accvgpr_read_b32 v112, a174
  v_accvgpr_read_b32 v116, a190
  v_accvgpr_read_b32 v113, a175
  v_accvgpr_read_b32 v117, a191
  v_pk_mul_f32 v[110:111], v[110:111], v[114:115]
  v_pk_mul_f32 v[112:113], v[112:113], v[116:117]
  v_cvt_pk_bf16_f32 v98, v110, v111
  v_cvt_pk_bf16_f32 v99, v112, v113
  buffer_store_dwordx4 v[96:99], v25, s[44:47], s54 offen offset:3072 sc1
  v_accvgpr_read_b32 v110, a192
  v_accvgpr_read_b32 v114, a208
  v_accvgpr_read_b32 v111, a193
  v_accvgpr_read_b32 v115, a209
  v_accvgpr_read_b32 v112, a194
  v_accvgpr_read_b32 v116, a210
  v_accvgpr_read_b32 v113, a195
  v_accvgpr_read_b32 v117, a211
  v_pk_mul_f32 v[110:111], v[110:111], v[114:115]
  v_pk_mul_f32 v[112:113], v[112:113], v[116:117]
  v_cvt_pk_bf16_f32 v118, v110, v111
  v_cvt_pk_bf16_f32 v119, v112, v113
  buffer_store_dwordx2 v[118:119], v25, s[44:47], s3 offen offset:0 sc1
  v_accvgpr_read_b32 v110, a196
  v_accvgpr_read_b32 v114, a212
  v_accvgpr_read_b32 v111, a197
  v_accvgpr_read_b32 v115, a213
  v_accvgpr_read_b32 v112, a198
  v_accvgpr_read_b32 v116, a214
  v_accvgpr_read_b32 v113, a199
  v_accvgpr_read_b32 v117, a215
  v_pk_mul_f32 v[110:111], v[110:111], v[114:115]
  v_pk_mul_f32 v[112:113], v[112:113], v[116:117]
  v_cvt_pk_bf16_f32 v122, v110, v111
  v_cvt_pk_bf16_f32 v123, v112, v113
  buffer_store_dwordx2 v[122:123], v25, s[44:47], s3 offen offset:1024 sc1
  v_accvgpr_read_b32 v110, a200
  v_accvgpr_read_b32 v114, a216
  v_accvgpr_read_b32 v111, a201
  v_accvgpr_read_b32 v115, a217
  v_accvgpr_read_b32 v112, a202
  v_accvgpr_read_b32 v116, a218
  v_accvgpr_read_b32 v113, a203
  v_accvgpr_read_b32 v117, a219
  v_pk_mul_f32 v[110:111], v[110:111], v[114:115]
  v_pk_mul_f32 v[112:113], v[112:113], v[116:117]
  v_cvt_pk_bf16_f32 v96, v110, v111
  v_cvt_pk_bf16_f32 v97, v112, v113
  buffer_store_dwordx2 v[96:97], v25, s[44:47], s3 offen offset:2048 sc1
  v_accvgpr_read_b32 v110, a204
  v_accvgpr_read_b32 v114, a220
  v_accvgpr_read_b32 v111, a205
  v_accvgpr_read_b32 v115, a221
  v_accvgpr_read_b32 v112, a206
  v_accvgpr_read_b32 v116, a222
  v_accvgpr_read_b32 v113, a207
  v_accvgpr_read_b32 v117, a223
  v_pk_mul_f32 v[110:111], v[110:111], v[114:115]
  v_pk_mul_f32 v[112:113], v[112:113], v[116:117]
  v_cvt_pk_bf16_f32 v118, v110, v111
  v_cvt_pk_bf16_f32 v119, v112, v113
  buffer_store_dwordx2 v[118:119], v25, s[44:47], s3 offen offset:3072 sc1
  v_pk_mul_f32 v[128:129], v[128:129], s[70:71]
  v_pk_mul_f32 v[130:131], v[130:131], s[70:71]
  v_pk_mul_f32 v[144:145], v[144:145], s[70:71]
  v_pk_mul_f32 v[146:147], v[146:147], s[70:71]
  v_cvt_pk_bf16_f32 v128, v128, v129
  v_cvt_pk_bf16_f32 v129, v130, v131
  v_cvt_pk_bf16_f32 v130, v144, v145
  v_cvt_pk_bf16_f32 v131, v146, v147
  v_pk_mul_f32 v[132:133], v[132:133], s[70:71]
  v_pk_mul_f32 v[134:135], v[134:135], s[70:71]
  v_pk_mul_f32 v[148:149], v[148:149], s[70:71]
  v_pk_mul_f32 v[150:151], v[150:151], s[70:71]
  v_cvt_pk_bf16_f32 v132, v132, v133
  v_cvt_pk_bf16_f32 v133, v134, v135
  v_cvt_pk_bf16_f32 v134, v148, v149
  v_cvt_pk_bf16_f32 v135, v150, v151
  v_pk_mul_f32 v[136:137], v[136:137], s[70:71]
  v_pk_mul_f32 v[138:139], v[138:139], s[70:71]
  v_pk_mul_f32 v[152:153], v[152:153], s[70:71]
  v_pk_mul_f32 v[154:155], v[154:155], s[70:71]
  v_cvt_pk_bf16_f32 v136, v136, v137
  v_cvt_pk_bf16_f32 v137, v138, v139
  v_cvt_pk_bf16_f32 v138, v152, v153
  v_cvt_pk_bf16_f32 v139, v154, v155
  v_pk_mul_f32 v[140:141], v[140:141], s[70:71]
  v_pk_mul_f32 v[142:143], v[142:143], s[70:71]
  v_pk_mul_f32 v[156:157], v[156:157], s[70:71]
  v_pk_mul_f32 v[158:159], v[158:159], s[70:71]
  v_cvt_pk_bf16_f32 v140, v140, v141
  v_cvt_pk_bf16_f32 v141, v142, v143
  v_cvt_pk_bf16_f32 v142, v156, v157
  v_cvt_pk_bf16_f32 v143, v158, v159
  s_mov_b64 exec, s[56:57]
  v_swap_b32 v128, v130
  v_swap_b32 v129, v131
  v_swap_b32 v132, v134
  v_swap_b32 v133, v135
  v_swap_b32 v136, v138
  v_swap_b32 v137, v139
  v_swap_b32 v140, v142
  v_swap_b32 v141, v143
  s_mov_b64 exec, -1
  v_pk_mul_f32 v[160:161], v[160:161], s[70:71]
  v_pk_mul_f32 v[162:163], v[162:163], s[70:71]
  v_pk_mul_f32 v[176:177], v[176:177], s[70:71]
  v_pk_mul_f32 v[178:179], v[178:179], s[70:71]
  v_cvt_pk_bf16_f32 v160, v160, v161
  v_cvt_pk_bf16_f32 v161, v162, v163
  v_cvt_pk_bf16_f32 v162, v176, v177
  v_cvt_pk_bf16_f32 v163, v178, v179
  v_pk_mul_f32 v[164:165], v[164:165], s[70:71]
  v_pk_mul_f32 v[166:167], v[166:167], s[70:71]
  v_pk_mul_f32 v[180:181], v[180:181], s[70:71]
  v_pk_mul_f32 v[182:183], v[182:183], s[70:71]
  v_cvt_pk_bf16_f32 v164, v164, v165
  v_cvt_pk_bf16_f32 v165, v166, v167
  v_cvt_pk_bf16_f32 v166, v180, v181
  v_cvt_pk_bf16_f32 v167, v182, v183
  v_pk_mul_f32 v[168:169], v[168:169], s[70:71]
  v_pk_mul_f32 v[170:171], v[170:171], s[70:71]
  v_pk_mul_f32 v[184:185], v[184:185], s[70:71]
  v_pk_mul_f32 v[186:187], v[186:187], s[70:71]
  v_cvt_pk_bf16_f32 v168, v168, v169
  v_cvt_pk_bf16_f32 v169, v170, v171
  v_cvt_pk_bf16_f32 v170, v184, v185
  v_cvt_pk_bf16_f32 v171, v186, v187
  v_pk_mul_f32 v[172:173], v[172:173], s[70:71]
  v_pk_mul_f32 v[174:175], v[174:175], s[70:71]
  v_pk_mul_f32 v[188:189], v[188:189], s[70:71]
  v_pk_mul_f32 v[190:191], v[190:191], s[70:71]
  v_cvt_pk_bf16_f32 v172, v172, v173
  v_cvt_pk_bf16_f32 v173, v174, v175
  v_cvt_pk_bf16_f32 v174, v188, v189
  v_cvt_pk_bf16_f32 v175, v190, v191
  s_mov_b64 exec, s[56:57]
  v_swap_b32 v160, v162
  v_swap_b32 v161, v163
  v_swap_b32 v164, v166
  v_swap_b32 v165, v167
  v_swap_b32 v168, v170
  v_swap_b32 v169, v171
  v_swap_b32 v172, v174
  v_swap_b32 v173, v175
  s_mov_b64 exec, -1
  v_pk_mul_f32 v[192:193], v[192:193], s[70:71]
  v_pk_mul_f32 v[194:195], v[194:195], s[70:71]
  v_pk_mul_f32 v[208:209], v[208:209], s[70:71]
  v_pk_mul_f32 v[210:211], v[210:211], s[70:71]
  v_cvt_pk_bf16_f32 v192, v192, v193
  v_cvt_pk_bf16_f32 v193, v194, v195
  v_cvt_pk_bf16_f32 v194, v208, v209
  v_cvt_pk_bf16_f32 v195, v210, v211
  v_pk_mul_f32 v[196:197], v[196:197], s[70:71]
  v_pk_mul_f32 v[198:199], v[198:199], s[70:71]
  v_pk_mul_f32 v[212:213], v[212:213], s[70:71]
  v_pk_mul_f32 v[214:215], v[214:215], s[70:71]
  v_cvt_pk_bf16_f32 v196, v196, v197
  v_cvt_pk_bf16_f32 v197, v198, v199
  v_cvt_pk_bf16_f32 v198, v212, v213
  v_cvt_pk_bf16_f32 v199, v214, v215
  v_pk_mul_f32 v[200:201], v[200:201], s[70:71]
  v_pk_mul_f32 v[202:203], v[202:203], s[70:71]
  v_pk_mul_f32 v[216:217], v[216:217], s[70:71]
  v_pk_mul_f32 v[218:219], v[218:219], s[70:71]
  v_cvt_pk_bf16_f32 v200, v200, v201
  v_cvt_pk_bf16_f32 v201, v202, v203
  v_cvt_pk_bf16_f32 v202, v216, v217
  v_cvt_pk_bf16_f32 v203, v218, v219
  v_pk_mul_f32 v[204:205], v[204:205], s[70:71]
  v_pk_mul_f32 v[206:207], v[206:207], s[70:71]
  v_pk_mul_f32 v[220:221], v[220:221], s[70:71]
  v_pk_mul_f32 v[222:223], v[222:223], s[70:71]
  v_cvt_pk_bf16_f32 v204, v204, v205
  v_cvt_pk_bf16_f32 v205, v206, v207
  v_cvt_pk_bf16_f32 v206, v220, v221
  v_cvt_pk_bf16_f32 v207, v222, v223
  s_mov_b64 exec, s[56:57]
  v_swap_b32 v192, v194
  v_swap_b32 v193, v195
  v_swap_b32 v196, v198
  v_swap_b32 v197, v199
  v_swap_b32 v200, v202
  v_swap_b32 v201, v203
  v_swap_b32 v204, v206
  v_swap_b32 v205, v207
  s_mov_b64 exec, -1
  v_mul_f32 v224, s70, v224
  v_mul_f32 v225, s70, v225
  v_mul_f32 v226, s70, v226
  v_mul_f32 v227, s70, v227
  v_mul_f32 v240, s70, v240
  v_mul_f32 v241, s70, v241
  v_mul_f32 v242, s70, v242
  v_mul_f32 v243, s70, v243
  v_cvt_pk_bf16_f32 v224, v224, v225
  v_cvt_pk_bf16_f32 v225, v226, v227
  v_cvt_pk_bf16_f32 v226, v240, v241
  v_cvt_pk_bf16_f32 v227, v242, v243
  v_mul_f32 v228, s70, v228
  v_mul_f32 v229, s70, v229
  v_mul_f32 v230, s70, v230
  v_mul_f32 v231, s70, v231
  v_mul_f32 v244, s70, v244
  v_mul_f32 v245, s70, v245
  v_mul_f32 v246, s70, v246
  v_mul_f32 v247, s70, v247
  v_cvt_pk_bf16_f32 v228, v228, v229
  v_cvt_pk_bf16_f32 v229, v230, v231
  v_cvt_pk_bf16_f32 v230, v244, v245
  v_cvt_pk_bf16_f32 v231, v246, v247
  v_mul_f32 v232, s70, v232
  v_mul_f32 v233, s70, v233
  v_mul_f32 v234, s70, v234
  v_mul_f32 v235, s70, v235
  v_mul_f32 v248, s70, v248
  v_mul_f32 v249, s70, v249
  v_mul_f32 v250, s70, v250
  v_mul_f32 v251, s70, v251
  v_cvt_pk_bf16_f32 v232, v232, v233
  v_cvt_pk_bf16_f32 v233, v234, v235
  v_cvt_pk_bf16_f32 v234, v248, v249
  v_cvt_pk_bf16_f32 v235, v250, v251
  v_mul_f32 v236, s70, v236
  v_mul_f32 v237, s70, v237
  v_mul_f32 v238, s70, v238
  v_mul_f32 v239, s70, v239
  v_mul_f32 v252, s70, v252
  v_mul_f32 v253, s70, v253
  v_mul_f32 v254, s70, v254
  v_mul_f32 v255, s70, v255
  v_cvt_pk_bf16_f32 v236, v236, v237
  v_cvt_pk_bf16_f32 v237, v238, v239
  v_cvt_pk_bf16_f32 v238, v252, v253
  v_cvt_pk_bf16_f32 v239, v254, v255
  s_mov_b64 exec, s[56:57]
  v_swap_b32 v224, v226
  v_swap_b32 v225, v227
  v_swap_b32 v228, v230
  v_swap_b32 v229, v231
  v_swap_b32 v232, v234
  v_swap_b32 v233, v235
  v_swap_b32 v236, v238
  v_swap_b32 v237, v239
  s_mov_b64 exec, -1
  v_mov_b32 v11, v105
  v_xor_b32 v12, 64, v105
  v_xor_b32 v13, 0x80, v105
  v_xor_b32 v14, 0xc0, v105
  s_mov_b32 s100, 0xffff8000
  s_mov_b32 s101, 0x20000
  s_add_u32 s4, s5, 0x20000
  s_waitcnt vmcnt(28)
  s_barrier
  ds_read_b128 v[64:67], v11 offset:0
  ds_read_b128 v[68:71], v12 offset:0
  ds_read_b128 v[72:75], v13 offset:0
  ds_read_b128 v[76:79], v14 offset:0
  ds_read_b128 v[80:83], v11 offset:4096
  ds_read_b128 v[84:87], v12 offset:4096
  ds_read_b128 v[88:91], v13 offset:4096
  ds_read_b128 v[92:95], v14 offset:4096
  s_add_u32 m0, s5, 0x10000
  s_nop 0
  buffer_load_dwordx4 v17, s[28:31], s55 offen offset:0 lds
  buffer_load_dwordx4 v18, s[28:31], s55 offen offset:1024 lds
  s_waitcnt lgkmcnt(4)
  v_mfma_f32_16x16x32_bf16 v[144:147], v[64:67], v[128:131], 0
  v_mov_b32 v15, v106
  v_mov_b32 v16, v107
  v_mfma_f32_16x16x32_bf16 v[144:147], v[68:71], v[160:163], v[144:147]
  v_mov_b32 v7, v101
  v_mov_b32 v8, v102
  v_mfma_f32_16x16x32_bf16 v[144:147], v[72:75], v[192:195], v[144:147]
  v_mov_b32 v9, v103
  v_mov_b32 v10, v104
  v_mfma_f32_16x16x32_bf16 v[144:147], v[76:79], v[224:227], v[144:147]
  v_mov_b32 v127, v108
  s_waitcnt lgkmcnt(0)
  v_mfma_f32_16x16x32_bf16 v[176:179], v[80:83], v[128:131], 0
  ds_read_b128 a[144:147], v11 offset:8192
  ds_read_b128 a[148:151], v12 offset:8192
  v_mfma_f32_16x16x32_bf16 v[176:179], v[84:87], v[160:163], v[176:179]
  buffer_load_dwordx4 v19, s[28:31], s55 offen offset:2048 lds
  v_mfma_f32_16x16x32_bf16 v[176:179], v[88:91], v[192:195], v[176:179]
  v_and_b32 v120, 3, v1
  v_cmp_eq_u32 vcc, 0, v120
  v_mfma_f32_16x16x32_bf16 v[176:179], v[92:95], v[224:227], v[176:179]
  ds_read_b128 a[152:155], v13 offset:8192
  ds_read_b128 a[156:159], v14 offset:8192
  v_mfma_f32_16x16x32_bf16 v[148:151], v[64:67], v[132:135], 0
  buffer_load_dwordx4 v20, s[28:31], s55 offen offset:3072 lds
  v_mfma_f32_16x16x32_bf16 v[148:151], v[68:71], v[164:167], v[148:151]
  v_mov_b32 v121, 0x3f803f80
  v_add_u32 v26, 0x1000, v25
  v_mfma_f32_16x16x32_bf16 v[148:151], v[72:75], v[196:199], v[148:151]
  v_cndmask_b32 v112, 0, v121, vcc
  v_cndmask_b32 v113, 0, v121, vcc
  v_mfma_f32_16x16x32_bf16 v[148:151], v[76:79], v[228:231], v[148:151]
  ds_read_b128 a[160:163], v11 offset:12288
  ds_read_b128 a[164:167], v12 offset:12288
  v_mfma_f32_16x16x32_bf16 v[180:183], v[80:83], v[132:135], 0
  s_add_u32 m0, s5, 0x14000
  v_max3_f32 v116, v144, v145, v146
  v_mfma_f32_16x16x32_bf16 v[180:183], v[84:87], v[164:167], v[180:183]
  buffer_load_dwordx4 v21, s[36:39], s55 offen offset:0 lds
  v_mfma_f32_16x16x32_bf16 v[180:183], v[88:91], v[196:199], v[180:183]
  v_max3_f32 v117, v147, v176, v177
  v_max3_f32 v116, v116, v178, v179
  v_mfma_f32_16x16x32_bf16 v[180:183], v[92:95], v[228:231], v[180:183]
  ds_read_b128 a[168:171], v13 offset:12288
  ds_read_b128 a[172:175], v14 offset:12288
  v_mfma_f32_16x16x32_bf16 v[152:155], v[64:67], v[136:139], 0
  buffer_load_dwordx4 v22, s[36:39], s55 offen offset:1024 lds
  v_mfma_f32_16x16x32_bf16 v[152:155], v[68:71], v[168:171], v[152:155]
  v_max_f32 v116, v116, v117
  v_mov_b32 v117, v116
  v_mfma_f32_16x16x32_bf16 v[152:155], v[72:75], v[200:203], v[152:155]
  s_nop 1
  v_permlane16_swap_b32 v116, v117
  v_mfma_f32_16x16x32_bf16 v[152:155], v[76:79], v[232:235], v[152:155]
  buffer_load_dwordx4 v23, s[36:39], s55 offen offset:2048 lds
  v_mfma_f32_16x16x32_bf16 v[184:187], v[80:83], v[136:139], 0
  v_max_f32 v116, v116, v117
  v_mov_b32 v117, v116
  v_mfma_f32_16x16x32_bf16 v[184:187], v[84:87], v[168:171], v[184:187]
  s_nop 1
  v_permlane32_swap_b32 v116, v117
  v_mfma_f32_16x16x32_bf16 v[184:187], v[88:91], v[200:203], v[184:187]
  buffer_load_dwordx4 v24, s[36:39], s55 offen offset:3072 lds
  v_mfma_f32_16x16x32_bf16 v[184:187], v[92:95], v[232:235], v[184:187]
  v_max_f32 v116, v116, v117
  v_sub_f32 v96, 0, v116
  v_mfma_f32_16x16x32_bf16 v[156:159], v[64:67], v[140:143], 0
  v_sub_f32 v97, 0, v116
  v_sub_f32 v98, 0, v116
  v_mfma_f32_16x16x32_bf16 v[156:159], v[68:71], v[172:175], v[156:159]
  s_add_u32 s55, s55, 0x4000
  v_sub_f32 v99, 0, v116
  v_mfma_f32_16x16x32_bf16 v[156:159], v[72:75], v[204:207], v[156:159]
  v_sub_f32 v144, v144, v116
  v_sub_f32 v145, v145, v116
  v_mfma_f32_16x16x32_bf16 v[156:159], v[76:79], v[236:239], v[156:159]
  v_sub_f32 v146, v146, v116
  v_sub_f32 v147, v147, v116
  v_mfma_f32_16x16x32_bf16 v[188:191], v[80:83], v[140:143], 0
  v_sub_f32 v176, v176, v116
  v_sub_f32 v177, v177, v116
  v_mfma_f32_16x16x32_bf16 v[188:191], v[84:87], v[172:175], v[188:191]
  v_sub_f32 v178, v178, v116
  v_sub_f32 v179, v179, v116
  v_mfma_f32_16x16x32_bf16 v[188:191], v[88:91], v[204:207], v[188:191]
  v_max3_f32 v118, v148, v149, v150
  v_max3_f32 v119, v151, v180, v181
  v_mfma_f32_16x16x32_bf16 v[188:191], v[92:95], v[236:239], v[188:191]
  v_max3_f32 v118, v118, v182, v183
  s_waitcnt lgkmcnt(4)
  v_mfma_f32_16x16x32_bf16 v[208:211], a[144:147], v[128:131], v[96:99]
  v_max_f32 v118, v118, v119
  v_mov_b32 v119, v118
  v_mfma_f32_16x16x32_bf16 v[208:211], a[148:151], v[160:163], v[208:211]
  s_nop 1
  v_permlane16_swap_b32 v118, v119
  v_mfma_f32_16x16x32_bf16 v[208:211], a[152:155], v[192:195], v[208:211]
  v_max_f32 v118, v118, v119
  v_mov_b32 v119, v118
  v_mfma_f32_16x16x32_bf16 v[208:211], a[156:159], v[224:227], v[208:211]
  s_nop 1
  s_waitcnt lgkmcnt(0)
  v_mfma_f32_16x16x32_bf16 v[240:243], a[160:163], v[128:131], v[96:99]
  v_permlane32_swap_b32 v118, v119
  v_max_f32 v118, v118, v119
  v_mfma_f32_16x16x32_bf16 v[240:243], a[164:167], v[160:163], v[240:243]
  v_sub_f32 v100, 0, v118
  v_sub_f32 v101, 0, v118
  v_sub_f32 v102, 0, v118
  v_sub_f32 v103, 0, v118
  v_mfma_f32_16x16x32_bf16 v[240:243], a[168:171], v[192:195], v[240:243]
  v_sub_f32 v148, v148, v118
  v_sub_f32 v149, v149, v118
  v_mfma_f32_16x16x32_bf16 v[240:243], a[172:175], v[224:227], v[240:243]
  v_sub_f32 v150, v150, v118
  v_sub_f32 v151, v151, v118
  v_mfma_f32_16x16x32_bf16 v[212:215], a[144:147], v[132:135], v[100:103]
  v_sub_f32 v180, v180, v118
  v_sub_f32 v181, v181, v118
  v_mfma_f32_16x16x32_bf16 v[212:215], a[148:151], v[164:167], v[212:215]
  v_sub_f32 v182, v182, v118
  v_sub_f32 v183, v183, v118
  v_mfma_f32_16x16x32_bf16 v[212:215], a[152:155], v[196:199], v[212:215]
  v_max3_f32 v116, v152, v153, v154
  v_max3_f32 v117, v155, v184, v185
  v_mfma_f32_16x16x32_bf16 v[212:215], a[156:159], v[228:231], v[212:215]
  v_max3_f32 v116, v116, v186, v187
  v_max_f32 v116, v116, v117
  v_mfma_f32_16x16x32_bf16 v[244:247], a[160:163], v[132:135], v[100:103]
  v_mov_b32 v117, v116
  s_nop 1
  v_mfma_f32_16x16x32_bf16 v[244:247], a[164:167], v[164:167], v[244:247]
  v_permlane16_swap_b32 v116, v117
  v_max_f32 v116, v116, v117
  v_mov_b32 v117, v116
  s_nop 1
  v_permlane32_swap_b32 v116, v117
  v_max_f32 v116, v116, v117
  v_sub_f32 v104, 0, v116
  v_sub_f32 v105, 0, v116
  v_sub_f32 v106, 0, v116
  v_sub_f32 v107, 0, v116
  v_mfma_f32_16x16x32_bf16 v[244:247], a[168:171], v[196:199], v[244:247]
  v_sub_f32 v152, v152, v116
  v_sub_f32 v153, v153, v116
  v_mfma_f32_16x16x32_bf16 v[244:247], a[172:175], v[228:231], v[244:247]
  v_sub_f32 v154, v154, v116
  v_sub_f32 v155, v155, v116
  v_mfma_f32_16x16x32_bf16 v[216:219], a[144:147], v[136:139], v[104:107]
  v_sub_f32 v184, v184, v116
  v_sub_f32 v185, v185, v116
  v_mfma_f32_16x16x32_bf16 v[216:219], a[148:151], v[168:171], v[216:219]
  v_sub_f32 v186, v186, v116
  v_sub_f32 v187, v187, v116
  v_mfma_f32_16x16x32_bf16 v[216:219], a[152:155], v[200:203], v[216:219]
  s_waitcnt vmcnt(8)
  s_barrier
  v_mfma_f32_16x16x32_bf16 v[216:219], a[156:159], v[232:235], v[216:219]
  s_mov_b32 s59, s100
  v_add_u32 v15, s59, v15
  v_mfma_f32_16x16x32_bf16 v[248:251], a[160:163], v[136:139], v[104:107]
  v_add_u32 v16, s59, v16
  ds_read_b64_tr_b16 v[32:33], v15 offset:0
  v_mfma_f32_16x16x32_bf16 v[248:251], a[164:167], v[168:171], v[248:251]
  ds_read_b64_tr_b16 v[34:35], v15 offset:2048
  v_mov_b32 v126, 2
  v_max3_f32 v118, v156, v157, v158
  v_max3_f32 v119, v159, v188, v189
  v_max3_f32 v118, v118, v190, v191
  v_max_f32 v118, v118, v119
  v_mov_b32 v119, v118
  s_nop 1
  v_permlane16_swap_b32 v118, v119
  v_max_f32 v118, v118, v119
  v_mov_b32 v119, v118
  s_nop 1
  v_permlane32_swap_b32 v118, v119
  v_max_f32 v118, v118, v119
  v_sub_f32 v108, 0, v118
  v_sub_f32 v109, 0, v118
  v_sub_f32 v110, 0, v118
  v_sub_f32 v111, 0, v118
  v_mfma_f32_16x16x32_bf16 v[248:251], a[168:171], v[200:203], v[248:251]
  buffer_store_byte v126, v29, s[64:67], 0 offen sc1
  v_mfma_f32_16x16x32_bf16 v[248:251], a[172:175], v[232:235], v[248:251]
  ds_read_b64_tr_b16 v[36:37], v16 offset:0
  ds_read_b64_tr_b16 v[38:39], v16 offset:2048
  v_mfma_f32_16x16x32_bf16 v[220:223], a[144:147], v[140:143], v[108:111]
  v_sub_f32 v156, v156, v118
  v_sub_f32 v157, v157, v118
  v_mfma_f32_16x16x32_bf16 v[220:223], a[148:151], v[172:175], v[220:223]
  v_sub_f32 v158, v158, v118
  v_sub_f32 v159, v159, v118
  v_sub_f32 v188, v188, v118
  v_sub_f32 v189, v189, v118
  v_sub_f32 v190, v190, v118
  v_sub_f32 v191, v191, v118
  v_mfma_f32_16x16x32_bf16 v[220:223], a[152:155], v[204:207], v[220:223]
  v_exp_f32 v144, v144
  v_mfma_f32_16x16x32_bf16 v[220:223], a[156:159], v[236:239], v[220:223]
  ds_read_b64_tr_b16 v[40:41], v15 offset:512
  ds_read_b64_tr_b16 v[42:43], v15 offset:2560
  v_mfma_f32_16x16x32_bf16 v[252:255], a[160:163], v[140:143], v[108:111]
  v_exp_f32 v145, v145
  v_mfma_f32_16x16x32_bf16 v[252:255], a[164:167], v[172:175], v[252:255]
  v_exp_f32 v146, v146
  v_exp_f32 v147, v147
  v_exp_f32 v176, v176
  v_exp_f32 v177, v177
  v_exp_f32 v178, v178
  v_exp_f32 v179, v179
  v_exp_f32 v148, v148
  v_exp_f32 v149, v149
  v_exp_f32 v150, v150
  v_exp_f32 v151, v151
  v_exp_f32 v180, v180
  v_exp_f32 v181, v181
  v_exp_f32 v182, v182
  v_exp_f32 v183, v183
  v_exp_f32 v152, v152
  v_exp_f32 v153, v153
  v_exp_f32 v154, v154
  v_exp_f32 v155, v155
  v_exp_f32 v184, v184
  v_exp_f32 v185, v185
  v_exp_f32 v186, v186
  v_exp_f32 v187, v187
  v_exp_f32 v156, v156
  v_exp_f32 v157, v157
  v_exp_f32 v158, v158
  v_exp_f32 v159, v159
  v_exp_f32 v188, v188
  v_exp_f32 v189, v189
  v_exp_f32 v190, v190
  v_exp_f32 v191, v191
  v_mfma_f32_16x16x32_bf16 v[252:255], a[168:171], v[204:207], v[252:255]
  v_cvt_pk_bf16_f32 v144, v144, v145
  v_cvt_pk_bf16_f32 v145, v146, v147
  v_cvt_pk_bf16_f32 v146, v176, v177
  v_cvt_pk_bf16_f32 v147, v178, v179
  v_cvt_pk_bf16_f32 v148, v148, v149
  v_cvt_pk_bf16_f32 v149, v150, v151
  v_cvt_pk_bf16_f32 v150, v180, v181
  v_cvt_pk_bf16_f32 v151, v182, v183
  v_cvt_pk_bf16_f32 v152, v152, v153
  v_cvt_pk_bf16_f32 v153, v154, v155
  v_cvt_pk_bf16_f32 v154, v184, v185
  v_cvt_pk_bf16_f32 v155, v186, v187
  v_cvt_pk_bf16_f32 v156, v156, v157
  v_cvt_pk_bf16_f32 v157, v158, v159
  v_cvt_pk_bf16_f32 v158, v188, v189
  v_cvt_pk_bf16_f32 v159, v190, v191
  v_mfma_f32_16x16x32_bf16 v[252:255], a[172:175], v[236:239], v[252:255]
  ds_read_b64_tr_b16 v[44:45], v16 offset:512
  s_waitcnt lgkmcnt(3)
  v_mfma_f32_16x16x32_bf16 a[0:3], v[32:35], v[144:147], 0
  ds_read_b64_tr_b16 v[46:47], v16 offset:2560
  v_cndmask_b32 v114, 0, v121, vcc
  v_mfma_f32_16x16x32_bf16 a[4:7], v[32:35], v[148:151], 0
  v_cndmask_b32 v115, 0, v121, vcc
  v_add_u32 v4, 0x10000, v2
  v_mfma_f32_16x16x32_bf16 a[8:11], v[32:35], v[152:155], 0
  v_add_u32 v5, 0x10000, v3
  v_add_u32 v6, 0x20000, v2
  v_mfma_f32_16x16x32_bf16 a[12:15], v[32:35], v[156:159], 0
  ds_read_b64_tr_b16 v[48:49], v15 offset:8192
  ds_read_b64_tr_b16 v[50:51], v15 offset:10240
  v_mfma_f32_16x16x32_bf16 a[16:19], v[36:39], v[144:147], 0
  v_exp_f32 v208, v208
  v_mfma_f32_16x16x32_bf16 a[20:23], v[36:39], v[148:151], 0
  v_exp_f32 v209, v209
  v_mfma_f32_16x16x32_bf16 a[24:27], v[36:39], v[152:155], 0
  s_mov_b32 s90, s100
  s_add_u32 m0, s5, 0x8000
  v_mfma_f32_16x16x32_bf16 a[28:31], v[36:39], v[156:159], 0
  ds_read_b64_tr_b16 v[52:53], v16 offset:8192
  s_waitcnt lgkmcnt(3)
  v_mfma_f32_16x16x32_bf16 a[32:35], v[40:43], v[144:147], 0
  ds_read_b64_tr_b16 v[54:55], v16 offset:10240
  v_cvt_pk_bf16_f32 v208, v208, v209
  v_mfma_f32_16x16x32_bf16 a[36:39], v[40:43], v[148:151], 0
  v_add_u32 v11, s90, v11
  v_add_u32 v12, s90, v12
  v_mfma_f32_16x16x32_bf16 a[40:43], v[40:43], v[152:155], 0
  buffer_load_dwordx4 v17, s[28:31], s55 offen offset:0 lds
  v_mfma_f32_16x16x32_bf16 a[44:47], v[40:43], v[156:159], 0
  ds_read_b64_tr_b16 v[56:57], v15 offset:8704
  ds_read_b64_tr_b16 v[58:59], v15 offset:10752
  v_mfma_f32_16x16x32_bf16 a[48:51], v[44:47], v[144:147], 0
  v_add_u32 v13, s90, v13
  v_add_u32 v14, s90, v14
  v_mfma_f32_16x16x32_bf16 a[52:55], v[44:47], v[148:151], 0
  v_exp_f32 v210, v210
  v_mfma_f32_16x16x32_bf16 a[56:59], v[44:47], v[152:155], 0
  v_exp_f32 v211, v211
  v_mfma_f32_16x16x32_bf16 a[60:63], v[44:47], v[156:159], 0
  ds_read_b64_tr_b16 v[60:61], v16 offset:8704
  s_waitcnt lgkmcnt(3)
  v_mfma_f32_16x16x32_bf16 a[64:67], v[48:51], v[144:147], 0
  ds_read_b64_tr_b16 v[62:63], v16 offset:10752
  ds_read_b128 v[64:67], v11 offset:0
  v_mfma_f32_16x16x32_bf16 a[68:71], v[48:51], v[148:151], 0
  ds_read_b128 v[68:71], v12 offset:0
  v_cvt_pk_bf16_f32 v209, v210, v211
  v_mfma_f32_16x16x32_bf16 a[72:75], v[48:51], v[152:155], 0
  ds_read_b128 v[72:75], v13 offset:0
  ds_read_b128 v[76:79], v14 offset:0
  v_mfma_f32_16x16x32_bf16 a[76:79], v[48:51], v[156:159], 0
  v_exp_f32 v240, v240
  v_mfma_f32_16x16x32_bf16 a[80:83], v[52:55], v[144:147], 0
  v_exp_f32 v241, v241
  v_mfma_f32_16x16x32_bf16 a[84:87], v[52:55], v[148:151], 0
  ds_read_b128 v[80:83], v11 offset:4096
  ds_read_b128 v[84:87], v12 offset:4096
  v_mfma_f32_16x16x32_bf16 a[88:91], v[52:55], v[152:155], 0
  v_exp_f32 v242, v242
  v_mfma_f32_16x16x32_bf16 a[92:95], v[52:55], v[156:159], 0
  v_cvt_pk_bf16_f32 v210, v240, v241
  s_waitcnt lgkmcnt(6)
  v_mfma_f32_16x16x32_bf16 a[96:99], v[56:59], v[144:147], 0
  ds_read_b128 v[88:91], v13 offset:4096
  ds_read_b128 v[92:95], v14 offset:4096
  v_mfma_f32_16x16x32_bf16 a[100:103], v[56:59], v[148:151], 0
  buffer_load_dwordx4 v18, s[28:31], s55 offen offset:1024 lds
  v_mfma_f32_16x16x32_bf16 a[104:107], v[56:59], v[152:155], 0
  v_exp_f32 v243, v243
  v_mfma_f32_16x16x32_bf16 a[108:111], v[56:59], v[156:159], 0
  v_exp_f32 v212, v212
  v_mfma_f32_16x16x32_bf16 a[112:115], v[60:63], v[144:147], 0
  v_exp_f32 v213, v213
  v_mfma_f32_16x16x32_bf16 a[116:119], v[60:63], v[148:151], 0
  v_exp_f32 v214, v214
  v_mfma_f32_16x16x32_bf16 a[120:123], v[60:63], v[152:155], 0
  v_exp_f32 v215, v215
  v_mfma_f32_16x16x32_bf16 a[124:127], v[60:63], v[156:159], 0
  v_exp_f32 v244, v244
  v_mfma_f32_16x16x32_bf16 a[128:131], v[112:115], v[144:147], 0
  v_exp_f32 v245, v245
  v_mfma_f32_16x16x32_bf16 a[132:135], v[112:115], v[148:151], 0
  v_cvt_pk_bf16_f32 v211, v242, v243
  v_cvt_pk_bf16_f32 v212, v212, v213
  v_mfma_f32_16x16x32_bf16 a[136:139], v[112:115], v[152:155], 0
  v_exp_f32 v246, v246
  v_mfma_f32_16x16x32_bf16 a[140:143], v[112:115], v[156:159], 0
  v_cvt_pk_bf16_f32 v213, v214, v215
  s_waitcnt lgkmcnt(4)
  v_mfma_f32_16x16x32_bf16 v[144:147], v[64:67], v[128:131], v[96:99]
  v_exp_f32 v247, v247
  v_mfma_f32_16x16x32_bf16 v[144:147], v[68:71], v[160:163], v[144:147]
  v_exp_f32 v216, v216
  v_mfma_f32_16x16x32_bf16 v[144:147], v[72:75], v[192:195], v[144:147]
  buffer_load_dwordx4 v19, s[28:31], s55 offen offset:2048 lds
  v_mfma_f32_16x16x32_bf16 v[144:147], v[76:79], v[224:227], v[144:147]
  v_cvt_pk_bf16_f32 v214, v244, v245
  s_waitcnt lgkmcnt(0)
  v_mfma_f32_16x16x32_bf16 v[176:179], v[80:83], v[128:131], v[96:99]
  v_exp_f32 v217, v217
  v_mfma_f32_16x16x32_bf16 v[176:179], v[84:87], v[160:163], v[176:179]
  v_exp_f32 v218, v218
  v_mfma_f32_16x16x32_bf16 v[176:179], v[88:91], v[192:195], v[176:179]
  v_exp_f32 v219, v219
  v_mfma_f32_16x16x32_bf16 v[176:179], v[92:95], v[224:227], v[176:179]
  v_exp_f32 v248, v248
  v_mfma_f32_16x16x32_bf16 v[148:151], v[64:67], v[132:135], v[100:103]
  v_exp_f32 v249, v249
  v_mfma_f32_16x16x32_bf16 v[148:151], v[68:71], v[164:167], v[148:151]
  v_cvt_pk_bf16_f32 v215, v246, v247
  v_cvt_pk_bf16_f32 v216, v216, v217
  v_mfma_f32_16x16x32_bf16 v[148:151], v[72:75], v[196:199], v[148:151]
  v_exp_f32 v250, v250
  v_mfma_f32_16x16x32_bf16 v[148:151], v[76:79], v[228:231], v[148:151]
  v_exp_f32 v251, v251
  v_mfma_f32_16x16x32_bf16 v[180:183], v[80:83], v[132:135], v[100:103]
  v_exp_f32 v220, v220
  v_mfma_f32_16x16x32_bf16 v[180:183], v[84:87], v[164:167], v[180:183]
  v_exp_f32 v221, v221
  v_mfma_f32_16x16x32_bf16 v[180:183], v[88:91], v[196:199], v[180:183]
  v_cvt_pk_bf16_f32 v217, v218, v219
  v_cvt_pk_bf16_f32 v218, v248, v249
  v_mfma_f32_16x16x32_bf16 v[180:183], v[92:95], v[228:231], v[180:183]
  buffer_load_dwordx4 v20, s[28:31], s55 offen offset:3072 lds
  v_mfma_f32_16x16x32_bf16 v[152:155], v[64:67], v[136:139], v[104:107]
  v_exp_f32 v222, v222
  v_mfma_f32_16x16x32_bf16 v[152:155], v[68:71], v[168:171], v[152:155]
  v_exp_f32 v223, v223
  v_mfma_f32_16x16x32_bf16 v[152:155], v[72:75], v[200:203], v[152:155]
  v_exp_f32 v252, v252
  v_mfma_f32_16x16x32_bf16 v[152:155], v[76:79], v[232:235], v[152:155]
  ds_read_b64_tr_b16 v[32:33], v15 offset:4096
  ds_read_b64_tr_b16 v[34:35], v15 offset:6144
  v_mfma_f32_16x16x32_bf16 v[184:187], v[80:83], v[136:139], v[104:107]
  v_exp_f32 v253, v253
  v_mfma_f32_16x16x32_bf16 v[184:187], v[84:87], v[168:171], v[184:187]
  v_cvt_pk_bf16_f32 v219, v250, v251
  v_cvt_pk_bf16_f32 v220, v220, v221
  v_mfma_f32_16x16x32_bf16 v[184:187], v[88:91], v[200:203], v[184:187]
  v_exp_f32 v254, v254
  v_mfma_f32_16x16x32_bf16 v[184:187], v[92:95], v[232:235], v[184:187]
  ds_read_b64_tr_b16 v[36:37], v16 offset:4096
  ds_read_b64_tr_b16 v[38:39], v16 offset:6144
  v_mfma_f32_16x16x32_bf16 v[156:159], v[64:67], v[140:143], v[108:111]
  v_exp_f32 v255, v255
  v_mfma_f32_16x16x32_bf16 v[156:159], v[68:71], v[172:175], v[156:159]
  v_cvt_pk_bf16_f32 v221, v222, v223
  v_cvt_pk_bf16_f32 v222, v252, v253
  v_mfma_f32_16x16x32_bf16 v[156:159], v[72:75], v[204:207], v[156:159]
  v_cvt_pk_bf16_f32 v223, v254, v255
  v_add_u32 v30, 0x20000, v3
  v_mfma_f32_16x16x32_bf16 v[156:159], v[76:79], v[236:239], v[156:159]
  ds_read_b64_tr_b16 v[40:41], v15 offset:4608
  ds_read_b64_tr_b16 v[42:43], v15 offset:6656
  v_mfma_f32_16x16x32_bf16 v[188:191], v[80:83], v[140:143], v[108:111]
  s_add_u32 m0, s5, 0xc000
  s_mov_b32 s71, s50
  v_mfma_f32_16x16x32_bf16 v[188:191], v[84:87], v[172:175], v[188:191]
  buffer_load_dwordx4 v21, s[36:39], s55 offen offset:0 lds
  v_mfma_f32_16x16x32_bf16 v[188:191], v[88:91], v[204:207], v[188:191]
  s_mov_b32 s53, s51
  s_mov_b32 s88, 3
  v_mfma_f32_16x16x32_bf16 v[188:191], v[92:95], v[236:239], v[188:191]
  ds_read_b64_tr_b16 v[44:45], v16 offset:4608
  s_waitcnt lgkmcnt(3)
  v_mfma_f32_16x16x32_bf16 a[0:3], v[32:35], v[208:211], a[0:3]
  ds_read_b64_tr_b16 v[46:47], v16 offset:6656
  s_mov_b32 s91, 3
  v_mfma_f32_16x16x32_bf16 a[4:7], v[32:35], v[212:215], a[4:7]
  v_mfma_f32_16x16x32_bf16 a[8:11], v[32:35], v[216:219], a[8:11]
  v_mfma_f32_16x16x32_bf16 a[12:15], v[32:35], v[220:223], a[12:15]
  ds_read_b64_tr_b16 v[48:49], v15 offset:12288
  ds_read_b64_tr_b16 v[50:51], v15 offset:14336
  v_mfma_f32_16x16x32_bf16 a[16:19], v[36:39], v[208:211], a[16:19]
  v_exp_f32 v144, v144
  v_mfma_f32_16x16x32_bf16 a[20:23], v[36:39], v[212:215], a[20:23]
  v_exp_f32 v145, v145
  v_mfma_f32_16x16x32_bf16 a[24:27], v[36:39], v[216:219], a[24:27]
  ds_read_b128 a[144:147], v11 offset:8192
  ds_read_b128 a[148:151], v12 offset:8192
  v_mfma_f32_16x16x32_bf16 a[28:31], v[36:39], v[220:223], a[28:31]
  ds_read_b64_tr_b16 v[52:53], v16 offset:12288
  s_waitcnt lgkmcnt(5)
  v_mfma_f32_16x16x32_bf16 a[32:35], v[40:43], v[208:211], a[32:35]
  ds_read_b64_tr_b16 v[54:55], v16 offset:14336
  v_cvt_pk_bf16_f32 v144, v144, v145
  v_mfma_f32_16x16x32_bf16 a[36:39], v[40:43], v[212:215], a[36:39]
  v_exp_f32 v146, v146
  v_mfma_f32_16x16x32_bf16 a[40:43], v[40:43], v[216:219], a[40:43]
  ds_read_b128 a[152:155], v13 offset:8192
  ds_read_b128 a[156:159], v14 offset:8192
  v_mfma_f32_16x16x32_bf16 a[44:47], v[40:43], v[220:223], a[44:47]
  ds_read_b64_tr_b16 v[56:57], v15 offset:12800
  ds_read_b64_tr_b16 v[58:59], v15 offset:14848
  v_mfma_f32_16x16x32_bf16 a[48:51], v[44:47], v[208:211], a[48:51]
  buffer_load_dwordx4 v22, s[36:39], s55 offen offset:1024 lds
  v_mfma_f32_16x16x32_bf16 a[52:55], v[44:47], v[212:215], a[52:55]
  v_exp_f32 v147, v147
  v_mfma_f32_16x16x32_bf16 a[56:59], v[44:47], v[216:219], a[56:59]
  ds_read_b128 a[160:163], v11 offset:12288
  ds_read_b128 a[164:167], v12 offset:12288
  v_mfma_f32_16x16x32_bf16 a[60:63], v[44:47], v[220:223], a[60:63]
  ds_read_b64_tr_b16 v[60:61], v16 offset:12800
  s_waitcnt lgkmcnt(7)
  v_mfma_f32_16x16x32_bf16 a[64:67], v[48:51], v[208:211], a[64:67]
  ds_read_b64_tr_b16 v[62:63], v16 offset:14848
  v_cvt_pk_bf16_f32 v145, v146, v147
  v_mfma_f32_16x16x32_bf16 a[68:71], v[48:51], v[212:215], a[68:71]
  v_exp_f32 v176, v176
  v_mfma_f32_16x16x32_bf16 a[72:75], v[48:51], v[216:219], a[72:75]
  ds_read_b128 a[168:171], v13 offset:12288
  ds_read_b128 a[172:175], v14 offset:12288
  v_mfma_f32_16x16x32_bf16 a[76:79], v[48:51], v[220:223], a[76:79]
  v_exp_f32 v177, v177
  v_mfma_f32_16x16x32_bf16 a[80:83], v[52:55], v[208:211], a[80:83]
  v_exp_f32 v178, v178
  v_mfma_f32_16x16x32_bf16 a[84:87], v[52:55], v[212:215], a[84:87]
  v_exp_f32 v179, v179
  v_mfma_f32_16x16x32_bf16 a[88:91], v[52:55], v[216:219], a[88:91]
  v_exp_f32 v148, v148
  v_mfma_f32_16x16x32_bf16 a[92:95], v[52:55], v[220:223], a[92:95]
  v_cvt_pk_bf16_f32 v146, v176, v177
  s_waitcnt lgkmcnt(2)
  v_mfma_f32_16x16x32_bf16 a[96:99], v[56:59], v[208:211], a[96:99]
  v_exp_f32 v149, v149
  v_mfma_f32_16x16x32_bf16 a[100:103], v[56:59], v[212:215], a[100:103]
  buffer_load_dwordx4 v23, s[36:39], s55 offen offset:2048 lds
  v_mfma_f32_16x16x32_bf16 a[104:107], v[56:59], v[216:219], a[104:107]
  v_exp_f32 v150, v150
  v_mfma_f32_16x16x32_bf16 a[108:111], v[56:59], v[220:223], a[108:111]
  v_exp_f32 v151, v151
  v_mfma_f32_16x16x32_bf16 a[112:115], v[60:63], v[208:211], a[112:115]
  v_exp_f32 v180, v180
  v_mfma_f32_16x16x32_bf16 a[116:119], v[60:63], v[212:215], a[116:119]
  v_exp_f32 v181, v181
  v_mfma_f32_16x16x32_bf16 a[120:123], v[60:63], v[216:219], a[120:123]
  v_cvt_pk_bf16_f32 v147, v178, v179
  v_cvt_pk_bf16_f32 v148, v148, v149
  v_mfma_f32_16x16x32_bf16 a[124:127], v[60:63], v[220:223], a[124:127]
  v_exp_f32 v182, v182
  v_mfma_f32_16x16x32_bf16 a[128:131], v[112:115], v[208:211], a[128:131]
  v_exp_f32 v183, v183
  v_mfma_f32_16x16x32_bf16 a[132:135], v[112:115], v[212:215], a[132:135]
  v_exp_f32 v152, v152
  v_mfma_f32_16x16x32_bf16 a[136:139], v[112:115], v[216:219], a[136:139]
  v_exp_f32 v153, v153
  v_mfma_f32_16x16x32_bf16 a[140:143], v[112:115], v[220:223], a[140:143]
  v_cvt_pk_bf16_f32 v149, v150, v151
  v_mfma_f32_16x16x32_bf16 v[208:211], a[144:147], v[128:131], v[96:99]
  v_exp_f32 v154, v154
  v_mfma_f32_16x16x32_bf16 v[208:211], a[148:151], v[160:163], v[208:211]
  v_exp_f32 v155, v155
  v_mfma_f32_16x16x32_bf16 v[208:211], a[152:155], v[192:195], v[208:211]
  buffer_load_dwordx4 v24, s[36:39], s55 offen offset:3072 lds
  v_mfma_f32_16x16x32_bf16 v[208:211], a[156:159], v[224:227], v[208:211]
  v_cvt_pk_bf16_f32 v150, v180, v181
  s_waitcnt lgkmcnt(0)
  v_mfma_f32_16x16x32_bf16 v[240:243], a[160:163], v[128:131], v[96:99]
  v_exp_f32 v184, v184
  v_mfma_f32_16x16x32_bf16 v[240:243], a[164:167], v[160:163], v[240:243]
  v_exp_f32 v185, v185
  v_mfma_f32_16x16x32_bf16 v[240:243], a[168:171], v[192:195], v[240:243]
  v_cvt_pk_bf16_f32 v151, v182, v183
  v_cvt_pk_bf16_f32 v152, v152, v153
  v_mfma_f32_16x16x32_bf16 v[240:243], a[172:175], v[224:227], v[240:243]
  v_exp_f32 v186, v186
  v_mfma_f32_16x16x32_bf16 v[212:215], a[144:147], v[132:135], v[100:103]
  v_exp_f32 v187, v187
  v_mfma_f32_16x16x32_bf16 v[212:215], a[148:151], v[164:167], v[212:215]
  v_exp_f32 v156, v156
  v_mfma_f32_16x16x32_bf16 v[212:215], a[152:155], v[196:199], v[212:215]
  v_exp_f32 v157, v157
  v_mfma_f32_16x16x32_bf16 v[212:215], a[156:159], v[228:231], v[212:215]
  v_cvt_pk_bf16_f32 v153, v154, v155
  v_cvt_pk_bf16_f32 v154, v184, v185
  v_mfma_f32_16x16x32_bf16 v[244:247], a[160:163], v[132:135], v[100:103]
  v_exp_f32 v158, v158
  v_mfma_f32_16x16x32_bf16 v[244:247], a[164:167], v[164:167], v[244:247]
  v_exp_f32 v159, v159
  v_mfma_f32_16x16x32_bf16 v[244:247], a[168:171], v[196:199], v[244:247]
  v_exp_f32 v188, v188
  v_mfma_f32_16x16x32_bf16 v[244:247], a[172:175], v[228:231], v[244:247]
  s_add_u32 s55, s55, 0x4000
  v_cvt_pk_bf16_f32 v155, v186, v187
  v_mfma_f32_16x16x32_bf16 v[216:219], a[144:147], v[136:139], v[104:107]
  v_exp_f32 v189, v189
  v_mfma_f32_16x16x32_bf16 v[216:219], a[148:151], v[168:171], v[216:219]
  v_exp_f32 v190, v190
  v_mfma_f32_16x16x32_bf16 v[216:219], a[152:155], v[200:203], v[216:219]
  s_waitcnt vmcnt(13)
  s_barrier
  v_mfma_f32_16x16x32_bf16 v[216:219], a[156:159], v[232:235], v[216:219]
  s_mov_b32 s59, s100
  v_add_u32 v15, s59, v15
  v_mfma_f32_16x16x32_bf16 v[248:251], a[160:163], v[136:139], v[104:107]
  v_add_u32 v16, s59, v16
  ds_read_b64_tr_b16 v[32:33], v15 offset:0
  v_mfma_f32_16x16x32_bf16 v[248:251], a[164:167], v[168:171], v[248:251]
  ds_read_b64_tr_b16 v[34:35], v15 offset:2048
  v_cvt_pk_bf16_f32 v156, v156, v157
  v_mfma_f32_16x16x32_bf16 v[248:251], a[168:171], v[200:203], v[248:251]
  v_exp_f32 v191, v191
  v_mfma_f32_16x16x32_bf16 v[248:251], a[172:175], v[232:235], v[248:251]
  ds_read_b64_tr_b16 v[36:37], v16 offset:0
  ds_read_b64_tr_b16 v[38:39], v16 offset:2048
  v_mfma_f32_16x16x32_bf16 v[220:223], a[144:147], v[140:143], v[108:111]
  v_cvt_pk_bf16_f32 v157, v158, v159
  v_cvt_pk_bf16_f32 v158, v188, v189
  v_mfma_f32_16x16x32_bf16 v[220:223], a[148:151], v[172:175], v[220:223]
  v_cvt_pk_bf16_f32 v159, v190, v191
  v_mfma_f32_16x16x32_bf16 v[220:223], a[152:155], v[204:207], v[220:223]
  v_mfma_f32_16x16x32_bf16 v[220:223], a[156:159], v[236:239], v[220:223]
  ds_read_b64_tr_b16 v[40:41], v15 offset:512
  ds_read_b64_tr_b16 v[42:43], v15 offset:2560
  v_mfma_f32_16x16x32_bf16 v[252:255], a[160:163], v[140:143], v[108:111]
  v_mfma_f32_16x16x32_bf16 v[252:255], a[164:167], v[172:175], v[252:255]
  global_load_dword v127, v127, s[68:69]
  v_mfma_f32_16x16x32_bf16 v[252:255], a[168:171], v[204:207], v[252:255]
  v_mfma_f32_16x16x32_bf16 v[252:255], a[172:175], v[236:239], v[252:255]
  ds_read_b64_tr_b16 v[44:45], v16 offset:512
  s_waitcnt lgkmcnt(3)
  v_mfma_f32_16x16x32_bf16 a[0:3], v[32:35], v[144:147], a[0:3]
  ds_read_b64_tr_b16 v[46:47], v16 offset:2560
  v_mfma_f32_16x16x32_bf16 a[4:7], v[32:35], v[148:151], a[4:7]
  v_mfma_f32_16x16x32_bf16 a[8:11], v[32:35], v[152:155], a[8:11]
  v_mfma_f32_16x16x32_bf16 a[12:15], v[32:35], v[156:159], a[12:15]
L_A:
  v_mfma_f32_16x16x32_bf16 a[16:19], v[36:39], v[144:147], a[16:19]
  s_add_u32 s88, s88, 1
  s_cmp_eq_u32 s88, 5
  s_cselect_b32 s88, 0, s88
  v_mfma_f32_16x16x32_bf16 a[20:23], v[36:39], v[148:151], a[20:23]
  s_lshl_b32 s89, s88, 15
  s_sub_u32 s89, s4, s89
  v_mfma_f32_16x16x32_bf16 a[24:27], v[36:39], v[152:155], a[24:27]
  ds_read_b64_tr_b16 v[48:49], v15 offset:8192
  ds_read_b64_tr_b16 v[50:51], v15 offset:10240
  v_mfma_f32_16x16x32_bf16 a[28:31], v[36:39], v[156:159], a[28:31]
  ds_read_b64_tr_b16 v[52:53], v16 offset:8192
  s_waitcnt lgkmcnt(3)
  v_mfma_f32_16x16x32_bf16 a[32:35], v[40:43], v[144:147], a[32:35]
  ds_read_b64_tr_b16 v[54:55], v16 offset:10240
  s_add_u32 m0, s89, 0
  v_mfma_f32_16x16x32_bf16 a[36:39], v[40:43], v[148:151], a[36:39]
  s_cmp_eq_u32 s88, 2
  s_cselect_b32 s90, s101, s100
  v_mfma_f32_16x16x32_bf16 a[40:43], v[40:43], v[152:155], a[40:43]
  v_add_u32 v11, s90, v11
  v_add_u32 v12, s90, v12
  v_mfma_f32_16x16x32_bf16 a[44:47], v[40:43], v[156:159], a[44:47]
  ds_read_b64_tr_b16 v[56:57], v15 offset:8704
  ds_read_b64_tr_b16 v[58:59], v15 offset:10752
  v_mfma_f32_16x16x32_bf16 a[48:51], v[44:47], v[144:147], a[48:51]
  v_add_u32 v13, s90, v13
  v_add_u32 v14, s90, v14
  v_mfma_f32_16x16x32_bf16 a[52:55], v[44:47], v[148:151], a[52:55]
  buffer_load_dwordx4 v17, s[28:31], s55 offen offset:0 lds
  v_mfma_f32_16x16x32_bf16 a[56:59], v[44:47], v[152:155], a[56:59]
  v_exp_f32 v208, v208
  v_mfma_f32_16x16x32_bf16 a[60:63], v[44:47], v[156:159], a[60:63]
  ds_read_b64_tr_b16 v[60:61], v16 offset:8704
  s_waitcnt lgkmcnt(3)
  v_mfma_f32_16x16x32_bf16 a[64:67], v[48:51], v[144:147], a[64:67]
  ds_read_b64_tr_b16 v[62:63], v16 offset:10752
  ds_read_b128 v[64:67], v11 offset:0
  v_mfma_f32_16x16x32_bf16 a[68:71], v[48:51], v[148:151], a[68:71]
  ds_read_b128 v[68:71], v12 offset:0
  v_mfma_f32_16x16x32_bf16 a[72:75], v[48:51], v[152:155], a[72:75]
  ds_read_b128 v[72:75], v13 offset:0
  ds_read_b128 v[76:79], v14 offset:0
  v_mfma_f32_16x16x32_bf16 a[76:79], v[48:51], v[156:159], a[76:79]
  v_exp_f32 v209, v209
  v_mfma_f32_16x16x32_bf16 a[80:83], v[52:55], v[144:147], a[80:83]
  v_exp_f32 v210, v210
  v_mfma_f32_16x16x32_bf16 a[84:87], v[52:55], v[148:151], a[84:87]
  ds_read_b128 v[80:83], v11 offset:4096
  ds_read_b128 v[84:87], v12 offset:4096
  v_mfma_f32_16x16x32_bf16 a[88:91], v[52:55], v[152:155], a[88:91]
  v_exp_f32 v211, v211
  v_mfma_f32_16x16x32_bf16 a[92:95], v[52:55], v[156:159], a[92:95]
  v_cvt_pk_bf16_f32 v208, v208, v209
  s_waitcnt lgkmcnt(6)
  v_mfma_f32_16x16x32_bf16 a[96:99], v[56:59], v[144:147], a[96:99]
  ds_read_b128 v[88:91], v13 offset:4096
  ds_read_b128 v[92:95], v14 offset:4096
  v_mfma_f32_16x16x32_bf16 a[100:103], v[56:59], v[148:151], a[100:103]
  v_exp_f32 v240, v240
  v_mfma_f32_16x16x32_bf16 a[104:107], v[56:59], v[152:155], a[104:107]
  buffer_load_dwordx4 v18, s[28:31], s55 offen offset:1024 lds
  v_mfma_f32_16x16x32_bf16 a[108:111], v[56:59], v[156:159], a[108:111]
  v_exp_f32 v241, v241
  v_mfma_f32_16x16x32_bf16 a[112:115], v[60:63], v[144:147], a[112:115]
  v_exp_f32 v242, v242
  v_mfma_f32_16x16x32_bf16 a[116:119], v[60:63], v[148:151], a[116:119]
  v_exp_f32 v243, v243
  v_mfma_f32_16x16x32_bf16 a[120:123], v[60:63], v[152:155], a[120:123]
  v_exp_f32 v212, v212
  v_mfma_f32_16x16x32_bf16 a[124:127], v[60:63], v[156:159], a[124:127]
  v_exp_f32 v213, v213
  v_mfma_f32_16x16x32_bf16 a[128:131], v[112:115], v[144:147], a[128:131]
  v_cvt_pk_bf16_f32 v209, v210, v211
  v_cvt_pk_bf16_f32 v210, v240, v241
  v_mfma_f32_16x16x32_bf16 a[132:135], v[112:115], v[148:151], a[132:135]
  v_exp_f32 v214, v214
  v_mfma_f32_16x16x32_bf16 a[136:139], v[112:115], v[152:155], a[136:139]
  v_exp_f32 v215, v215
  v_mfma_f32_16x16x32_bf16 a[140:143], v[112:115], v[156:159], a[140:143]
  v_cvt_pk_bf16_f32 v211, v242, v243
  s_waitcnt lgkmcnt(4)
  v_mfma_f32_16x16x32_bf16 v[144:147], v[64:67], v[128:131], v[96:99]
  v_exp_f32 v244, v244
  v_mfma_f32_16x16x32_bf16 v[144:147], v[68:71], v[160:163], v[144:147]
  v_exp_f32 v245, v245
  v_mfma_f32_16x16x32_bf16 v[144:147], v[72:75], v[192:195], v[144:147]
  v_exp_f32 v246, v246
  v_mfma_f32_16x16x32_bf16 v[144:147], v[76:79], v[224:227], v[144:147]
  v_cvt_pk_bf16_f32 v212, v212, v213
  s_waitcnt lgkmcnt(0)
  v_mfma_f32_16x16x32_bf16 v[176:179], v[80:83], v[128:131], v[96:99]
  buffer_load_dwordx4 v19, s[28:31], s55 offen offset:2048 lds
  v_mfma_f32_16x16x32_bf16 v[176:179], v[84:87], v[160:163], v[176:179]
  v_exp_f32 v247, v247
  v_mfma_f32_16x16x32_bf16 v[176:179], v[88:91], v[192:195], v[176:179]
  v_exp_f32 v216, v216
  v_mfma_f32_16x16x32_bf16 v[176:179], v[92:95], v[224:227], v[176:179]
  v_exp_f32 v217, v217
  v_mfma_f32_16x16x32_bf16 v[148:151], v[64:67], v[132:135], v[100:103]
  v_cvt_pk_bf16_f32 v213, v214, v215
  v_cvt_pk_bf16_f32 v214, v244, v245
  v_mfma_f32_16x16x32_bf16 v[148:151], v[68:71], v[164:167], v[148:151]
  v_exp_f32 v218, v218
  v_mfma_f32_16x16x32_bf16 v[148:151], v[72:75], v[196:199], v[148:151]
  v_exp_f32 v219, v219
  v_mfma_f32_16x16x32_bf16 v[148:151], v[76:79], v[228:231], v[148:151]
  v_exp_f32 v248, v248
  v_mfma_f32_16x16x32_bf16 v[180:183], v[80:83], v[132:135], v[100:103]
  v_exp_f32 v249, v249
  v_mfma_f32_16x16x32_bf16 v[180:183], v[84:87], v[164:167], v[180:183]
  v_cvt_pk_bf16_f32 v215, v246, v247
  v_cvt_pk_bf16_f32 v216, v216, v217
  v_mfma_f32_16x16x32_bf16 v[180:183], v[88:91], v[196:199], v[180:183]
  v_exp_f32 v250, v250
  v_mfma_f32_16x16x32_bf16 v[180:183], v[92:95], v[228:231], v[180:183]
  v_exp_f32 v251, v251
  v_mfma_f32_16x16x32_bf16 v[152:155], v[64:67], v[136:139], v[104:107]
  v_exp_f32 v220, v220
  v_mfma_f32_16x16x32_bf16 v[152:155], v[68:71], v[168:171], v[152:155]
  buffer_load_dwordx4 v20, s[28:31], s55 offen offset:3072 lds
  v_mfma_f32_16x16x32_bf16 v[152:155], v[72:75], v[200:203], v[152:155]
  v_exp_f32 v221, v221
  v_mfma_f32_16x16x32_bf16 v[152:155], v[76:79], v[232:235], v[152:155]
  ds_read_b64_tr_b16 v[32:33], v15 offset:4096
  ds_read_b64_tr_b16 v[34:35], v15 offset:6144
  v_mfma_f32_16x16x32_bf16 v[184:187], v[80:83], v[136:139], v[104:107]
  v_cvt_pk_bf16_f32 v217, v218, v219
  v_cvt_pk_bf16_f32 v218, v248, v249
  v_mfma_f32_16x16x32_bf16 v[184:187], v[84:87], v[168:171], v[184:187]
  v_exp_f32 v222, v222
  v_mfma_f32_16x16x32_bf16 v[184:187], v[88:91], v[200:203], v[184:187]
  v_exp_f32 v223, v223
  v_mfma_f32_16x16x32_bf16 v[184:187], v[92:95], v[232:235], v[184:187]
  ds_read_b64_tr_b16 v[36:37], v16 offset:4096
  ds_read_b64_tr_b16 v[38:39], v16 offset:6144
  v_mfma_f32_16x16x32_bf16 v[156:159], v[64:67], v[140:143], v[108:111]
  v_exp_f32 v252, v252
  v_mfma_f32_16x16x32_bf16 v[156:159], v[68:71], v[172:175], v[156:159]
  v_exp_f32 v253, v253
  v_mfma_f32_16x16x32_bf16 v[156:159], v[72:75], v[204:207], v[156:159]
  v_cvt_pk_bf16_f32 v219, v250, v251
  v_cvt_pk_bf16_f32 v220, v220, v221
  v_mfma_f32_16x16x32_bf16 v[156:159], v[76:79], v[236:239], v[156:159]
  ds_read_b64_tr_b16 v[40:41], v15 offset:4608
  ds_read_b64_tr_b16 v[42:43], v15 offset:6656
  v_mfma_f32_16x16x32_bf16 v[188:191], v[80:83], v[140:143], v[108:111]
  v_exp_f32 v254, v254
  v_mfma_f32_16x16x32_bf16 v[188:191], v[84:87], v[172:175], v[188:191]
  v_exp_f32 v255, v255
  v_mfma_f32_16x16x32_bf16 v[188:191], v[88:91], v[204:207], v[188:191]
  s_add_u32 m0, s89, 16384
  v_cvt_pk_bf16_f32 v221, v222, v223
  v_cvt_pk_bf16_f32 v222, v252, v253
  v_cvt_pk_bf16_f32 v223, v254, v255
  v_mfma_f32_16x16x32_bf16 v[188:191], v[92:95], v[236:239], v[188:191]
  ds_read_b64_tr_b16 v[44:45], v16 offset:4608
  s_waitcnt lgkmcnt(3)
  v_mfma_f32_16x16x32_bf16 a[0:3], v[32:35], v[208:211], a[0:3]
  ds_read_b64_tr_b16 v[46:47], v16 offset:6656
  v_mfma_f32_16x16x32_bf16 a[4:7], v[32:35], v[212:215], a[4:7]
  buffer_load_dwordx4 v21, s[36:39], s55 offen offset:0 lds
  v_mfma_f32_16x16x32_bf16 a[8:11], v[32:35], v[216:219], a[8:11]
  v_mfma_f32_16x16x32_bf16 a[12:15], v[32:35], v[220:223], a[12:15]
  ds_read_b64_tr_b16 v[48:49], v15 offset:12288
  ds_read_b64_tr_b16 v[50:51], v15 offset:14336
  v_mfma_f32_16x16x32_bf16 a[16:19], v[36:39], v[208:211], a[16:19]
  v_exp_f32 v144, v144
  v_mfma_f32_16x16x32_bf16 a[20:23], v[36:39], v[212:215], a[20:23]
  v_exp_f32 v145, v145
  v_mfma_f32_16x16x32_bf16 a[24:27], v[36:39], v[216:219], a[24:27]
  ds_read_b128 a[144:147], v11 offset:8192
  ds_read_b128 a[148:151], v12 offset:8192
  v_mfma_f32_16x16x32_bf16 a[28:31], v[36:39], v[220:223], a[28:31]
  ds_read_b64_tr_b16 v[52:53], v16 offset:12288
  s_waitcnt lgkmcnt(5)
  v_mfma_f32_16x16x32_bf16 a[32:35], v[40:43], v[208:211], a[32:35]
  ds_read_b64_tr_b16 v[54:55], v16 offset:14336
  v_cvt_pk_bf16_f32 v144, v144, v145
  v_mfma_f32_16x16x32_bf16 a[36:39], v[40:43], v[212:215], a[36:39]
  v_exp_f32 v146, v146
  v_mfma_f32_16x16x32_bf16 a[40:43], v[40:43], v[216:219], a[40:43]
  ds_read_b128 a[152:155], v13 offset:8192
  ds_read_b128 a[156:159], v14 offset:8192
  v_mfma_f32_16x16x32_bf16 a[44:47], v[40:43], v[220:223], a[44:47]
  ds_read_b64_tr_b16 v[56:57], v15 offset:12800
  ds_read_b64_tr_b16 v[58:59], v15 offset:14848
  v_mfma_f32_16x16x32_bf16 a[48:51], v[44:47], v[208:211], a[48:51]
  v_exp_f32 v147, v147
  v_mfma_f32_16x16x32_bf16 a[52:55], v[44:47], v[212:215], a[52:55]
  v_exp_f32 v176, v176
  v_mfma_f32_16x16x32_bf16 a[56:59], v[44:47], v[216:219], a[56:59]
  ds_read_b128 a[160:163], v11 offset:12288
  ds_read_b128 a[164:167], v12 offset:12288
  v_mfma_f32_16x16x32_bf16 a[60:63], v[44:47], v[220:223], a[60:63]
  ds_read_b64_tr_b16 v[60:61], v16 offset:12800
  s_waitcnt lgkmcnt(7)
  v_mfma_f32_16x16x32_bf16 a[64:67], v[48:51], v[208:211], a[64:67]
  ds_read_b64_tr_b16 v[62:63], v16 offset:14848
  v_cvt_pk_bf16_f32 v145, v146, v147
  v_mfma_f32_16x16x32_bf16 a[68:71], v[48:51], v[212:215], a[68:71]
  buffer_load_dwordx4 v22, s[36:39], s55 offen offset:1024 lds
  v_mfma_f32_16x16x32_bf16 a[72:75], v[48:51], v[216:219], a[72:75]
  ds_read_b128 a[168:171], v13 offset:12288
  ds_read_b128 a[172:175], v14 offset:12288
  v_mfma_f32_16x16x32_bf16 a[76:79], v[48:51], v[220:223], a[76:79]
  v_exp_f32 v177, v177
  v_mfma_f32_16x16x32_bf16 a[80:83], v[52:55], v[208:211], a[80:83]
  v_exp_f32 v178, v178
  v_mfma_f32_16x16x32_bf16 a[84:87], v[52:55], v[212:215], a[84:87]
  v_exp_f32 v179, v179
  v_mfma_f32_16x16x32_bf16 a[88:91], v[52:55], v[216:219], a[88:91]
  v_exp_f32 v148, v148
  v_mfma_f32_16x16x32_bf16 a[92:95], v[52:55], v[220:223], a[92:95]
  v_cvt_pk_bf16_f32 v146, v176, v177
  s_waitcnt lgkmcnt(2)
  v_mfma_f32_16x16x32_bf16 a[96:99], v[56:59], v[208:211], a[96:99]
  v_exp_f32 v149, v149
  v_mfma_f32_16x16x32_bf16 a[100:103], v[56:59], v[212:215], a[100:103]
  v_exp_f32 v150, v150
  v_mfma_f32_16x16x32_bf16 a[104:107], v[56:59], v[216:219], a[104:107]
  v_exp_f32 v151, v151
  v_mfma_f32_16x16x32_bf16 a[108:111], v[56:59], v[220:223], a[108:111]
  v_exp_f32 v180, v180
  v_mfma_f32_16x16x32_bf16 a[112:115], v[60:63], v[208:211], a[112:115]
  v_exp_f32 v181, v181
  v_mfma_f32_16x16x32_bf16 a[116:119], v[60:63], v[212:215], a[116:119]
  v_cvt_pk_bf16_f32 v147, v178, v179
  v_cvt_pk_bf16_f32 v148, v148, v149
  v_mfma_f32_16x16x32_bf16 a[120:123], v[60:63], v[216:219], a[120:123]
  buffer_load_dwordx4 v23, s[36:39], s55 offen offset:2048 lds
  v_mfma_f32_16x16x32_bf16 a[124:127], v[60:63], v[220:223], a[124:127]
  v_exp_f32 v182, v182
  v_mfma_f32_16x16x32_bf16 a[128:131], v[112:115], v[208:211], a[128:131]
  v_exp_f32 v183, v183
  v_mfma_f32_16x16x32_bf16 a[132:135], v[112:115], v[212:215], a[132:135]
  v_exp_f32 v152, v152
  v_mfma_f32_16x16x32_bf16 a[136:139], v[112:115], v[216:219], a[136:139]
  v_exp_f32 v153, v153
  v_mfma_f32_16x16x32_bf16 a[140:143], v[112:115], v[220:223], a[140:143]
  v_cvt_pk_bf16_f32 v149, v150, v151
  s_waitcnt lgkmcnt(8)
  v_mfma_f32_16x16x32_bf16 v[208:211], a[144:147], v[128:131], v[96:99]
  v_exp_f32 v154, v154
  v_mfma_f32_16x16x32_bf16 v[208:211], a[148:151], v[160:163], v[208:211]
  v_exp_f32 v155, v155
  v_mfma_f32_16x16x32_bf16 v[208:211], a[152:155], v[192:195], v[208:211]
  v_cvt_pk_bf16_f32 v150, v180, v181
  v_cvt_pk_bf16_f32 v151, v182, v183
  v_mfma_f32_16x16x32_bf16 v[208:211], a[156:159], v[224:227], v[208:211]
  v_cvt_pk_bf16_f32 v152, v152, v153
  s_waitcnt lgkmcnt(0)
  v_mfma_f32_16x16x32_bf16 v[240:243], a[160:163], v[128:131], v[96:99]
  v_exp_f32 v184, v184
  v_mfma_f32_16x16x32_bf16 v[240:243], a[164:167], v[160:163], v[240:243]
  v_exp_f32 v185, v185
  v_mfma_f32_16x16x32_bf16 v[240:243], a[168:171], v[192:195], v[240:243]
  v_exp_f32 v186, v186
  v_mfma_f32_16x16x32_bf16 v[240:243], a[172:175], v[224:227], v[240:243]
  buffer_load_dwordx4 v24, s[36:39], s55 offen offset:3072 lds
  v_mfma_f32_16x16x32_bf16 v[212:215], a[144:147], v[132:135], v[100:103]
  v_exp_f32 v187, v187
  v_mfma_f32_16x16x32_bf16 v[212:215], a[148:151], v[164:167], v[212:215]
  v_exp_f32 v156, v156
  v_mfma_f32_16x16x32_bf16 v[212:215], a[152:155], v[196:199], v[212:215]
  v_exp_f32 v157, v157
  v_mfma_f32_16x16x32_bf16 v[212:215], a[156:159], v[228:231], v[212:215]
  v_cvt_pk_bf16_f32 v153, v154, v155
  v_cvt_pk_bf16_f32 v154, v184, v185
  v_mfma_f32_16x16x32_bf16 v[244:247], a[160:163], v[132:135], v[100:103]
  v_exp_f32 v158, v158
  v_mfma_f32_16x16x32_bf16 v[244:247], a[164:167], v[164:167], v[244:247]
  v_exp_f32 v159, v159
  v_mfma_f32_16x16x32_bf16 v[244:247], a[168:171], v[196:199], v[244:247]
  v_exp_f32 v188, v188
  v_mfma_f32_16x16x32_bf16 v[244:247], a[172:175], v[228:231], v[244:247]
  v_exp_f32 v189, v189
  v_mfma_f32_16x16x32_bf16 v[216:219], a[144:147], v[136:139], v[104:107]
  v_cvt_pk_bf16_f32 v155, v186, v187
  v_cvt_pk_bf16_f32 v156, v156, v157
  v_mfma_f32_16x16x32_bf16 v[216:219], a[148:151], v[168:171], v[216:219]
  v_exp_f32 v190, v190
  v_mfma_f32_16x16x32_bf16 v[216:219], a[152:155], v[200:203], v[216:219]
  s_waitcnt vmcnt(12)
  s_barrier
  v_mfma_f32_16x16x32_bf16 v[216:219], a[156:159], v[232:235], v[216:219]
  s_cmp_eq_u32 s88, 2
  s_cselect_b32 s59, s101, s100
  v_mfma_f32_16x16x32_bf16 v[248:251], a[160:163], v[136:139], v[104:107]
  v_add_u32 v15, s59, v15
  v_add_u32 v16, s59, v16
  v_mfma_f32_16x16x32_bf16 v[248:251], a[164:167], v[168:171], v[248:251]
  ds_read_b64_tr_b16 v[32:33], v15 offset:0
  ds_read_b64_tr_b16 v[34:35], v15 offset:2048
  v_mfma_f32_16x16x32_bf16 v[248:251], a[168:171], v[200:203], v[248:251]
  s_add_u32 s55, s55, 0x4000
  v_cvt_pk_bf16_f32 v157, v158, v159
  v_mfma_f32_16x16x32_bf16 v[248:251], a[172:175], v[232:235], v[248:251]
  ds_read_b64_tr_b16 v[36:37], v16 offset:0
  ds_read_b64_tr_b16 v[38:39], v16 offset:2048
  v_mfma_f32_16x16x32_bf16 v[220:223], a[144:147], v[140:143], v[108:111]
  v_exp_f32 v191, v191
  v_mfma_f32_16x16x32_bf16 v[220:223], a[148:151], v[172:175], v[220:223]
  v_cvt_pk_bf16_f32 v158, v188, v189
  v_cvt_pk_bf16_f32 v159, v190, v191
  v_mfma_f32_16x16x32_bf16 v[220:223], a[152:155], v[204:207], v[220:223]
  v_mfma_f32_16x16x32_bf16 v[220:223], a[156:159], v[236:239], v[220:223]
  ds_read_b64_tr_b16 v[40:41], v15 offset:512
  ds_read_b64_tr_b16 v[42:43], v15 offset:2560
  v_mfma_f32_16x16x32_bf16 v[252:255], a[160:163], v[140:143], v[108:111]
  v_mfma_f32_16x16x32_bf16 v[252:255], a[164:167], v[172:175], v[252:255]
  v_mfma_f32_16x16x32_bf16 v[252:255], a[168:171], v[204:207], v[252:255]
  v_mfma_f32_16x16x32_bf16 v[252:255], a[172:175], v[236:239], v[252:255]
  ds_read_b64_tr_b16 v[44:45], v16 offset:512
  s_waitcnt lgkmcnt(3)
  v_mfma_f32_16x16x32_bf16 a[0:3], v[32:35], v[144:147], a[0:3]
  ds_read_b64_tr_b16 v[46:47], v16 offset:2560
  v_mfma_f32_16x16x32_bf16 a[4:7], v[32:35], v[148:151], a[4:7]
  v_mfma_f32_16x16x32_bf16 a[8:11], v[32:35], v[152:155], a[8:11]
  v_mfma_f32_16x16x32_bf16 a[12:15], v[32:35], v[156:159], a[12:15]
  s_sub_u32 s91, s91, 1
  s_cbranch_scc0 L_A
  v_mfma_f32_16x16x32_bf16 a[16:19], v[36:39], v[144:147], a[16:19]
  ds_read_b64_tr_b16 v[48:49], v15 offset:8192
  ds_read_b64_tr_b16 v[50:51], v15 offset:10240
  v_mfma_f32_16x16x32_bf16 a[20:23], v[36:39], v[148:151], a[20:23]
  buffer_load_ubyte v125, v28, s[64:67], 0 offen sc1
  v_mfma_f32_16x16x32_bf16 a[24:27], v[36:39], v[152:155], a[24:27]
  s_mov_b32 s90, s100
  v_mfma_f32_16x16x32_bf16 a[28:31], v[36:39], v[156:159], a[28:31]
  ds_read_b64_tr_b16 v[52:53], v16 offset:8192
  s_waitcnt lgkmcnt(3)
  v_mfma_f32_16x16x32_bf16 a[32:35], v[40:43], v[144:147], a[32:35]
  ds_read_b64_tr_b16 v[54:55], v16 offset:10240
  v_mfma_f32_16x16x32_bf16 a[36:39], v[40:43], v[148:151], a[36:39]
  v_add_u32 v11, s90, v11
  v_add_u32 v12, s90, v12
  v_mfma_f32_16x16x32_bf16 a[40:43], v[40:43], v[152:155], a[40:43]
  v_exp_f32 v208, v208
  v_mfma_f32_16x16x32_bf16 a[44:47], v[40:43], v[156:159], a[44:47]
  ds_read_b64_tr_b16 v[56:57], v15 offset:8704
  ds_read_b64_tr_b16 v[58:59], v15 offset:10752
  v_mfma_f32_16x16x32_bf16 a[48:51], v[44:47], v[144:147], a[48:51]
  v_add_u32 v13, s90, v13
  v_add_u32 v14, s90, v14
  v_mfma_f32_16x16x32_bf16 a[52:55], v[44:47], v[148:151], a[52:55]
  s_add_u32 m0, s5, 0x0
  v_mfma_f32_16x16x32_bf16 a[56:59], v[44:47], v[152:155], a[56:59]
  buffer_load_dwordx4 v7, s[80:83], s71 offen offset:0 lds
  v_mfma_f32_16x16x32_bf16 a[60:63], v[44:47], v[156:159], a[60:63]
  ds_read_b64_tr_b16 v[60:61], v16 offset:8704
  s_waitcnt lgkmcnt(3)
  v_mfma_f32_16x16x32_bf16 a[64:67], v[48:51], v[144:147], a[64:67]
  ds_read_b64_tr_b16 v[62:63], v16 offset:10752
  ds_read_b128 v[64:67], v11 offset:0
  v_mfma_f32_16x16x32_bf16 a[68:71], v[48:51], v[148:151], a[68:71]
  ds_read_b128 v[68:71], v12 offset:0
  v_mfma_f32_16x16x32_bf16 a[72:75], v[48:51], v[152:155], a[72:75]
  ds_read_b128 v[72:75], v13 offset:0
  ds_read_b128 v[76:79], v14 offset:0
  v_mfma_f32_16x16x32_bf16 a[76:79], v[48:51], v[156:159], a[76:79]
  v_exp_f32 v209, v209
  v_mfma_f32_16x16x32_bf16 a[80:83], v[52:55], v[144:147], a[80:83]
  buffer_load_dwordx4 v8, s[80:83], s71 offen offset:1024 lds
  v_mfma_f32_16x16x32_bf16 a[84:87], v[52:55], v[148:151], a[84:87]
  ds_read_b128 v[80:83], v11 offset:4096
  ds_read_b128 v[84:87], v12 offset:4096
  v_mfma_f32_16x16x32_bf16 a[88:91], v[52:55], v[152:155], a[88:91]
  v_exp_f32 v210, v210
  v_mfma_f32_16x16x32_bf16 a[92:95], v[52:55], v[156:159], a[92:95]
  v_cvt_pk_bf16_f32 v208, v208, v209
  s_waitcnt lgkmcnt(6)
  v_mfma_f32_16x16x32_bf16 a[96:99], v[56:59], v[144:147], a[96:99]
  ds_read_b128 v[88:91], v13 offset:4096
  ds_read_b128 v[92:95], v14 offset:4096
  v_mfma_f32_16x16x32_bf16 a[100:103], v[56:59], v[148:151], a[100:103]
  v_exp_f32 v211, v211
  v_mfma_f32_16x16x32_bf16 a[104:107], v[56:59], v[152:155], a[104:107]
  buffer_load_dwordx4 v9, s[80:83], s71 offen offset:2048 lds
  v_mfma_f32_16x16x32_bf16 a[108:111], v[56:59], v[156:159], a[108:111]
  v_exp_f32 v240, v240
  v_mfma_f32_16x16x32_bf16 a[112:115], v[60:63], v[144:147], a[112:115]
  v_exp_f32 v241, v241
  v_mfma_f32_16x16x32_bf16 a[116:119], v[60:63], v[148:151], a[116:119]
  v_exp_f32 v242, v242
  v_mfma_f32_16x16x32_bf16 a[120:123], v[60:63], v[152:155], a[120:123]
  v_exp_f32 v243, v243
  v_mfma_f32_16x16x32_bf16 a[124:127], v[60:63], v[156:159], a[124:127]
  v_exp_f32 v212, v212
  v_mfma_f32_16x16x32_bf16 a[128:131], v[112:115], v[144:147], a[128:131]
  buffer_load_dwordx4 v10, s[80:83], s71 offen offset:3072 lds
  v_mfma_f32_16x16x32_bf16 a[132:135], v[112:115], v[148:151], a[132:135]
  v_exp_f32 v213, v213
  v_mfma_f32_16x16x32_bf16 a[136:139], v[112:115], v[152:155], a[136:139]
  v_cvt_pk_bf16_f32 v209, v210, v211
  v_cvt_pk_bf16_f32 v210, v240, v241
  v_mfma_f32_16x16x32_bf16 a[140:143], v[112:115], v[156:159], a[140:143]
  v_cvt_pk_bf16_f32 v211, v242, v243
  s_waitcnt lgkmcnt(4)
  v_mfma_f32_16x16x32_bf16 v[144:147], v[64:67], v[128:131], v[96:99]
  v_exp_f32 v214, v214
  v_mfma_f32_16x16x32_bf16 v[144:147], v[68:71], v[160:163], v[144:147]
  v_exp_f32 v215, v215
  v_mfma_f32_16x16x32_bf16 v[144:147], v[72:75], v[192:195], v[144:147]
  s_add_u32 s71, s71, 0x20000
  s_add_u32 m0, s5, 0x4000
  v_mfma_f32_16x16x32_bf16 v[144:147], v[76:79], v[224:227], v[144:147]
  v_cvt_pk_bf16_f32 v212, v212, v213
  s_waitcnt lgkmcnt(0)
  v_mfma_f32_16x16x32_bf16 v[176:179], v[80:83], v[128:131], v[96:99]
  buffer_load_dwordx4 v7, s[80:83], s71 offen offset:0 lds
  v_mfma_f32_16x16x32_bf16 v[176:179], v[84:87], v[160:163], v[176:179]
  v_exp_f32 v244, v244
  v_mfma_f32_16x16x32_bf16 v[176:179], v[88:91], v[192:195], v[176:179]
  v_exp_f32 v245, v245
  v_mfma_f32_16x16x32_bf16 v[176:179], v[92:95], v[224:227], v[176:179]
  v_exp_f32 v246, v246
  v_mfma_f32_16x16x32_bf16 v[148:151], v[64:67], v[132:135], v[100:103]
  v_exp_f32 v247, v247
  v_mfma_f32_16x16x32_bf16 v[148:151], v[68:71], v[164:167], v[148:151]
  v_exp_f32 v216, v216
  v_mfma_f32_16x16x32_bf16 v[148:151], v[72:75], v[196:199], v[148:151]
  buffer_load_dwordx4 v8, s[80:83], s71 offen offset:1024 lds
  v_mfma_f32_16x16x32_bf16 v[148:151], v[76:79], v[228:231], v[148:151]
  v_exp_f32 v217, v217
  v_mfma_f32_16x16x32_bf16 v[180:183], v[80:83], v[132:135], v[100:103]
  v_cvt_pk_bf16_f32 v213, v214, v215
  v_cvt_pk_bf16_f32 v214, v244, v245
  v_mfma_f32_16x16x32_bf16 v[180:183], v[84:87], v[164:167], v[180:183]
  v_exp_f32 v218, v218
  v_mfma_f32_16x16x32_bf16 v[180:183], v[88:91], v[196:199], v[180:183]
  v_exp_f32 v219, v219
  v_mfma_f32_16x16x32_bf16 v[180:183], v[92:95], v[228:231], v[180:183]
  v_exp_f32 v248, v248
  v_mfma_f32_16x16x32_bf16 v[152:155], v[64:67], v[136:139], v[104:107]
  buffer_load_dwordx4 v9, s[80:83], s71 offen offset:2048 lds
  v_mfma_f32_16x16x32_bf16 v[152:155], v[68:71], v[168:171], v[152:155]
  v_exp_f32 v249, v249
  v_mfma_f32_16x16x32_bf16 v[152:155], v[72:75], v[200:203], v[152:155]
  v_cvt_pk_bf16_f32 v215, v246, v247
  v_cvt_pk_bf16_f32 v216, v216, v217
  v_mfma_f32_16x16x32_bf16 v[152:155], v[76:79], v[232:235], v[152:155]
  ds_read_b64_tr_b16 v[32:33], v15 offset:4096
  ds_read_b64_tr_b16 v[34:35], v15 offset:6144
  v_mfma_f32_16x16x32_bf16 v[184:187], v[80:83], v[136:139], v[104:107]
  v_exp_f32 v250, v250
  v_mfma_f32_16x16x32_bf16 v[184:187], v[84:87], v[168:171], v[184:187]
  v_exp_f32 v251, v251
  v_mfma_f32_16x16x32_bf16 v[184:187], v[88:91], v[200:203], v[184:187]
  buffer_load_dwordx4 v10, s[80:83], s71 offen offset:3072 lds
  v_mfma_f32_16x16x32_bf16 v[184:187], v[92:95], v[232:235], v[184:187]
  ds_read_b64_tr_b16 v[36:37], v16 offset:4096
  ds_read_b64_tr_b16 v[38:39], v16 offset:6144
  v_mfma_f32_16x16x32_bf16 v[156:159], v[64:67], v[140:143], v[108:111]
  v_exp_f32 v220, v220
  v_mfma_f32_16x16x32_bf16 v[156:159], v[68:71], v[172:175], v[156:159]
  v_exp_f32 v221, v221
  v_mfma_f32_16x16x32_bf16 v[156:159], v[72:75], v[204:207], v[156:159]
  v_cvt_pk_bf16_f32 v217, v218, v219
  v_cvt_pk_bf16_f32 v218, v248, v249
  v_mfma_f32_16x16x32_bf16 v[156:159], v[76:79], v[236:239], v[156:159]
  ds_read_b64_tr_b16 v[40:41], v15 offset:4608
  ds_read_b64_tr_b16 v[42:43], v15 offset:6656
  v_mfma_f32_16x16x32_bf16 v[188:191], v[80:83], v[140:143], v[108:111]
  s_add_u32 s71, s71, 0x20000
  s_add_u32 m0, s5, 0x8000
  v_mfma_f32_16x16x32_bf16 v[188:191], v[84:87], v[172:175], v[188:191]
  buffer_load_dwordx4 v7, s[80:83], s71 offen offset:0 lds
  v_exp_f32 v222, v222
  v_exp_f32 v223, v223
  v_exp_f32 v252, v252
  v_exp_f32 v253, v253
  v_exp_f32 v254, v254
  v_exp_f32 v255, v255
  v_mfma_f32_16x16x32_bf16 v[188:191], v[88:91], v[204:207], v[188:191]
  v_cvt_pk_bf16_f32 v219, v250, v251
  v_cvt_pk_bf16_f32 v220, v220, v221
  v_cvt_pk_bf16_f32 v221, v222, v223
  v_cvt_pk_bf16_f32 v222, v252, v253
  v_cvt_pk_bf16_f32 v223, v254, v255
  v_mfma_f32_16x16x32_bf16 v[188:191], v[92:95], v[236:239], v[188:191]
  ds_read_b64_tr_b16 v[44:45], v16 offset:4608
  s_waitcnt lgkmcnt(3)
  v_mfma_f32_16x16x32_bf16 a[0:3], v[32:35], v[208:211], a[0:3]
  ds_read_b64_tr_b16 v[46:47], v16 offset:6656
  v_mfma_f32_16x16x32_bf16 a[4:7], v[32:35], v[212:215], a[4:7]
  v_exp_f32 v144, v144
  v_mfma_f32_16x16x32_bf16 a[8:11], v[32:35], v[216:219], a[8:11]
  v_exp_f32 v145, v145
  v_mfma_f32_16x16x32_bf16 a[12:15], v[32:35], v[220:223], a[12:15]
  ds_read_b64_tr_b16 v[48:49], v15 offset:12288
  ds_read_b64_tr_b16 v[50:51], v15 offset:14336
  v_mfma_f32_16x16x32_bf16 a[16:19], v[36:39], v[208:211], a[16:19]
  buffer_load_dwordx4 v8, s[80:83], s71 offen offset:1024 lds
  v_mfma_f32_16x16x32_bf16 a[20:23], v[36:39], v[212:215], a[20:23]
  v_exp_f32 v146, v146
  v_mfma_f32_16x16x32_bf16 a[24:27], v[36:39], v[216:219], a[24:27]
  ds_read_b128 a[144:147], v11 offset:8192
  ds_read_b128 a[148:151], v12 offset:8192
  v_mfma_f32_16x16x32_bf16 a[28:31], v[36:39], v[220:223], a[28:31]
  ds_read_b64_tr_b16 v[52:53], v16 offset:12288
  s_waitcnt lgkmcnt(5)
  v_mfma_f32_16x16x32_bf16 a[32:35], v[40:43], v[208:211], a[32:35]
  ds_read_b64_tr_b16 v[54:55], v16 offset:14336
  v_cvt_pk_bf16_f32 v144, v144, v145
  v_mfma_f32_16x16x32_bf16 a[36:39], v[40:43], v[212:215], a[36:39]
  v_exp_f32 v147, v147
  v_mfma_f32_16x16x32_bf16 a[40:43], v[40:43], v[216:219], a[40:43]
  ds_read_b128 a[152:155], v13 offset:8192
  ds_read_b128 a[156:159], v14 offset:8192
  v_mfma_f32_16x16x32_bf16 a[44:47], v[40:43], v[220:223], a[44:47]
  ds_read_b64_tr_b16 v[56:57], v15 offset:12800
  ds_read_b64_tr_b16 v[58:59], v15 offset:14848
  v_mfma_f32_16x16x32_bf16 a[48:51], v[44:47], v[208:211], a[48:51]
  buffer_load_dwordx4 v9, s[80:83], s71 offen offset:2048 lds
  v_mfma_f32_16x16x32_bf16 a[52:55], v[44:47], v[212:215], a[52:55]
  v_exp_f32 v176, v176
  v_mfma_f32_16x16x32_bf16 a[56:59], v[44:47], v[216:219], a[56:59]
  ds_read_b128 a[160:163], v11 offset:12288
  ds_read_b128 a[164:167], v12 offset:12288
  v_mfma_f32_16x16x32_bf16 a[60:63], v[44:47], v[220:223], a[60:63]
  ds_read_b64_tr_b16 v[60:61], v16 offset:12800
  s_waitcnt lgkmcnt(7)
  v_mfma_f32_16x16x32_bf16 a[64:67], v[48:51], v[208:211], a[64:67]
  ds_read_b64_tr_b16 v[62:63], v16 offset:14848
  v_cvt_pk_bf16_f32 v145, v146, v147
  v_mfma_f32_16x16x32_bf16 a[68:71], v[48:51], v[212:215], a[68:71]
  v_exp_f32 v177, v177
  v_mfma_f32_16x16x32_bf16 a[72:75], v[48:51], v[216:219], a[72:75]
  ds_read_b128 a[168:171], v13 offset:12288
  ds_read_b128 a[172:175], v14 offset:12288
  v_mfma_f32_16x16x32_bf16 a[76:79], v[48:51], v[220:223], a[76:79]
  buffer_load_dwordx4 v10, s[80:83], s71 offen offset:3072 lds
  v_mfma_f32_16x16x32_bf16 a[80:83], v[52:55], v[208:211], a[80:83]
  v_exp_f32 v178, v178
  v_mfma_f32_16x16x32_bf16 a[84:87], v[52:55], v[212:215], a[84:87]
  v_exp_f32 v179, v179
  v_mfma_f32_16x16x32_bf16 a[88:91], v[52:55], v[216:219], a[88:91]
  v_exp_f32 v148, v148
  v_mfma_f32_16x16x32_bf16 a[92:95], v[52:55], v[220:223], a[92:95]
  v_cvt_pk_bf16_f32 v146, v176, v177
  s_waitcnt lgkmcnt(2)
  v_mfma_f32_16x16x32_bf16 a[96:99], v[56:59], v[208:211], a[96:99]
  v_exp_f32 v149, v149
  v_mfma_f32_16x16x32_bf16 a[100:103], v[56:59], v[212:215], a[100:103]
  s_add_u32 s71, s71, 0x20000
  s_add_u32 m0, s5, 0xc000
  v_mfma_f32_16x16x32_bf16 a[104:107], v[56:59], v[216:219], a[104:107]
  buffer_load_dwordx4 v7, s[80:83], s71 offen offset:0 lds
  v_mfma_f32_16x16x32_bf16 a[108:111], v[56:59], v[220:223], a[108:111]
  v_exp_f32 v150, v150
  v_mfma_f32_16x16x32_bf16 a[112:115], v[60:63], v[208:211], a[112:115]
  v_exp_f32 v151, v151
  v_mfma_f32_16x16x32_bf16 a[116:119], v[60:63], v[212:215], a[116:119]
  v_exp_f32 v180, v180
  v_mfma_f32_16x16x32_bf16 a[120:123], v[60:63], v[216:219], a[120:123]
  v_exp_f32 v181, v181
  v_mfma_f32_16x16x32_bf16 a[124:127], v[60:63], v[220:223], a[124:127]
  v_cvt_pk_bf16_f32 v147, v178, v179
  v_cvt_pk_bf16_f32 v148, v148, v149
  v_mfma_f32_16x16x32_bf16 a[128:131], v[112:115], v[208:211], a[128:131]
  buffer_load_dwordx4 v8, s[80:83], s71 offen offset:1024 lds
  v_mfma_f32_16x16x32_bf16 a[132:135], v[112:115], v[212:215], a[132:135]
  v_exp_f32 v182, v182
  v_mfma_f32_16x16x32_bf16 a[136:139], v[112:115], v[216:219], a[136:139]
  v_exp_f32 v183, v183
  v_mfma_f32_16x16x32_bf16 a[140:143], v[112:115], v[220:223], a[140:143]
  v_cvt_pk_bf16_f32 v149, v150, v151
  v_mfma_f32_16x16x32_bf16 v[208:211], a[144:147], v[128:131], v[96:99]
  v_exp_f32 v152, v152
  v_mfma_f32_16x16x32_bf16 v[208:211], a[148:151], v[160:163], v[208:211]
  v_exp_f32 v153, v153
  v_mfma_f32_16x16x32_bf16 v[208:211], a[152:155], v[192:195], v[208:211]
  buffer_load_dwordx4 v9, s[80:83], s71 offen offset:2048 lds
  v_mfma_f32_16x16x32_bf16 v[208:211], a[156:159], v[224:227], v[208:211]
  v_cvt_pk_bf16_f32 v150, v180, v181
  s_waitcnt lgkmcnt(0)
  v_mfma_f32_16x16x32_bf16 v[240:243], a[160:163], v[128:131], v[96:99]
  v_exp_f32 v154, v154
  v_mfma_f32_16x16x32_bf16 v[240:243], a[164:167], v[160:163], v[240:243]
  v_exp_f32 v155, v155
  v_mfma_f32_16x16x32_bf16 v[240:243], a[168:171], v[192:195], v[240:243]
  v_exp_f32 v184, v184
  v_mfma_f32_16x16x32_bf16 v[240:243], a[172:175], v[224:227], v[240:243]
  v_exp_f32 v185, v185
  v_mfma_f32_16x16x32_bf16 v[212:215], a[144:147], v[132:135], v[100:103]
  buffer_load_dwordx4 v10, s[80:83], s71 offen offset:3072 lds
  v_mfma_f32_16x16x32_bf16 v[212:215], a[148:151], v[164:167], v[212:215]
  v_cvt_pk_bf16_f32 v151, v182, v183
  v_cvt_pk_bf16_f32 v152, v152, v153
  v_mfma_f32_16x16x32_bf16 v[212:215], a[152:155], v[196:199], v[212:215]
  v_exp_f32 v186, v186
  v_mfma_f32_16x16x32_bf16 v[212:215], a[156:159], v[228:231], v[212:215]
  v_exp_f32 v187, v187
  v_mfma_f32_16x16x32_bf16 v[244:247], a[160:163], v[132:135], v[100:103]
  v_exp_f32 v156, v156
  v_mfma_f32_16x16x32_bf16 v[244:247], a[164:167], v[164:167], v[244:247]
  v_exp_f32 v157, v157
  v_mfma_f32_16x16x32_bf16 v[244:247], a[168:171], v[196:199], v[244:247]
  s_add_u32 s71, s71, 0x20000
  v_cvt_pk_bf16_f32 v153, v154, v155
  v_mfma_f32_16x16x32_bf16 v[244:247], a[172:175], v[228:231], v[244:247]
  v_exp_f32 v158, v158
  v_mfma_f32_16x16x32_bf16 v[216:219], a[144:147], v[136:139], v[104:107]
  v_exp_f32 v159, v159
  v_mfma_f32_16x16x32_bf16 v[216:219], a[148:151], v[168:171], v[216:219]
  v_cvt_pk_bf16_f32 v154, v184, v185
  v_cvt_pk_bf16_f32 v155, v186, v187
  v_mfma_f32_16x16x32_bf16 v[216:219], a[152:155], v[200:203], v[216:219]
  s_waitcnt vmcnt(21)
  s_barrier
  v_mfma_f32_16x16x32_bf16 v[216:219], a[156:159], v[232:235], v[216:219]
  s_mov_b32 s59, s100
  v_add_u32 v15, s59, v15
  v_mfma_f32_16x16x32_bf16 v[248:251], a[160:163], v[136:139], v[104:107]
  v_add_u32 v16, s59, v16
  ds_read_b64_tr_b16 v[32:33], v15 offset:0
  v_mfma_f32_16x16x32_bf16 v[248:251], a[164:167], v[168:171], v[248:251]
  ds_read_b64_tr_b16 v[34:35], v15 offset:2048
  v_cvt_pk_bf16_f32 v156, v156, v157
  v_mfma_f32_16x16x32_bf16 v[248:251], a[168:171], v[200:203], v[248:251]
  v_exp_f32 v188, v188
  v_mfma_f32_16x16x32_bf16 v[248:251], a[172:175], v[232:235], v[248:251]
  ds_read_b64_tr_b16 v[36:37], v16 offset:0
  ds_read_b64_tr_b16 v[38:39], v16 offset:2048
  v_mfma_f32_16x16x32_bf16 v[220:223], a[144:147], v[140:143], v[108:111]
  v_exp_f32 v189, v189
  v_mfma_f32_16x16x32_bf16 v[220:223], a[148:151], v[172:175], v[220:223]
  v_exp_f32 v190, v190
  v_mfma_f32_16x16x32_bf16 v[220:223], a[152:155], v[204:207], v[220:223]
  v_exp_f32 v191, v191
  v_mfma_f32_16x16x32_bf16 v[220:223], a[156:159], v[236:239], v[220:223]
  ds_read_b64_tr_b16 v[40:41], v15 offset:512
  ds_read_b64_tr_b16 v[42:43], v15 offset:2560
  v_mfma_f32_16x16x32_bf16 v[252:255], a[160:163], v[140:143], v[108:111]
  v_exp_f32 v208, v208
  v_mfma_f32_16x16x32_bf16 v[252:255], a[164:167], v[172:175], v[252:255]
  v_exp_f32 v209, v209
  v_mfma_f32_16x16x32_bf16 v[252:255], a[168:171], v[204:207], v[252:255]
  v_cvt_pk_bf16_f32 v157, v158, v159
  v_cvt_pk_bf16_f32 v158, v188, v189
  v_cvt_pk_bf16_f32 v159, v190, v191
  v_mfma_f32_16x16x32_bf16 v[252:255], a[172:175], v[236:239], v[252:255]
  ds_read_b64_tr_b16 v[44:45], v16 offset:512
  s_waitcnt lgkmcnt(3)
  v_mfma_f32_16x16x32_bf16 a[0:3], v[32:35], v[144:147], a[0:3]
  ds_read_b64_tr_b16 v[46:47], v16 offset:2560
  v_cvt_pk_bf16_f32 v208, v208, v209
  v_mfma_f32_16x16x32_bf16 a[4:7], v[32:35], v[148:151], a[4:7]
  v_exp_f32 v210, v210
  v_mfma_f32_16x16x32_bf16 a[8:11], v[32:35], v[152:155], a[8:11]
  v_exp_f32 v211, v211
  v_mfma_f32_16x16x32_bf16 a[12:15], v[32:35], v[156:159], a[12:15]
  ds_read_b64_tr_b16 v[48:49], v15 offset:8192
  ds_read_b64_tr_b16 v[50:51], v15 offset:10240
  v_mfma_f32_16x16x32_bf16 a[16:19], v[36:39], v[144:147], a[16:19]
  s_waitcnt vmcnt(16)
  v_cmp_gt_u32 vcc, 2, v125
  s_and_b32 s62, vcc_lo, -1
  s_cbranch_scc1 L_spin0
L_spin0_ret:
  v_mfma_f32_16x16x32_bf16 a[20:23], v[36:39], v[148:151], a[20:23]
  buffer_load_dwordx4 a[176:179], v25, s[44:47], s72 offen offset:0 sc1
  v_mfma_f32_16x16x32_bf16 a[24:27], v[36:39], v[152:155], a[24:27]
  s_mov_b32 s90, s100
  v_cvt_pk_bf16_f32 v209, v210, v211
  v_mfma_f32_16x16x32_bf16 a[28:31], v[36:39], v[156:159], a[28:31]
  ds_read_b64_tr_b16 v[52:53], v16 offset:8192
  s_waitcnt lgkmcnt(3)
  v_mfma_f32_16x16x32_bf16 a[32:35], v[40:43], v[144:147], a[32:35]
  ds_read_b64_tr_b16 v[54:55], v16 offset:10240
  v_mfma_f32_16x16x32_bf16 a[36:39], v[40:43], v[148:151], a[36:39]
  v_add_u32 v11, s90, v11
  v_add_u32 v12, s90, v12
  v_mfma_f32_16x16x32_bf16 a[40:43], v[40:43], v[152:155], a[40:43]
  v_exp_f32 v240, v240
  v_mfma_f32_16x16x32_bf16 a[44:47], v[40:43], v[156:159], a[44:47]
  ds_read_b64_tr_b16 v[56:57], v15 offset:8704
  ds_read_b64_tr_b16 v[58:59], v15 offset:10752
  v_mfma_f32_16x16x32_bf16 a[48:51], v[44:47], v[144:147], a[48:51]
  v_add_u32 v13, s90, v13
  v_add_u32 v14, s90, v14
  v_mfma_f32_16x16x32_bf16 a[52:55], v[44:47], v[148:151], a[52:55]
  buffer_load_dwordx4 a[180:183], v25, s[44:47], s72 offen offset:1024 sc1
  v_mfma_f32_16x16x32_bf16 a[56:59], v[44:47], v[152:155], a[56:59]
  v_exp_f32 v241, v241
  v_mfma_f32_16x16x32_bf16 a[60:63], v[44:47], v[156:159], a[60:63]
  ds_read_b64_tr_b16 v[60:61], v16 offset:8704
  s_waitcnt lgkmcnt(3)
  v_mfma_f32_16x16x32_bf16 a[64:67], v[48:51], v[144:147], a[64:67]
  ds_read_b64_tr_b16 v[62:63], v16 offset:10752
  ds_read_b128 v[64:67], v11 offset:0
  v_mfma_f32_16x16x32_bf16 a[68:71], v[48:51], v[148:151], a[68:71]
  ds_read_b128 v[68:71], v12 offset:0
  v_cvt_pk_bf16_f32 v210, v240, v241
  v_mfma_f32_16x16x32_bf16 a[72:75], v[48:51], v[152:155], a[72:75]
  ds_read_b128 v[72:75], v13 offset:0
  ds_read_b128 v[76:79], v14 offset:0
  v_mfma_f32_16x16x32_bf16 a[76:79], v[48:51], v[156:159], a[76:79]
  buffer_load_dwordx4 a[184:187], v25, s[44:47], s72 offen offset:2048 sc1
  v_mfma_f32_16x16x32_bf16 a[80:83], v[52:55], v[144:147], a[80:83]
  v_exp_f32 v242, v242
  v_mfma_f32_16x16x32_bf16 a[84:87], v[52:55], v[148:151], a[84:87]
  ds_read_b128 v[80:83], v11 offset:4096
  ds_read_b128 v[84:87], v12 offset:4096
  v_mfma_f32_16x16x32_bf16 a[88:91], v[52:55], v[152:155], a[88:91]
  v_exp_f32 v243, v243
  v_mfma_f32_16x16x32_bf16 a[92:95], v[52:55], v[156:159], a[92:95]
  v_cvt_pk_bf16_f32 v211, v242, v243
  s_waitcnt lgkmcnt(6)
  v_mfma_f32_16x16x32_bf16 a[96:99], v[56:59], v[144:147], a[96:99]
  ds_read_b128 v[88:91], v13 offset:4096
  ds_read_b128 v[92:95], v14 offset:4096
  v_mfma_f32_16x16x32_bf16 a[100:103], v[56:59], v[148:151], a[100:103]
  buffer_load_dwordx4 a[188:191], v25, s[44:47], s72 offen offset:3072 sc1
  v_mfma_f32_16x16x32_bf16 a[104:107], v[56:59], v[152:155], a[104:107]
  v_exp_f32 v212, v212
  v_mfma_f32_16x16x32_bf16 a[108:111], v[56:59], v[156:159], a[108:111]
  v_exp_f32 v213, v213
  v_mfma_f32_16x16x32_bf16 a[112:115], v[60:63], v[144:147], a[112:115]
  v_exp_f32 v214, v214
  v_mfma_f32_16x16x32_bf16 a[116:119], v[60:63], v[148:151], a[116:119]
  v_exp_f32 v215, v215
  v_mfma_f32_16x16x32_bf16 a[120:123], v[60:63], v[152:155], a[120:123]
  v_exp_f32 v244, v244
  v_mfma_f32_16x16x32_bf16 a[124:127], v[60:63], v[156:159], a[124:127]
  buffer_load_dwordx4 a[192:195], v26, s[44:47], s72 offen offset:0 sc1
  v_mfma_f32_16x16x32_bf16 a[128:131], v[112:115], v[144:147], a[128:131]
  v_exp_f32 v245, v245
  v_mfma_f32_16x16x32_bf16 a[132:135], v[112:115], v[148:151], a[132:135]
  v_exp_f32 v246, v246
  v_mfma_f32_16x16x32_bf16 a[136:139], v[112:115], v[152:155], a[136:139]
  v_exp_f32 v247, v247
  v_mfma_f32_16x16x32_bf16 a[140:143], v[112:115], v[156:159], a[140:143]
  v_cvt_pk_bf16_f32 v212, v212, v213
  s_waitcnt lgkmcnt(4)
  v_mfma_f32_16x16x32_bf16 v[144:147], v[64:67], v[128:131], v[96:99]
  v_exp_f32 v216, v216
  v_mfma_f32_16x16x32_bf16 v[144:147], v[68:71], v[160:163], v[144:147]
  buffer_load_dwordx4 a[196:199], v26, s[44:47], s72 offen offset:1024 sc1
  v_mfma_f32_16x16x32_bf16 v[144:147], v[72:75], v[192:195], v[144:147]
  v_exp_f32 v217, v217
  v_mfma_f32_16x16x32_bf16 v[144:147], v[76:79], v[224:227], v[144:147]
  v_cvt_pk_bf16_f32 v213, v214, v215
  s_waitcnt lgkmcnt(0)
  v_mfma_f32_16x16x32_bf16 v[176:179], v[80:83], v[128:131], v[96:99]
  v_exp_f32 v218, v218
  v_mfma_f32_16x16x32_bf16 v[176:179], v[84:87], v[160:163], v[176:179]
  v_exp_f32 v219, v219
  v_mfma_f32_16x16x32_bf16 v[176:179], v[88:91], v[192:195], v[176:179]
  v_cvt_pk_bf16_f32 v214, v244, v245
  v_cvt_pk_bf16_f32 v215, v246, v247
  v_mfma_f32_16x16x32_bf16 v[176:179], v[92:95], v[224:227], v[176:179]
  buffer_load_dwordx4 a[200:203], v26, s[44:47], s72 offen offset:2048 sc1
  v_mfma_f32_16x16x32_bf16 v[148:151], v[64:67], v[132:135], v[100:103]
  v_exp_f32 v248, v248
  v_mfma_f32_16x16x32_bf16 v[148:151], v[68:71], v[164:167], v[148:151]
  v_exp_f32 v249, v249
  v_mfma_f32_16x16x32_bf16 v[148:151], v[72:75], v[196:199], v[148:151]
  v_exp_f32 v250, v250
  v_mfma_f32_16x16x32_bf16 v[148:151], v[76:79], v[228:231], v[148:151]
  v_exp_f32 v251, v251
  v_mfma_f32_16x16x32_bf16 v[180:183], v[80:83], v[132:135], v[100:103]
  v_cvt_pk_bf16_f32 v216, v216, v217
  v_cvt_pk_bf16_f32 v217, v218, v219
  v_mfma_f32_16x16x32_bf16 v[180:183], v[84:87], v[164:167], v[180:183]
  buffer_load_dwordx4 a[204:207], v26, s[44:47], s72 offen offset:3072 sc1
  v_mfma_f32_16x16x32_bf16 v[180:183], v[88:91], v[196:199], v[180:183]
  v_exp_f32 v220, v220
  v_mfma_f32_16x16x32_bf16 v[180:183], v[92:95], v[228:231], v[180:183]
  v_exp_f32 v221, v221
  v_mfma_f32_16x16x32_bf16 v[152:155], v[64:67], v[136:139], v[104:107]
  v_exp_f32 v222, v222
  v_mfma_f32_16x16x32_bf16 v[152:155], v[68:71], v[168:171], v[152:155]
  v_exp_f32 v223, v223
  v_mfma_f32_16x16x32_bf16 v[152:155], v[72:75], v[200:203], v[152:155]
  v_cvt_pk_bf16_f32 v218, v248, v249
  v_cvt_pk_bf16_f32 v219, v250, v251
  v_mfma_f32_16x16x32_bf16 v[152:155], v[76:79], v[232:235], v[152:155]
  ds_read_b64_tr_b16 v[32:33], v15 offset:4096
  ds_read_b64_tr_b16 v[34:35], v15 offset:6144
  v_mfma_f32_16x16x32_bf16 v[184:187], v[80:83], v[136:139], v[104:107]
  s_add_u32 s72, s72, 0x2000
  v_cvt_pk_bf16_f32 v220, v220, v221
  v_mfma_f32_16x16x32_bf16 v[184:187], v[84:87], v[168:171], v[184:187]
  buffer_load_dwordx4 a[208:211], v25, s[44:47], s72 offen offset:0 sc1
  v_mfma_f32_16x16x32_bf16 v[184:187], v[88:91], v[200:203], v[184:187]
  v_exp_f32 v252, v252
  v_mfma_f32_16x16x32_bf16 v[184:187], v[92:95], v[232:235], v[184:187]
  ds_read_b64_tr_b16 v[36:37], v16 offset:4096
  ds_read_b64_tr_b16 v[38:39], v16 offset:6144
  v_mfma_f32_16x16x32_bf16 v[156:159], v[64:67], v[140:143], v[108:111]
  v_exp_f32 v253, v253
  v_mfma_f32_16x16x32_bf16 v[156:159], v[68:71], v[172:175], v[156:159]
  v_exp_f32 v254, v254
  v_mfma_f32_16x16x32_bf16 v[156:159], v[72:75], v[204:207], v[156:159]
  v_exp_f32 v255, v255
  v_mfma_f32_16x16x32_bf16 v[156:159], v[76:79], v[236:239], v[156:159]
  ds_read_b64_tr_b16 v[40:41], v15 offset:4608
  ds_read_b64_tr_b16 v[42:43], v15 offset:6656
  v_mfma_f32_16x16x32_bf16 v[188:191], v[80:83], v[140:143], v[108:111]
  buffer_load_dwordx4 a[212:215], v25, s[44:47], s72 offen offset:1024 sc1
  v_mfma_f32_16x16x32_bf16 v[188:191], v[84:87], v[172:175], v[188:191]
  v_exp_f32 v144, v144
  v_mfma_f32_16x16x32_bf16 v[188:191], v[88:91], v[204:207], v[188:191]
  v_cvt_pk_bf16_f32 v221, v222, v223
  v_cvt_pk_bf16_f32 v222, v252, v253
  v_cvt_pk_bf16_f32 v223, v254, v255
  v_mfma_f32_16x16x32_bf16 v[188:191], v[92:95], v[236:239], v[188:191]
  ds_read_b64_tr_b16 v[44:45], v16 offset:4608
  s_waitcnt lgkmcnt(3)
  v_mfma_f32_16x16x32_bf16 a[0:3], v[32:35], v[208:211], a[0:3]
  ds_read_b64_tr_b16 v[46:47], v16 offset:6656
  v_mfma_f32_16x16x32_bf16 a[4:7], v[32:35], v[212:215], a[4:7]
  v_exp_f32 v145, v145
  v_mfma_f32_16x16x32_bf16 a[8:11], v[32:35], v[216:219], a[8:11]
  buffer_load_dwordx4 a[216:219], v25, s[44:47], s72 offen offset:2048 sc1
  v_mfma_f32_16x16x32_bf16 a[12:15], v[32:35], v[220:223], a[12:15]
  ds_read_b64_tr_b16 v[48:49], v15 offset:12288
  ds_read_b64_tr_b16 v[50:51], v15 offset:14336
  v_mfma_f32_16x16x32_bf16 a[16:19], v[36:39], v[208:211], a[16:19]
  v_exp_f32 v146, v146
  v_mfma_f32_16x16x32_bf16 a[20:23], v[36:39], v[212:215], a[20:23]
  v_exp_f32 v147, v147
  v_mfma_f32_16x16x32_bf16 a[24:27], v[36:39], v[216:219], a[24:27]
  ds_read_b128 a[144:147], v11 offset:8192
  ds_read_b128 a[148:151], v12 offset:8192
  v_mfma_f32_16x16x32_bf16 a[28:31], v[36:39], v[220:223], a[28:31]
  ds_read_b64_tr_b16 v[52:53], v16 offset:12288
  s_waitcnt lgkmcnt(5)
  v_mfma_f32_16x16x32_bf16 a[32:35], v[40:43], v[208:211], a[32:35]
  ds_read_b64_tr_b16 v[54:55], v16 offset:14336
  v_cvt_pk_bf16_f32 v144, v144, v145
  v_mfma_f32_16x16x32_bf16 a[36:39], v[40:43], v[212:215], a[36:39]
  buffer_load_dwordx4 a[220:223], v25, s[44:47], s72 offen offset:3072 sc1
  v_mfma_f32_16x16x32_bf16 a[40:43], v[40:43], v[216:219], a[40:43]
  ds_read_b128 a[152:155], v13 offset:8192
  ds_read_b128 a[156:159], v14 offset:8192
  v_mfma_f32_16x16x32_bf16 a[44:47], v[40:43], v[220:223], a[44:47]
  ds_read_b64_tr_b16 v[56:57], v15 offset:12800
  ds_read_b64_tr_b16 v[58:59], v15 offset:14848
  v_mfma_f32_16x16x32_bf16 a[48:51], v[44:47], v[208:211], a[48:51]
  v_exp_f32 v176, v176
  v_mfma_f32_16x16x32_bf16 a[52:55], v[44:47], v[212:215], a[52:55]
  v_exp_f32 v177, v177
  v_mfma_f32_16x16x32_bf16 a[56:59], v[44:47], v[216:219], a[56:59]
  ds_read_b128 a[160:163], v11 offset:12288
  ds_read_b128 a[164:167], v12 offset:12288
  v_mfma_f32_16x16x32_bf16 a[60:63], v[44:47], v[220:223], a[60:63]
  ds_read_b64_tr_b16 v[60:61], v16 offset:12800
  s_waitcnt lgkmcnt(7)
  v_mfma_f32_16x16x32_bf16 a[64:67], v[48:51], v[208:211], a[64:67]
  ds_read_b64_tr_b16 v[62:63], v16 offset:14848
  v_cvt_pk_bf16_f32 v145, v146, v147
  v_mfma_f32_16x16x32_bf16 a[68:71], v[48:51], v[212:215], a[68:71]
  buffer_load_dwordx4 a[224:227], v26, s[44:47], s72 offen offset:0 sc1
  v_mfma_f32_16x16x32_bf16 a[72:75], v[48:51], v[216:219], a[72:75]
  ds_read_b128 a[168:171], v13 offset:12288
  ds_read_b128 a[172:175], v14 offset:12288
  v_mfma_f32_16x16x32_bf16 a[76:79], v[48:51], v[220:223], a[76:79]
  v_exp_f32 v178, v178
  v_mfma_f32_16x16x32_bf16 a[80:83], v[52:55], v[208:211], a[80:83]
  v_exp_f32 v179, v179
  v_mfma_f32_16x16x32_bf16 a[84:87], v[52:55], v[212:215], a[84:87]
  v_exp_f32 v148, v148
  v_mfma_f32_16x16x32_bf16 a[88:91], v[52:55], v[216:219], a[88:91]
  v_exp_f32 v149, v149
  v_mfma_f32_16x16x32_bf16 a[92:95], v[52:55], v[220:223], a[92:95]
  v_cvt_pk_bf16_f32 v146, v176, v177
  s_waitcnt lgkmcnt(2)
  v_mfma_f32_16x16x32_bf16 a[96:99], v[56:59], v[208:211], a[96:99]
  buffer_load_dwordx4 a[228:231], v26, s[44:47], s72 offen offset:1024 sc1
  v_mfma_f32_16x16x32_bf16 a[100:103], v[56:59], v[212:215], a[100:103]
  v_exp_f32 v150, v150
  v_mfma_f32_16x16x32_bf16 a[104:107], v[56:59], v[216:219], a[104:107]
  v_exp_f32 v151, v151
  v_mfma_f32_16x16x32_bf16 a[108:111], v[56:59], v[220:223], a[108:111]
  v_exp_f32 v180, v180
  v_mfma_f32_16x16x32_bf16 a[112:115], v[60:63], v[208:211], a[112:115]
  v_exp_f32 v181, v181
  v_mfma_f32_16x16x32_bf16 a[116:119], v[60:63], v[212:215], a[116:119]
  v_cvt_pk_bf16_f32 v147, v178, v179
  v_cvt_pk_bf16_f32 v148, v148, v149
  v_mfma_f32_16x16x32_bf16 a[120:123], v[60:63], v[216:219], a[120:123]
  buffer_load_dwordx4 a[232:235], v26, s[44:47], s72 offen offset:2048 sc1
  v_mfma_f32_16x16x32_bf16 a[124:127], v[60:63], v[220:223], a[124:127]
  v_exp_f32 v182, v182
  v_mfma_f32_16x16x32_bf16 a[128:131], v[112:115], v[208:211], a[128:131]
  v_exp_f32 v183, v183
  v_mfma_f32_16x16x32_bf16 a[132:135], v[112:115], v[212:215], a[132:135]
  v_exp_f32 v152, v152
  v_mfma_f32_16x16x32_bf16 a[136:139], v[112:115], v[216:219], a[136:139]
  v_exp_f32 v153, v153
  v_mfma_f32_16x16x32_bf16 a[140:143], v[112:115], v[220:223], a[140:143]
  v_cvt_pk_bf16_f32 v149, v150, v151
  v_mfma_f32_16x16x32_bf16 v[208:211], a[144:147], v[128:131], v[96:99]
  buffer_load_dwordx4 a[236:239], v26, s[44:47], s72 offen offset:3072 sc1
  v_mfma_f32_16x16x32_bf16 v[208:211], a[148:151], v[160:163], v[208:211]
  v_exp_f32 v154, v154
  v_mfma_f32_16x16x32_bf16 v[208:211], a[152:155], v[192:195], v[208:211]
  v_exp_f32 v155, v155
  v_mfma_f32_16x16x32_bf16 v[208:211], a[156:159], v[224:227], v[208:211]
  v_cvt_pk_bf16_f32 v150, v180, v181
  s_waitcnt lgkmcnt(0)
  v_mfma_f32_16x16x32_bf16 v[240:243], a[160:163], v[128:131], v[96:99]
  v_exp_f32 v184, v184
  v_mfma_f32_16x16x32_bf16 v[240:243], a[164:167], v[160:163], v[240:243]
  v_exp_f32 v185, v185
  v_mfma_f32_16x16x32_bf16 v[240:243], a[168:171], v[192:195], v[240:243]
  s_add_u32 s72, s72, 0x2000
  v_cvt_pk_bf16_f32 v151, v182, v183
  v_mfma_f32_16x16x32_bf16 v[240:243], a[172:175], v[224:227], v[240:243]
  v_exp_f32 v186, v186
  v_mfma_f32_16x16x32_bf16 v[212:215], a[144:147], v[132:135], v[100:103]
  v_exp_f32 v187, v187
  v_mfma_f32_16x16x32_bf16 v[212:215], a[148:151], v[164:167], v[212:215]
  v_cvt_pk_bf16_f32 v152, v152, v153
  v_cvt_pk_bf16_f32 v153, v154, v155
  v_mfma_f32_16x16x32_bf16 v[212:215], a[152:155], v[196:199], v[212:215]
  v_exp_f32 v156, v156
  v_mfma_f32_16x16x32_bf16 v[212:215], a[156:159], v[228:231], v[212:215]
  v_exp_f32 v157, v157
  v_mfma_f32_16x16x32_bf16 v[244:247], a[160:163], v[132:135], v[100:103]
  v_exp_f32 v158, v158
  v_mfma_f32_16x16x32_bf16 v[244:247], a[164:167], v[164:167], v[244:247]
  v_exp_f32 v159, v159
  v_mfma_f32_16x16x32_bf16 v[244:247], a[168:171], v[196:199], v[244:247]
  v_cvt_pk_bf16_f32 v154, v184, v185
  v_cvt_pk_bf16_f32 v155, v186, v187
  v_mfma_f32_16x16x32_bf16 v[244:247], a[172:175], v[228:231], v[244:247]
  v_exp_f32 v188, v188
  v_mfma_f32_16x16x32_bf16 v[216:219], a[144:147], v[136:139], v[104:107]
  v_exp_f32 v189, v189
  v_mfma_f32_16x16x32_bf16 v[216:219], a[148:151], v[168:171], v[216:219]
  v_exp_f32 v190, v190
  v_mfma_f32_16x16x32_bf16 v[216:219], a[152:155], v[200:203], v[216:219]
  s_barrier
  v_mfma_f32_16x16x32_bf16 v[216:219], a[156:159], v[232:235], v[216:219]
  s_mov_b32 s59, s100
  v_add_u32 v15, s59, v15
  v_mfma_f32_16x16x32_bf16 v[248:251], a[160:163], v[136:139], v[104:107]
  v_add_u32 v16, s59, v16
  ds_read_b64_tr_b16 v[32:33], v15 offset:0
  v_mfma_f32_16x16x32_bf16 v[248:251], a[164:167], v[168:171], v[248:251]
  ds_read_b64_tr_b16 v[34:35], v15 offset:2048
  v_cvt_pk_bf16_f32 v156, v156, v157
  v_mfma_f32_16x16x32_bf16 v[248:251], a[168:171], v[200:203], v[248:251]
  v_exp_f32 v191, v191
  v_mfma_f32_16x16x32_bf16 v[248:251], a[172:175], v[232:235], v[248:251]
  ds_read_b64_tr_b16 v[36:37], v16 offset:0
  ds_read_b64_tr_b16 v[38:39], v16 offset:2048
  v_mfma_f32_16x16x32_bf16 v[220:223], a[144:147], v[140:143], v[108:111]
  v_exp_f32 v208, v208
  v_mfma_f32_16x16x32_bf16 v[220:223], a[148:151], v[172:175], v[220:223]
  v_exp_f32 v209, v209
  v_mfma_f32_16x16x32_bf16 v[220:223], a[152:155], v[204:207], v[220:223]
  v_cvt_pk_bf16_f32 v157, v158, v159
  v_cvt_pk_bf16_f32 v158, v188, v189
  v_mfma_f32_16x16x32_bf16 v[220:223], a[156:159], v[236:239], v[220:223]
  ds_read_b64_tr_b16 v[40:41], v15 offset:512
  ds_read_b64_tr_b16 v[42:43], v15 offset:2560
  v_mfma_f32_16x16x32_bf16 v[252:255], a[160:163], v[140:143], v[108:111]
  v_exp_f32 v210, v210
  v_mfma_f32_16x16x32_bf16 v[252:255], a[164:167], v[172:175], v[252:255]
  v_exp_f32 v211, v211
  v_mfma_f32_16x16x32_bf16 v[252:255], a[168:171], v[204:207], v[252:255]
  s_add_u32 m0, s5, 0x20000
  v_cvt_pk_bf16_f32 v159, v190, v191
  v_mfma_f32_16x16x32_bf16 v[252:255], a[172:175], v[236:239], v[252:255]
  ds_read_b64_tr_b16 v[44:45], v16 offset:512
  s_waitcnt lgkmcnt(3)
  v_mfma_f32_16x16x32_bf16 a[0:3], v[32:35], v[144:147], a[0:3]
  ds_read_b64_tr_b16 v[46:47], v16 offset:2560
  v_cvt_pk_bf16_f32 v208, v208, v209
  v_mfma_f32_16x16x32_bf16 a[4:7], v[32:35], v[148:151], a[4:7]
  buffer_load_dwordx4 v7, s[80:83], s71 offen offset:0 lds
  v_mfma_f32_16x16x32_bf16 a[8:11], v[32:35], v[152:155], a[8:11]
  v_exp_f32 v240, v240
  v_mfma_f32_16x16x32_bf16 a[12:15], v[32:35], v[156:159], a[12:15]
  ds_read_b64_tr_b16 v[48:49], v15 offset:8192
  ds_read_b64_tr_b16 v[50:51], v15 offset:10240
  v_mfma_f32_16x16x32_bf16 a[16:19], v[36:39], v[144:147], a[16:19]
  buffer_load_dwordx4 v8, s[80:83], s71 offen offset:1024 lds
  v_mfma_f32_16x16x32_bf16 a[20:23], v[36:39], v[148:151], a[20:23]
  v_exp_f32 v241, v241
  v_mfma_f32_16x16x32_bf16 a[24:27], v[36:39], v[152:155], a[24:27]
  buffer_load_dwordx4 v9, s[80:83], s71 offen offset:2048 lds
  v_mfma_f32_16x16x32_bf16 a[28:31], v[36:39], v[156:159], a[28:31]
  ds_read_b64_tr_b16 v[52:53], v16 offset:8192
  s_waitcnt lgkmcnt(3)
  v_mfma_f32_16x16x32_bf16 a[32:35], v[40:43], v[144:147], a[32:35]
  ds_read_b64_tr_b16 v[54:55], v16 offset:10240
  v_cvt_pk_bf16_f32 v209, v210, v211
  v_mfma_f32_16x16x32_bf16 a[36:39], v[40:43], v[148:151], a[36:39]
  buffer_load_dwordx4 v10, s[80:83], s71 offen offset:3072 lds
  v_mfma_f32_16x16x32_bf16 a[40:43], v[40:43], v[152:155], a[40:43]
  v_exp_f32 v242, v242
  v_mfma_f32_16x16x32_bf16 a[44:47], v[40:43], v[156:159], a[44:47]
  ds_read_b64_tr_b16 v[56:57], v15 offset:8704
  ds_read_b64_tr_b16 v[58:59], v15 offset:10752
  v_mfma_f32_16x16x32_bf16 a[48:51], v[44:47], v[144:147], a[48:51]
  s_add_u32 s71, s71, 0x20000
  s_add_u32 m0, s5, 0x24000
  v_mfma_f32_16x16x32_bf16 a[52:55], v[44:47], v[148:151], a[52:55]
  buffer_load_dwordx4 v7, s[80:83], s71 offen offset:0 lds
  v_mfma_f32_16x16x32_bf16 a[56:59], v[44:47], v[152:155], a[56:59]
  v_exp_f32 v243, v243
  v_mfma_f32_16x16x32_bf16 a[60:63], v[44:47], v[156:159], a[60:63]
  ds_read_b64_tr_b16 v[60:61], v16 offset:8704
  s_waitcnt lgkmcnt(3)
  v_mfma_f32_16x16x32_bf16 a[64:67], v[48:51], v[144:147], a[64:67]
  ds_read_b64_tr_b16 v[62:63], v16 offset:10752
  v_cvt_pk_bf16_f32 v210, v240, v241
  v_mfma_f32_16x16x32_bf16 a[68:71], v[48:51], v[148:151], a[68:71]
  buffer_load_dwordx4 v8, s[80:83], s71 offen offset:1024 lds
  v_mfma_f32_16x16x32_bf16 a[72:75], v[48:51], v[152:155], a[72:75]
  v_exp_f32 v212, v212
  v_mfma_f32_16x16x32_bf16 a[76:79], v[48:51], v[156:159], a[76:79]
  buffer_load_dwordx4 v9, s[80:83], s71 offen offset:2048 lds
  v_mfma_f32_16x16x32_bf16 a[80:83], v[52:55], v[144:147], a[80:83]
  v_exp_f32 v213, v213
  v_mfma_f32_16x16x32_bf16 a[84:87], v[52:55], v[148:151], a[84:87]
  buffer_load_dwordx4 v10, s[80:83], s71 offen offset:3072 lds
  v_mfma_f32_16x16x32_bf16 a[88:91], v[52:55], v[152:155], a[88:91]
  v_exp_f32 v214, v214
  v_mfma_f32_16x16x32_bf16 a[92:95], v[52:55], v[156:159], a[92:95]
  s_add_u32 s71, s71, 0x20000
  s_waitcnt lgkmcnt(0)
  v_mfma_f32_16x16x32_bf16 a[96:99], v[56:59], v[144:147], a[96:99]
  v_exp_f32 v215, v215
  v_mfma_f32_16x16x32_bf16 a[100:103], v[56:59], v[148:151], a[100:103]
  v_exp_f32 v244, v244
  v_mfma_f32_16x16x32_bf16 a[104:107], v[56:59], v[152:155], a[104:107]
  v_exp_f32 v245, v245
  v_mfma_f32_16x16x32_bf16 a[108:111], v[56:59], v[156:159], a[108:111]
  ds_read_b64_tr_b16 v[32:33], v15 offset:4096
  ds_read_b64_tr_b16 v[34:35], v15 offset:6144
  v_mfma_f32_16x16x32_bf16 a[112:115], v[60:63], v[144:147], a[112:115]
  v_cvt_pk_bf16_f32 v211, v242, v243
  v_cvt_pk_bf16_f32 v212, v212, v213
  v_mfma_f32_16x16x32_bf16 a[116:119], v[60:63], v[148:151], a[116:119]
  v_exp_f32 v246, v246
  v_mfma_f32_16x16x32_bf16 a[120:123], v[60:63], v[152:155], a[120:123]
  v_exp_f32 v247, v247
  v_mfma_f32_16x16x32_bf16 a[124:127], v[60:63], v[156:159], a[124:127]
  ds_read_b64_tr_b16 v[36:37], v16 offset:4096
  ds_read_b64_tr_b16 v[38:39], v16 offset:6144
  v_mfma_f32_16x16x32_bf16 a[128:131], v[112:115], v[144:147], a[128:131]
  v_exp_f32 v216, v216
  v_mfma_f32_16x16x32_bf16 a[132:135], v[112:115], v[148:151], a[132:135]
  v_exp_f32 v217, v217
  v_exp_f32 v218, v218
  v_exp_f32 v219, v219
  v_exp_f32 v248, v248
  v_exp_f32 v249, v249
  v_exp_f32 v250, v250
  v_exp_f32 v251, v251
  v_exp_f32 v220, v220
  v_exp_f32 v221, v221
  v_exp_f32 v222, v222
  v_exp_f32 v223, v223
  v_exp_f32 v252, v252
  v_exp_f32 v253, v253
  v_exp_f32 v254, v254
  v_exp_f32 v255, v255
  v_mfma_f32_16x16x32_bf16 a[136:139], v[112:115], v[152:155], a[136:139]
  v_cvt_pk_bf16_f32 v213, v214, v215
  v_cvt_pk_bf16_f32 v214, v244, v245
  v_cvt_pk_bf16_f32 v215, v246, v247
  v_cvt_pk_bf16_f32 v216, v216, v217
  v_cvt_pk_bf16_f32 v217, v218, v219
  v_cvt_pk_bf16_f32 v218, v248, v249
  v_cvt_pk_bf16_f32 v219, v250, v251
  v_cvt_pk_bf16_f32 v220, v220, v221
  v_cvt_pk_bf16_f32 v221, v222, v223
  v_cvt_pk_bf16_f32 v222, v252, v253
  v_cvt_pk_bf16_f32 v223, v254, v255
  v_mfma_f32_16x16x32_bf16 a[140:143], v[112:115], v[156:159], a[140:143]
  ds_read_b64_tr_b16 v[40:41], v15 offset:4608
  ds_read_b64_tr_b16 v[42:43], v15 offset:6656
  v_mfma_f32_16x16x32_bf16 a[128:131], v[112:115], v[208:211], a[128:131]
  s_add_u32 m0, s5, 0x18000
  v_mfma_f32_16x16x32_bf16 a[132:135], v[112:115], v[212:215], a[132:135]
  buffer_load_dwordx4 v7, s[80:83], s71 offen offset:0 lds
  v_mfma_f32_16x16x32_bf16 a[136:139], v[112:115], v[216:219], a[136:139]
  buffer_load_dwordx4 v8, s[80:83], s71 offen offset:1024 lds
  v_mfma_f32_16x16x32_bf16 a[140:143], v[112:115], v[220:223], a[140:143]
  ds_read_b64_tr_b16 v[44:45], v16 offset:4608
  s_waitcnt lgkmcnt(3)
  v_mfma_f32_16x16x32_bf16 a[0:3], v[32:35], v[208:211], a[0:3]
  ds_read_b64_tr_b16 v[46:47], v16 offset:6656
  v_mfma_f32_16x16x32_bf16 a[4:7], v[32:35], v[212:215], a[4:7]
  buffer_load_dwordx4 v9, s[80:83], s71 offen offset:2048 lds
  v_mfma_f32_16x16x32_bf16 a[8:11], v[32:35], v[216:219], a[8:11]
  buffer_load_dwordx4 v10, s[80:83], s71 offen offset:3072 lds
  v_mfma_f32_16x16x32_bf16 a[12:15], v[32:35], v[220:223], a[12:15]
  ds_read_b64_tr_b16 v[48:49], v15 offset:12288
  ds_read_b64_tr_b16 v[50:51], v15 offset:14336
  v_mfma_f32_16x16x32_bf16 a[16:19], v[36:39], v[208:211], a[16:19]
  s_add_u32 s71, s71, 0x20000
  s_add_u32 m0, s5, 0x1c000
  v_mfma_f32_16x16x32_bf16 a[20:23], v[36:39], v[212:215], a[20:23]
  buffer_load_dwordx4 v7, s[80:83], s71 offen offset:0 lds
  v_mfma_f32_16x16x32_bf16 a[24:27], v[36:39], v[216:219], a[24:27]
  buffer_load_dwordx4 v8, s[80:83], s71 offen offset:1024 lds
  buffer_load_dwordx4 v9, s[80:83], s71 offen offset:2048 lds
  buffer_load_dwordx4 v10, s[80:83], s71 offen offset:3072 lds
  s_add_u32 s71, s71, 0x20000
  v_mfma_f32_16x16x32_bf16 a[28:31], v[36:39], v[220:223], a[28:31]
  v_accvgpr_read_b32 v116, a128
  v_accvgpr_read_b32 v117, a132
  v_accvgpr_read_b32 v118, a136
  v_accvgpr_read_b32 v119, a140
  v_max3_f32 v124, v116, v117, v118
  s_mov_b32 s62, 0x4b800000
  v_max_f32 v124, v124, v119
  v_cmp_nge_f32 vcc, s62, v124
  s_cbranch_vccnz L_fallback
L_fb_ret:
  v_rcp_f32 v120, v116
  v_rcp_f32 v121, v117
  v_rcp_f32 v122, v118
  v_rcp_f32 v123, v119
  s_waitcnt lgkmcnt(2)
  v_mfma_f32_16x16x32_bf16 a[32:35], v[40:43], v[208:211], a[32:35]
  ds_read_b64_tr_b16 v[52:53], v16 offset:12288
  ds_read_b64_tr_b16 v[54:55], v16 offset:14336
  v_mfma_f32_16x16x32_bf16 a[36:39], v[40:43], v[212:215], a[36:39]
  buffer_load_dwordx4 a[144:147], v25, s[44:47], s72 offen offset:0 sc1
  s_add_u32 s54, s53, 4096
  v_mfma_f32_16x16x32_bf16 a[40:43], v[40:43], v[216:219], a[40:43]
  buffer_load_dwordx4 a[148:151], v25, s[44:47], s72 offen offset:1024 sc1
  s_add_u32 s55, s53, 8192
  v_mfma_f32_16x16x32_bf16 a[44:47], v[40:43], v[220:223], a[44:47]
  ds_read_b64_tr_b16 v[56:57], v15 offset:12800
  ds_read_b64_tr_b16 v[58:59], v15 offset:14848
  s_add_u32 s3, s53, 12288
  v_mfma_f32_16x16x32_bf16 a[48:51], v[44:47], v[208:211], a[48:51]
  buffer_load_dwordx4 a[152:155], v25, s[44:47], s72 offen offset:2048 sc1
  v_lshrrev_b32 v21, 2, v1
  v_mfma_f32_16x16x32_bf16 a[52:55], v[44:47], v[212:215], a[52:55]
  buffer_load_dwordx4 a[156:159], v25, s[44:47], s72 offen offset:3072 sc1
  s_lshl_b32 s62, s32, 8
  v_mfma_f32_16x16x32_bf16 a[56:59], v[44:47], v[216:219], a[56:59]
  buffer_load_dwordx4 a[160:163], v26, s[44:47], s72 offen offset:0 sc1
  s_lshl_b32 s63, s33, 6
  v_mfma_f32_16x16x32_bf16 a[60:63], v[44:47], v[220:223], a[60:63]
  s_waitcnt vmcnt(49)
  s_barrier
  s_waitcnt lgkmcnt(2)
  v_mfma_f32_16x16x32_bf16 a[64:67], v[48:51], v[208:211], a[64:67]
  ds_read_b64_tr_b16 v[60:61], v16 offset:12800
  ds_read_b64_tr_b16 v[62:63], v16 offset:14848
  s_add_u32 s62, s62, s63
  v_mfma_f32_16x16x32_bf16 a[68:71], v[48:51], v[212:215], a[68:71]
  ds_read_b64_tr_b16 v[64:65], v2 offset:0
  ds_read_b64_tr_b16 v[66:67], v2 offset:2048
  v_add_u32 v21, s62, v21
  v_mfma_f32_16x16x32_bf16 a[72:75], v[48:51], v[216:219], a[72:75]
  ds_read_b64_tr_b16 v[68:69], v2 offset:4096
  ds_read_b64_tr_b16 v[70:71], v2 offset:6144
  v_lshlrev_b32 v21, 11, v21
  v_mfma_f32_16x16x32_bf16 a[76:79], v[48:51], v[220:223], a[76:79]
  buffer_load_dwordx4 a[164:167], v26, s[44:47], s72 offen offset:1024 sc1
  v_and_b32 v24, 3, v1
  v_mfma_f32_16x16x32_bf16 a[80:83], v[52:55], v[208:211], a[80:83]
  buffer_load_dwordx4 a[168:171], v26, s[44:47], s72 offen offset:2048 sc1
  v_lshl_add_u32 v21, v24, 4, v21
  v_mfma_f32_16x16x32_bf16 a[84:87], v[52:55], v[212:215], a[84:87]
  buffer_load_dwordx4 a[172:175], v26, s[44:47], s72 offen offset:3072 sc1
  s_lshl_b32 s62, s48, 6
  v_mfma_f32_16x16x32_bf16 a[88:91], v[52:55], v[216:219], a[88:91]
  s_add_u32 s72, s72, 0x2000
  s_add_u32 s62, s62, s49
  v_add_u32 v21, s62, v21
  v_mfma_f32_16x16x32_bf16 a[92:95], v[52:55], v[220:223], a[92:95]
  ds_read_b64_tr_b16 v[72:73], v3 offset:0
  v_and_b32 v24, 15, v1
  s_waitcnt lgkmcnt(5)
  v_mfma_f32_16x16x32_bf16 a[96:99], v[56:59], v[208:211], a[96:99]
  ds_read_b64_tr_b16 v[74:75], v3 offset:2048
  v_lshlrev_b32 v24, 6, v24
  v_lshrrev_b32 v31, 4, v1
  v_mfma_f32_16x16x32_bf16 a[100:103], v[56:59], v[212:215], a[100:103]
  ds_read_b64_tr_b16 v[76:77], v3 offset:4096
  v_lshl_add_u32 v24, v31, 4, v24
  s_add_u32 s62, s5, 0x14000
  v_mfma_f32_16x16x32_bf16 a[104:107], v[56:59], v[216:219], a[104:107]
  ds_read_b64_tr_b16 v[78:79], v3 offset:6144
  v_add_u32 v24, s62, v24
  v_add_u32 v31, s62, v25
  v_mfma_f32_16x16x32_bf16 a[108:111], v[56:59], v[220:223], a[108:111]
  buffer_load_dwordx4 a[240:243], v25, s[44:47], s72 offen offset:0 sc1
  s_mov_b32 s8, 0
  v_mfma_f32_16x16x32_bf16 a[112:115], v[60:63], v[208:211], a[112:115]
  buffer_load_dwordx4 a[244:247], v25, s[44:47], s72 offen offset:1024 sc1
  s_mov_b32 s9, 31744
  v_mfma_f32_16x16x32_bf16 a[116:119], v[60:63], v[212:215], a[116:119]
  buffer_load_dwordx4 a[248:251], v25, s[44:47], s72 offen offset:2048 sc1
  s_mov_b32 s10, 63488
  v_mfma_f32_16x16x32_bf16 a[120:123], v[60:63], v[216:219], a[120:123]
  buffer_load_dwordx4 a[252:255], v25, s[44:47], s72 offen offset:3072 sc1
  s_mov_b32 s11, 95232
  v_mfma_f32_16x16x32_bf16 a[124:127], v[60:63], v[220:223], a[124:127]
  v_accvgpr_read_b32 v96, a0
  s_waitcnt vmcnt(36)
  s_waitcnt lgkmcnt(4)
  v_mfma_f32_16x16x32_bf16 v[128:131], v[64:67], a[176:179], 0
  ds_read_b64_tr_b16 v[80:81], v2 offset:512
  ds_read_b64_tr_b16 v[82:83], v2 offset:2560
  v_accvgpr_read_b32 v97, a1
  v_mfma_f32_16x16x32_bf16 v[128:131], v[68:71], a[192:195], v[128:131]
  ds_read_b64_tr_b16 v[84:85], v2 offset:4608
  v_accvgpr_read_b32 v98, a2
  v_accvgpr_read_b32 v99, a3
  v_mfma_f32_16x16x32_bf16 v[132:135], v[64:67], a[180:183], 0
  ds_read_b64_tr_b16 v[86:87], v2 offset:6656
  v_accvgpr_read_b32 v100, a16
  v_accvgpr_read_b32 v101, a17
  v_mfma_f32_16x16x32_bf16 v[132:135], v[68:71], a[196:199], v[132:135]
  buffer_load_dwordx4 a[128:131], v26, s[44:47], s72 offen offset:0 sc1
  v_accvgpr_read_b32 v102, a18
  v_mfma_f32_16x16x32_bf16 v[136:139], v[64:67], a[184:187], 0
  buffer_load_dwordx4 a[132:135], v26, s[44:47], s72 offen offset:1024 sc1
  v_accvgpr_read_b32 v103, a19
  v_mfma_f32_16x16x32_bf16 v[136:139], v[68:71], a[200:203], v[136:139]
  buffer_load_dwordx4 a[136:139], v26, s[44:47], s72 offen offset:2048 sc1
  v_mul_f32 v96, v96, v120
  v_mfma_f32_16x16x32_bf16 v[140:143], v[64:67], a[188:191], 0
  buffer_load_dwordx4 a[140:143], v26, s[44:47], s72 offen offset:3072 sc1
  v_mul_f32 v97, v97, v120
  v_mfma_f32_16x16x32_bf16 v[140:143], v[68:71], a[204:207], v[140:143]
  ds_read_b64_tr_b16 v[88:89], v3 offset:512
  v_mul_f32 v98, v98, v120
  s_waitcnt lgkmcnt(5)
  v_mfma_f32_16x16x32_bf16 v[144:147], v[72:75], a[176:179], 0
  ds_read_b64_tr_b16 v[90:91], v3 offset:2560
  s_add_u32 s72, s72, 0x2000
  v_mul_f32 v99, v99, v120
  v_mfma_f32_16x16x32_bf16 v[144:147], v[76:79], a[192:195], v[144:147]
  ds_read_b64_tr_b16 v[92:93], v3 offset:4608
  v_mul_f32 v100, v100, v120
  v_mul_f32 v101, v101, v120
  v_mfma_f32_16x16x32_bf16 v[148:151], v[72:75], a[180:183], 0
  ds_read_b64_tr_b16 v[94:95], v3 offset:6656
  v_mul_f32 v102, v102, v120
  v_mul_f32 v103, v103, v120
  v_mfma_f32_16x16x32_bf16 v[148:151], v[76:79], a[196:199], v[148:151]
  buffer_load_dwordx4 v[32:35], v25, s[44:47], s72 offen offset:0 sc1
  v_cvt_pk_bf16_f32 v112, v96, v97
  v_mfma_f32_16x16x32_bf16 v[152:155], v[72:75], a[184:187], 0
  v_cvt_pk_bf16_f32 v113, v98, v99
  v_cvt_pk_bf16_f32 v114, v100, v101
  v_cvt_pk_bf16_f32 v115, v102, v103
  v_mfma_f32_16x16x32_bf16 v[152:155], v[76:79], a[200:203], v[152:155]
  buffer_store_dwordx4 v[112:115], v25, s[40:43], s53 offen offset:0 sc1
  v_accvgpr_read_b32 v104, a4
  v_accvgpr_read_b32 v105, a5
  v_mfma_f32_16x16x32_bf16 v[156:159], v[72:75], a[188:191], 0
  buffer_load_dwordx4 v[36:39], v25, s[44:47], s72 offen offset:1024 sc1
  v_accvgpr_read_b32 v106, a6
  v_mfma_f32_16x16x32_bf16 v[156:159], v[76:79], a[204:207], v[156:159]
  ds_read_b64_tr_b16 v[64:65], v2 offset:8192
  v_accvgpr_read_b32 v107, a7
  s_waitcnt lgkmcnt(5)
  v_mfma_f32_16x16x32_bf16 v[160:163], v[80:83], a[176:179], 0
  ds_read_b64_tr_b16 v[66:67], v2 offset:10240
  v_accvgpr_read_b32 v108, a20
  v_accvgpr_read_b32 v109, a21
  v_mfma_f32_16x16x32_bf16 v[160:163], v[84:87], a[192:195], v[160:163]
  ds_read_b64_tr_b16 v[68:69], v2 offset:12288
  v_accvgpr_read_b32 v110, a22
  v_accvgpr_read_b32 v111, a23
  v_mfma_f32_16x16x32_bf16 v[164:167], v[80:83], a[180:183], 0
  ds_read_b64_tr_b16 v[70:71], v2 offset:14336
  v_mul_f32 v104, v104, v121
  v_mul_f32 v105, v105, v121
  v_mfma_f32_16x16x32_bf16 v[164:167], v[84:87], a[196:199], v[164:167]
  buffer_load_dwordx4 v[40:43], v25, s[44:47], s72 offen offset:2048 sc1
  v_mul_f32 v106, v106, v121
  v_mfma_f32_16x16x32_bf16 v[168:171], v[80:83], a[184:187], 0
  v_mul_f32 v107, v107, v121
  v_mul_f32 v108, v108, v121
  v_mul_f32 v109, v109, v121
  v_mfma_f32_16x16x32_bf16 v[168:171], v[84:87], a[200:203], v[168:171]
  v_mul_f32 v110, v110, v121
  v_mul_f32 v111, v111, v121
  v_cvt_pk_bf16_f32 v116, v104, v105
  v_mfma_f32_16x16x32_bf16 v[172:175], v[80:83], a[188:191], 0
  buffer_load_dwordx4 v[44:47], v25, s[44:47], s72 offen offset:3072 sc1
  v_cvt_pk_bf16_f32 v117, v106, v107
  v_mfma_f32_16x16x32_bf16 v[172:175], v[84:87], a[204:207], v[172:175]
  ds_read_b64_tr_b16 v[72:73], v3 offset:8192
  v_cvt_pk_bf16_f32 v118, v108, v109
  s_waitcnt lgkmcnt(5)
  v_mfma_f32_16x16x32_bf16 v[176:179], v[88:91], a[176:179], 0
  ds_read_b64_tr_b16 v[74:75], v3 offset:10240
  v_cvt_pk_bf16_f32 v119, v110, v111
  buffer_store_dwordx4 v[116:119], v25, s[40:43], s53 offen offset:1024 sc1
  v_mfma_f32_16x16x32_bf16 v[176:179], v[92:95], a[192:195], v[176:179]
  ds_read_b64_tr_b16 v[76:77], v3 offset:12288
  v_accvgpr_read_b32 v96, a8
  v_accvgpr_read_b32 v97, a9
  v_mfma_f32_16x16x32_bf16 v[180:183], v[88:91], a[180:183], 0
  ds_read_b64_tr_b16 v[78:79], v3 offset:14336
  v_accvgpr_read_b32 v98, a10
  v_accvgpr_read_b32 v99, a11
  v_mfma_f32_16x16x32_bf16 v[180:183], v[92:95], a[196:199], v[180:183]
  buffer_load_dwordx4 v[48:51], v26, s[44:47], s72 offen offset:0 sc1
  v_accvgpr_read_b32 v100, a24
  v_mfma_f32_16x16x32_bf16 v[184:187], v[88:91], a[184:187], 0
  v_accvgpr_read_b32 v101, a25
  v_accvgpr_read_b32 v102, a26
  v_accvgpr_read_b32 v103, a27
  v_mfma_f32_16x16x32_bf16 v[184:187], v[92:95], a[200:203], v[184:187]
  v_mul_f32 v96, v96, v122
  v_mul_f32 v97, v97, v122
  v_mul_f32 v98, v98, v122
  v_mfma_f32_16x16x32_bf16 v[188:191], v[88:91], a[188:191], 0
  buffer_load_dwordx4 v[52:55], v26, s[44:47], s72 offen offset:1024 sc1
  v_mul_f32 v99, v99, v122
  v_mfma_f32_16x16x32_bf16 v[188:191], v[92:95], a[204:207], v[188:191]
  ds_read_b64_tr_b16 v[80:81], v2 offset:8704
  v_mul_f32 v100, v100, v122
  s_waitcnt lgkmcnt(5)
  v_mfma_f32_16x16x32_bf16 v[192:195], v[64:67], a[176:179], 0
  ds_read_b64_tr_b16 v[82:83], v2 offset:10752
  v_mul_f32 v101, v101, v122
  v_mul_f32 v102, v102, v122
  v_mfma_f32_16x16x32_bf16 v[192:195], v[68:71], a[192:195], v[192:195]
  ds_read_b64_tr_b16 v[84:85], v2 offset:12800
  v_mul_f32 v103, v103, v122
  v_cvt_pk_bf16_f32 v112, v96, v97
  v_mfma_f32_16x16x32_bf16 v[196:199], v[64:67], a[180:183], 0
  ds_read_b64_tr_b16 v[86:87], v2 offset:14848
  v_cvt_pk_bf16_f32 v113, v98, v99
  v_cvt_pk_bf16_f32 v114, v100, v101
  v_mfma_f32_16x16x32_bf16 v[196:199], v[68:71], a[196:199], v[196:199]
  buffer_load_dwordx4 v[56:59], v26, s[44:47], s72 offen offset:2048 sc1
  v_cvt_pk_bf16_f32 v115, v102, v103
  v_mfma_f32_16x16x32_bf16 v[200:203], v[64:67], a[184:187], 0
  buffer_store_dwordx4 v[112:115], v25, s[40:43], s53 offen offset:2048 sc1
  v_mfma_f32_16x16x32_bf16 v[200:203], v[68:71], a[200:203], v[200:203]
  v_mfma_f32_16x16x32_bf16 v[204:207], v[64:67], a[188:191], 0
  buffer_load_dwordx4 v[60:63], v26, s[44:47], s72 offen offset:3072 sc1
  v_mfma_f32_16x16x32_bf16 v[204:207], v[68:71], a[204:207], v[204:207]
  ds_read_b64_tr_b16 v[88:89], v3 offset:8704
  v_accvgpr_read_b32 v104, a12
  s_waitcnt lgkmcnt(5)
  v_mfma_f32_16x16x32_bf16 v[208:211], v[72:75], a[176:179], 0
  ds_read_b64_tr_b16 v[90:91], v3 offset:10752
  v_accvgpr_read_b32 v105, a13
  v_accvgpr_read_b32 v106, a14
  v_mfma_f32_16x16x32_bf16 v[208:211], v[76:79], a[192:195], v[208:211]
  ds_read_b64_tr_b16 v[92:93], v3 offset:12800
  s_add_u32 s72, s72, 0x2000
  v_accvgpr_read_b32 v107, a15
  v_mfma_f32_16x16x32_bf16 v[212:215], v[72:75], a[180:183], 0
  ds_read_b64_tr_b16 v[94:95], v3 offset:14848
  v_accvgpr_read_b32 v108, a28
  v_accvgpr_read_b32 v109, a29
  v_mfma_f32_16x16x32_bf16 v[212:215], v[76:79], a[196:199], v[212:215]
  v_accvgpr_read_b32 v110, a30
  v_accvgpr_read_b32 v111, a31
  v_mul_f32 v104, v104, v123
  v_mfma_f32_16x16x32_bf16 v[216:219], v[72:75], a[184:187], 0
  v_mul_f32 v105, v105, v123
  v_mul_f32 v106, v106, v123
  v_mul_f32 v107, v107, v123
  v_mfma_f32_16x16x32_bf16 v[216:219], v[76:79], a[200:203], v[216:219]
  v_mul_f32 v108, v108, v123
  v_mul_f32 v109, v109, v123
  v_mul_f32 v110, v110, v123
  v_mfma_f32_16x16x32_bf16 v[220:223], v[72:75], a[188:191], 0
  v_mul_f32 v111, v111, v123
  v_cvt_pk_bf16_f32 v116, v104, v105
  v_cvt_pk_bf16_f32 v117, v106, v107
  v_mfma_f32_16x16x32_bf16 v[220:223], v[76:79], a[204:207], v[220:223]
  s_barrier
  s_waitcnt lgkmcnt(4)
  v_mfma_f32_16x16x32_bf16 v[224:227], v[80:83], a[176:179], 0
  ds_read_b64_tr_b16 v[64:65], v2 offset:16384
  ds_read_b64_tr_b16 v[66:67], v2 offset:18432
  v_cvt_pk_bf16_f32 v118, v108, v109
  v_mfma_f32_16x16x32_bf16 v[224:227], v[84:87], a[192:195], v[224:227]
  ds_read_b64_tr_b16 v[68:69], v2 offset:20480
  v_cvt_pk_bf16_f32 v119, v110, v111
  buffer_store_dwordx4 v[116:119], v25, s[40:43], s53 offen offset:3072 sc1
  v_mfma_f32_16x16x32_bf16 v[228:231], v[80:83], a[180:183], 0
  ds_read_b64_tr_b16 v[70:71], v2 offset:22528
  v_mfma_f32_16x16x32_bf16 v[228:231], v[84:87], a[196:199], v[228:231]
  v_mfma_f32_16x16x32_bf16 v[232:235], v[80:83], a[184:187], 0
  v_mfma_f32_16x16x32_bf16 v[232:235], v[84:87], a[200:203], v[232:235]
  v_mfma_f32_16x16x32_bf16 v[236:239], v[80:83], a[188:191], 0
  v_mfma_f32_16x16x32_bf16 v[236:239], v[84:87], a[204:207], v[236:239]
  ds_read_b64_tr_b16 v[72:73], v3 offset:16384
  v_accvgpr_read_b32 v96, a32
  s_waitcnt lgkmcnt(5)
  v_mfma_f32_16x16x32_bf16 v[240:243], v[88:91], a[176:179], 0
  ds_read_b64_tr_b16 v[74:75], v3 offset:18432
  v_accvgpr_read_b32 v97, a33
  v_accvgpr_read_b32 v98, a34
  v_mfma_f32_16x16x32_bf16 v[240:243], v[92:95], a[192:195], v[240:243]
  ds_read_b64_tr_b16 v[76:77], v3 offset:20480
  v_accvgpr_read_b32 v99, a35
  v_accvgpr_read_b32 v100, a48
  v_mfma_f32_16x16x32_bf16 v[244:247], v[88:91], a[180:183], 0
  ds_read_b64_tr_b16 v[78:79], v3 offset:22528
  v_accvgpr_read_b32 v101, a49
  v_accvgpr_read_b32 v102, a50
  v_mfma_f32_16x16x32_bf16 v[244:247], v[92:95], a[196:199], v[244:247]
  v_accvgpr_read_b32 v103, a51
  v_mul_f32 v96, v96, v120
  v_mul_f32 v97, v97, v120
  v_mfma_f32_16x16x32_bf16 v[248:251], v[88:91], a[184:187], 0
  v_mul_f32 v98, v98, v120
  v_mul_f32 v99, v99, v120
  v_mul_f32 v100, v100, v120
  v_mfma_f32_16x16x32_bf16 v[248:251], v[92:95], a[200:203], v[248:251]
  v_mul_f32 v101, v101, v120
  v_mul_f32 v102, v102, v120
  v_mul_f32 v103, v103, v120
  v_mfma_f32_16x16x32_bf16 v[252:255], v[88:91], a[188:191], 0
  v_cvt_pk_bf16_f32 v112, v96, v97
  v_cvt_pk_bf16_f32 v113, v98, v99
  v_cvt_pk_bf16_f32 v114, v100, v101
  v_mfma_f32_16x16x32_bf16 v[252:255], v[92:95], a[204:207], v[252:255]
  v_cvt_pk_bf16_f32 v115, v102, v103
  s_waitcnt vmcnt(44)
  s_waitcnt lgkmcnt(4)
  v_mfma_f32_16x16x32_bf16 v[128:131], v[64:67], a[208:211], v[128:131]
  ds_read_b64_tr_b16 v[80:81], v2 offset:16896
  ds_read_b64_tr_b16 v[82:83], v2 offset:18944
  buffer_store_dwordx4 v[112:115], v25, s[40:43], s54 offen offset:0 sc1
  v_mfma_f32_16x16x32_bf16 v[128:131], v[68:71], a[224:227], v[128:131]
  ds_read_b64_tr_b16 v[84:85], v2 offset:20992
  v_mfma_f32_16x16x32_bf16 v[132:135], v[64:67], a[212:215], v[132:135]
  ds_read_b64_tr_b16 v[86:87], v2 offset:23040
  v_mfma_f32_16x16x32_bf16 v[132:135], v[68:71], a[228:231], v[132:135]
  buffer_load_dwordx4 a[176:179], v25, s[44:47], s72 offen offset:0 sc1
  v_mfma_f32_16x16x32_bf16 v[136:139], v[64:67], a[216:219], v[136:139]
  v_mfma_f32_16x16x32_bf16 v[136:139], v[68:71], a[232:235], v[136:139]
  v_mfma_f32_16x16x32_bf16 v[140:143], v[64:67], a[220:223], v[140:143]
  buffer_load_dwordx4 a[180:183], v25, s[44:47], s72 offen offset:1024 sc1
  v_mfma_f32_16x16x32_bf16 v[140:143], v[68:71], a[236:239], v[140:143]
  ds_read_b64_tr_b16 v[88:89], v3 offset:16896
  v_accvgpr_read_b32 v104, a36
  s_waitcnt lgkmcnt(5)
  v_mfma_f32_16x16x32_bf16 v[144:147], v[72:75], a[208:211], v[144:147]
  ds_read_b64_tr_b16 v[90:91], v3 offset:18944
  v_accvgpr_read_b32 v105, a37
  v_accvgpr_read_b32 v106, a38
  v_mfma_f32_16x16x32_bf16 v[144:147], v[76:79], a[224:227], v[144:147]
  ds_read_b64_tr_b16 v[92:93], v3 offset:20992
  v_accvgpr_read_b32 v107, a39
  v_accvgpr_read_b32 v108, a52
  v_mfma_f32_16x16x32_bf16 v[148:151], v[72:75], a[212:215], v[148:151]
  ds_read_b64_tr_b16 v[94:95], v3 offset:23040
  v_accvgpr_read_b32 v109, a53
  v_accvgpr_read_b32 v110, a54
  v_mfma_f32_16x16x32_bf16 v[148:151], v[76:79], a[228:231], v[148:151]
  buffer_load_dwordx4 a[184:187], v25, s[44:47], s72 offen offset:2048 sc1
  v_accvgpr_read_b32 v111, a55
  v_mfma_f32_16x16x32_bf16 v[152:155], v[72:75], a[216:219], v[152:155]
  v_mul_f32 v104, v104, v121
  v_mul_f32 v105, v105, v121
  v_mul_f32 v106, v106, v121
  v_mfma_f32_16x16x32_bf16 v[152:155], v[76:79], a[232:235], v[152:155]
  v_mul_f32 v107, v107, v121
  v_mul_f32 v108, v108, v121
  v_mul_f32 v109, v109, v121
  v_mfma_f32_16x16x32_bf16 v[156:159], v[72:75], a[220:223], v[156:159]
  buffer_load_dwordx4 a[188:191], v25, s[44:47], s72 offen offset:3072 sc1
  v_mul_f32 v110, v110, v121
  v_mfma_f32_16x16x32_bf16 v[156:159], v[76:79], a[236:239], v[156:159]
  ds_read_b64_tr_b16 v[64:65], v2 offset:24576
  v_mul_f32 v111, v111, v121
  s_waitcnt lgkmcnt(5)
  v_mfma_f32_16x16x32_bf16 v[160:163], v[80:83], a[208:211], v[160:163]
  ds_read_b64_tr_b16 v[66:67], v2 offset:26624
  v_cvt_pk_bf16_f32 v116, v104, v105
  v_cvt_pk_bf16_f32 v117, v106, v107
  v_mfma_f32_16x16x32_bf16 v[160:163], v[84:87], a[224:227], v[160:163]
  ds_read_b64_tr_b16 v[68:69], v2 offset:28672
  v_cvt_pk_bf16_f32 v118, v108, v109
  v_cvt_pk_bf16_f32 v119, v110, v111
  v_mfma_f32_16x16x32_bf16 v[164:167], v[80:83], a[212:215], v[164:167]
  ds_read_b64_tr_b16 v[70:71], v2 offset:30720
  buffer_store_dwordx4 v[116:119], v25, s[40:43], s54 offen offset:1024 sc1
  v_mfma_f32_16x16x32_bf16 v[164:167], v[84:87], a[228:231], v[164:167]
  buffer_load_dwordx4 a[192:195], v26, s[44:47], s72 offen offset:0 sc1
  v_mfma_f32_16x16x32_bf16 v[168:171], v[80:83], a[216:219], v[168:171]
  v_mfma_f32_16x16x32_bf16 v[168:171], v[84:87], a[232:235], v[168:171]
  v_mfma_f32_16x16x32_bf16 v[172:175], v[80:83], a[220:223], v[172:175]
  buffer_load_dwordx4 a[196:199], v26, s[44:47], s72 offen offset:1024 sc1
  v_mfma_f32_16x16x32_bf16 v[172:175], v[84:87], a[236:239], v[172:175]
  ds_read_b64_tr_b16 v[72:73], v3 offset:24576
  v_accvgpr_read_b32 v96, a40
  s_waitcnt lgkmcnt(5)
  v_mfma_f32_16x16x32_bf16 v[176:179], v[88:91], a[208:211], v[176:179]
  ds_read_b64_tr_b16 v[74:75], v3 offset:26624
  v_accvgpr_read_b32 v97, a41
  v_accvgpr_read_b32 v98, a42
  v_mfma_f32_16x16x32_bf16 v[176:179], v[92:95], a[224:227], v[176:179]
  ds_read_b64_tr_b16 v[76:77], v3 offset:28672
  v_accvgpr_read_b32 v99, a43
  v_accvgpr_read_b32 v100, a56
  v_mfma_f32_16x16x32_bf16 v[180:183], v[88:91], a[212:215], v[180:183]
  ds_read_b64_tr_b16 v[78:79], v3 offset:30720
  v_accvgpr_read_b32 v101, a57
  v_accvgpr_read_b32 v102, a58
  v_mfma_f32_16x16x32_bf16 v[180:183], v[92:95], a[228:231], v[180:183]
  buffer_load_dwordx4 a[200:203], v26, s[44:47], s72 offen offset:2048 sc1
  v_accvgpr_read_b32 v103, a59
  v_mfma_f32_16x16x32_bf16 v[184:187], v[88:91], a[216:219], v[184:187]
  v_mul_f32 v96, v96, v122
  v_mul_f32 v97, v97, v122
  v_mul_f32 v98, v98, v122
  v_mfma_f32_16x16x32_bf16 v[184:187], v[92:95], a[232:235], v[184:187]
  v_mul_f32 v99, v99, v122
  v_mul_f32 v100, v100, v122
  v_mul_f32 v101, v101, v122
  v_mfma_f32_16x16x32_bf16 v[188:191], v[88:91], a[220:223], v[188:191]
  buffer_load_dwordx4 a[204:207], v26, s[44:47], s72 offen offset:3072 sc1
  v_mul_f32 v102, v102, v122
  v_mfma_f32_16x16x32_bf16 v[188:191], v[92:95], a[236:239], v[188:191]
  ds_read_b64_tr_b16 v[80:81], v2 offset:25088
  v_mul_f32 v103, v103, v122
  s_waitcnt lgkmcnt(5)
  v_mfma_f32_16x16x32_bf16 v[192:195], v[64:67], a[208:211], v[192:195]
  ds_read_b64_tr_b16 v[82:83], v2 offset:27136
  v_cvt_pk_bf16_f32 v112, v96, v97
  v_cvt_pk_bf16_f32 v113, v98, v99
  v_mfma_f32_16x16x32_bf16 v[192:195], v[68:71], a[224:227], v[192:195]
  ds_read_b64_tr_b16 v[84:85], v2 offset:29184
  s_add_u32 s72, s72, 0x2000
  v_cvt_pk_bf16_f32 v114, v100, v101
  v_mfma_f32_16x16x32_bf16 v[196:199], v[64:67], a[212:215], v[196:199]
  ds_read_b64_tr_b16 v[86:87], v2 offset:31232
  v_cvt_pk_bf16_f32 v115, v102, v103
  buffer_store_dwordx4 v[112:115], v25, s[40:43], s54 offen offset:2048 sc1
  v_mfma_f32_16x16x32_bf16 v[196:199], v[68:71], a[228:231], v[196:199]
  v_mfma_f32_16x16x32_bf16 v[200:203], v[64:67], a[216:219], v[200:203]
  v_mfma_f32_16x16x32_bf16 v[200:203], v[68:71], a[232:235], v[200:203]
  v_mfma_f32_16x16x32_bf16 v[204:207], v[64:67], a[220:223], v[204:207]
  v_mfma_f32_16x16x32_bf16 v[204:207], v[68:71], a[236:239], v[204:207]
  ds_read_b64_tr_b16 v[88:89], v3 offset:25088
  v_accvgpr_read_b32 v104, a44
  s_waitcnt lgkmcnt(5)
  v_mfma_f32_16x16x32_bf16 v[208:211], v[72:75], a[208:211], v[208:211]
  ds_read_b64_tr_b16 v[90:91], v3 offset:27136
  v_accvgpr_read_b32 v105, a45
  v_accvgpr_read_b32 v106, a46
  v_mfma_f32_16x16x32_bf16 v[208:211], v[76:79], a[224:227], v[208:211]
  ds_read_b64_tr_b16 v[92:93], v3 offset:29184
  v_accvgpr_read_b32 v107, a47
  v_accvgpr_read_b32 v108, a60
  v_mfma_f32_16x16x32_bf16 v[212:215], v[72:75], a[212:215], v[212:215]
  ds_read_b64_tr_b16 v[94:95], v3 offset:31232
  v_accvgpr_read_b32 v109, a61
  v_accvgpr_read_b32 v110, a62
  v_mfma_f32_16x16x32_bf16 v[212:215], v[76:79], a[228:231], v[212:215]
  v_accvgpr_read_b32 v111, a63
  v_mul_f32 v104, v104, v123
  v_mul_f32 v105, v105, v123
  v_mfma_f32_16x16x32_bf16 v[216:219], v[72:75], a[216:219], v[216:219]
  v_mul_f32 v106, v106, v123
  v_mul_f32 v107, v107, v123
  v_mul_f32 v108, v108, v123
  v_mfma_f32_16x16x32_bf16 v[216:219], v[76:79], a[232:235], v[216:219]
  v_mul_f32 v109, v109, v123
  v_mul_f32 v110, v110, v123
  v_mul_f32 v111, v111, v123
  v_mfma_f32_16x16x32_bf16 v[220:223], v[72:75], a[220:223], v[220:223]
  v_cvt_pk_bf16_f32 v116, v104, v105
  v_cvt_pk_bf16_f32 v117, v106, v107
  v_cvt_pk_bf16_f32 v118, v108, v109
  v_mfma_f32_16x16x32_bf16 v[220:223], v[76:79], a[236:239], v[220:223]
  s_barrier
  s_waitcnt lgkmcnt(4)
  v_mfma_f32_16x16x32_bf16 v[224:227], v[80:83], a[208:211], v[224:227]
  ds_read_b64_tr_b16 v[64:65], v2 offset:32768
  ds_read_b64_tr_b16 v[66:67], v2 offset:34816
  v_cvt_pk_bf16_f32 v119, v110, v111
  v_mfma_f32_16x16x32_bf16 v[224:227], v[84:87], a[224:227], v[224:227]
  ds_read_b64_tr_b16 v[68:69], v2 offset:36864
  buffer_store_dwordx4 v[116:119], v25, s[40:43], s54 offen offset:3072 sc1
  v_mfma_f32_16x16x32_bf16 v[228:231], v[80:83], a[212:215], v[228:231]
  ds_read_b64_tr_b16 v[70:71], v2 offset:38912
  v_mfma_f32_16x16x32_bf16 v[228:231], v[84:87], a[228:231], v[228:231]
  v_mfma_f32_16x16x32_bf16 v[232:235], v[80:83], a[216:219], v[232:235]
  v_mfma_f32_16x16x32_bf16 v[232:235], v[84:87], a[232:235], v[232:235]
  v_mfma_f32_16x16x32_bf16 v[236:239], v[80:83], a[220:223], v[236:239]
  v_mfma_f32_16x16x32_bf16 v[236:239], v[84:87], a[236:239], v[236:239]
  ds_read_b64_tr_b16 v[72:73], v3 offset:32768
  v_accvgpr_read_b32 v96, a64
  s_waitcnt lgkmcnt(5)
  v_mfma_f32_16x16x32_bf16 v[240:243], v[88:91], a[208:211], v[240:243]
  ds_read_b64_tr_b16 v[74:75], v3 offset:34816
  v_accvgpr_read_b32 v97, a65
  v_accvgpr_read_b32 v98, a66
  v_mfma_f32_16x16x32_bf16 v[240:243], v[92:95], a[224:227], v[240:243]
  ds_read_b64_tr_b16 v[76:77], v3 offset:36864
  v_accvgpr_read_b32 v99, a67
  v_accvgpr_read_b32 v100, a80
  v_mfma_f32_16x16x32_bf16 v[244:247], v[88:91], a[212:215], v[244:247]
  ds_read_b64_tr_b16 v[78:79], v3 offset:38912
  v_accvgpr_read_b32 v101, a81
  v_accvgpr_read_b32 v102, a82
  v_mfma_f32_16x16x32_bf16 v[244:247], v[92:95], a[228:231], v[244:247]
  v_accvgpr_read_b32 v103, a83
  v_mul_f32 v96, v96, v120
  v_mul_f32 v97, v97, v120
  v_mfma_f32_16x16x32_bf16 v[248:251], v[88:91], a[216:219], v[248:251]
  v_mul_f32 v98, v98, v120
  v_mul_f32 v99, v99, v120
  v_mul_f32 v100, v100, v120
  v_mfma_f32_16x16x32_bf16 v[248:251], v[92:95], a[232:235], v[248:251]
  v_mul_f32 v101, v101, v120
  v_mul_f32 v102, v102, v120
  v_mul_f32 v103, v103, v120
  v_mfma_f32_16x16x32_bf16 v[252:255], v[88:91], a[220:223], v[252:255]
  v_cvt_pk_bf16_f32 v112, v96, v97
  v_cvt_pk_bf16_f32 v113, v98, v99
  v_cvt_pk_bf16_f32 v114, v100, v101
  v_mfma_f32_16x16x32_bf16 v[252:255], v[92:95], a[236:239], v[252:255]
  v_cvt_pk_bf16_f32 v115, v102, v103
  s_waitcnt vmcnt(32)
  s_waitcnt lgkmcnt(4)
  v_mfma_f32_16x16x32_bf16 v[128:131], v[64:67], a[144:147], v[128:131]
  ds_read_b64_tr_b16 v[80:81], v2 offset:33280
  ds_read_b64_tr_b16 v[82:83], v2 offset:35328
  buffer_store_dwordx4 v[112:115], v25, s[40:43], s55 offen offset:0 sc1
  v_mfma_f32_16x16x32_bf16 v[128:131], v[68:71], a[160:163], v[128:131]
  ds_read_b64_tr_b16 v[84:85], v2 offset:37376
  v_mfma_f32_16x16x32_bf16 v[132:135], v[64:67], a[148:151], v[132:135]
  ds_read_b64_tr_b16 v[86:87], v2 offset:39424
  v_mfma_f32_16x16x32_bf16 v[132:135], v[68:71], a[164:167], v[132:135]
  buffer_load_dwordx4 a[208:211], v25, s[44:47], s72 offen offset:0 sc1
  v_mfma_f32_16x16x32_bf16 v[136:139], v[64:67], a[152:155], v[136:139]
  v_mfma_f32_16x16x32_bf16 v[136:139], v[68:71], a[168:171], v[136:139]
  v_mfma_f32_16x16x32_bf16 v[140:143], v[64:67], a[156:159], v[140:143]
  buffer_load_dwordx4 a[212:215], v25, s[44:47], s72 offen offset:1024 sc1
  v_mfma_f32_16x16x32_bf16 v[140:143], v[68:71], a[172:175], v[140:143]
  ds_read_b64_tr_b16 v[88:89], v3 offset:33280
  v_accvgpr_read_b32 v104, a68
  s_waitcnt lgkmcnt(5)
  v_mfma_f32_16x16x32_bf16 v[144:147], v[72:75], a[144:147], v[144:147]
  ds_read_b64_tr_b16 v[90:91], v3 offset:35328
  v_accvgpr_read_b32 v105, a69
  v_accvgpr_read_b32 v106, a70
  v_mfma_f32_16x16x32_bf16 v[144:147], v[76:79], a[160:163], v[144:147]
  ds_read_b64_tr_b16 v[92:93], v3 offset:37376
  v_accvgpr_read_b32 v107, a71
  v_accvgpr_read_b32 v108, a84
  v_mfma_f32_16x16x32_bf16 v[148:151], v[72:75], a[148:151], v[148:151]
  ds_read_b64_tr_b16 v[94:95], v3 offset:39424
  v_accvgpr_read_b32 v109, a85
  v_accvgpr_read_b32 v110, a86
  v_mfma_f32_16x16x32_bf16 v[148:151], v[76:79], a[164:167], v[148:151]
  buffer_load_dwordx4 a[216:219], v25, s[44:47], s72 offen offset:2048 sc1
  v_accvgpr_read_b32 v111, a87
  v_mfma_f32_16x16x32_bf16 v[152:155], v[72:75], a[152:155], v[152:155]
  v_mul_f32 v104, v104, v121
  v_mul_f32 v105, v105, v121
  v_mul_f32 v106, v106, v121
  v_mfma_f32_16x16x32_bf16 v[152:155], v[76:79], a[168:171], v[152:155]
  v_mul_f32 v107, v107, v121
  v_mul_f32 v108, v108, v121
  v_mul_f32 v109, v109, v121
  v_mfma_f32_16x16x32_bf16 v[156:159], v[72:75], a[156:159], v[156:159]
  buffer_load_dwordx4 a[220:223], v25, s[44:47], s72 offen offset:3072 sc1
  v_mul_f32 v110, v110, v121
  v_mfma_f32_16x16x32_bf16 v[156:159], v[76:79], a[172:175], v[156:159]
  ds_read_b64_tr_b16 v[64:65], v2 offset:40960
  v_mul_f32 v111, v111, v121
  s_waitcnt lgkmcnt(5)
  v_mfma_f32_16x16x32_bf16 v[160:163], v[80:83], a[144:147], v[160:163]
  ds_read_b64_tr_b16 v[66:67], v2 offset:43008
  v_cvt_pk_bf16_f32 v116, v104, v105
  v_cvt_pk_bf16_f32 v117, v106, v107
  v_mfma_f32_16x16x32_bf16 v[160:163], v[84:87], a[160:163], v[160:163]
  ds_read_b64_tr_b16 v[68:69], v2 offset:45056
  v_cvt_pk_bf16_f32 v118, v108, v109
  v_cvt_pk_bf16_f32 v119, v110, v111
  v_mfma_f32_16x16x32_bf16 v[164:167], v[80:83], a[148:151], v[164:167]
  ds_read_b64_tr_b16 v[70:71], v2 offset:47104
  buffer_store_dwordx4 v[116:119], v25, s[40:43], s55 offen offset:1024 sc1
  v_mfma_f32_16x16x32_bf16 v[164:167], v[84:87], a[164:167], v[164:167]
  buffer_load_dwordx4 a[224:227], v26, s[44:47], s72 offen offset:0 sc1
  v_mfma_f32_16x16x32_bf16 v[168:171], v[80:83], a[152:155], v[168:171]
  v_mfma_f32_16x16x32_bf16 v[168:171], v[84:87], a[168:171], v[168:171]
  v_mfma_f32_16x16x32_bf16 v[172:175], v[80:83], a[156:159], v[172:175]
  buffer_load_dwordx4 a[228:231], v26, s[44:47], s72 offen offset:1024 sc1
  v_mfma_f32_16x16x32_bf16 v[172:175], v[84:87], a[172:175], v[172:175]
  ds_read_b64_tr_b16 v[72:73], v3 offset:40960
  v_accvgpr_read_b32 v96, a72
  s_waitcnt lgkmcnt(5)
  v_mfma_f32_16x16x32_bf16 v[176:179], v[88:91], a[144:147], v[176:179]
  ds_read_b64_tr_b16 v[74:75], v3 offset:43008
  v_accvgpr_read_b32 v97, a73
  v_accvgpr_read_b32 v98, a74
  v_mfma_f32_16x16x32_bf16 v[176:179], v[92:95], a[160:163], v[176:179]
  ds_read_b64_tr_b16 v[76:77], v3 offset:45056
  v_accvgpr_read_b32 v99, a75
  v_accvgpr_read_b32 v100, a88
  v_mfma_f32_16x16x32_bf16 v[180:183], v[88:91], a[148:151], v[180:183]
  ds_read_b64_tr_b16 v[78:79], v3 offset:47104
  v_accvgpr_read_b32 v101, a89
  v_accvgpr_read_b32 v102, a90
  v_mfma_f32_16x16x32_bf16 v[180:183], v[92:95], a[164:167], v[180:183]
  buffer_load_dwordx4 a[232:235], v26, s[44:47], s72 offen offset:2048 sc1
  v_accvgpr_read_b32 v103, a91
  v_mfma_f32_16x16x32_bf16 v[184:187], v[88:91], a[152:155], v[184:187]
  v_mul_f32 v96, v96, v122
  v_mul_f32 v97, v97, v122
  v_mul_f32 v98, v98, v122
  v_mfma_f32_16x16x32_bf16 v[184:187], v[92:95], a[168:171], v[184:187]
  v_mul_f32 v99, v99, v122
  v_mul_f32 v100, v100, v122
  v_mul_f32 v101, v101, v122
  v_mfma_f32_16x16x32_bf16 v[188:191], v[88:91], a[156:159], v[188:191]
  buffer_load_dwordx4 a[236:239], v26, s[44:47], s72 offen offset:3072 sc1
  v_mul_f32 v102, v102, v122
  v_mfma_f32_16x16x32_bf16 v[188:191], v[92:95], a[172:175], v[188:191]
  ds_read_b64_tr_b16 v[80:81], v2 offset:41472
  v_mul_f32 v103, v103, v122
  s_waitcnt lgkmcnt(5)
  v_mfma_f32_16x16x32_bf16 v[192:195], v[64:67], a[144:147], v[192:195]
  ds_read_b64_tr_b16 v[82:83], v2 offset:43520
  v_cvt_pk_bf16_f32 v112, v96, v97
  v_cvt_pk_bf16_f32 v113, v98, v99
  v_mfma_f32_16x16x32_bf16 v[192:195], v[68:71], a[160:163], v[192:195]
  ds_read_b64_tr_b16 v[84:85], v2 offset:45568
  s_add_u32 s72, s72, 0x2000
  v_cvt_pk_bf16_f32 v114, v100, v101
  v_mfma_f32_16x16x32_bf16 v[196:199], v[64:67], a[148:151], v[196:199]
  ds_read_b64_tr_b16 v[86:87], v2 offset:47616
  v_cvt_pk_bf16_f32 v115, v102, v103
  buffer_store_dwordx4 v[112:115], v25, s[40:43], s55 offen offset:2048 sc1
  v_mfma_f32_16x16x32_bf16 v[196:199], v[68:71], a[164:167], v[196:199]
  v_mfma_f32_16x16x32_bf16 v[200:203], v[64:67], a[152:155], v[200:203]
  v_mfma_f32_16x16x32_bf16 v[200:203], v[68:71], a[168:171], v[200:203]
  v_mfma_f32_16x16x32_bf16 v[204:207], v[64:67], a[156:159], v[204:207]
  v_mfma_f32_16x16x32_bf16 v[204:207], v[68:71], a[172:175], v[204:207]
  ds_read_b64_tr_b16 v[88:89], v3 offset:41472
  v_accvgpr_read_b32 v104, a76
  s_waitcnt lgkmcnt(5)
  v_mfma_f32_16x16x32_bf16 v[208:211], v[72:75], a[144:147], v[208:211]
  ds_read_b64_tr_b16 v[90:91], v3 offset:43520
  v_accvgpr_read_b32 v105, a77
  v_accvgpr_read_b32 v106, a78
  v_mfma_f32_16x16x32_bf16 v[208:211], v[76:79], a[160:163], v[208:211]
  ds_read_b64_tr_b16 v[92:93], v3 offset:45568
  v_accvgpr_read_b32 v107, a79
  v_accvgpr_read_b32 v108, a92
  v_mfma_f32_16x16x32_bf16 v[212:215], v[72:75], a[148:151], v[212:215]
  ds_read_b64_tr_b16 v[94:95], v3 offset:47616
  v_accvgpr_read_b32 v109, a93
  v_accvgpr_read_b32 v110, a94
  v_mfma_f32_16x16x32_bf16 v[212:215], v[76:79], a[164:167], v[212:215]
  v_accvgpr_read_b32 v111, a95
  v_mul_f32 v104, v104, v123
  v_mul_f32 v105, v105, v123
  v_mfma_f32_16x16x32_bf16 v[216:219], v[72:75], a[152:155], v[216:219]
  v_mul_f32 v106, v106, v123
  v_mul_f32 v107, v107, v123
  v_mul_f32 v108, v108, v123
  v_mfma_f32_16x16x32_bf16 v[216:219], v[76:79], a[168:171], v[216:219]
  v_mul_f32 v109, v109, v123
  v_mul_f32 v110, v110, v123
  v_mul_f32 v111, v111, v123
  v_mfma_f32_16x16x32_bf16 v[220:223], v[72:75], a[156:159], v[220:223]
  v_cvt_pk_bf16_f32 v116, v104, v105
  v_cvt_pk_bf16_f32 v117, v106, v107
  v_cvt_pk_bf16_f32 v118, v108, v109
  v_mfma_f32_16x16x32_bf16 v[220:223], v[76:79], a[172:175], v[220:223]
  s_barrier
  s_waitcnt lgkmcnt(4)
  v_mfma_f32_16x16x32_bf16 v[224:227], v[80:83], a[144:147], v[224:227]
  ds_read_b64_tr_b16 v[64:65], v2 offset:49152
  ds_read_b64_tr_b16 v[66:67], v2 offset:51200
  v_cvt_pk_bf16_f32 v119, v110, v111
  v_mfma_f32_16x16x32_bf16 v[224:227], v[84:87], a[160:163], v[224:227]
  ds_read_b64_tr_b16 v[68:69], v2 offset:53248
  buffer_store_dwordx4 v[116:119], v25, s[40:43], s55 offen offset:3072 sc1
  v_mfma_f32_16x16x32_bf16 v[228:231], v[80:83], a[148:151], v[228:231]
  ds_read_b64_tr_b16 v[70:71], v2 offset:55296
  v_mfma_f32_16x16x32_bf16 v[228:231], v[84:87], a[164:167], v[228:231]
  v_mfma_f32_16x16x32_bf16 v[232:235], v[80:83], a[152:155], v[232:235]
  v_mfma_f32_16x16x32_bf16 v[232:235], v[84:87], a[168:171], v[232:235]
  v_mfma_f32_16x16x32_bf16 v[236:239], v[80:83], a[156:159], v[236:239]
  v_mfma_f32_16x16x32_bf16 v[236:239], v[84:87], a[172:175], v[236:239]
  ds_read_b64_tr_b16 v[72:73], v3 offset:49152
  v_accvgpr_read_b32 v96, a96
  s_waitcnt lgkmcnt(5)
  v_mfma_f32_16x16x32_bf16 v[240:243], v[88:91], a[144:147], v[240:243]
  ds_read_b64_tr_b16 v[74:75], v3 offset:51200
  v_accvgpr_read_b32 v97, a97
  v_accvgpr_read_b32 v98, a98
  v_mfma_f32_16x16x32_bf16 v[240:243], v[92:95], a[160:163], v[240:243]
  ds_read_b64_tr_b16 v[76:77], v3 offset:53248
  v_accvgpr_read_b32 v99, a99
  v_accvgpr_read_b32 v100, a112
  v_mfma_f32_16x16x32_bf16 v[244:247], v[88:91], a[148:151], v[244:247]
  ds_read_b64_tr_b16 v[78:79], v3 offset:55296
  v_accvgpr_read_b32 v101, a113
  v_accvgpr_read_b32 v102, a114
  v_mfma_f32_16x16x32_bf16 v[244:247], v[92:95], a[164:167], v[244:247]
  v_accvgpr_read_b32 v103, a115
  v_mul_f32 v96, v96, v120
  v_mul_f32 v97, v97, v120
  v_mfma_f32_16x16x32_bf16 v[248:251], v[88:91], a[152:155], v[248:251]
  v_mul_f32 v98, v98, v120
  v_mul_f32 v99, v99, v120
  v_mul_f32 v100, v100, v120
  v_mfma_f32_16x16x32_bf16 v[248:251], v[92:95], a[168:171], v[248:251]
  v_mul_f32 v101, v101, v120
  v_mul_f32 v102, v102, v120
  v_mul_f32 v103, v103, v120
  v_mfma_f32_16x16x32_bf16 v[252:255], v[88:91], a[156:159], v[252:255]
  v_cvt_pk_bf16_f32 v112, v96, v97
  v_cvt_pk_bf16_f32 v113, v98, v99
  v_cvt_pk_bf16_f32 v114, v100, v101
  v_mfma_f32_16x16x32_bf16 v[252:255], v[92:95], a[172:175], v[252:255]
  v_cvt_pk_bf16_f32 v115, v102, v103
  s_waitcnt vmcnt(36)
  s_waitcnt lgkmcnt(4)
  v_mfma_f32_16x16x32_bf16 v[128:131], v[64:67], a[240:243], v[128:131]
  ds_read_b64_tr_b16 v[80:81], v2 offset:49664
  ds_read_b64_tr_b16 v[82:83], v2 offset:51712
  buffer_store_dwordx4 v[112:115], v25, s[40:43], s3 offen offset:0 sc1
  v_mfma_f32_16x16x32_bf16 v[128:131], v[68:71], a[128:131], v[128:131]
  ds_read_b64_tr_b16 v[84:85], v2 offset:53760
  v_mfma_f32_16x16x32_bf16 v[132:135], v[64:67], a[244:247], v[132:135]
  ds_read_b64_tr_b16 v[86:87], v2 offset:55808
  v_mfma_f32_16x16x32_bf16 v[132:135], v[68:71], a[132:135], v[132:135]
  buffer_load_dwordx4 a[144:147], v25, s[44:47], s72 offen offset:0 sc1
  v_mfma_f32_16x16x32_bf16 v[136:139], v[64:67], a[248:251], v[136:139]
  v_mfma_f32_16x16x32_bf16 v[136:139], v[68:71], a[136:139], v[136:139]
  v_mfma_f32_16x16x32_bf16 v[140:143], v[64:67], a[252:255], v[140:143]
  buffer_load_dwordx4 a[148:151], v25, s[44:47], s72 offen offset:1024 sc1
  v_mfma_f32_16x16x32_bf16 v[140:143], v[68:71], a[140:143], v[140:143]
  ds_read_b64_tr_b16 v[88:89], v3 offset:49664
  v_accvgpr_read_b32 v104, a100
  s_waitcnt lgkmcnt(5)
  v_mfma_f32_16x16x32_bf16 v[144:147], v[72:75], a[240:243], v[144:147]
  ds_read_b64_tr_b16 v[90:91], v3 offset:51712
  v_accvgpr_read_b32 v105, a101
  v_accvgpr_read_b32 v106, a102
  v_mfma_f32_16x16x32_bf16 v[144:147], v[76:79], a[128:131], v[144:147]
  ds_read_b64_tr_b16 v[92:93], v3 offset:53760
  v_accvgpr_read_b32 v107, a103
  v_accvgpr_read_b32 v108, a116
  v_mfma_f32_16x16x32_bf16 v[148:151], v[72:75], a[244:247], v[148:151]
  ds_read_b64_tr_b16 v[94:95], v3 offset:55808
  v_accvgpr_read_b32 v109, a117
  v_accvgpr_read_b32 v110, a118
  v_mfma_f32_16x16x32_bf16 v[148:151], v[76:79], a[132:135], v[148:151]
  buffer_load_dwordx4 a[152:155], v25, s[44:47], s72 offen offset:2048 sc1
  v_accvgpr_read_b32 v111, a119
  v_mfma_f32_16x16x32_bf16 v[152:155], v[72:75], a[248:251], v[152:155]
  v_mul_f32 v104, v104, v121
  v_mul_f32 v105, v105, v121
  v_mul_f32 v106, v106, v121
  v_mfma_f32_16x16x32_bf16 v[152:155], v[76:79], a[136:139], v[152:155]
  v_mul_f32 v107, v107, v121
  v_mul_f32 v108, v108, v121
  v_mul_f32 v109, v109, v121
  v_mfma_f32_16x16x32_bf16 v[156:159], v[72:75], a[252:255], v[156:159]
  buffer_load_dwordx4 a[156:159], v25, s[44:47], s72 offen offset:3072 sc1
  v_mul_f32 v110, v110, v121
  v_mfma_f32_16x16x32_bf16 v[156:159], v[76:79], a[140:143], v[156:159]
  ds_read_b64_tr_b16 v[64:65], v2 offset:57344
  v_mul_f32 v111, v111, v121
  s_waitcnt lgkmcnt(5)
  v_mfma_f32_16x16x32_bf16 v[160:163], v[80:83], a[240:243], v[160:163]
  ds_read_b64_tr_b16 v[66:67], v2 offset:59392
  v_cvt_pk_bf16_f32 v116, v104, v105
  v_cvt_pk_bf16_f32 v117, v106, v107
  v_mfma_f32_16x16x32_bf16 v[160:163], v[84:87], a[128:131], v[160:163]
  ds_read_b64_tr_b16 v[68:69], v2 offset:61440
  v_cvt_pk_bf16_f32 v118, v108, v109
  v_cvt_pk_bf16_f32 v119, v110, v111
  v_mfma_f32_16x16x32_bf16 v[164:167], v[80:83], a[244:247], v[164:167]
  ds_read_b64_tr_b16 v[70:71], v2 offset:63488
  buffer_store_dwordx4 v[116:119], v25, s[40:43], s3 offen offset:1024 sc1
  v_mfma_f32_16x16x32_bf16 v[164:167], v[84:87], a[132:135], v[164:167]
  buffer_load_dwordx4 a[160:163], v26, s[44:47], s72 offen offset:0 sc1
  v_mfma_f32_16x16x32_bf16 v[168:171], v[80:83], a[248:251], v[168:171]
  v_mfma_f32_16x16x32_bf16 v[168:171], v[84:87], a[136:139], v[168:171]
  v_mfma_f32_16x16x32_bf16 v[172:175], v[80:83], a[252:255], v[172:175]
  buffer_load_dwordx4 a[164:167], v26, s[44:47], s72 offen offset:1024 sc1
  v_mfma_f32_16x16x32_bf16 v[172:175], v[84:87], a[140:143], v[172:175]
  ds_read_b64_tr_b16 v[72:73], v3 offset:57344
  v_accvgpr_read_b32 v96, a104
  s_waitcnt lgkmcnt(5)
  v_mfma_f32_16x16x32_bf16 v[176:179], v[88:91], a[240:243], v[176:179]
  ds_read_b64_tr_b16 v[74:75], v3 offset:59392
  v_accvgpr_read_b32 v97, a105
  v_accvgpr_read_b32 v98, a106
  v_mfma_f32_16x16x32_bf16 v[176:179], v[92:95], a[128:131], v[176:179]
  ds_read_b64_tr_b16 v[76:77], v3 offset:61440
  v_accvgpr_read_b32 v99, a107
  v_accvgpr_read_b32 v100, a120
  v_mfma_f32_16x16x32_bf16 v[180:183], v[88:91], a[244:247], v[180:183]
  ds_read_b64_tr_b16 v[78:79], v3 offset:63488
  v_accvgpr_read_b32 v101, a121
  v_accvgpr_read_b32 v102, a122
  v_mfma_f32_16x16x32_bf16 v[180:183], v[92:95], a[132:135], v[180:183]
  buffer_load_dwordx4 a[168:171], v26, s[44:47], s72 offen offset:2048 sc1
  v_accvgpr_read_b32 v103, a123
  v_mfma_f32_16x16x32_bf16 v[184:187], v[88:91], a[248:251], v[184:187]
  v_mul_f32 v96, v96, v122
  v_mul_f32 v97, v97, v122
  v_mul_f32 v98, v98, v122
  v_mfma_f32_16x16x32_bf16 v[184:187], v[92:95], a[136:139], v[184:187]
  v_mul_f32 v99, v99, v122
  v_mul_f32 v100, v100, v122
  v_mul_f32 v101, v101, v122
  v_mfma_f32_16x16x32_bf16 v[188:191], v[88:91], a[252:255], v[188:191]
  buffer_load_dwordx4 a[172:175], v26, s[44:47], s72 offen offset:3072 sc1
  v_mul_f32 v102, v102, v122
  v_mfma_f32_16x16x32_bf16 v[188:191], v[92:95], a[140:143], v[188:191]
  ds_read_b64_tr_b16 v[80:81], v2 offset:57856
  v_mul_f32 v103, v103, v122
  s_waitcnt lgkmcnt(5)
  v_mfma_f32_16x16x32_bf16 v[192:195], v[64:67], a[240:243], v[192:195]
  ds_read_b64_tr_b16 v[82:83], v2 offset:59904
  v_cvt_pk_bf16_f32 v112, v96, v97
  v_cvt_pk_bf16_f32 v113, v98, v99
  v_mfma_f32_16x16x32_bf16 v[192:195], v[68:71], a[128:131], v[192:195]
  ds_read_b64_tr_b16 v[84:85], v2 offset:61952
  s_add_u32 s72, s72, 0x2000
  v_cvt_pk_bf16_f32 v114, v100, v101
  v_mfma_f32_16x16x32_bf16 v[196:199], v[64:67], a[244:247], v[196:199]
  ds_read_b64_tr_b16 v[86:87], v2 offset:64000
  v_cvt_pk_bf16_f32 v115, v102, v103
  buffer_store_dwordx4 v[112:115], v25, s[40:43], s3 offen offset:2048 sc1
  v_mfma_f32_16x16x32_bf16 v[196:199], v[68:71], a[132:135], v[196:199]
  v_mfma_f32_16x16x32_bf16 v[200:203], v[64:67], a[248:251], v[200:203]
  v_mfma_f32_16x16x32_bf16 v[200:203], v[68:71], a[136:139], v[200:203]
  v_mfma_f32_16x16x32_bf16 v[204:207], v[64:67], a[252:255], v[204:207]
  v_mfma_f32_16x16x32_bf16 v[204:207], v[68:71], a[140:143], v[204:207]
  ds_read_b64_tr_b16 v[88:89], v3 offset:57856
  v_accvgpr_read_b32 v104, a108
  s_waitcnt lgkmcnt(5)
  v_mfma_f32_16x16x32_bf16 v[208:211], v[72:75], a[240:243], v[208:211]
  ds_read_b64_tr_b16 v[90:91], v3 offset:59904
  v_accvgpr_read_b32 v105, a109
  v_accvgpr_read_b32 v106, a110
  v_mfma_f32_16x16x32_bf16 v[208:211], v[76:79], a[128:131], v[208:211]
  ds_read_b64_tr_b16 v[92:93], v3 offset:61952
  v_accvgpr_read_b32 v107, a111
  v_accvgpr_read_b32 v108, a124
  v_mfma_f32_16x16x32_bf16 v[212:215], v[72:75], a[244:247], v[212:215]
  ds_read_b64_tr_b16 v[94:95], v3 offset:64000
  v_accvgpr_read_b32 v109, a125
  v_accvgpr_read_b32 v110, a126
  v_mfma_f32_16x16x32_bf16 v[212:215], v[76:79], a[132:135], v[212:215]
  v_accvgpr_read_b32 v111, a127
  v_mul_f32 v104, v104, v123
  v_mul_f32 v105, v105, v123
  v_mfma_f32_16x16x32_bf16 v[216:219], v[72:75], a[248:251], v[216:219]
  v_mul_f32 v106, v106, v123
  v_mul_f32 v107, v107, v123
  v_mul_f32 v108, v108, v123
  v_mfma_f32_16x16x32_bf16 v[216:219], v[76:79], a[136:139], v[216:219]
  v_mul_f32 v109, v109, v123
  v_mul_f32 v110, v110, v123
  v_mul_f32 v111, v111, v123
  v_mfma_f32_16x16x32_bf16 v[220:223], v[72:75], a[252:255], v[220:223]
  v_cvt_pk_bf16_f32 v116, v104, v105
  v_cvt_pk_bf16_f32 v117, v106, v107
  v_cvt_pk_bf16_f32 v118, v108, v109
  v_mfma_f32_16x16x32_bf16 v[220:223], v[76:79], a[140:143], v[220:223]
  s_barrier
  s_waitcnt lgkmcnt(4)
  v_mfma_f32_16x16x32_bf16 v[224:227], v[80:83], a[240:243], v[224:227]
  ds_read_b64_tr_b16 v[64:65], v6 offset:0
  ds_read_b64_tr_b16 v[66:67], v6 offset:2048
  v_cvt_pk_bf16_f32 v119, v110, v111
  v_mfma_f32_16x16x32_bf16 v[224:227], v[84:87], a[128:131], v[224:227]
  ds_read_b64_tr_b16 v[68:69], v6 offset:4096
  buffer_store_dwordx4 v[116:119], v25, s[40:43], s3 offen offset:3072 sc1
  v_mfma_f32_16x16x32_bf16 v[228:231], v[80:83], a[244:247], v[228:231]
  ds_read_b64_tr_b16 v[70:71], v6 offset:6144
  v_mfma_f32_16x16x32_bf16 v[228:231], v[84:87], a[132:135], v[228:231]
  v_mfma_f32_16x16x32_bf16 v[232:235], v[80:83], a[248:251], v[232:235]
  v_mfma_f32_16x16x32_bf16 v[232:235], v[84:87], a[136:139], v[232:235]
  v_mfma_f32_16x16x32_bf16 v[236:239], v[80:83], a[252:255], v[236:239]
  v_mfma_f32_16x16x32_bf16 v[236:239], v[84:87], a[140:143], v[236:239]
  ds_read_b64_tr_b16 v[72:73], v30 offset:0
  s_waitcnt lgkmcnt(5)
  v_mfma_f32_16x16x32_bf16 v[240:243], v[88:91], a[240:243], v[240:243]
  ds_read_b64_tr_b16 v[74:75], v30 offset:2048
  v_mfma_f32_16x16x32_bf16 v[240:243], v[92:95], a[128:131], v[240:243]
  ds_read_b64_tr_b16 v[76:77], v30 offset:4096
  v_mfma_f32_16x16x32_bf16 v[244:247], v[88:91], a[244:247], v[244:247]
  ds_read_b64_tr_b16 v[78:79], v30 offset:6144
  v_mfma_f32_16x16x32_bf16 v[244:247], v[92:95], a[132:135], v[244:247]
  v_mfma_f32_16x16x32_bf16 v[248:251], v[88:91], a[248:251], v[248:251]
  v_mfma_f32_16x16x32_bf16 v[248:251], v[92:95], a[136:139], v[248:251]
  v_mfma_f32_16x16x32_bf16 v[252:255], v[88:91], a[252:255], v[252:255]
  v_mfma_f32_16x16x32_bf16 v[252:255], v[92:95], a[140:143], v[252:255]
  s_waitcnt vmcnt(37)
  s_waitcnt lgkmcnt(4)
  v_mfma_f32_16x16x32_bf16 v[128:131], v[64:67], v[32:35], v[128:131]
  ds_read_b64_tr_b16 v[80:81], v6 offset:512
  ds_read_b64_tr_b16 v[82:83], v6 offset:2560
  v_mfma_f32_16x16x32_bf16 v[128:131], v[68:71], v[48:51], v[128:131]
  ds_read_b64_tr_b16 v[84:85], v6 offset:4608
  s_add_u32 m0, s5, 0x10000
  v_mfma_f32_16x16x32_bf16 v[132:135], v[64:67], v[36:39], v[132:135]
  ds_read_b64_tr_b16 v[86:87], v6 offset:6656
  v_mfma_f32_16x16x32_bf16 v[132:135], v[68:71], v[52:55], v[132:135]
  buffer_load_dwordx4 v7, s[80:83], s71 offen offset:0 lds
  v_mfma_f32_16x16x32_bf16 v[136:139], v[64:67], v[40:43], v[136:139]
  v_mfma_f32_16x16x32_bf16 v[136:139], v[68:71], v[56:59], v[136:139]
  v_mfma_f32_16x16x32_bf16 v[140:143], v[64:67], v[44:47], v[140:143]
  buffer_load_dwordx4 v8, s[80:83], s71 offen offset:1024 lds
  v_mfma_f32_16x16x32_bf16 v[140:143], v[68:71], v[60:63], v[140:143]
  ds_read_b64_tr_b16 v[88:89], v30 offset:512
  s_waitcnt lgkmcnt(5)
  v_mfma_f32_16x16x32_bf16 v[144:147], v[72:75], v[32:35], v[144:147]
  ds_read_b64_tr_b16 v[90:91], v30 offset:2560
  v_mfma_f32_16x16x32_bf16 v[144:147], v[76:79], v[48:51], v[144:147]
  ds_read_b64_tr_b16 v[92:93], v30 offset:4608
  v_mfma_f32_16x16x32_bf16 v[148:151], v[72:75], v[36:39], v[148:151]
  ds_read_b64_tr_b16 v[94:95], v30 offset:6656
  v_mfma_f32_16x16x32_bf16 v[148:151], v[76:79], v[52:55], v[148:151]
  buffer_load_dwordx4 v9, s[80:83], s71 offen offset:2048 lds
  v_mfma_f32_16x16x32_bf16 v[152:155], v[72:75], v[40:43], v[152:155]
  v_mfma_f32_16x16x32_bf16 v[152:155], v[76:79], v[56:59], v[152:155]
  v_mfma_f32_16x16x32_bf16 v[156:159], v[72:75], v[44:47], v[156:159]
  buffer_load_dwordx4 v10, s[80:83], s71 offen offset:3072 lds
  v_mfma_f32_16x16x32_bf16 v[156:159], v[76:79], v[60:63], v[156:159]
  ds_read_b64_tr_b16 v[64:65], v6 offset:8192
  s_waitcnt lgkmcnt(5)
  v_mfma_f32_16x16x32_bf16 v[160:163], v[80:83], v[32:35], v[160:163]
  ds_read_b64_tr_b16 v[66:67], v6 offset:10240
  v_mfma_f32_16x16x32_bf16 v[160:163], v[84:87], v[48:51], v[160:163]
  ds_read_b64_tr_b16 v[68:69], v6 offset:12288
  s_add_u32 s71, s71, 0x20000
  v_mfma_f32_16x16x32_bf16 v[164:167], v[80:83], v[36:39], v[164:167]
  ds_read_b64_tr_b16 v[70:71], v6 offset:14336
  v_mfma_f32_16x16x32_bf16 v[164:167], v[84:87], v[52:55], v[164:167]
  buffer_load_dwordx4 a[240:243], v25, s[44:47], s72 offen offset:0 sc1
  v_mfma_f32_16x16x32_bf16 v[168:171], v[80:83], v[40:43], v[168:171]
  v_mfma_f32_16x16x32_bf16 v[168:171], v[84:87], v[56:59], v[168:171]
  v_mfma_f32_16x16x32_bf16 v[172:175], v[80:83], v[44:47], v[172:175]
  buffer_load_dwordx4 a[244:247], v25, s[44:47], s72 offen offset:1024 sc1
  v_mfma_f32_16x16x32_bf16 v[172:175], v[84:87], v[60:63], v[172:175]
  ds_read_b64_tr_b16 v[72:73], v30 offset:8192
  s_waitcnt lgkmcnt(5)
  v_mfma_f32_16x16x32_bf16 v[176:179], v[88:91], v[32:35], v[176:179]
  ds_read_b64_tr_b16 v[74:75], v30 offset:10240
  v_mfma_f32_16x16x32_bf16 v[176:179], v[92:95], v[48:51], v[176:179]
  ds_read_b64_tr_b16 v[76:77], v30 offset:12288
  v_mfma_f32_16x16x32_bf16 v[180:183], v[88:91], v[36:39], v[180:183]
  ds_read_b64_tr_b16 v[78:79], v30 offset:14336
  v_mfma_f32_16x16x32_bf16 v[180:183], v[92:95], v[52:55], v[180:183]
  buffer_load_dwordx4 a[248:251], v25, s[44:47], s72 offen offset:2048 sc1
  v_mfma_f32_16x16x32_bf16 v[184:187], v[88:91], v[40:43], v[184:187]
  v_mfma_f32_16x16x32_bf16 v[184:187], v[92:95], v[56:59], v[184:187]
  v_mfma_f32_16x16x32_bf16 v[188:191], v[88:91], v[44:47], v[188:191]
  buffer_load_dwordx4 a[252:255], v25, s[44:47], s72 offen offset:3072 sc1
  v_mfma_f32_16x16x32_bf16 v[188:191], v[92:95], v[60:63], v[188:191]
  ds_read_b64_tr_b16 v[80:81], v6 offset:8704
  s_waitcnt lgkmcnt(5)
  v_mfma_f32_16x16x32_bf16 v[192:195], v[64:67], v[32:35], v[192:195]
  ds_read_b64_tr_b16 v[82:83], v6 offset:10752
  v_mfma_f32_16x16x32_bf16 v[192:195], v[68:71], v[48:51], v[192:195]
  ds_read_b64_tr_b16 v[84:85], v6 offset:12800
  v_mfma_f32_16x16x32_bf16 v[196:199], v[64:67], v[36:39], v[196:199]
  ds_read_b64_tr_b16 v[86:87], v6 offset:14848
  v_mfma_f32_16x16x32_bf16 v[196:199], v[68:71], v[52:55], v[196:199]
  buffer_load_dwordx4 a[128:131], v26, s[44:47], s72 offen offset:0 sc1
  v_mfma_f32_16x16x32_bf16 v[200:203], v[64:67], v[40:43], v[200:203]
  v_mfma_f32_16x16x32_bf16 v[200:203], v[68:71], v[56:59], v[200:203]
  v_mfma_f32_16x16x32_bf16 v[204:207], v[64:67], v[44:47], v[204:207]
  buffer_load_dwordx4 a[132:135], v26, s[44:47], s72 offen offset:1024 sc1
  v_mfma_f32_16x16x32_bf16 v[204:207], v[68:71], v[60:63], v[204:207]
  ds_read_b64_tr_b16 v[88:89], v30 offset:8704
  s_waitcnt lgkmcnt(5)
  v_mfma_f32_16x16x32_bf16 v[208:211], v[72:75], v[32:35], v[208:211]
  ds_read_b64_tr_b16 v[90:91], v30 offset:10752
  v_mfma_f32_16x16x32_bf16 v[208:211], v[76:79], v[48:51], v[208:211]
  ds_read_b64_tr_b16 v[92:93], v30 offset:12800
  v_mfma_f32_16x16x32_bf16 v[212:215], v[72:75], v[36:39], v[212:215]
  ds_read_b64_tr_b16 v[94:95], v30 offset:14848
  v_mfma_f32_16x16x32_bf16 v[212:215], v[76:79], v[52:55], v[212:215]
  buffer_load_dwordx4 a[136:139], v26, s[44:47], s72 offen offset:2048 sc1
  v_mfma_f32_16x16x32_bf16 v[216:219], v[72:75], v[40:43], v[216:219]
  v_mfma_f32_16x16x32_bf16 v[216:219], v[76:79], v[56:59], v[216:219]
  v_mfma_f32_16x16x32_bf16 v[220:223], v[72:75], v[44:47], v[220:223]
  buffer_load_dwordx4 a[140:143], v26, s[44:47], s72 offen offset:3072 sc1
  v_mfma_f32_16x16x32_bf16 v[220:223], v[76:79], v[60:63], v[220:223]
  s_waitcnt vmcnt(12)
  s_barrier
  s_waitcnt lgkmcnt(4)
  v_mfma_f32_16x16x32_bf16 v[224:227], v[80:83], v[32:35], v[224:227]
  ds_read_b64_tr_b16 v[64:65], v6 offset:16384
  ds_read_b64_tr_b16 v[66:67], v6 offset:18432
  v_mfma_f32_16x16x32_bf16 v[224:227], v[84:87], v[48:51], v[224:227]
  ds_read_b64_tr_b16 v[68:69], v6 offset:20480
  s_add_u32 s72, s72, 0x2000
  v_mfma_f32_16x16x32_bf16 v[228:231], v[80:83], v[36:39], v[228:231]
  ds_read_b64_tr_b16 v[70:71], v6 offset:22528
  v_mov_b32 v126, 3
  v_mfma_f32_16x16x32_bf16 v[228:231], v[84:87], v[52:55], v[228:231]
  buffer_store_byte v126, v29, s[64:67], 0 offen sc1
  s_lshl_b32 s62, s32, 5
  v_mfma_f32_16x16x32_bf16 v[232:235], v[80:83], v[40:43], v[232:235]
  s_add_u32 s62, s62, s34
  s_lshl_b32 s63, s62, 17
  v_mfma_f32_16x16x32_bf16 v[232:235], v[84:87], v[56:59], v[232:235]
  s_lshl_b32 s4, s33, 12
  s_add_u32 s63, s63, s4
  v_mfma_f32_16x16x32_bf16 v[236:239], v[80:83], v[44:47], v[236:239]
  v_add_u32 v17, s63, v25
  v_xor_b32 v18, 0x100000, v17
  v_mfma_f32_16x16x32_bf16 v[236:239], v[84:87], v[60:63], v[236:239]
  ds_read_b64_tr_b16 v[72:73], v30 offset:16384
  s_waitcnt lgkmcnt(5)
  v_mfma_f32_16x16x32_bf16 v[240:243], v[88:91], v[32:35], v[240:243]
  ds_read_b64_tr_b16 v[74:75], v30 offset:18432
  v_xor_b32 v19, 0x200000, v17
  v_mfma_f32_16x16x32_bf16 v[240:243], v[92:95], v[48:51], v[240:243]
  ds_read_b64_tr_b16 v[76:77], v30 offset:20480
  v_xor_b32 v20, 0x300000, v17
  v_mfma_f32_16x16x32_bf16 v[244:247], v[88:91], v[36:39], v[244:247]
  ds_read_b64_tr_b16 v[78:79], v30 offset:22528
  s_lshl_b32 s62, s62, 17
  v_mfma_f32_16x16x32_bf16 v[244:247], v[92:95], v[52:55], v[244:247]
  s_lshl_b32 s4, s33, 2
  s_add_u32 s62, s62, s4
  v_mfma_f32_16x16x32_bf16 v[248:251], v[88:91], v[40:43], v[248:251]
  s_add_u32 s62, s62, 0x20
  v_mov_b32 v22, s62
  v_mfma_f32_16x16x32_bf16 v[248:251], v[92:95], v[56:59], v[248:251]
  s_xor_b32 s16, s62, 0x100001
  s_xor_b32 s17, s62, 0x200002
  v_mfma_f32_16x16x32_bf16 v[252:255], v[88:91], v[44:47], v[252:255]
  s_xor_b32 s18, s62, 0x300003
  v_cmp_eq_u32 vcc, 0, v1
  v_mfma_f32_16x16x32_bf16 v[252:255], v[92:95], v[60:63], v[252:255]
  s_waitcnt lgkmcnt(4)
  v_mfma_f32_16x16x32_bf16 v[128:131], v[64:67], a[176:179], v[128:131]
  ds_read_b64_tr_b16 v[80:81], v6 offset:16896
  ds_read_b64_tr_b16 v[82:83], v6 offset:18944
  v_mfma_f32_16x16x32_bf16 v[128:131], v[68:71], a[192:195], v[128:131]
  ds_read_b64_tr_b16 v[84:85], v6 offset:20992
  s_add_u32 m0, s5, 0x0
  v_mfma_f32_16x16x32_bf16 v[132:135], v[64:67], a[180:183], v[132:135]
  ds_read_b64_tr_b16 v[86:87], v6 offset:23040
  v_mov_b32 v23, 0x7ff00000
  v_mfma_f32_16x16x32_bf16 v[132:135], v[68:71], a[196:199], v[132:135]
  buffer_load_dwordx4 v7, s[80:83], s71 offen offset:0 lds
  v_mfma_f32_16x16x32_bf16 v[136:139], v[64:67], a[184:187], v[136:139]
  s_nop 0
  v_cndmask_b32 v23, v23, 0, vcc
  v_mfma_f32_16x16x32_bf16 v[136:139], v[68:71], a[200:203], v[136:139]
  s_mov_b32 s52, 0
  s_mov_b32 s53, 0x8000
  v_mfma_f32_16x16x32_bf16 v[140:143], v[64:67], a[188:191], v[140:143]
  buffer_load_dwordx4 v8, s[80:83], s71 offen offset:1024 lds
  v_mfma_f32_16x16x32_bf16 v[140:143], v[68:71], a[204:207], v[140:143]
  ds_read_b64_tr_b16 v[88:89], v30 offset:16896
  s_waitcnt lgkmcnt(5)
  v_mfma_f32_16x16x32_bf16 v[144:147], v[72:75], a[176:179], v[144:147]
  ds_read_b64_tr_b16 v[90:91], v30 offset:18944
  s_mov_b32 s54, 0x10000
  v_mfma_f32_16x16x32_bf16 v[144:147], v[76:79], a[192:195], v[144:147]
  ds_read_b64_tr_b16 v[92:93], v30 offset:20992
  s_mov_b32 s55, 0x18000
  v_mfma_f32_16x16x32_bf16 v[148:151], v[72:75], a[180:183], v[148:151]
  ds_read_b64_tr_b16 v[94:95], v30 offset:23040
  s_mov_b32 s68, 0xbfb8aa3b
  v_mfma_f32_16x16x32_bf16 v[148:151], v[76:79], a[196:199], v[148:151]
  buffer_load_dwordx4 v9, s[80:83], s71 offen offset:2048 lds
  v_mfma_f32_16x16x32_bf16 v[152:155], v[72:75], a[184:187], v[152:155]
  s_mov_b32 s69, 0xffff0000
  v_mfma_f32_16x16x32_bf16 v[152:155], v[76:79], a[200:203], v[152:155]
  v_mfma_f32_16x16x32_bf16 v[156:159], v[72:75], a[188:191], v[156:159]
  buffer_load_dwordx4 v10, s[80:83], s71 offen offset:3072 lds
  v_mfma_f32_16x16x32_bf16 v[156:159], v[76:79], a[204:207], v[156:159]
  ds_read_b64_tr_b16 v[64:65], v6 offset:24576
  s_waitcnt lgkmcnt(5)
  v_mfma_f32_16x16x32_bf16 v[160:163], v[80:83], a[176:179], v[160:163]
  ds_read_b64_tr_b16 v[66:67], v6 offset:26624
  v_mfma_f32_16x16x32_bf16 v[160:163], v[84:87], a[192:195], v[160:163]
  ds_read_b64_tr_b16 v[68:69], v6 offset:28672
  s_add_u32 s71, s71, 0x20000
  v_mfma_f32_16x16x32_bf16 v[164:167], v[80:83], a[180:183], v[164:167]
  ds_read_b64_tr_b16 v[70:71], v6 offset:30720
  v_mfma_f32_16x16x32_bf16 v[164:167], v[84:87], a[196:199], v[164:167]
  buffer_load_dwordx4 v[32:35], v25, s[44:47], s72 offen offset:0 sc1
  v_mfma_f32_16x16x32_bf16 v[168:171], v[80:83], a[184:187], v[168:171]
  v_mfma_f32_16x16x32_bf16 v[168:171], v[84:87], a[200:203], v[168:171]
  v_mfma_f32_16x16x32_bf16 v[172:175], v[80:83], a[188:191], v[172:175]
  buffer_load_dwordx4 v[36:39], v25, s[44:47], s72 offen offset:1024 sc1
  v_mfma_f32_16x16x32_bf16 v[172:175], v[84:87], a[204:207], v[172:175]
  ds_read_b64_tr_b16 v[72:73], v30 offset:24576
  s_waitcnt lgkmcnt(5)
  v_mfma_f32_16x16x32_bf16 v[176:179], v[88:91], a[176:179], v[176:179]
  ds_read_b64_tr_b16 v[74:75], v30 offset:26624
  v_mfma_f32_16x16x32_bf16 v[176:179], v[92:95], a[192:195], v[176:179]
  ds_read_b64_tr_b16 v[76:77], v30 offset:28672
  v_mfma_f32_16x16x32_bf16 v[180:183], v[88:91], a[180:183], v[180:183]
  ds_read_b64_tr_b16 v[78:79], v30 offset:30720
  v_mfma_f32_16x16x32_bf16 v[180:183], v[92:95], a[196:199], v[180:183]
  buffer_load_dwordx4 v[40:43], v25, s[44:47], s72 offen offset:2048 sc1
  v_mfma_f32_16x16x32_bf16 v[184:187], v[88:91], a[184:187], v[184:187]
  v_mfma_f32_16x16x32_bf16 v[184:187], v[92:95], a[200:203], v[184:187]
  v_mfma_f32_16x16x32_bf16 v[188:191], v[88:91], a[188:191], v[188:191]
  buffer_load_dwordx4 v[44:47], v25, s[44:47], s72 offen offset:3072 sc1
  v_mfma_f32_16x16x32_bf16 v[188:191], v[92:95], a[204:207], v[188:191]
  ds_read_b64_tr_b16 v[80:81], v6 offset:25088
  s_waitcnt lgkmcnt(5)
  v_mfma_f32_16x16x32_bf16 v[192:195], v[64:67], a[176:179], v[192:195]
  ds_read_b64_tr_b16 v[82:83], v6 offset:27136
  v_mfma_f32_16x16x32_bf16 v[192:195], v[68:71], a[192:195], v[192:195]
  ds_read_b64_tr_b16 v[84:85], v6 offset:29184
  v_mfma_f32_16x16x32_bf16 v[196:199], v[64:67], a[180:183], v[196:199]
  ds_read_b64_tr_b16 v[86:87], v6 offset:31232
  v_mfma_f32_16x16x32_bf16 v[196:199], v[68:71], a[196:199], v[196:199]
  buffer_load_dwordx4 v[48:51], v26, s[44:47], s72 offen offset:0 sc1
  v_mfma_f32_16x16x32_bf16 v[200:203], v[64:67], a[184:187], v[200:203]
  v_mfma_f32_16x16x32_bf16 v[200:203], v[68:71], a[200:203], v[200:203]
  v_mfma_f32_16x16x32_bf16 v[204:207], v[64:67], a[188:191], v[204:207]
  buffer_load_dwordx4 v[52:55], v26, s[44:47], s72 offen offset:1024 sc1
  v_mfma_f32_16x16x32_bf16 v[204:207], v[68:71], a[204:207], v[204:207]
  ds_read_b64_tr_b16 v[88:89], v30 offset:25088
  s_waitcnt lgkmcnt(5)
  v_mfma_f32_16x16x32_bf16 v[208:211], v[72:75], a[176:179], v[208:211]
  ds_read_b64_tr_b16 v[90:91], v30 offset:27136
  v_mfma_f32_16x16x32_bf16 v[208:211], v[76:79], a[192:195], v[208:211]
  ds_read_b64_tr_b16 v[92:93], v30 offset:29184
  v_mfma_f32_16x16x32_bf16 v[212:215], v[72:75], a[180:183], v[212:215]
  ds_read_b64_tr_b16 v[94:95], v30 offset:31232
  v_mfma_f32_16x16x32_bf16 v[212:215], v[76:79], a[196:199], v[212:215]
  buffer_load_dwordx4 v[56:59], v26, s[44:47], s72 offen offset:2048 sc1
  v_mfma_f32_16x16x32_bf16 v[216:219], v[72:75], a[184:187], v[216:219]
  v_mfma_f32_16x16x32_bf16 v[216:219], v[76:79], a[200:203], v[216:219]
  v_mfma_f32_16x16x32_bf16 v[220:223], v[72:75], a[188:191], v[220:223]
  buffer_load_dwordx4 v[60:63], v26, s[44:47], s72 offen offset:3072 sc1
  v_mfma_f32_16x16x32_bf16 v[220:223], v[76:79], a[204:207], v[220:223]
  s_barrier
  s_waitcnt lgkmcnt(4)
  v_mfma_f32_16x16x32_bf16 v[224:227], v[80:83], a[176:179], v[224:227]
  ds_read_b64_tr_b16 v[64:65], v4 offset:32768
  ds_read_b64_tr_b16 v[66:67], v4 offset:34816
  v_mfma_f32_16x16x32_bf16 v[224:227], v[84:87], a[192:195], v[224:227]
  ds_read_b64_tr_b16 v[68:69], v4 offset:36864
  s_add_u32 s72, s72, 0x2000
  v_mfma_f32_16x16x32_bf16 v[228:231], v[80:83], a[180:183], v[228:231]
  ds_read_b64_tr_b16 v[70:71], v4 offset:38912
  v_mfma_f32_16x16x32_bf16 v[228:231], v[84:87], a[196:199], v[228:231]
  v_mfma_f32_16x16x32_bf16 v[232:235], v[80:83], a[184:187], v[232:235]
  v_mfma_f32_16x16x32_bf16 v[232:235], v[84:87], a[200:203], v[232:235]
  v_mfma_f32_16x16x32_bf16 v[236:239], v[80:83], a[188:191], v[236:239]
  v_mfma_f32_16x16x32_bf16 v[236:239], v[84:87], a[204:207], v[236:239]
  ds_read_b64_tr_b16 v[72:73], v5 offset:32768
  s_waitcnt lgkmcnt(5)
  v_mfma_f32_16x16x32_bf16 v[240:243], v[88:91], a[176:179], v[240:243]
  ds_read_b64_tr_b16 v[74:75], v5 offset:34816
  v_mfma_f32_16x16x32_bf16 v[240:243], v[92:95], a[192:195], v[240:243]
  ds_read_b64_tr_b16 v[76:77], v5 offset:36864
  v_mfma_f32_16x16x32_bf16 v[244:247], v[88:91], a[180:183], v[244:247]
  ds_read_b64_tr_b16 v[78:79], v5 offset:38912
  v_mfma_f32_16x16x32_bf16 v[244:247], v[92:95], a[196:199], v[244:247]
  v_mfma_f32_16x16x32_bf16 v[248:251], v[88:91], a[184:187], v[248:251]
  v_mfma_f32_16x16x32_bf16 v[248:251], v[92:95], a[200:203], v[248:251]
  v_mfma_f32_16x16x32_bf16 v[252:255], v[88:91], a[188:191], v[252:255]
  v_mfma_f32_16x16x32_bf16 v[252:255], v[92:95], a[204:207], v[252:255]
  s_waitcnt lgkmcnt(4)
  v_mfma_f32_16x16x32_bf16 v[128:131], v[64:67], a[208:211], v[128:131]
  ds_read_b64_tr_b16 v[80:81], v4 offset:33280
  ds_read_b64_tr_b16 v[82:83], v4 offset:35328
  v_mfma_f32_16x16x32_bf16 v[128:131], v[68:71], a[224:227], v[128:131]
  ds_read_b64_tr_b16 v[84:85], v4 offset:37376
  s_add_u32 m0, s5, 0x4000
  v_mfma_f32_16x16x32_bf16 v[132:135], v[64:67], a[212:215], v[132:135]
  ds_read_b64_tr_b16 v[86:87], v4 offset:39424
  v_mfma_f32_16x16x32_bf16 v[132:135], v[68:71], a[228:231], v[132:135]
  buffer_load_dwordx4 v7, s[80:83], s71 offen offset:0 lds
  v_mfma_f32_16x16x32_bf16 v[136:139], v[64:67], a[216:219], v[136:139]
  v_mfma_f32_16x16x32_bf16 v[136:139], v[68:71], a[232:235], v[136:139]
  v_mfma_f32_16x16x32_bf16 v[140:143], v[64:67], a[220:223], v[140:143]
  buffer_load_dwordx4 v8, s[80:83], s71 offen offset:1024 lds
  v_mfma_f32_16x16x32_bf16 v[140:143], v[68:71], a[236:239], v[140:143]
  ds_read_b64_tr_b16 v[88:89], v5 offset:33280
  s_waitcnt lgkmcnt(5)
  v_mfma_f32_16x16x32_bf16 v[144:147], v[72:75], a[208:211], v[144:147]
  ds_read_b64_tr_b16 v[90:91], v5 offset:35328
  v_mfma_f32_16x16x32_bf16 v[144:147], v[76:79], a[224:227], v[144:147]
  ds_read_b64_tr_b16 v[92:93], v5 offset:37376
  v_mfma_f32_16x16x32_bf16 v[148:151], v[72:75], a[212:215], v[148:151]
  ds_read_b64_tr_b16 v[94:95], v5 offset:39424
  v_mfma_f32_16x16x32_bf16 v[148:151], v[76:79], a[228:231], v[148:151]
  buffer_load_dwordx4 v9, s[80:83], s71 offen offset:2048 lds
  v_mfma_f32_16x16x32_bf16 v[152:155], v[72:75], a[216:219], v[152:155]
  v_mfma_f32_16x16x32_bf16 v[152:155], v[76:79], a[232:235], v[152:155]
  v_mfma_f32_16x16x32_bf16 v[156:159], v[72:75], a[220:223], v[156:159]
  buffer_load_dwordx4 v10, s[80:83], s71 offen offset:3072 lds
  v_mfma_f32_16x16x32_bf16 v[156:159], v[76:79], a[236:239], v[156:159]
  ds_read_b64_tr_b16 v[64:65], v4 offset:40960
  s_waitcnt lgkmcnt(5)
  v_mfma_f32_16x16x32_bf16 v[160:163], v[80:83], a[208:211], v[160:163]
  ds_read_b64_tr_b16 v[66:67], v4 offset:43008
  v_mfma_f32_16x16x32_bf16 v[160:163], v[84:87], a[224:227], v[160:163]
  ds_read_b64_tr_b16 v[68:69], v4 offset:45056
  s_add_u32 s71, s71, 0x20000
  v_mfma_f32_16x16x32_bf16 v[164:167], v[80:83], a[212:215], v[164:167]
  ds_read_b64_tr_b16 v[70:71], v4 offset:47104
  v_mfma_f32_16x16x32_bf16 v[164:167], v[84:87], a[228:231], v[164:167]
  buffer_load_dwordx4 a[176:179], v25, s[44:47], s72 offen offset:0 sc1
  v_mfma_f32_16x16x32_bf16 v[168:171], v[80:83], a[216:219], v[168:171]
  v_mfma_f32_16x16x32_bf16 v[168:171], v[84:87], a[232:235], v[168:171]
  v_mfma_f32_16x16x32_bf16 v[172:175], v[80:83], a[220:223], v[172:175]
  buffer_load_dwordx4 a[180:183], v25, s[44:47], s72 offen offset:1024 sc1
  v_mfma_f32_16x16x32_bf16 v[172:175], v[84:87], a[236:239], v[172:175]
  ds_read_b64_tr_b16 v[72:73], v5 offset:40960
  s_waitcnt lgkmcnt(5)
  v_mfma_f32_16x16x32_bf16 v[176:179], v[88:91], a[208:211], v[176:179]
  ds_read_b64_tr_b16 v[74:75], v5 offset:43008
  v_mfma_f32_16x16x32_bf16 v[176:179], v[92:95], a[224:227], v[176:179]
  ds_read_b64_tr_b16 v[76:77], v5 offset:45056
  v_mfma_f32_16x16x32_bf16 v[180:183], v[88:91], a[212:215], v[180:183]
  ds_read_b64_tr_b16 v[78:79], v5 offset:47104
  v_mfma_f32_16x16x32_bf16 v[180:183], v[92:95], a[228:231], v[180:183]
  buffer_load_dwordx4 a[184:187], v25, s[44:47], s72 offen offset:2048 sc1
  v_mfma_f32_16x16x32_bf16 v[184:187], v[88:91], a[216:219], v[184:187]
  v_mfma_f32_16x16x32_bf16 v[184:187], v[92:95], a[232:235], v[184:187]
  v_mfma_f32_16x16x32_bf16 v[188:191], v[88:91], a[220:223], v[188:191]
  buffer_load_dwordx4 a[188:191], v25, s[44:47], s72 offen offset:3072 sc1
  v_mfma_f32_16x16x32_bf16 v[188:191], v[92:95], a[236:239], v[188:191]
  ds_read_b64_tr_b16 v[80:81], v4 offset:41472
  s_waitcnt lgkmcnt(5)
  v_mfma_f32_16x16x32_bf16 v[192:195], v[64:67], a[208:211], v[192:195]
  ds_read_b64_tr_b16 v[82:83], v4 offset:43520
  v_mfma_f32_16x16x32_bf16 v[192:195], v[68:71], a[224:227], v[192:195]
  ds_read_b64_tr_b16 v[84:85], v4 offset:45568
  v_mfma_f32_16x16x32_bf16 v[196:199], v[64:67], a[212:215], v[196:199]
  ds_read_b64_tr_b16 v[86:87], v4 offset:47616
  v_mfma_f32_16x16x32_bf16 v[196:199], v[68:71], a[228:231], v[196:199]
  buffer_load_dwordx4 a[192:195], v26, s[44:47], s72 offen offset:0 sc1
  v_mfma_f32_16x16x32_bf16 v[200:203], v[64:67], a[216:219], v[200:203]
  v_mfma_f32_16x16x32_bf16 v[200:203], v[68:71], a[232:235], v[200:203]
  v_mfma_f32_16x16x32_bf16 v[204:207], v[64:67], a[220:223], v[204:207]
  buffer_load_dwordx4 a[196:199], v26, s[44:47], s72 offen offset:1024 sc1
  v_mfma_f32_16x16x32_bf16 v[204:207], v[68:71], a[236:239], v[204:207]
  ds_read_b64_tr_b16 v[88:89], v5 offset:41472
  s_waitcnt lgkmcnt(5)
  v_mfma_f32_16x16x32_bf16 v[208:211], v[72:75], a[208:211], v[208:211]
  ds_read_b64_tr_b16 v[90:91], v5 offset:43520
  v_mfma_f32_16x16x32_bf16 v[208:211], v[76:79], a[224:227], v[208:211]
  ds_read_b64_tr_b16 v[92:93], v5 offset:45568
  v_mfma_f32_16x16x32_bf16 v[212:215], v[72:75], a[212:215], v[212:215]
  ds_read_b64_tr_b16 v[94:95], v5 offset:47616
  v_mfma_f32_16x16x32_bf16 v[212:215], v[76:79], a[228:231], v[212:215]
  buffer_load_dwordx4 a[200:203], v26, s[44:47], s72 offen offset:2048 sc1
  v_mfma_f32_16x16x32_bf16 v[216:219], v[72:75], a[216:219], v[216:219]
  v_mfma_f32_16x16x32_bf16 v[216:219], v[76:79], a[232:235], v[216:219]
  v_mfma_f32_16x16x32_bf16 v[220:223], v[72:75], a[220:223], v[220:223]
  buffer_load_dwordx4 a[204:207], v26, s[44:47], s72 offen offset:3072 sc1
  v_mfma_f32_16x16x32_bf16 v[220:223], v[76:79], a[236:239], v[220:223]
  s_barrier
  s_waitcnt lgkmcnt(4)
  v_mfma_f32_16x16x32_bf16 v[224:227], v[80:83], a[208:211], v[224:227]
  ds_read_b64_tr_b16 v[64:65], v4 offset:49152
  ds_read_b64_tr_b16 v[66:67], v4 offset:51200
  v_mfma_f32_16x16x32_bf16 v[224:227], v[84:87], a[224:227], v[224:227]
  ds_read_b64_tr_b16 v[68:69], v4 offset:53248
  s_add_u32 s72, s72, 0x2000
  v_mfma_f32_16x16x32_bf16 v[228:231], v[80:83], a[212:215], v[228:231]
  ds_read_b64_tr_b16 v[70:71], v4 offset:55296
  v_mfma_f32_16x16x32_bf16 v[228:231], v[84:87], a[228:231], v[228:231]
  v_mfma_f32_16x16x32_bf16 v[232:235], v[80:83], a[216:219], v[232:235]
  v_mfma_f32_16x16x32_bf16 v[232:235], v[84:87], a[232:235], v[232:235]
  v_mfma_f32_16x16x32_bf16 v[236:239], v[80:83], a[220:223], v[236:239]
  v_mfma_f32_16x16x32_bf16 v[236:239], v[84:87], a[236:239], v[236:239]
  ds_read_b64_tr_b16 v[72:73], v5 offset:49152
  s_waitcnt lgkmcnt(5)
  v_mfma_f32_16x16x32_bf16 v[240:243], v[88:91], a[208:211], v[240:243]
  ds_read_b64_tr_b16 v[74:75], v5 offset:51200
  v_mfma_f32_16x16x32_bf16 v[240:243], v[92:95], a[224:227], v[240:243]
  ds_read_b64_tr_b16 v[76:77], v5 offset:53248
  v_mfma_f32_16x16x32_bf16 v[244:247], v[88:91], a[212:215], v[244:247]
  ds_read_b64_tr_b16 v[78:79], v5 offset:55296
  v_mfma_f32_16x16x32_bf16 v[244:247], v[92:95], a[228:231], v[244:247]
  v_mfma_f32_16x16x32_bf16 v[248:251], v[88:91], a[216:219], v[248:251]
  v_mfma_f32_16x16x32_bf16 v[248:251], v[92:95], a[232:235], v[248:251]
  v_mfma_f32_16x16x32_bf16 v[252:255], v[88:91], a[220:223], v[252:255]
  v_mfma_f32_16x16x32_bf16 v[252:255], v[92:95], a[236:239], v[252:255]
  s_waitcnt lgkmcnt(4)
  v_mfma_f32_16x16x32_bf16 v[128:131], v[64:67], a[144:147], v[128:131]
  ds_read_b64_tr_b16 v[80:81], v4 offset:49664
  ds_read_b64_tr_b16 v[82:83], v4 offset:51712
  v_mfma_f32_16x16x32_bf16 v[128:131], v[68:71], a[160:163], v[128:131]
  ds_read_b64_tr_b16 v[84:85], v4 offset:53760
  s_add_u32 m0, s5, 0x8000
  v_mfma_f32_16x16x32_bf16 v[132:135], v[64:67], a[148:151], v[132:135]
  ds_read_b64_tr_b16 v[86:87], v4 offset:55808
  v_mfma_f32_16x16x32_bf16 v[132:135], v[68:71], a[164:167], v[132:135]
  buffer_load_dwordx4 v7, s[80:83], s71 offen offset:0 lds
  v_mfma_f32_16x16x32_bf16 v[136:139], v[64:67], a[152:155], v[136:139]
  v_mfma_f32_16x16x32_bf16 v[136:139], v[68:71], a[168:171], v[136:139]
  v_mfma_f32_16x16x32_bf16 v[140:143], v[64:67], a[156:159], v[140:143]
  buffer_load_dwordx4 v8, s[80:83], s71 offen offset:1024 lds
  v_mfma_f32_16x16x32_bf16 v[140:143], v[68:71], a[172:175], v[140:143]
  ds_read_b64_tr_b16 v[88:89], v5 offset:49664
  s_waitcnt lgkmcnt(5)
  v_mfma_f32_16x16x32_bf16 v[144:147], v[72:75], a[144:147], v[144:147]
  ds_read_b64_tr_b16 v[90:91], v5 offset:51712
  v_mfma_f32_16x16x32_bf16 v[144:147], v[76:79], a[160:163], v[144:147]
  ds_read_b64_tr_b16 v[92:93], v5 offset:53760
  v_mfma_f32_16x16x32_bf16 v[148:151], v[72:75], a[148:151], v[148:151]
  ds_read_b64_tr_b16 v[94:95], v5 offset:55808
  v_mfma_f32_16x16x32_bf16 v[148:151], v[76:79], a[164:167], v[148:151]
  buffer_load_dwordx4 v9, s[80:83], s71 offen offset:2048 lds
  v_mfma_f32_16x16x32_bf16 v[152:155], v[72:75], a[152:155], v[152:155]
  v_mfma_f32_16x16x32_bf16 v[152:155], v[76:79], a[168:171], v[152:155]
  v_mfma_f32_16x16x32_bf16 v[156:159], v[72:75], a[156:159], v[156:159]
  buffer_load_dwordx4 v10, s[80:83], s71 offen offset:3072 lds
  v_mfma_f32_16x16x32_bf16 v[156:159], v[76:79], a[172:175], v[156:159]
  ds_read_b64_tr_b16 v[64:65], v4 offset:57344
  s_waitcnt lgkmcnt(5)
  v_mfma_f32_16x16x32_bf16 v[160:163], v[80:83], a[144:147], v[160:163]
  ds_read_b64_tr_b16 v[66:67], v4 offset:59392
  v_mfma_f32_16x16x32_bf16 v[160:163], v[84:87], a[160:163], v[160:163]
  ds_read_b64_tr_b16 v[68:69], v4 offset:61440
  s_add_u32 s71, s71, 0x20000
  v_mfma_f32_16x16x32_bf16 v[164:167], v[80:83], a[148:151], v[164:167]
  ds_read_b64_tr_b16 v[70:71], v4 offset:63488
  v_mfma_f32_16x16x32_bf16 v[164:167], v[84:87], a[164:167], v[164:167]
  buffer_load_dwordx4 a[208:211], v25, s[44:47], s72 offen offset:0 sc1
  v_mfma_f32_16x16x32_bf16 v[168:171], v[80:83], a[152:155], v[168:171]
  v_mfma_f32_16x16x32_bf16 v[168:171], v[84:87], a[168:171], v[168:171]
  v_mfma_f32_16x16x32_bf16 v[172:175], v[80:83], a[156:159], v[172:175]
  buffer_load_dwordx4 a[212:215], v25, s[44:47], s72 offen offset:1024 sc1
  v_mfma_f32_16x16x32_bf16 v[172:175], v[84:87], a[172:175], v[172:175]
  ds_read_b64_tr_b16 v[72:73], v5 offset:57344
  s_waitcnt lgkmcnt(5)
  v_mfma_f32_16x16x32_bf16 v[176:179], v[88:91], a[144:147], v[176:179]
  ds_read_b64_tr_b16 v[74:75], v5 offset:59392
  v_mfma_f32_16x16x32_bf16 v[176:179], v[92:95], a[160:163], v[176:179]
  ds_read_b64_tr_b16 v[76:77], v5 offset:61440
  v_mfma_f32_16x16x32_bf16 v[180:183], v[88:91], a[148:151], v[180:183]
  ds_read_b64_tr_b16 v[78:79], v5 offset:63488
  v_mfma_f32_16x16x32_bf16 v[180:183], v[92:95], a[164:167], v[180:183]
  buffer_load_dwordx4 a[216:219], v25, s[44:47], s72 offen offset:2048 sc1
  v_mfma_f32_16x16x32_bf16 v[184:187], v[88:91], a[152:155], v[184:187]
  v_mfma_f32_16x16x32_bf16 v[184:187], v[92:95], a[168:171], v[184:187]
  v_mfma_f32_16x16x32_bf16 v[188:191], v[88:91], a[156:159], v[188:191]
  buffer_load_dwordx4 a[220:223], v25, s[44:47], s72 offen offset:3072 sc1
  v_mfma_f32_16x16x32_bf16 v[188:191], v[92:95], a[172:175], v[188:191]
  ds_read_b64_tr_b16 v[80:81], v4 offset:57856
  s_waitcnt lgkmcnt(5)
  v_mfma_f32_16x16x32_bf16 v[192:195], v[64:67], a[144:147], v[192:195]
  ds_read_b64_tr_b16 v[82:83], v4 offset:59904
  v_mfma_f32_16x16x32_bf16 v[192:195], v[68:71], a[160:163], v[192:195]
  ds_read_b64_tr_b16 v[84:85], v4 offset:61952
  v_mfma_f32_16x16x32_bf16 v[196:199], v[64:67], a[148:151], v[196:199]
  ds_read_b64_tr_b16 v[86:87], v4 offset:64000
  v_mfma_f32_16x16x32_bf16 v[196:199], v[68:71], a[164:167], v[196:199]
  buffer_load_dwordx4 a[224:227], v26, s[44:47], s72 offen offset:0 sc1
  v_mfma_f32_16x16x32_bf16 v[200:203], v[64:67], a[152:155], v[200:203]
  v_mfma_f32_16x16x32_bf16 v[200:203], v[68:71], a[168:171], v[200:203]
  v_mfma_f32_16x16x32_bf16 v[204:207], v[64:67], a[156:159], v[204:207]
  buffer_load_dwordx4 a[228:231], v26, s[44:47], s72 offen offset:1024 sc1
  v_mfma_f32_16x16x32_bf16 v[204:207], v[68:71], a[172:175], v[204:207]
  ds_read_b64_tr_b16 v[88:89], v5 offset:57856
  s_waitcnt lgkmcnt(5)
  v_mfma_f32_16x16x32_bf16 v[208:211], v[72:75], a[144:147], v[208:211]
  ds_read_b64_tr_b16 v[90:91], v5 offset:59904
  v_mfma_f32_16x16x32_bf16 v[208:211], v[76:79], a[160:163], v[208:211]
  ds_read_b64_tr_b16 v[92:93], v5 offset:61952
  v_mfma_f32_16x16x32_bf16 v[212:215], v[72:75], a[148:151], v[212:215]
  ds_read_b64_tr_b16 v[94:95], v5 offset:64000
  v_mfma_f32_16x16x32_bf16 v[212:215], v[76:79], a[164:167], v[212:215]
  buffer_load_dwordx4 a[232:235], v26, s[44:47], s72 offen offset:2048 sc1
  v_mfma_f32_16x16x32_bf16 v[216:219], v[72:75], a[152:155], v[216:219]
  v_mfma_f32_16x16x32_bf16 v[216:219], v[76:79], a[168:171], v[216:219]
  v_mfma_f32_16x16x32_bf16 v[220:223], v[72:75], a[156:159], v[220:223]
  buffer_load_dwordx4 a[236:239], v26, s[44:47], s72 offen offset:3072 sc1
  v_mfma_f32_16x16x32_bf16 v[220:223], v[76:79], a[172:175], v[220:223]
  s_waitcnt vmcnt(45)
  s_barrier
  s_waitcnt lgkmcnt(4)
  v_mfma_f32_16x16x32_bf16 v[224:227], v[80:83], a[144:147], v[224:227]
  ds_read_b64_tr_b16 v[64:65], v4 offset:0
  ds_read_b64_tr_b16 v[66:67], v4 offset:2048
  v_mfma_f32_16x16x32_bf16 v[224:227], v[84:87], a[160:163], v[224:227]
  ds_read_b64_tr_b16 v[68:69], v4 offset:4096
  s_add_u32 s72, s72, 0x2000
  v_mfma_f32_16x16x32_bf16 v[228:231], v[80:83], a[148:151], v[228:231]
  ds_read_b64_tr_b16 v[70:71], v4 offset:6144
  v_mfma_f32_16x16x32_bf16 v[228:231], v[84:87], a[164:167], v[228:231]
  v_mfma_f32_16x16x32_bf16 v[232:235], v[80:83], a[152:155], v[232:235]
  v_mfma_f32_16x16x32_bf16 v[232:235], v[84:87], a[168:171], v[232:235]
  v_mfma_f32_16x16x32_bf16 v[236:239], v[80:83], a[156:159], v[236:239]
  v_mfma_f32_16x16x32_bf16 v[236:239], v[84:87], a[172:175], v[236:239]
  ds_read_b64_tr_b16 v[72:73], v5 offset:0
  s_waitcnt lgkmcnt(5)
  v_mfma_f32_16x16x32_bf16 v[240:243], v[88:91], a[144:147], v[240:243]
  ds_read_b64_tr_b16 v[74:75], v5 offset:2048
  v_mfma_f32_16x16x32_bf16 v[240:243], v[92:95], a[160:163], v[240:243]
  ds_read_b64_tr_b16 v[76:77], v5 offset:4096
  v_mfma_f32_16x16x32_bf16 v[244:247], v[88:91], a[148:151], v[244:247]
  ds_read_b64_tr_b16 v[78:79], v5 offset:6144
  v_mfma_f32_16x16x32_bf16 v[244:247], v[92:95], a[164:167], v[244:247]
  v_mfma_f32_16x16x32_bf16 v[248:251], v[88:91], a[152:155], v[248:251]
  v_mfma_f32_16x16x32_bf16 v[248:251], v[92:95], a[168:171], v[248:251]
  v_mfma_f32_16x16x32_bf16 v[252:255], v[88:91], a[156:159], v[252:255]
  v_mfma_f32_16x16x32_bf16 v[252:255], v[92:95], a[172:175], v[252:255]
  s_waitcnt vmcnt(37)
  s_waitcnt lgkmcnt(4)
  v_mfma_f32_16x16x32_bf16 v[128:131], v[64:67], a[240:243], v[128:131]
  ds_read_b64_tr_b16 v[80:81], v4 offset:512
  ds_read_b64_tr_b16 v[82:83], v4 offset:2560
  v_mfma_f32_16x16x32_bf16 v[128:131], v[68:71], a[128:131], v[128:131]
  ds_read_b64_tr_b16 v[84:85], v4 offset:4608
  s_add_u32 m0, s5, 0xc000
  v_mfma_f32_16x16x32_bf16 v[132:135], v[64:67], a[244:247], v[132:135]
  ds_read_b64_tr_b16 v[86:87], v4 offset:6656
  v_mfma_f32_16x16x32_bf16 v[132:135], v[68:71], a[132:135], v[132:135]
  buffer_load_dwordx4 v7, s[80:83], s71 offen offset:0 lds
  v_mfma_f32_16x16x32_bf16 v[136:139], v[64:67], a[248:251], v[136:139]
  v_mfma_f32_16x16x32_bf16 v[136:139], v[68:71], a[136:139], v[136:139]
  v_mfma_f32_16x16x32_bf16 v[140:143], v[64:67], a[252:255], v[140:143]
  buffer_load_dwordx4 v8, s[80:83], s71 offen offset:1024 lds
  v_mfma_f32_16x16x32_bf16 v[140:143], v[68:71], a[140:143], v[140:143]
  ds_read_b64_tr_b16 v[88:89], v5 offset:512
  s_waitcnt lgkmcnt(5)
  v_mfma_f32_16x16x32_bf16 v[144:147], v[72:75], a[240:243], v[144:147]
  ds_read_b64_tr_b16 v[90:91], v5 offset:2560
  v_mfma_f32_16x16x32_bf16 v[144:147], v[76:79], a[128:131], v[144:147]
  ds_read_b64_tr_b16 v[92:93], v5 offset:4608
  v_mfma_f32_16x16x32_bf16 v[148:151], v[72:75], a[244:247], v[148:151]
  ds_read_b64_tr_b16 v[94:95], v5 offset:6656
  v_mfma_f32_16x16x32_bf16 v[148:151], v[76:79], a[132:135], v[148:151]
  buffer_load_dwordx4 v9, s[80:83], s71 offen offset:2048 lds
  v_mfma_f32_16x16x32_bf16 v[152:155], v[72:75], a[248:251], v[152:155]
  v_mfma_f32_16x16x32_bf16 v[152:155], v[76:79], a[136:139], v[152:155]
  v_mfma_f32_16x16x32_bf16 v[156:159], v[72:75], a[252:255], v[156:159]
  buffer_load_dwordx4 v10, s[80:83], s71 offen offset:3072 lds
  v_mfma_f32_16x16x32_bf16 v[156:159], v[76:79], a[140:143], v[156:159]
  ds_read_b64_tr_b16 v[64:65], v4 offset:8192
  s_waitcnt lgkmcnt(5)
  v_mfma_f32_16x16x32_bf16 v[160:163], v[80:83], a[240:243], v[160:163]
  ds_read_b64_tr_b16 v[66:67], v4 offset:10240
  v_mfma_f32_16x16x32_bf16 v[160:163], v[84:87], a[128:131], v[160:163]
  ds_read_b64_tr_b16 v[68:69], v4 offset:12288
  s_add_u32 s71, s71, 0x20000
  v_mfma_f32_16x16x32_bf16 v[164:167], v[80:83], a[244:247], v[164:167]
  ds_read_b64_tr_b16 v[70:71], v4 offset:14336
  v_mfma_f32_16x16x32_bf16 v[164:167], v[84:87], a[132:135], v[164:167]
  buffer_load_dwordx4 a[144:147], v25, s[44:47], s72 offen offset:0 sc1
  v_mfma_f32_16x16x32_bf16 v[168:171], v[80:83], a[248:251], v[168:171]
  v_mfma_f32_16x16x32_bf16 v[168:171], v[84:87], a[136:139], v[168:171]
  v_mfma_f32_16x16x32_bf16 v[172:175], v[80:83], a[252:255], v[172:175]
  buffer_load_dwordx4 a[148:151], v25, s[44:47], s72 offen offset:1024 sc1
  v_mfma_f32_16x16x32_bf16 v[172:175], v[84:87], a[140:143], v[172:175]
  ds_read_b64_tr_b16 v[72:73], v5 offset:8192
  s_waitcnt lgkmcnt(5)
  v_mfma_f32_16x16x32_bf16 v[176:179], v[88:91], a[240:243], v[176:179]
  ds_read_b64_tr_b16 v[74:75], v5 offset:10240
  v_mfma_f32_16x16x32_bf16 v[176:179], v[92:95], a[128:131], v[176:179]
  ds_read_b64_tr_b16 v[76:77], v5 offset:12288
  v_mfma_f32_16x16x32_bf16 v[180:183], v[88:91], a[244:247], v[180:183]
  ds_read_b64_tr_b16 v[78:79], v5 offset:14336
  v_mfma_f32_16x16x32_bf16 v[180:183], v[92:95], a[132:135], v[180:183]
  buffer_load_dwordx4 a[152:155], v25, s[44:47], s72 offen offset:2048 sc1
  v_mfma_f32_16x16x32_bf16 v[184:187], v[88:91], a[248:251], v[184:187]
  v_mfma_f32_16x16x32_bf16 v[184:187], v[92:95], a[136:139], v[184:187]
  v_mfma_f32_16x16x32_bf16 v[188:191], v[88:91], a[252:255], v[188:191]
  buffer_load_dwordx4 a[156:159], v25, s[44:47], s72 offen offset:3072 sc1
  v_mfma_f32_16x16x32_bf16 v[188:191], v[92:95], a[140:143], v[188:191]
  ds_read_b64_tr_b16 v[80:81], v4 offset:8704
  s_waitcnt lgkmcnt(5)
  v_mfma_f32_16x16x32_bf16 v[192:195], v[64:67], a[240:243], v[192:195]
  ds_read_b64_tr_b16 v[82:83], v4 offset:10752
  v_mfma_f32_16x16x32_bf16 v[192:195], v[68:71], a[128:131], v[192:195]
  ds_read_b64_tr_b16 v[84:85], v4 offset:12800
  v_mfma_f32_16x16x32_bf16 v[196:199], v[64:67], a[244:247], v[196:199]
  ds_read_b64_tr_b16 v[86:87], v4 offset:14848
  v_mfma_f32_16x16x32_bf16 v[196:199], v[68:71], a[132:135], v[196:199]
  buffer_load_dwordx4 a[160:163], v26, s[44:47], s72 offen offset:0 sc1
  v_mfma_f32_16x16x32_bf16 v[200:203], v[64:67], a[248:251], v[200:203]
  v_mfma_f32_16x16x32_bf16 v[200:203], v[68:71], a[136:139], v[200:203]
  v_mfma_f32_16x16x32_bf16 v[204:207], v[64:67], a[252:255], v[204:207]
  buffer_load_dwordx4 a[164:167], v26, s[44:47], s72 offen offset:1024 sc1
  v_mfma_f32_16x16x32_bf16 v[204:207], v[68:71], a[140:143], v[204:207]
  ds_read_b64_tr_b16 v[88:89], v5 offset:8704
  s_waitcnt lgkmcnt(5)
  v_mfma_f32_16x16x32_bf16 v[208:211], v[72:75], a[240:243], v[208:211]
  ds_read_b64_tr_b16 v[90:91], v5 offset:10752
  v_mfma_f32_16x16x32_bf16 v[208:211], v[76:79], a[128:131], v[208:211]
  ds_read_b64_tr_b16 v[92:93], v5 offset:12800
  v_mfma_f32_16x16x32_bf16 v[212:215], v[72:75], a[244:247], v[212:215]
  ds_read_b64_tr_b16 v[94:95], v5 offset:14848
  v_mfma_f32_16x16x32_bf16 v[212:215], v[76:79], a[132:135], v[212:215]
  buffer_load_dwordx4 a[168:171], v26, s[44:47], s72 offen offset:2048 sc1
  v_mfma_f32_16x16x32_bf16 v[216:219], v[72:75], a[248:251], v[216:219]
  v_mfma_f32_16x16x32_bf16 v[216:219], v[76:79], a[136:139], v[216:219]
  v_mfma_f32_16x16x32_bf16 v[220:223], v[72:75], a[252:255], v[220:223]
  buffer_load_dwordx4 a[172:175], v26, s[44:47], s72 offen offset:3072 sc1
  v_mfma_f32_16x16x32_bf16 v[220:223], v[76:79], a[140:143], v[220:223]
  s_waitcnt vmcnt(44)
  s_barrier
  s_waitcnt lgkmcnt(4)
  v_mfma_f32_16x16x32_bf16 v[224:227], v[80:83], a[240:243], v[224:227]
  ds_read_b64_tr_b16 v[64:65], v2 offset:0
  ds_read_b64_tr_b16 v[66:67], v2 offset:2048
  v_mfma_f32_16x16x32_bf16 v[224:227], v[84:87], a[128:131], v[224:227]
  ds_read_b64_tr_b16 v[68:69], v2 offset:4096
  s_add_u32 s72, s72, 0x2000
  v_mfma_f32_16x16x32_bf16 v[228:231], v[80:83], a[244:247], v[228:231]
  ds_read_b64_tr_b16 v[70:71], v2 offset:6144
  v_mfma_f32_16x16x32_bf16 v[228:231], v[84:87], a[132:135], v[228:231]
  buffer_load_ubyte v125, v28, s[64:67], 0 offen sc1
  v_mfma_f32_16x16x32_bf16 v[232:235], v[80:83], a[248:251], v[232:235]
  v_mfma_f32_16x16x32_bf16 v[232:235], v[84:87], a[136:139], v[232:235]
  v_mfma_f32_16x16x32_bf16 v[236:239], v[80:83], a[252:255], v[236:239]
  v_mfma_f32_16x16x32_bf16 v[236:239], v[84:87], a[140:143], v[236:239]
  ds_read_b64_tr_b16 v[72:73], v3 offset:0
  s_waitcnt lgkmcnt(5)
  v_mfma_f32_16x16x32_bf16 v[240:243], v[88:91], a[240:243], v[240:243]
  ds_read_b64_tr_b16 v[74:75], v3 offset:2048
  v_mfma_f32_16x16x32_bf16 v[240:243], v[92:95], a[128:131], v[240:243]
  ds_read_b64_tr_b16 v[76:77], v3 offset:4096
  v_mfma_f32_16x16x32_bf16 v[244:247], v[88:91], a[244:247], v[244:247]
  ds_read_b64_tr_b16 v[78:79], v3 offset:6144
  v_mfma_f32_16x16x32_bf16 v[244:247], v[92:95], a[132:135], v[244:247]
  v_mfma_f32_16x16x32_bf16 v[248:251], v[88:91], a[248:251], v[248:251]
  v_mfma_f32_16x16x32_bf16 v[248:251], v[92:95], a[136:139], v[248:251]
  v_mfma_f32_16x16x32_bf16 v[252:255], v[88:91], a[252:255], v[252:255]
  v_mfma_f32_16x16x32_bf16 v[252:255], v[92:95], a[140:143], v[252:255]
  s_waitcnt vmcnt(37)
  s_waitcnt lgkmcnt(4)
  v_mfma_f32_16x16x32_bf16 v[128:131], v[64:67], v[32:35], v[128:131]
  ds_read_b64_tr_b16 v[80:81], v2 offset:512
  ds_read_b64_tr_b16 v[82:83], v2 offset:2560
  v_mfma_f32_16x16x32_bf16 v[128:131], v[68:71], v[48:51], v[128:131]
  ds_read_b64_tr_b16 v[84:85], v2 offset:4608
  s_add_u32 m0, s5, 0x20000
  v_mfma_f32_16x16x32_bf16 v[132:135], v[64:67], v[36:39], v[132:135]
  ds_read_b64_tr_b16 v[86:87], v2 offset:6656
  v_mfma_f32_16x16x32_bf16 v[132:135], v[68:71], v[52:55], v[132:135]
  buffer_load_dwordx4 v7, s[80:83], s71 offen offset:0 lds
  v_mfma_f32_16x16x32_bf16 v[136:139], v[64:67], v[40:43], v[136:139]
  v_mfma_f32_16x16x32_bf16 v[136:139], v[68:71], v[56:59], v[136:139]
  v_mfma_f32_16x16x32_bf16 v[140:143], v[64:67], v[44:47], v[140:143]
  buffer_load_dwordx4 v8, s[80:83], s71 offen offset:1024 lds
  v_mfma_f32_16x16x32_bf16 v[140:143], v[68:71], v[60:63], v[140:143]
  ds_read_b64_tr_b16 v[88:89], v3 offset:512
  s_waitcnt lgkmcnt(5)
  v_mfma_f32_16x16x32_bf16 v[144:147], v[72:75], v[32:35], v[144:147]
  ds_read_b64_tr_b16 v[90:91], v3 offset:2560
  v_mfma_f32_16x16x32_bf16 v[144:147], v[76:79], v[48:51], v[144:147]
  ds_read_b64_tr_b16 v[92:93], v3 offset:4608
  v_mfma_f32_16x16x32_bf16 v[148:151], v[72:75], v[36:39], v[148:151]
  ds_read_b64_tr_b16 v[94:95], v3 offset:6656
  v_mfma_f32_16x16x32_bf16 v[148:151], v[76:79], v[52:55], v[148:151]
  buffer_load_dwordx4 v9, s[80:83], s71 offen offset:2048 lds
  v_mfma_f32_16x16x32_bf16 v[152:155], v[72:75], v[40:43], v[152:155]
  v_mfma_f32_16x16x32_bf16 v[152:155], v[76:79], v[56:59], v[152:155]
  v_mfma_f32_16x16x32_bf16 v[156:159], v[72:75], v[44:47], v[156:159]
  buffer_load_dwordx4 v10, s[80:83], s71 offen offset:3072 lds
  v_mfma_f32_16x16x32_bf16 v[156:159], v[76:79], v[60:63], v[156:159]
  ds_read_b64_tr_b16 v[64:65], v2 offset:8192
  s_waitcnt lgkmcnt(5)
  v_mfma_f32_16x16x32_bf16 v[160:163], v[80:83], v[32:35], v[160:163]
  ds_read_b64_tr_b16 v[66:67], v2 offset:10240
  v_mfma_f32_16x16x32_bf16 v[160:163], v[84:87], v[48:51], v[160:163]
  ds_read_b64_tr_b16 v[68:69], v2 offset:12288
  s_add_u32 s71, s71, 0x20000
  v_mfma_f32_16x16x32_bf16 v[164:167], v[80:83], v[36:39], v[164:167]
  ds_read_b64_tr_b16 v[70:71], v2 offset:14336
  v_mfma_f32_16x16x32_bf16 v[164:167], v[84:87], v[52:55], v[164:167]
  buffer_load_dwordx4 a[240:243], v25, s[44:47], s72 offen offset:0 sc1
  v_mfma_f32_16x16x32_bf16 v[168:171], v[80:83], v[40:43], v[168:171]
  v_mfma_f32_16x16x32_bf16 v[168:171], v[84:87], v[56:59], v[168:171]
  v_mfma_f32_16x16x32_bf16 v[172:175], v[80:83], v[44:47], v[172:175]
  buffer_load_dwordx4 a[244:247], v25, s[44:47], s72 offen offset:1024 sc1
  v_mfma_f32_16x16x32_bf16 v[172:175], v[84:87], v[60:63], v[172:175]
  ds_read_b64_tr_b16 v[72:73], v3 offset:8192
  s_waitcnt lgkmcnt(5)
  v_mfma_f32_16x16x32_bf16 v[176:179], v[88:91], v[32:35], v[176:179]
  ds_read_b64_tr_b16 v[74:75], v3 offset:10240
  v_mfma_f32_16x16x32_bf16 v[176:179], v[92:95], v[48:51], v[176:179]
  ds_read_b64_tr_b16 v[76:77], v3 offset:12288
  v_mfma_f32_16x16x32_bf16 v[180:183], v[88:91], v[36:39], v[180:183]
  ds_read_b64_tr_b16 v[78:79], v3 offset:14336
  v_mfma_f32_16x16x32_bf16 v[180:183], v[92:95], v[52:55], v[180:183]
  buffer_load_dwordx4 a[248:251], v25, s[44:47], s72 offen offset:2048 sc1
  v_mfma_f32_16x16x32_bf16 v[184:187], v[88:91], v[40:43], v[184:187]
  v_mfma_f32_16x16x32_bf16 v[184:187], v[92:95], v[56:59], v[184:187]
  v_mfma_f32_16x16x32_bf16 v[188:191], v[88:91], v[44:47], v[188:191]
  buffer_load_dwordx4 a[252:255], v25, s[44:47], s72 offen offset:3072 sc1
  v_mfma_f32_16x16x32_bf16 v[188:191], v[92:95], v[60:63], v[188:191]
  ds_read_b64_tr_b16 v[80:81], v2 offset:8704
  s_waitcnt lgkmcnt(5)
  v_mfma_f32_16x16x32_bf16 v[192:195], v[64:67], v[32:35], v[192:195]
  ds_read_b64_tr_b16 v[82:83], v2 offset:10752
  v_mfma_f32_16x16x32_bf16 v[192:195], v[68:71], v[48:51], v[192:195]
  ds_read_b64_tr_b16 v[84:85], v2 offset:12800
  v_mfma_f32_16x16x32_bf16 v[196:199], v[64:67], v[36:39], v[196:199]
  ds_read_b64_tr_b16 v[86:87], v2 offset:14848
  v_mfma_f32_16x16x32_bf16 v[196:199], v[68:71], v[52:55], v[196:199]
  buffer_load_dwordx4 a[128:131], v26, s[44:47], s72 offen offset:0 sc1
  v_mfma_f32_16x16x32_bf16 v[200:203], v[64:67], v[40:43], v[200:203]
  v_mfma_f32_16x16x32_bf16 v[200:203], v[68:71], v[56:59], v[200:203]
  v_mfma_f32_16x16x32_bf16 v[204:207], v[64:67], v[44:47], v[204:207]
  buffer_load_dwordx4 a[132:135], v26, s[44:47], s72 offen offset:1024 sc1
  v_mfma_f32_16x16x32_bf16 v[204:207], v[68:71], v[60:63], v[204:207]
  ds_read_b64_tr_b16 v[88:89], v3 offset:8704
  s_waitcnt lgkmcnt(5)
  v_mfma_f32_16x16x32_bf16 v[208:211], v[72:75], v[32:35], v[208:211]
  ds_read_b64_tr_b16 v[90:91], v3 offset:10752
  v_mfma_f32_16x16x32_bf16 v[208:211], v[76:79], v[48:51], v[208:211]
  ds_read_b64_tr_b16 v[92:93], v3 offset:12800
  v_mfma_f32_16x16x32_bf16 v[212:215], v[72:75], v[36:39], v[212:215]
  ds_read_b64_tr_b16 v[94:95], v3 offset:14848
  v_mfma_f32_16x16x32_bf16 v[212:215], v[76:79], v[52:55], v[212:215]
  buffer_load_dwordx4 a[136:139], v26, s[44:47], s72 offen offset:2048 sc1
  v_mfma_f32_16x16x32_bf16 v[216:219], v[72:75], v[40:43], v[216:219]
  v_mfma_f32_16x16x32_bf16 v[216:219], v[76:79], v[56:59], v[216:219]
  v_mfma_f32_16x16x32_bf16 v[220:223], v[72:75], v[44:47], v[220:223]
  buffer_load_dwordx4 a[140:143], v26, s[44:47], s72 offen offset:3072 sc1
  v_mfma_f32_16x16x32_bf16 v[220:223], v[76:79], v[60:63], v[220:223]
  s_waitcnt vmcnt(45)
  s_barrier
  s_waitcnt lgkmcnt(4)
  v_mfma_f32_16x16x32_bf16 v[224:227], v[80:83], v[32:35], v[224:227]
  ds_read_b64_tr_b16 v[64:65], v2 offset:16384
  ds_read_b64_tr_b16 v[66:67], v2 offset:18432
  v_mfma_f32_16x16x32_bf16 v[224:227], v[84:87], v[48:51], v[224:227]
  ds_read_b64_tr_b16 v[68:69], v2 offset:20480
  s_add_u32 s72, s72, 0x2000
  v_mfma_f32_16x16x32_bf16 v[228:231], v[80:83], v[36:39], v[228:231]
  ds_read_b64_tr_b16 v[70:71], v2 offset:22528
  v_mfma_f32_16x16x32_bf16 v[228:231], v[84:87], v[52:55], v[228:231]
  v_mfma_f32_16x16x32_bf16 v[232:235], v[80:83], v[40:43], v[232:235]
  v_mfma_f32_16x16x32_bf16 v[232:235], v[84:87], v[56:59], v[232:235]
  v_mfma_f32_16x16x32_bf16 v[236:239], v[80:83], v[44:47], v[236:239]
  v_mfma_f32_16x16x32_bf16 v[236:239], v[84:87], v[60:63], v[236:239]
  ds_read_b64_tr_b16 v[72:73], v3 offset:16384
  s_waitcnt lgkmcnt(5)
  v_mfma_f32_16x16x32_bf16 v[240:243], v[88:91], v[32:35], v[240:243]
  ds_read_b64_tr_b16 v[74:75], v3 offset:18432
  v_mfma_f32_16x16x32_bf16 v[240:243], v[92:95], v[48:51], v[240:243]
  ds_read_b64_tr_b16 v[76:77], v3 offset:20480
  v_mfma_f32_16x16x32_bf16 v[244:247], v[88:91], v[36:39], v[244:247]
  ds_read_b64_tr_b16 v[78:79], v3 offset:22528
  v_mfma_f32_16x16x32_bf16 v[244:247], v[92:95], v[52:55], v[244:247]
  v_mfma_f32_16x16x32_bf16 v[248:251], v[88:91], v[40:43], v[248:251]
  v_mfma_f32_16x16x32_bf16 v[248:251], v[92:95], v[56:59], v[248:251]
  v_mfma_f32_16x16x32_bf16 v[252:255], v[88:91], v[44:47], v[252:255]
  v_mfma_f32_16x16x32_bf16 v[252:255], v[92:95], v[60:63], v[252:255]
  s_waitcnt vmcnt(37)
  s_waitcnt lgkmcnt(4)
  v_mfma_f32_16x16x32_bf16 v[128:131], v[64:67], a[176:179], v[128:131]
  ds_read_b64_tr_b16 v[80:81], v2 offset:16896
  ds_read_b64_tr_b16 v[82:83], v2 offset:18944
  v_mfma_f32_16x16x32_bf16 v[128:131], v[68:71], a[192:195], v[128:131]
  ds_read_b64_tr_b16 v[84:85], v2 offset:20992
  s_mov_b32 s71, s74
  v_mfma_f32_16x16x32_bf16 v[132:135], v[64:67], a[180:183], v[132:135]
  ds_read_b64_tr_b16 v[86:87], v2 offset:23040
  s_add_u32 m0, s5, 0x24000
  v_mfma_f32_16x16x32_bf16 v[132:135], v[68:71], a[196:199], v[132:135]
  buffer_load_dwordx4 v7, s[76:79], s71 offen offset:0 lds
  v_mfma_f32_16x16x32_bf16 v[136:139], v[64:67], a[184:187], v[136:139]
  buffer_load_dwordx4 v8, s[76:79], s71 offen offset:1024 lds
  v_mfma_f32_16x16x32_bf16 v[136:139], v[68:71], a[200:203], v[136:139]
  buffer_load_dwordx4 v9, s[76:79], s71 offen offset:2048 lds
  v_mfma_f32_16x16x32_bf16 v[140:143], v[64:67], a[188:191], v[140:143]
  buffer_load_dwordx4 v10, s[76:79], s71 offen offset:3072 lds
  v_mfma_f32_16x16x32_bf16 v[140:143], v[68:71], a[204:207], v[140:143]
  ds_read_b64_tr_b16 v[88:89], v3 offset:16896
  s_waitcnt lgkmcnt(5)
  v_mfma_f32_16x16x32_bf16 v[144:147], v[72:75], a[176:179], v[144:147]
  ds_read_b64_tr_b16 v[90:91], v3 offset:18944
  s_add_u32 s71, s71, 0x20000
  v_mfma_f32_16x16x32_bf16 v[144:147], v[76:79], a[192:195], v[144:147]
  ds_read_b64_tr_b16 v[92:93], v3 offset:20992
  s_waitcnt vmcnt(16)
  v_cmp_gt_u32 vcc, 3, v125
  s_and_b32 s62, vcc_lo, -1
  s_cbranch_scc1 L_spin1
L_spin1_ret:
  v_mfma_f32_16x16x32_bf16 v[148:151], v[72:75], a[180:183], v[148:151]
  ds_read_b64_tr_b16 v[94:95], v3 offset:23040
  s_mov_b32 s72, s75
  v_mfma_f32_16x16x32_bf16 v[148:151], v[76:79], a[196:199], v[148:151]
  buffer_load_dwordx4 v[32:35], v25, s[40:43], s72 offen offset:0 sc1
  v_mfma_f32_16x16x32_bf16 v[152:155], v[72:75], a[184:187], v[152:155]
  buffer_load_dwordx4 v[36:39], v25, s[40:43], s72 offen offset:1024 sc1
  v_mfma_f32_16x16x32_bf16 v[152:155], v[76:79], a[200:203], v[152:155]
  buffer_load_dwordx4 v[40:43], v25, s[40:43], s72 offen offset:2048 sc1
  v_mfma_f32_16x16x32_bf16 v[156:159], v[72:75], a[188:191], v[156:159]
  buffer_load_dwordx4 v[44:47], v25, s[40:43], s72 offen offset:3072 sc1
  v_mfma_f32_16x16x32_bf16 v[156:159], v[76:79], a[204:207], v[156:159]
  ds_read_b64_tr_b16 v[64:65], v2 offset:24576
  s_waitcnt lgkmcnt(5)
  v_mfma_f32_16x16x32_bf16 v[160:163], v[80:83], a[176:179], v[160:163]
  ds_read_b64_tr_b16 v[66:67], v2 offset:26624
  v_mfma_f32_16x16x32_bf16 v[160:163], v[84:87], a[192:195], v[160:163]
  ds_read_b64_tr_b16 v[68:69], v2 offset:28672
  v_mfma_f32_16x16x32_bf16 v[164:167], v[80:83], a[180:183], v[164:167]
  ds_read_b64_tr_b16 v[70:71], v2 offset:30720
  v_mfma_f32_16x16x32_bf16 v[164:167], v[84:87], a[196:199], v[164:167]
  buffer_load_dwordx4 v[48:51], v26, s[40:43], s72 offen offset:0 sc1
  v_mfma_f32_16x16x32_bf16 v[168:171], v[80:83], a[184:187], v[168:171]
  buffer_load_dwordx4 v[52:55], v26, s[40:43], s72 offen offset:1024 sc1
  v_mfma_f32_16x16x32_bf16 v[168:171], v[84:87], a[200:203], v[168:171]
  buffer_load_dwordx4 v[56:59], v26, s[40:43], s72 offen offset:2048 sc1
  v_mfma_f32_16x16x32_bf16 v[172:175], v[80:83], a[188:191], v[172:175]
  buffer_load_dwordx4 v[60:63], v26, s[40:43], s72 offen offset:3072 sc1
  v_mfma_f32_16x16x32_bf16 v[172:175], v[84:87], a[204:207], v[172:175]
  ds_read_b64_tr_b16 v[72:73], v3 offset:24576
  s_waitcnt lgkmcnt(5)
  v_mfma_f32_16x16x32_bf16 v[176:179], v[88:91], a[176:179], v[176:179]
  ds_read_b64_tr_b16 v[74:75], v3 offset:26624
  s_add_u32 s72, s72, 0x2000
  v_mfma_f32_16x16x32_bf16 v[176:179], v[92:95], a[192:195], v[176:179]
  ds_read_b64_tr_b16 v[76:77], v3 offset:28672
  v_mfma_f32_16x16x32_bf16 v[180:183], v[88:91], a[180:183], v[180:183]
  ds_read_b64_tr_b16 v[78:79], v3 offset:30720
  v_mfma_f32_16x16x32_bf16 v[180:183], v[92:95], a[196:199], v[180:183]
  v_mfma_f32_16x16x32_bf16 v[184:187], v[88:91], a[184:187], v[184:187]
  v_mfma_f32_16x16x32_bf16 v[184:187], v[92:95], a[200:203], v[184:187]
  v_mfma_f32_16x16x32_bf16 v[188:191], v[88:91], a[188:191], v[188:191]
  v_mfma_f32_16x16x32_bf16 v[188:191], v[92:95], a[204:207], v[188:191]
  ds_read_b64_tr_b16 v[80:81], v2 offset:25088
  s_waitcnt lgkmcnt(5)
  v_mfma_f32_16x16x32_bf16 v[192:195], v[64:67], a[176:179], v[192:195]
  ds_read_b64_tr_b16 v[82:83], v2 offset:27136
  v_mfma_f32_16x16x32_bf16 v[192:195], v[68:71], a[192:195], v[192:195]
  ds_read_b64_tr_b16 v[84:85], v2 offset:29184
  v_mfma_f32_16x16x32_bf16 v[196:199], v[64:67], a[180:183], v[196:199]
  ds_read_b64_tr_b16 v[86:87], v2 offset:31232
  v_mfma_f32_16x16x32_bf16 v[196:199], v[68:71], a[196:199], v[196:199]
  v_mfma_f32_16x16x32_bf16 v[200:203], v[64:67], a[184:187], v[200:203]
  v_mfma_f32_16x16x32_bf16 v[200:203], v[68:71], a[200:203], v[200:203]
  v_mfma_f32_16x16x32_bf16 v[204:207], v[64:67], a[188:191], v[204:207]
  v_mfma_f32_16x16x32_bf16 v[204:207], v[68:71], a[204:207], v[204:207]
  ds_read_b64_tr_b16 v[88:89], v3 offset:25088
  s_waitcnt lgkmcnt(5)
  v_mfma_f32_16x16x32_bf16 v[208:211], v[72:75], a[176:179], v[208:211]
  ds_read_b64_tr_b16 v[90:91], v3 offset:27136
  v_mfma_f32_16x16x32_bf16 v[208:211], v[76:79], a[192:195], v[208:211]
  ds_read_b64_tr_b16 v[92:93], v3 offset:29184
  v_mfma_f32_16x16x32_bf16 v[212:215], v[72:75], a[180:183], v[212:215]
  ds_read_b64_tr_b16 v[94:95], v3 offset:31232
  v_mfma_f32_16x16x32_bf16 v[212:215], v[76:79], a[196:199], v[212:215]
  v_mfma_f32_16x16x32_bf16 v[216:219], v[72:75], a[184:187], v[216:219]
  v_mfma_f32_16x16x32_bf16 v[216:219], v[76:79], a[200:203], v[216:219]
  v_mfma_f32_16x16x32_bf16 v[220:223], v[72:75], a[188:191], v[220:223]
  v_mfma_f32_16x16x32_bf16 v[220:223], v[76:79], a[204:207], v[220:223]
  s_barrier
  s_waitcnt lgkmcnt(4)
  v_mfma_f32_16x16x32_bf16 v[224:227], v[80:83], a[176:179], v[224:227]
  ds_read_b64_tr_b16 v[64:65], v2 offset:32768
  ds_read_b64_tr_b16 v[66:67], v2 offset:34816
  v_mfma_f32_16x16x32_bf16 v[224:227], v[84:87], a[192:195], v[224:227]
  ds_read_b64_tr_b16 v[68:69], v2 offset:36864
  v_mfma_f32_16x16x32_bf16 v[228:231], v[80:83], a[180:183], v[228:231]
  ds_read_b64_tr_b16 v[70:71], v2 offset:38912
  v_mfma_f32_16x16x32_bf16 v[228:231], v[84:87], a[196:199], v[228:231]
  v_mfma_f32_16x16x32_bf16 v[232:235], v[80:83], a[184:187], v[232:235]
  v_mfma_f32_16x16x32_bf16 v[232:235], v[84:87], a[200:203], v[232:235]
  v_mfma_f32_16x16x32_bf16 v[236:239], v[80:83], a[188:191], v[236:239]
  v_mfma_f32_16x16x32_bf16 v[236:239], v[84:87], a[204:207], v[236:239]
  ds_read_b64_tr_b16 v[72:73], v3 offset:32768
  s_waitcnt lgkmcnt(5)
  v_mfma_f32_16x16x32_bf16 v[240:243], v[88:91], a[176:179], v[240:243]
  ds_read_b64_tr_b16 v[74:75], v3 offset:34816
  v_mfma_f32_16x16x32_bf16 v[240:243], v[92:95], a[192:195], v[240:243]
  ds_read_b64_tr_b16 v[76:77], v3 offset:36864
  v_mfma_f32_16x16x32_bf16 v[244:247], v[88:91], a[180:183], v[244:247]
  ds_read_b64_tr_b16 v[78:79], v3 offset:38912
  v_mfma_f32_16x16x32_bf16 v[244:247], v[92:95], a[196:199], v[244:247]
  v_mfma_f32_16x16x32_bf16 v[248:251], v[88:91], a[184:187], v[248:251]
  v_mfma_f32_16x16x32_bf16 v[248:251], v[92:95], a[200:203], v[248:251]
  v_mfma_f32_16x16x32_bf16 v[252:255], v[88:91], a[188:191], v[252:255]
  v_mfma_f32_16x16x32_bf16 v[252:255], v[92:95], a[204:207], v[252:255]
  s_waitcnt lgkmcnt(4)
  v_mfma_f32_16x16x32_bf16 v[128:131], v[64:67], a[208:211], v[128:131]
  ds_read_b64_tr_b16 v[80:81], v2 offset:33280
  ds_read_b64_tr_b16 v[82:83], v2 offset:35328
  v_mfma_f32_16x16x32_bf16 v[128:131], v[68:71], a[224:227], v[128:131]
  ds_read_b64_tr_b16 v[84:85], v2 offset:37376
  s_add_u32 m0, s5, 0x18000
  v_mfma_f32_16x16x32_bf16 v[132:135], v[64:67], a[212:215], v[132:135]
  ds_read_b64_tr_b16 v[86:87], v2 offset:39424
  v_mfma_f32_16x16x32_bf16 v[132:135], v[68:71], a[228:231], v[132:135]
  buffer_load_dwordx4 v7, s[76:79], s71 offen offset:0 lds
  v_mfma_f32_16x16x32_bf16 v[136:139], v[64:67], a[216:219], v[136:139]
  v_mfma_f32_16x16x32_bf16 v[136:139], v[68:71], a[232:235], v[136:139]
  v_mfma_f32_16x16x32_bf16 v[140:143], v[64:67], a[220:223], v[140:143]
  buffer_load_dwordx4 v8, s[76:79], s71 offen offset:1024 lds
  v_mfma_f32_16x16x32_bf16 v[140:143], v[68:71], a[236:239], v[140:143]
  ds_read_b64_tr_b16 v[88:89], v3 offset:33280
  s_waitcnt lgkmcnt(5)
  v_mfma_f32_16x16x32_bf16 v[144:147], v[72:75], a[208:211], v[144:147]
  ds_read_b64_tr_b16 v[90:91], v3 offset:35328
  v_mfma_f32_16x16x32_bf16 v[144:147], v[76:79], a[224:227], v[144:147]
  ds_read_b64_tr_b16 v[92:93], v3 offset:37376
  v_mfma_f32_16x16x32_bf16 v[148:151], v[72:75], a[212:215], v[148:151]
  ds_read_b64_tr_b16 v[94:95], v3 offset:39424
  v_mfma_f32_16x16x32_bf16 v[148:151], v[76:79], a[228:231], v[148:151]
  buffer_load_dwordx4 v9, s[76:79], s71 offen offset:2048 lds
  v_mfma_f32_16x16x32_bf16 v[152:155], v[72:75], a[216:219], v[152:155]
  v_mfma_f32_16x16x32_bf16 v[152:155], v[76:79], a[232:235], v[152:155]
  v_mfma_f32_16x16x32_bf16 v[156:159], v[72:75], a[220:223], v[156:159]
  buffer_load_dwordx4 v10, s[76:79], s71 offen offset:3072 lds
  v_mfma_f32_16x16x32_bf16 v[156:159], v[76:79], a[236:239], v[156:159]
  ds_read_b64_tr_b16 v[64:65], v2 offset:40960
  s_waitcnt lgkmcnt(5)
  v_mfma_f32_16x16x32_bf16 v[160:163], v[80:83], a[208:211], v[160:163]
  ds_read_b64_tr_b16 v[66:67], v2 offset:43008
  v_mfma_f32_16x16x32_bf16 v[160:163], v[84:87], a[224:227], v[160:163]
  ds_read_b64_tr_b16 v[68:69], v2 offset:45056
  s_add_u32 s71, s71, 0x20000
  v_mfma_f32_16x16x32_bf16 v[164:167], v[80:83], a[212:215], v[164:167]
  ds_read_b64_tr_b16 v[70:71], v2 offset:47104
  v_mfma_f32_16x16x32_bf16 v[164:167], v[84:87], a[228:231], v[164:167]
  buffer_load_dwordx4 a[176:179], v25, s[40:43], s72 offen offset:0 sc1
  v_mfma_f32_16x16x32_bf16 v[168:171], v[80:83], a[216:219], v[168:171]
  v_mfma_f32_16x16x32_bf16 v[168:171], v[84:87], a[232:235], v[168:171]
  v_mfma_f32_16x16x32_bf16 v[172:175], v[80:83], a[220:223], v[172:175]
  buffer_load_dwordx4 a[180:183], v25, s[40:43], s72 offen offset:1024 sc1
  v_mfma_f32_16x16x32_bf16 v[172:175], v[84:87], a[236:239], v[172:175]
  ds_read_b64_tr_b16 v[72:73], v3 offset:40960
  s_waitcnt lgkmcnt(5)
  v_mfma_f32_16x16x32_bf16 v[176:179], v[88:91], a[208:211], v[176:179]
  ds_read_b64_tr_b16 v[74:75], v3 offset:43008
  v_mfma_f32_16x16x32_bf16 v[176:179], v[92:95], a[224:227], v[176:179]
  ds_read_b64_tr_b16 v[76:77], v3 offset:45056
  v_mfma_f32_16x16x32_bf16 v[180:183], v[88:91], a[212:215], v[180:183]
  ds_read_b64_tr_b16 v[78:79], v3 offset:47104
  v_mfma_f32_16x16x32_bf16 v[180:183], v[92:95], a[228:231], v[180:183]
  buffer_load_dwordx4 a[184:187], v25, s[40:43], s72 offen offset:2048 sc1
  v_mfma_f32_16x16x32_bf16 v[184:187], v[88:91], a[216:219], v[184:187]
  v_mfma_f32_16x16x32_bf16 v[184:187], v[92:95], a[232:235], v[184:187]
  v_mfma_f32_16x16x32_bf16 v[188:191], v[88:91], a[220:223], v[188:191]
  buffer_load_dwordx4 a[188:191], v25, s[40:43], s72 offen offset:3072 sc1
  v_mfma_f32_16x16x32_bf16 v[188:191], v[92:95], a[236:239], v[188:191]
  ds_read_b64_tr_b16 v[80:81], v2 offset:41472
  s_waitcnt lgkmcnt(5)
  v_mfma_f32_16x16x32_bf16 v[192:195], v[64:67], a[208:211], v[192:195]
  ds_read_b64_tr_b16 v[82:83], v2 offset:43520
  v_mfma_f32_16x16x32_bf16 v[192:195], v[68:71], a[224:227], v[192:195]
  ds_read_b64_tr_b16 v[84:85], v2 offset:45568
  v_mfma_f32_16x16x32_bf16 v[196:199], v[64:67], a[212:215], v[196:199]
  ds_read_b64_tr_b16 v[86:87], v2 offset:47616
  v_mfma_f32_16x16x32_bf16 v[196:199], v[68:71], a[228:231], v[196:199]
  buffer_load_dwordx4 a[192:195], v26, s[40:43], s72 offen offset:0 sc1
  v_mfma_f32_16x16x32_bf16 v[200:203], v[64:67], a[216:219], v[200:203]
  v_mfma_f32_16x16x32_bf16 v[200:203], v[68:71], a[232:235], v[200:203]
  v_mfma_f32_16x16x32_bf16 v[204:207], v[64:67], a[220:223], v[204:207]
  buffer_load_dwordx4 a[196:199], v26, s[40:43], s72 offen offset:1024 sc1
  v_mfma_f32_16x16x32_bf16 v[204:207], v[68:71], a[236:239], v[204:207]
  ds_read_b64_tr_b16 v[88:89], v3 offset:41472
  s_waitcnt lgkmcnt(5)
  v_mfma_f32_16x16x32_bf16 v[208:211], v[72:75], a[208:211], v[208:211]
  ds_read_b64_tr_b16 v[90:91], v3 offset:43520
  v_mfma_f32_16x16x32_bf16 v[208:211], v[76:79], a[224:227], v[208:211]
  ds_read_b64_tr_b16 v[92:93], v3 offset:45568
  v_mfma_f32_16x16x32_bf16 v[212:215], v[72:75], a[212:215], v[212:215]
  ds_read_b64_tr_b16 v[94:95], v3 offset:47616
  v_mfma_f32_16x16x32_bf16 v[212:215], v[76:79], a[228:231], v[212:215]
  buffer_load_dwordx4 a[200:203], v26, s[40:43], s72 offen offset:2048 sc1
  v_mfma_f32_16x16x32_bf16 v[216:219], v[72:75], a[216:219], v[216:219]
  v_mfma_f32_16x16x32_bf16 v[216:219], v[76:79], a[232:235], v[216:219]
  v_mfma_f32_16x16x32_bf16 v[220:223], v[72:75], a[220:223], v[220:223]
  buffer_load_dwordx4 a[204:207], v26, s[40:43], s72 offen offset:3072 sc1
  v_mfma_f32_16x16x32_bf16 v[220:223], v[76:79], a[236:239], v[220:223]
  s_barrier
  s_waitcnt lgkmcnt(4)
  v_mfma_f32_16x16x32_bf16 v[224:227], v[80:83], a[208:211], v[224:227]
  ds_read_b64_tr_b16 v[64:65], v2 offset:49152
  ds_read_b64_tr_b16 v[66:67], v2 offset:51200
  v_mfma_f32_16x16x32_bf16 v[224:227], v[84:87], a[224:227], v[224:227]
  ds_read_b64_tr_b16 v[68:69], v2 offset:53248
  s_add_u32 s72, s72, 0x2000
  v_mfma_f32_16x16x32_bf16 v[228:231], v[80:83], a[212:215], v[228:231]
  ds_read_b64_tr_b16 v[70:71], v2 offset:55296
  v_mfma_f32_16x16x32_bf16 v[228:231], v[84:87], a[228:231], v[228:231]
  v_mfma_f32_16x16x32_bf16 v[232:235], v[80:83], a[216:219], v[232:235]
  v_mfma_f32_16x16x32_bf16 v[232:235], v[84:87], a[232:235], v[232:235]
  v_mfma_f32_16x16x32_bf16 v[236:239], v[80:83], a[220:223], v[236:239]
  v_mfma_f32_16x16x32_bf16 v[236:239], v[84:87], a[236:239], v[236:239]
  ds_read_b64_tr_b16 v[72:73], v3 offset:49152
  s_waitcnt lgkmcnt(5)
  v_mfma_f32_16x16x32_bf16 v[240:243], v[88:91], a[208:211], v[240:243]
  ds_read_b64_tr_b16 v[74:75], v3 offset:51200
  v_mfma_f32_16x16x32_bf16 v[240:243], v[92:95], a[224:227], v[240:243]
  ds_read_b64_tr_b16 v[76:77], v3 offset:53248
  v_mfma_f32_16x16x32_bf16 v[244:247], v[88:91], a[212:215], v[244:247]
  ds_read_b64_tr_b16 v[78:79], v3 offset:55296
  v_mfma_f32_16x16x32_bf16 v[244:247], v[92:95], a[228:231], v[244:247]
  v_mfma_f32_16x16x32_bf16 v[248:251], v[88:91], a[216:219], v[248:251]
  v_mfma_f32_16x16x32_bf16 v[248:251], v[92:95], a[232:235], v[248:251]
  v_mfma_f32_16x16x32_bf16 v[252:255], v[88:91], a[220:223], v[252:255]
  v_mfma_f32_16x16x32_bf16 v[252:255], v[92:95], a[236:239], v[252:255]
  s_waitcnt lgkmcnt(4)
  v_mfma_f32_16x16x32_bf16 v[128:131], v[64:67], a[144:147], v[128:131]
  ds_read_b64_tr_b16 v[80:81], v2 offset:49664
  ds_read_b64_tr_b16 v[82:83], v2 offset:51712
  v_mfma_f32_16x16x32_bf16 v[128:131], v[68:71], a[160:163], v[128:131]
  ds_read_b64_tr_b16 v[84:85], v2 offset:53760
  s_add_u32 m0, s5, 0x1c000
  v_mfma_f32_16x16x32_bf16 v[132:135], v[64:67], a[148:151], v[132:135]
  ds_read_b64_tr_b16 v[86:87], v2 offset:55808
  v_mfma_f32_16x16x32_bf16 v[132:135], v[68:71], a[164:167], v[132:135]
  buffer_load_dwordx4 v7, s[76:79], s71 offen offset:0 lds
  v_mfma_f32_16x16x32_bf16 v[136:139], v[64:67], a[152:155], v[136:139]
  v_mfma_f32_16x16x32_bf16 v[136:139], v[68:71], a[168:171], v[136:139]
  v_mfma_f32_16x16x32_bf16 v[140:143], v[64:67], a[156:159], v[140:143]
  buffer_load_dwordx4 v8, s[76:79], s71 offen offset:1024 lds
  v_mfma_f32_16x16x32_bf16 v[140:143], v[68:71], a[172:175], v[140:143]
  ds_read_b64_tr_b16 v[88:89], v3 offset:49664
  s_waitcnt lgkmcnt(5)
  v_mfma_f32_16x16x32_bf16 v[144:147], v[72:75], a[144:147], v[144:147]
  ds_read_b64_tr_b16 v[90:91], v3 offset:51712
  v_mfma_f32_16x16x32_bf16 v[144:147], v[76:79], a[160:163], v[144:147]
  ds_read_b64_tr_b16 v[92:93], v3 offset:53760
  v_mfma_f32_16x16x32_bf16 v[148:151], v[72:75], a[148:151], v[148:151]
  ds_read_b64_tr_b16 v[94:95], v3 offset:55808
  v_mfma_f32_16x16x32_bf16 v[148:151], v[76:79], a[164:167], v[148:151]
  buffer_load_dwordx4 v9, s[76:79], s71 offen offset:2048 lds
  v_mfma_f32_16x16x32_bf16 v[152:155], v[72:75], a[152:155], v[152:155]
  v_mfma_f32_16x16x32_bf16 v[152:155], v[76:79], a[168:171], v[152:155]
  v_mfma_f32_16x16x32_bf16 v[156:159], v[72:75], a[156:159], v[156:159]
  buffer_load_dwordx4 v10, s[76:79], s71 offen offset:3072 lds
  v_mfma_f32_16x16x32_bf16 v[156:159], v[76:79], a[172:175], v[156:159]
  ds_read_b64_tr_b16 v[64:65], v2 offset:57344
  s_waitcnt lgkmcnt(5)
  v_mfma_f32_16x16x32_bf16 v[160:163], v[80:83], a[144:147], v[160:163]
  ds_read_b64_tr_b16 v[66:67], v2 offset:59392
  v_mfma_f32_16x16x32_bf16 v[160:163], v[84:87], a[160:163], v[160:163]
  ds_read_b64_tr_b16 v[68:69], v2 offset:61440
  s_add_u32 s71, s71, 0x20000
  v_mfma_f32_16x16x32_bf16 v[164:167], v[80:83], a[148:151], v[164:167]
  ds_read_b64_tr_b16 v[70:71], v2 offset:63488
  v_mfma_f32_16x16x32_bf16 v[164:167], v[84:87], a[164:167], v[164:167]
  buffer_load_dwordx4 a[208:211], v25, s[40:43], s72 offen offset:0 sc1
  v_mfma_f32_16x16x32_bf16 v[168:171], v[80:83], a[152:155], v[168:171]
  v_mfma_f32_16x16x32_bf16 v[168:171], v[84:87], a[168:171], v[168:171]
  v_mfma_f32_16x16x32_bf16 v[172:175], v[80:83], a[156:159], v[172:175]
  buffer_load_dwordx4 a[212:215], v25, s[40:43], s72 offen offset:1024 sc1
  v_mfma_f32_16x16x32_bf16 v[172:175], v[84:87], a[172:175], v[172:175]
  ds_read_b64_tr_b16 v[72:73], v3 offset:57344
  s_waitcnt lgkmcnt(5)
  v_mfma_f32_16x16x32_bf16 v[176:179], v[88:91], a[144:147], v[176:179]
  ds_read_b64_tr_b16 v[74:75], v3 offset:59392
  v_mfma_f32_16x16x32_bf16 v[176:179], v[92:95], a[160:163], v[176:179]
  ds_read_b64_tr_b16 v[76:77], v3 offset:61440
  v_mfma_f32_16x16x32_bf16 v[180:183], v[88:91], a[148:151], v[180:183]
  ds_read_b64_tr_b16 v[78:79], v3 offset:63488
  v_mfma_f32_16x16x32_bf16 v[180:183], v[92:95], a[164:167], v[180:183]
  buffer_load_dwordx4 a[216:219], v25, s[40:43], s72 offen offset:2048 sc1
  v_mfma_f32_16x16x32_bf16 v[184:187], v[88:91], a[152:155], v[184:187]
  v_mfma_f32_16x16x32_bf16 v[184:187], v[92:95], a[168:171], v[184:187]
  v_mfma_f32_16x16x32_bf16 v[188:191], v[88:91], a[156:159], v[188:191]
  buffer_load_dwordx4 a[220:223], v25, s[40:43], s72 offen offset:3072 sc1
  v_mfma_f32_16x16x32_bf16 v[188:191], v[92:95], a[172:175], v[188:191]
  ds_read_b64_tr_b16 v[80:81], v2 offset:57856
  s_waitcnt lgkmcnt(5)
  v_mfma_f32_16x16x32_bf16 v[192:195], v[64:67], a[144:147], v[192:195]
  ds_read_b64_tr_b16 v[82:83], v2 offset:59904
  v_mfma_f32_16x16x32_bf16 v[192:195], v[68:71], a[160:163], v[192:195]
  ds_read_b64_tr_b16 v[84:85], v2 offset:61952
  v_mfma_f32_16x16x32_bf16 v[196:199], v[64:67], a[148:151], v[196:199]
  ds_read_b64_tr_b16 v[86:87], v2 offset:64000
  v_mfma_f32_16x16x32_bf16 v[196:199], v[68:71], a[164:167], v[196:199]
  buffer_load_dwordx4 a[224:227], v26, s[40:43], s72 offen offset:0 sc1
  v_mfma_f32_16x16x32_bf16 v[200:203], v[64:67], a[152:155], v[200:203]
  v_mfma_f32_16x16x32_bf16 v[200:203], v[68:71], a[168:171], v[200:203]
  v_mfma_f32_16x16x32_bf16 v[204:207], v[64:67], a[156:159], v[204:207]
  buffer_load_dwordx4 a[228:231], v26, s[40:43], s72 offen offset:1024 sc1
  v_mfma_f32_16x16x32_bf16 v[204:207], v[68:71], a[172:175], v[204:207]
  ds_read_b64_tr_b16 v[88:89], v3 offset:57856
  s_waitcnt lgkmcnt(5)
  v_mfma_f32_16x16x32_bf16 v[208:211], v[72:75], a[144:147], v[208:211]
  ds_read_b64_tr_b16 v[90:91], v3 offset:59904
  v_mfma_f32_16x16x32_bf16 v[208:211], v[76:79], a[160:163], v[208:211]
  ds_read_b64_tr_b16 v[92:93], v3 offset:61952
  v_mfma_f32_16x16x32_bf16 v[212:215], v[72:75], a[148:151], v[212:215]
  ds_read_b64_tr_b16 v[94:95], v3 offset:64000
  v_mfma_f32_16x16x32_bf16 v[212:215], v[76:79], a[164:167], v[212:215]
  buffer_load_dwordx4 a[232:235], v26, s[40:43], s72 offen offset:2048 sc1
  v_mfma_f32_16x16x32_bf16 v[216:219], v[72:75], a[152:155], v[216:219]
  v_mfma_f32_16x16x32_bf16 v[216:219], v[76:79], a[168:171], v[216:219]
  v_mfma_f32_16x16x32_bf16 v[220:223], v[72:75], a[156:159], v[220:223]
  buffer_load_dwordx4 a[236:239], v26, s[40:43], s72 offen offset:3072 sc1
  v_mfma_f32_16x16x32_bf16 v[220:223], v[76:79], a[172:175], v[220:223]
  s_waitcnt vmcnt(44)
  s_barrier
  s_waitcnt lgkmcnt(4)
  v_mfma_f32_16x16x32_bf16 v[224:227], v[80:83], a[144:147], v[224:227]
  ds_read_b64_tr_b16 v[64:65], v6 offset:0
  ds_read_b64_tr_b16 v[66:67], v6 offset:2048
  v_mfma_f32_16x16x32_bf16 v[224:227], v[84:87], a[160:163], v[224:227]
  ds_read_b64_tr_b16 v[68:69], v6 offset:4096
  s_add_u32 s72, s72, 0x2000
  v_mfma_f32_16x16x32_bf16 v[228:231], v[80:83], a[148:151], v[228:231]
  ds_read_b64_tr_b16 v[70:71], v6 offset:6144
  v_mfma_f32_16x16x32_bf16 v[228:231], v[84:87], a[164:167], v[228:231]
  v_mfma_f32_16x16x32_bf16 v[232:235], v[80:83], a[152:155], v[232:235]
  v_mfma_f32_16x16x32_bf16 v[232:235], v[84:87], a[168:171], v[232:235]
  v_mfma_f32_16x16x32_bf16 v[236:239], v[80:83], a[156:159], v[236:239]
  v_mfma_f32_16x16x32_bf16 v[236:239], v[84:87], a[172:175], v[236:239]
  ds_read_b64_tr_b16 v[72:73], v30 offset:0
  s_waitcnt lgkmcnt(5)
  v_mfma_f32_16x16x32_bf16 v[240:243], v[88:91], a[144:147], v[240:243]
  ds_read_b64_tr_b16 v[74:75], v30 offset:2048
  v_mfma_f32_16x16x32_bf16 v[240:243], v[92:95], a[160:163], v[240:243]
  ds_read_b64_tr_b16 v[76:77], v30 offset:4096
  v_mfma_f32_16x16x32_bf16 v[244:247], v[88:91], a[148:151], v[244:247]
  ds_read_b64_tr_b16 v[78:79], v30 offset:6144
  v_mfma_f32_16x16x32_bf16 v[244:247], v[92:95], a[164:167], v[244:247]
  v_mfma_f32_16x16x32_bf16 v[248:251], v[88:91], a[152:155], v[248:251]
  v_mfma_f32_16x16x32_bf16 v[248:251], v[92:95], a[168:171], v[248:251]
  v_mfma_f32_16x16x32_bf16 v[252:255], v[88:91], a[156:159], v[252:255]
  v_mfma_f32_16x16x32_bf16 v[252:255], v[92:95], a[172:175], v[252:255]
  s_waitcnt vmcnt(36)
  s_waitcnt lgkmcnt(4)
  v_mfma_f32_16x16x32_bf16 v[128:131], v[64:67], a[240:243], v[128:131]
  ds_read_b64_tr_b16 v[80:81], v6 offset:512
  ds_read_b64_tr_b16 v[82:83], v6 offset:2560
  v_mfma_f32_16x16x32_bf16 v[128:131], v[68:71], a[128:131], v[128:131]
  ds_read_b64_tr_b16 v[84:85], v6 offset:4608
  s_add_u32 m0, s5, 0x10000
  v_mfma_f32_16x16x32_bf16 v[132:135], v[64:67], a[244:247], v[132:135]
  ds_read_b64_tr_b16 v[86:87], v6 offset:6656
  v_mfma_f32_16x16x32_bf16 v[132:135], v[68:71], a[132:135], v[132:135]
  buffer_load_dwordx4 v7, s[76:79], s71 offen offset:0 lds
  v_mfma_f32_16x16x32_bf16 v[136:139], v[64:67], a[248:251], v[136:139]
  v_mfma_f32_16x16x32_bf16 v[136:139], v[68:71], a[136:139], v[136:139]
  v_mfma_f32_16x16x32_bf16 v[140:143], v[64:67], a[252:255], v[140:143]
  buffer_load_dwordx4 v8, s[76:79], s71 offen offset:1024 lds
  v_mfma_f32_16x16x32_bf16 v[140:143], v[68:71], a[140:143], v[140:143]
  ds_read_b64_tr_b16 v[88:89], v30 offset:512
  s_waitcnt lgkmcnt(5)
  v_mfma_f32_16x16x32_bf16 v[144:147], v[72:75], a[240:243], v[144:147]
  ds_read_b64_tr_b16 v[90:91], v30 offset:2560
  v_mfma_f32_16x16x32_bf16 v[144:147], v[76:79], a[128:131], v[144:147]
  ds_read_b64_tr_b16 v[92:93], v30 offset:4608
  v_mfma_f32_16x16x32_bf16 v[148:151], v[72:75], a[244:247], v[148:151]
  ds_read_b64_tr_b16 v[94:95], v30 offset:6656
  v_mfma_f32_16x16x32_bf16 v[148:151], v[76:79], a[132:135], v[148:151]
  buffer_load_dwordx4 v9, s[76:79], s71 offen offset:2048 lds
  v_mfma_f32_16x16x32_bf16 v[152:155], v[72:75], a[248:251], v[152:155]
  v_mfma_f32_16x16x32_bf16 v[152:155], v[76:79], a[136:139], v[152:155]
  v_mfma_f32_16x16x32_bf16 v[156:159], v[72:75], a[252:255], v[156:159]
  buffer_load_dwordx4 v10, s[76:79], s71 offen offset:3072 lds
  v_mfma_f32_16x16x32_bf16 v[156:159], v[76:79], a[140:143], v[156:159]
  ds_read_b64_tr_b16 v[64:65], v6 offset:8192
  s_waitcnt lgkmcnt(5)
  v_mfma_f32_16x16x32_bf16 v[160:163], v[80:83], a[240:243], v[160:163]
  ds_read_b64_tr_b16 v[66:67], v6 offset:10240
  v_mfma_f32_16x16x32_bf16 v[160:163], v[84:87], a[128:131], v[160:163]
  ds_read_b64_tr_b16 v[68:69], v6 offset:12288
  s_add_u32 s71, s71, 0x20000
  v_mfma_f32_16x16x32_bf16 v[164:167], v[80:83], a[244:247], v[164:167]
  ds_read_b64_tr_b16 v[70:71], v6 offset:14336
  v_mfma_f32_16x16x32_bf16 v[164:167], v[84:87], a[132:135], v[164:167]
  buffer_load_dwordx4 a[144:147], v25, s[40:43], s72 offen offset:0 sc1
  v_mfma_f32_16x16x32_bf16 v[168:171], v[80:83], a[248:251], v[168:171]
  v_mfma_f32_16x16x32_bf16 v[168:171], v[84:87], a[136:139], v[168:171]
  v_mfma_f32_16x16x32_bf16 v[172:175], v[80:83], a[252:255], v[172:175]
  buffer_load_dwordx4 a[148:151], v25, s[40:43], s72 offen offset:1024 sc1
  v_mfma_f32_16x16x32_bf16 v[172:175], v[84:87], a[140:143], v[172:175]
  ds_read_b64_tr_b16 v[72:73], v30 offset:8192
  s_waitcnt lgkmcnt(5)
  v_mfma_f32_16x16x32_bf16 v[176:179], v[88:91], a[240:243], v[176:179]
  ds_read_b64_tr_b16 v[74:75], v30 offset:10240
  v_mfma_f32_16x16x32_bf16 v[176:179], v[92:95], a[128:131], v[176:179]
  ds_read_b64_tr_b16 v[76:77], v30 offset:12288
  v_mfma_f32_16x16x32_bf16 v[180:183], v[88:91], a[244:247], v[180:183]
  ds_read_b64_tr_b16 v[78:79], v30 offset:14336
  v_mfma_f32_16x16x32_bf16 v[180:183], v[92:95], a[132:135], v[180:183]
  buffer_load_dwordx4 a[152:155], v25, s[40:43], s72 offen offset:2048 sc1
  v_mfma_f32_16x16x32_bf16 v[184:187], v[88:91], a[248:251], v[184:187]
  v_mfma_f32_16x16x32_bf16 v[184:187], v[92:95], a[136:139], v[184:187]
  v_mfma_f32_16x16x32_bf16 v[188:191], v[88:91], a[252:255], v[188:191]
  buffer_load_dwordx4 a[156:159], v25, s[40:43], s72 offen offset:3072 sc1
  v_mfma_f32_16x16x32_bf16 v[188:191], v[92:95], a[140:143], v[188:191]
  ds_read_b64_tr_b16 v[80:81], v6 offset:8704
  s_waitcnt lgkmcnt(5)
  v_mfma_f32_16x16x32_bf16 v[192:195], v[64:67], a[240:243], v[192:195]
  ds_read_b64_tr_b16 v[82:83], v6 offset:10752
  v_mfma_f32_16x16x32_bf16 v[192:195], v[68:71], a[128:131], v[192:195]
  ds_read_b64_tr_b16 v[84:85], v6 offset:12800
  v_mfma_f32_16x16x32_bf16 v[196:199], v[64:67], a[244:247], v[196:199]
  ds_read_b64_tr_b16 v[86:87], v6 offset:14848
  v_mfma_f32_16x16x32_bf16 v[196:199], v[68:71], a[132:135], v[196:199]
  buffer_load_dwordx4 a[160:163], v26, s[40:43], s72 offen offset:0 sc1
  v_mfma_f32_16x16x32_bf16 v[200:203], v[64:67], a[248:251], v[200:203]
  v_mfma_f32_16x16x32_bf16 v[200:203], v[68:71], a[136:139], v[200:203]
  v_mfma_f32_16x16x32_bf16 v[204:207], v[64:67], a[252:255], v[204:207]
  buffer_load_dwordx4 a[164:167], v26, s[40:43], s72 offen offset:1024 sc1
  v_mfma_f32_16x16x32_bf16 v[204:207], v[68:71], a[140:143], v[204:207]
  ds_read_b64_tr_b16 v[88:89], v30 offset:8704
  s_waitcnt lgkmcnt(5)
  v_mfma_f32_16x16x32_bf16 v[208:211], v[72:75], a[240:243], v[208:211]
  ds_read_b64_tr_b16 v[90:91], v30 offset:10752
  v_mfma_f32_16x16x32_bf16 v[208:211], v[76:79], a[128:131], v[208:211]
  ds_read_b64_tr_b16 v[92:93], v30 offset:12800
  v_mfma_f32_16x16x32_bf16 v[212:215], v[72:75], a[244:247], v[212:215]
  ds_read_b64_tr_b16 v[94:95], v30 offset:14848
  v_mfma_f32_16x16x32_bf16 v[212:215], v[76:79], a[132:135], v[212:215]
  buffer_load_dwordx4 a[168:171], v26, s[40:43], s72 offen offset:2048 sc1
  v_mfma_f32_16x16x32_bf16 v[216:219], v[72:75], a[248:251], v[216:219]
  v_mfma_f32_16x16x32_bf16 v[216:219], v[76:79], a[136:139], v[216:219]
  v_mfma_f32_16x16x32_bf16 v[220:223], v[72:75], a[252:255], v[220:223]
  buffer_load_dwordx4 a[172:175], v26, s[40:43], s72 offen offset:3072 sc1
  v_mfma_f32_16x16x32_bf16 v[220:223], v[76:79], a[140:143], v[220:223]
  s_waitcnt vmcnt(44)
  s_barrier
  s_waitcnt lgkmcnt(4)
  v_mfma_f32_16x16x32_bf16 v[224:227], v[80:83], a[240:243], v[224:227]
  ds_read_b64_tr_b16 v[64:65], v6 offset:16384
  ds_read_b64_tr_b16 v[66:67], v6 offset:18432
  v_mfma_f32_16x16x32_bf16 v[224:227], v[84:87], a[128:131], v[224:227]
  ds_read_b64_tr_b16 v[68:69], v6 offset:20480
  s_add_u32 s72, s72, 0x2000
  v_mfma_f32_16x16x32_bf16 v[228:231], v[80:83], a[244:247], v[228:231]
  ds_read_b64_tr_b16 v[70:71], v6 offset:22528
  v_mfma_f32_16x16x32_bf16 v[228:231], v[84:87], a[132:135], v[228:231]
  v_mfma_f32_16x16x32_bf16 v[232:235], v[80:83], a[248:251], v[232:235]
  v_mfma_f32_16x16x32_bf16 v[232:235], v[84:87], a[136:139], v[232:235]
  v_mfma_f32_16x16x32_bf16 v[236:239], v[80:83], a[252:255], v[236:239]
  v_mfma_f32_16x16x32_bf16 v[236:239], v[84:87], a[140:143], v[236:239]
  ds_read_b64_tr_b16 v[72:73], v30 offset:16384
  s_waitcnt lgkmcnt(5)
  v_mfma_f32_16x16x32_bf16 v[240:243], v[88:91], a[240:243], v[240:243]
  ds_read_b64_tr_b16 v[74:75], v30 offset:18432
  v_mfma_f32_16x16x32_bf16 v[240:243], v[92:95], a[128:131], v[240:243]
  ds_read_b64_tr_b16 v[76:77], v30 offset:20480
  v_mfma_f32_16x16x32_bf16 v[244:247], v[88:91], a[244:247], v[244:247]
  ds_read_b64_tr_b16 v[78:79], v30 offset:22528
  v_mfma_f32_16x16x32_bf16 v[244:247], v[92:95], a[132:135], v[244:247]
  v_mfma_f32_16x16x32_bf16 v[248:251], v[88:91], a[248:251], v[248:251]
  v_mfma_f32_16x16x32_bf16 v[248:251], v[92:95], a[136:139], v[248:251]
  v_mfma_f32_16x16x32_bf16 v[252:255], v[88:91], a[252:255], v[252:255]
  v_mfma_f32_16x16x32_bf16 v[252:255], v[92:95], a[140:143], v[252:255]
  s_waitcnt vmcnt(36)
  s_waitcnt lgkmcnt(4)
  v_mfma_f32_16x16x32_bf16 a[0:3], v[64:67], v[32:35], 0
  ds_read_b64_tr_b16 v[80:81], v6 offset:16896
  ds_read_b64_tr_b16 v[82:83], v6 offset:18944
  v_mfma_f32_16x16x32_bf16 a[0:3], v[68:71], v[48:51], a[0:3]
  ds_read_b64_tr_b16 v[84:85], v6 offset:20992
  s_add_u32 m0, s5, 0x0
  v_mfma_f32_16x16x32_bf16 a[4:7], v[64:67], v[36:39], 0
  ds_read_b64_tr_b16 v[86:87], v6 offset:23040
  v_mfma_f32_16x16x32_bf16 a[4:7], v[68:71], v[52:55], a[4:7]
  buffer_load_dwordx4 v7, s[76:79], s71 offen offset:0 lds
  v_mfma_f32_16x16x32_bf16 a[8:11], v[64:67], v[40:43], 0
  v_mfma_f32_16x16x32_bf16 a[8:11], v[68:71], v[56:59], a[8:11]
  v_mfma_f32_16x16x32_bf16 a[12:15], v[64:67], v[44:47], 0
  buffer_load_dwordx4 v8, s[76:79], s71 offen offset:1024 lds
  v_mfma_f32_16x16x32_bf16 a[12:15], v[68:71], v[60:63], a[12:15]
  ds_read_b64_tr_b16 v[88:89], v30 offset:16896
  s_waitcnt lgkmcnt(5)
  v_mfma_f32_16x16x32_bf16 a[16:19], v[72:75], v[32:35], 0
  ds_read_b64_tr_b16 v[90:91], v30 offset:18944
  v_mfma_f32_16x16x32_bf16 a[16:19], v[76:79], v[48:51], a[16:19]
  ds_read_b64_tr_b16 v[92:93], v30 offset:20992
  v_cvt_pk_bf16_f32 v160, v160, v161
  v_mfma_f32_16x16x32_bf16 a[20:23], v[72:75], v[36:39], 0
  ds_read_b64_tr_b16 v[94:95], v30 offset:23040
  v_cvt_pk_bf16_f32 v161, v162, v163
  v_mfma_f32_16x16x32_bf16 a[20:23], v[76:79], v[52:55], a[20:23]
  buffer_load_dwordx4 v9, s[76:79], s71 offen offset:2048 lds
  v_mfma_f32_16x16x32_bf16 a[24:27], v[72:75], v[40:43], 0
  v_cvt_pk_bf16_f32 v162, v164, v165
  v_cvt_pk_bf16_f32 v163, v166, v167
  v_mfma_f32_16x16x32_bf16 a[24:27], v[76:79], v[56:59], a[24:27]
  v_cvt_pk_bf16_f32 v164, v168, v169
  v_cvt_pk_bf16_f32 v165, v170, v171
  v_mfma_f32_16x16x32_bf16 a[28:31], v[72:75], v[44:47], 0
  buffer_load_dwordx4 v10, s[76:79], s71 offen offset:3072 lds
  v_mfma_f32_16x16x32_bf16 a[28:31], v[76:79], v[60:63], a[28:31]
  ds_read_b64_tr_b16 v[64:65], v6 offset:24576
  s_waitcnt lgkmcnt(5)
  v_mfma_f32_16x16x32_bf16 a[32:35], v[80:83], v[32:35], 0
  ds_read_b64_tr_b16 v[66:67], v6 offset:26624
  v_cvt_pk_bf16_f32 v166, v172, v173
  v_mfma_f32_16x16x32_bf16 a[32:35], v[84:87], v[48:51], a[32:35]
  ds_read_b64_tr_b16 v[68:69], v6 offset:28672
  s_add_u32 s71, s71, 0x20000
  v_mfma_f32_16x16x32_bf16 a[36:39], v[80:83], v[36:39], 0
  ds_read_b64_tr_b16 v[70:71], v6 offset:30720
  v_cvt_pk_bf16_f32 v167, v174, v175
  v_mfma_f32_16x16x32_bf16 a[36:39], v[84:87], v[52:55], a[36:39]
  buffer_load_dwordx4 a[240:243], v25, s[40:43], s72 offen offset:0 sc1
  v_mfma_f32_16x16x32_bf16 a[40:43], v[80:83], v[40:43], 0
  v_cvt_pk_bf16_f32 v168, v176, v177
  v_cvt_pk_bf16_f32 v169, v178, v179
  v_mfma_f32_16x16x32_bf16 a[40:43], v[84:87], v[56:59], a[40:43]
  v_cvt_pk_bf16_f32 v170, v180, v181
  v_cvt_pk_bf16_f32 v171, v182, v183
  v_mfma_f32_16x16x32_bf16 a[44:47], v[80:83], v[44:47], 0
  buffer_load_dwordx4 a[244:247], v25, s[40:43], s72 offen offset:1024 sc1
  v_mfma_f32_16x16x32_bf16 a[44:47], v[84:87], v[60:63], a[44:47]
  ds_read_b64_tr_b16 v[72:73], v30 offset:24576
  s_waitcnt lgkmcnt(5)
  v_mfma_f32_16x16x32_bf16 a[48:51], v[88:91], v[32:35], 0
  ds_read_b64_tr_b16 v[74:75], v30 offset:26624
  v_cvt_pk_bf16_f32 v172, v184, v185
  v_mfma_f32_16x16x32_bf16 a[48:51], v[92:95], v[48:51], a[48:51]
  ds_read_b64_tr_b16 v[76:77], v30 offset:28672
  v_cvt_pk_bf16_f32 v173, v186, v187
  v_mfma_f32_16x16x32_bf16 a[52:55], v[88:91], v[36:39], 0
  ds_read_b64_tr_b16 v[78:79], v30 offset:30720
  v_cvt_pk_bf16_f32 v174, v188, v189
  v_mfma_f32_16x16x32_bf16 a[52:55], v[92:95], v[52:55], a[52:55]
  buffer_load_dwordx4 a[248:251], v25, s[40:43], s72 offen offset:2048 sc1
  v_mfma_f32_16x16x32_bf16 a[56:59], v[88:91], v[40:43], 0
  v_cvt_pk_bf16_f32 v175, v190, v191
  s_mov_b32 s58, 0x4000
  v_mfma_f32_16x16x32_bf16 a[56:59], v[92:95], v[56:59], a[56:59]
  buffer_store_dwordx4 v[160:163], v17, s[64:67], s58 offen offset:0 sc1
  v_mfma_f32_16x16x32_bf16 a[60:63], v[88:91], v[44:47], 0
  buffer_load_dwordx4 a[252:255], v25, s[40:43], s72 offen offset:3072 sc1
  v_mfma_f32_16x16x32_bf16 a[60:63], v[92:95], v[60:63], a[60:63]
  ds_read_b64_tr_b16 v[80:81], v6 offset:25088
  s_waitcnt lgkmcnt(5)
  v_mfma_f32_16x16x32_bf16 a[64:67], v[64:67], v[32:35], 0
  ds_read_b64_tr_b16 v[82:83], v6 offset:27136
  v_mfma_f32_16x16x32_bf16 a[64:67], v[68:71], v[48:51], a[64:67]
  ds_read_b64_tr_b16 v[84:85], v6 offset:29184
  v_mfma_f32_16x16x32_bf16 a[68:71], v[64:67], v[36:39], 0
  ds_read_b64_tr_b16 v[86:87], v6 offset:31232
  v_mfma_f32_16x16x32_bf16 a[68:71], v[68:71], v[52:55], a[68:71]
  buffer_load_dwordx4 a[128:131], v26, s[40:43], s72 offen offset:0 sc1
  v_mfma_f32_16x16x32_bf16 a[72:75], v[64:67], v[40:43], 0
  v_mfma_f32_16x16x32_bf16 a[72:75], v[68:71], v[56:59], a[72:75]
  v_mfma_f32_16x16x32_bf16 a[76:79], v[64:67], v[44:47], 0
  buffer_load_dwordx4 a[132:135], v26, s[40:43], s72 offen offset:1024 sc1
  v_mfma_f32_16x16x32_bf16 a[76:79], v[68:71], v[60:63], a[76:79]
  ds_read_b64_tr_b16 v[88:89], v30 offset:25088
  s_waitcnt lgkmcnt(5)
  v_mfma_f32_16x16x32_bf16 a[80:83], v[72:75], v[32:35], 0
  ds_read_b64_tr_b16 v[90:91], v30 offset:27136
  v_mfma_f32_16x16x32_bf16 a[80:83], v[76:79], v[48:51], a[80:83]
  ds_read_b64_tr_b16 v[92:93], v30 offset:29184
  v_mfma_f32_16x16x32_bf16 a[84:87], v[72:75], v[36:39], 0
  ds_read_b64_tr_b16 v[94:95], v30 offset:31232
  v_mfma_f32_16x16x32_bf16 a[84:87], v[76:79], v[52:55], a[84:87]
  buffer_load_dwordx4 a[136:139], v26, s[40:43], s72 offen offset:2048 sc1
  v_mfma_f32_16x16x32_bf16 a[88:91], v[72:75], v[40:43], 0
  v_mfma_f32_16x16x32_bf16 a[88:91], v[76:79], v[56:59], a[88:91]
  v_mfma_f32_16x16x32_bf16 a[92:95], v[72:75], v[44:47], 0
  buffer_load_dwordx4 a[140:143], v26, s[40:43], s72 offen offset:3072 sc1
  v_mfma_f32_16x16x32_bf16 a[92:95], v[76:79], v[60:63], a[92:95]
  s_waitcnt vmcnt(45)
  s_barrier
  s_waitcnt lgkmcnt(4)
  v_mfma_f32_16x16x32_bf16 a[96:99], v[80:83], v[32:35], 0
  ds_read_b64_tr_b16 v[64:65], v4 offset:32768
  ds_read_b64_tr_b16 v[66:67], v4 offset:34816
  v_mfma_f32_16x16x32_bf16 a[96:99], v[84:87], v[48:51], a[96:99]
  ds_read_b64_tr_b16 v[68:69], v4 offset:36864
  s_add_u32 s72, s72, 0x2000
  v_mfma_f32_16x16x32_bf16 a[100:103], v[80:83], v[36:39], 0
  ds_read_b64_tr_b16 v[70:71], v4 offset:38912
  v_mfma_f32_16x16x32_bf16 a[100:103], v[84:87], v[52:55], a[100:103]
  v_mfma_f32_16x16x32_bf16 a[104:107], v[80:83], v[40:43], 0
  v_mfma_f32_16x16x32_bf16 a[104:107], v[84:87], v[56:59], a[104:107]
  buffer_store_dwordx4 v[164:167], v17, s[64:67], s58 offen offset:1024 sc1
  v_mfma_f32_16x16x32_bf16 a[108:111], v[80:83], v[44:47], 0
  v_mfma_f32_16x16x32_bf16 a[108:111], v[84:87], v[60:63], a[108:111]
  ds_read_b64_tr_b16 v[72:73], v5 offset:32768
  s_waitcnt lgkmcnt(5)
  v_mfma_f32_16x16x32_bf16 a[112:115], v[88:91], v[32:35], 0
  ds_read_b64_tr_b16 v[74:75], v5 offset:34816
  v_mfma_f32_16x16x32_bf16 a[112:115], v[92:95], v[48:51], a[112:115]
  ds_read_b64_tr_b16 v[76:77], v5 offset:36864
  v_mfma_f32_16x16x32_bf16 a[116:119], v[88:91], v[36:39], 0
  ds_read_b64_tr_b16 v[78:79], v5 offset:38912
  v_mfma_f32_16x16x32_bf16 a[116:119], v[92:95], v[52:55], a[116:119]
  v_mfma_f32_16x16x32_bf16 a[120:123], v[88:91], v[40:43], 0
  v_mfma_f32_16x16x32_bf16 a[120:123], v[92:95], v[56:59], a[120:123]
  v_mfma_f32_16x16x32_bf16 a[124:127], v[88:91], v[44:47], 0
  v_mfma_f32_16x16x32_bf16 a[124:127], v[92:95], v[60:63], a[124:127]
  s_waitcnt vmcnt(38)
  s_waitcnt lgkmcnt(4)
  v_mfma_f32_16x16x32_bf16 a[0:3], v[64:67], a[176:179], a[0:3]
  ds_read_b64_tr_b16 v[80:81], v4 offset:33280
  ds_read_b64_tr_b16 v[82:83], v4 offset:35328
  v_mfma_f32_16x16x32_bf16 a[0:3], v[68:71], a[192:195], a[0:3]
  ds_read_b64_tr_b16 v[84:85], v4 offset:37376
  s_add_u32 m0, s5, 0x4000
  v_mfma_f32_16x16x32_bf16 a[4:7], v[64:67], a[180:183], a[4:7]
  ds_read_b64_tr_b16 v[86:87], v4 offset:39424
  v_mfma_f32_16x16x32_bf16 a[4:7], v[68:71], a[196:199], a[4:7]
  buffer_load_dwordx4 v7, s[76:79], s71 offen offset:0 lds
  v_mfma_f32_16x16x32_bf16 a[8:11], v[64:67], a[184:187], a[8:11]
  v_mfma_f32_16x16x32_bf16 a[8:11], v[68:71], a[200:203], a[8:11]
  v_mfma_f32_16x16x32_bf16 a[12:15], v[64:67], a[188:191], a[12:15]
  buffer_load_dwordx4 v8, s[76:79], s71 offen offset:1024 lds
  v_mfma_f32_16x16x32_bf16 a[12:15], v[68:71], a[204:207], a[12:15]
  ds_read_b64_tr_b16 v[88:89], v5 offset:33280
  s_waitcnt lgkmcnt(5)
  v_mfma_f32_16x16x32_bf16 a[16:19], v[72:75], a[176:179], a[16:19]
  ds_read_b64_tr_b16 v[90:91], v5 offset:35328
  v_mfma_f32_16x16x32_bf16 a[16:19], v[76:79], a[192:195], a[16:19]
  ds_read_b64_tr_b16 v[92:93], v5 offset:37376
  v_mfma_f32_16x16x32_bf16 a[20:23], v[72:75], a[180:183], a[20:23]
  ds_read_b64_tr_b16 v[94:95], v5 offset:39424
  v_mfma_f32_16x16x32_bf16 a[20:23], v[76:79], a[196:199], a[20:23]
  buffer_load_dwordx4 v9, s[76:79], s71 offen offset:2048 lds
  v_mfma_f32_16x16x32_bf16 a[24:27], v[72:75], a[184:187], a[24:27]
  v_mfma_f32_16x16x32_bf16 a[24:27], v[76:79], a[200:203], a[24:27]
  buffer_store_dwordx4 v[168:171], v17, s[64:67], s58 offen offset:2048 sc1
  v_mfma_f32_16x16x32_bf16 a[28:31], v[72:75], a[188:191], a[28:31]
  buffer_load_dwordx4 v10, s[76:79], s71 offen offset:3072 lds
  v_mfma_f32_16x16x32_bf16 a[28:31], v[76:79], a[204:207], a[28:31]
  ds_read_b64_tr_b16 v[64:65], v4 offset:40960
  s_waitcnt lgkmcnt(5)
  v_mfma_f32_16x16x32_bf16 a[32:35], v[80:83], a[176:179], a[32:35]
  ds_read_b64_tr_b16 v[66:67], v4 offset:43008
  v_mfma_f32_16x16x32_bf16 a[32:35], v[84:87], a[192:195], a[32:35]
  ds_read_b64_tr_b16 v[68:69], v4 offset:45056
  s_add_u32 s71, s71, 0x20000
  v_mfma_f32_16x16x32_bf16 a[36:39], v[80:83], a[180:183], a[36:39]
  ds_read_b64_tr_b16 v[70:71], v4 offset:47104
  v_mfma_f32_16x16x32_bf16 a[36:39], v[84:87], a[196:199], a[36:39]
  buffer_load_dwordx4 v[32:35], v25, s[40:43], s72 offen offset:0 sc1
  v_mfma_f32_16x16x32_bf16 a[40:43], v[80:83], a[184:187], a[40:43]
  v_mfma_f32_16x16x32_bf16 a[40:43], v[84:87], a[200:203], a[40:43]
  v_mfma_f32_16x16x32_bf16 a[44:47], v[80:83], a[188:191], a[44:47]
  buffer_load_dwordx4 v[36:39], v25, s[40:43], s72 offen offset:1024 sc1
  v_mfma_f32_16x16x32_bf16 a[44:47], v[84:87], a[204:207], a[44:47]
  ds_read_b64_tr_b16 v[72:73], v5 offset:40960
  s_waitcnt lgkmcnt(5)
  v_mfma_f32_16x16x32_bf16 a[48:51], v[88:91], a[176:179], a[48:51]
  ds_read_b64_tr_b16 v[74:75], v5 offset:43008
  v_mfma_f32_16x16x32_bf16 a[48:51], v[92:95], a[192:195], a[48:51]
  ds_read_b64_tr_b16 v[76:77], v5 offset:45056
  v_mfma_f32_16x16x32_bf16 a[52:55], v[88:91], a[180:183], a[52:55]
  ds_read_b64_tr_b16 v[78:79], v5 offset:47104
  v_mfma_f32_16x16x32_bf16 a[52:55], v[92:95], a[196:199], a[52:55]
  buffer_load_dwordx4 v[40:43], v25, s[40:43], s72 offen offset:2048 sc1
  v_mfma_f32_16x16x32_bf16 a[56:59], v[88:91], a[184:187], a[56:59]
  v_mfma_f32_16x16x32_bf16 a[56:59], v[92:95], a[200:203], a[56:59]
  v_mfma_f32_16x16x32_bf16 a[60:63], v[88:91], a[188:191], a[60:63]
  buffer_load_dwordx4 v[44:47], v25, s[40:43], s72 offen offset:3072 sc1
  v_mfma_f32_16x16x32_bf16 a[60:63], v[92:95], a[204:207], a[60:63]
  ds_read_b64_tr_b16 v[80:81], v4 offset:41472
  s_waitcnt lgkmcnt(5)
  v_mfma_f32_16x16x32_bf16 a[64:67], v[64:67], a[176:179], a[64:67]
  ds_read_b64_tr_b16 v[82:83], v4 offset:43520
  v_mfma_f32_16x16x32_bf16 a[64:67], v[68:71], a[192:195], a[64:67]
  ds_read_b64_tr_b16 v[84:85], v4 offset:45568
  v_mfma_f32_16x16x32_bf16 a[68:71], v[64:67], a[180:183], a[68:71]
  ds_read_b64_tr_b16 v[86:87], v4 offset:47616
  v_mfma_f32_16x16x32_bf16 a[68:71], v[68:71], a[196:199], a[68:71]
  buffer_load_dwordx4 v[48:51], v26, s[40:43], s72 offen offset:0 sc1
  v_mfma_f32_16x16x32_bf16 a[72:75], v[64:67], a[184:187], a[72:75]
  v_mfma_f32_16x16x32_bf16 a[72:75], v[68:71], a[200:203], a[72:75]
  buffer_store_dwordx4 v[172:175], v17, s[64:67], s58 offen offset:3072 sc1
  v_mfma_f32_16x16x32_bf16 a[76:79], v[64:67], a[188:191], a[76:79]
  buffer_load_dwordx4 v[52:55], v26, s[40:43], s72 offen offset:1024 sc1
  v_mfma_f32_16x16x32_bf16 a[76:79], v[68:71], a[204:207], a[76:79]
  ds_read_b64_tr_b16 v[88:89], v5 offset:41472
  s_waitcnt lgkmcnt(5)
  v_mfma_f32_16x16x32_bf16 a[80:83], v[72:75], a[176:179], a[80:83]
  ds_read_b64_tr_b16 v[90:91], v5 offset:43520
  v_mfma_f32_16x16x32_bf16 a[80:83], v[76:79], a[192:195], a[80:83]
  ds_read_b64_tr_b16 v[92:93], v5 offset:45568
  v_cvt_pk_bf16_f32 v192, v192, v193
  v_mfma_f32_16x16x32_bf16 a[84:87], v[72:75], a[180:183], a[84:87]
  ds_read_b64_tr_b16 v[94:95], v5 offset:47616
  v_cvt_pk_bf16_f32 v193, v194, v195
  v_mfma_f32_16x16x32_bf16 a[84:87], v[76:79], a[196:199], a[84:87]
  buffer_load_dwordx4 v[56:59], v26, s[40:43], s72 offen offset:2048 sc1
  v_mfma_f32_16x16x32_bf16 a[88:91], v[72:75], a[184:187], a[88:91]
  v_cvt_pk_bf16_f32 v194, v196, v197
  v_cvt_pk_bf16_f32 v195, v198, v199
  v_mfma_f32_16x16x32_bf16 a[88:91], v[76:79], a[200:203], a[88:91]
  v_cvt_pk_bf16_f32 v196, v200, v201
  v_cvt_pk_bf16_f32 v197, v202, v203
  v_mfma_f32_16x16x32_bf16 a[92:95], v[72:75], a[188:191], a[92:95]
  buffer_load_dwordx4 v[60:63], v26, s[40:43], s72 offen offset:3072 sc1
  v_mfma_f32_16x16x32_bf16 a[92:95], v[76:79], a[204:207], a[92:95]
  s_waitcnt vmcnt(48)
  s_barrier
  s_waitcnt lgkmcnt(4)
  v_mfma_f32_16x16x32_bf16 a[96:99], v[80:83], a[176:179], a[96:99]
  ds_read_b64_tr_b16 v[64:65], v4 offset:49152
  ds_read_b64_tr_b16 v[66:67], v4 offset:51200
  v_mfma_f32_16x16x32_bf16 a[96:99], v[84:87], a[192:195], a[96:99]
  ds_read_b64_tr_b16 v[68:69], v4 offset:53248
  s_add_u32 s72, s72, 0x2000
  v_mfma_f32_16x16x32_bf16 a[100:103], v[80:83], a[180:183], a[100:103]
  ds_read_b64_tr_b16 v[70:71], v4 offset:55296
  v_cvt_pk_bf16_f32 v198, v204, v205
  v_mfma_f32_16x16x32_bf16 a[100:103], v[84:87], a[196:199], a[100:103]
  v_cvt_pk_bf16_f32 v199, v206, v207
  v_cvt_pk_bf16_f32 v200, v208, v209
  v_mfma_f32_16x16x32_bf16 a[104:107], v[80:83], a[184:187], a[104:107]
  v_cvt_pk_bf16_f32 v201, v210, v211
  v_cvt_pk_bf16_f32 v202, v212, v213
  v_mfma_f32_16x16x32_bf16 a[104:107], v[84:87], a[200:203], a[104:107]
  v_cvt_pk_bf16_f32 v203, v214, v215
  v_cvt_pk_bf16_f32 v204, v216, v217
  v_mfma_f32_16x16x32_bf16 a[108:111], v[80:83], a[188:191], a[108:111]
  v_cvt_pk_bf16_f32 v205, v218, v219
  v_cvt_pk_bf16_f32 v206, v220, v221
  v_mfma_f32_16x16x32_bf16 a[108:111], v[84:87], a[204:207], a[108:111]
  ds_read_b64_tr_b16 v[72:73], v5 offset:49152
  s_waitcnt lgkmcnt(5)
  v_mfma_f32_16x16x32_bf16 a[112:115], v[88:91], a[176:179], a[112:115]
  ds_read_b64_tr_b16 v[74:75], v5 offset:51200
  v_cvt_pk_bf16_f32 v207, v222, v223
  v_mfma_f32_16x16x32_bf16 a[112:115], v[92:95], a[192:195], a[112:115]
  ds_read_b64_tr_b16 v[76:77], v5 offset:53248
  s_mov_b32 s58, 0x8000
  v_mfma_f32_16x16x32_bf16 a[116:119], v[88:91], a[180:183], a[116:119]
  ds_read_b64_tr_b16 v[78:79], v5 offset:55296
  buffer_store_dwordx4 v[192:195], v17, s[64:67], s58 offen offset:0 sc1
  v_mfma_f32_16x16x32_bf16 a[116:119], v[92:95], a[196:199], a[116:119]
  v_mfma_f32_16x16x32_bf16 a[120:123], v[88:91], a[184:187], a[120:123]
  v_mfma_f32_16x16x32_bf16 a[120:123], v[92:95], a[200:203], a[120:123]
  v_mfma_f32_16x16x32_bf16 a[124:127], v[88:91], a[188:191], a[124:127]
  v_mfma_f32_16x16x32_bf16 a[124:127], v[92:95], a[204:207], a[124:127]
  s_waitcnt vmcnt(41)
  s_waitcnt lgkmcnt(4)
  v_mfma_f32_16x16x32_bf16 a[0:3], v[64:67], a[208:211], a[0:3]
  ds_read_b64_tr_b16 v[80:81], v4 offset:49664
  ds_read_b64_tr_b16 v[82:83], v4 offset:51712
  v_mfma_f32_16x16x32_bf16 a[0:3], v[68:71], a[224:227], a[0:3]
  ds_read_b64_tr_b16 v[84:85], v4 offset:53760
  s_add_u32 m0, s5, 0x8000
  v_mfma_f32_16x16x32_bf16 a[4:7], v[64:67], a[212:215], a[4:7]
  ds_read_b64_tr_b16 v[86:87], v4 offset:55808
  v_mfma_f32_16x16x32_bf16 a[4:7], v[68:71], a[228:231], a[4:7]
  buffer_load_dwordx4 v7, s[76:79], s71 offen offset:0 lds
  v_mfma_f32_16x16x32_bf16 a[8:11], v[64:67], a[216:219], a[8:11]
  v_mfma_f32_16x16x32_bf16 a[8:11], v[68:71], a[232:235], a[8:11]
  v_mfma_f32_16x16x32_bf16 a[12:15], v[64:67], a[220:223], a[12:15]
  buffer_load_dwordx4 v8, s[76:79], s71 offen offset:1024 lds
  v_mfma_f32_16x16x32_bf16 a[12:15], v[68:71], a[236:239], a[12:15]
  ds_read_b64_tr_b16 v[88:89], v5 offset:49664
  s_waitcnt lgkmcnt(5)
  v_mfma_f32_16x16x32_bf16 a[16:19], v[72:75], a[208:211], a[16:19]
  ds_read_b64_tr_b16 v[90:91], v5 offset:51712
  v_mfma_f32_16x16x32_bf16 a[16:19], v[76:79], a[224:227], a[16:19]
  ds_read_b64_tr_b16 v[92:93], v5 offset:53760
  v_mfma_f32_16x16x32_bf16 a[20:23], v[72:75], a[212:215], a[20:23]
  ds_read_b64_tr_b16 v[94:95], v5 offset:55808
  v_mfma_f32_16x16x32_bf16 a[20:23], v[76:79], a[228:231], a[20:23]
  buffer_load_dwordx4 v9, s[76:79], s71 offen offset:2048 lds
  v_mfma_f32_16x16x32_bf16 a[24:27], v[72:75], a[216:219], a[24:27]
  v_mfma_f32_16x16x32_bf16 a[24:27], v[76:79], a[232:235], a[24:27]
  v_mfma_f32_16x16x32_bf16 a[28:31], v[72:75], a[220:223], a[28:31]
  buffer_load_dwordx4 v10, s[76:79], s71 offen offset:3072 lds
  v_mfma_f32_16x16x32_bf16 a[28:31], v[76:79], a[236:239], a[28:31]
  ds_read_b64_tr_b16 v[64:65], v4 offset:57344
  s_waitcnt lgkmcnt(5)
  v_mfma_f32_16x16x32_bf16 a[32:35], v[80:83], a[208:211], a[32:35]
  ds_read_b64_tr_b16 v[66:67], v4 offset:59392
  v_mfma_f32_16x16x32_bf16 a[32:35], v[84:87], a[224:227], a[32:35]
  ds_read_b64_tr_b16 v[68:69], v4 offset:61440
  s_add_u32 s71, s71, 0x20000
  v_mfma_f32_16x16x32_bf16 a[36:39], v[80:83], a[212:215], a[36:39]
  ds_read_b64_tr_b16 v[70:71], v4 offset:63488
  buffer_store_dwordx4 v[196:199], v17, s[64:67], s58 offen offset:1024 sc1
  v_mfma_f32_16x16x32_bf16 a[36:39], v[84:87], a[228:231], a[36:39]
  buffer_load_dwordx4 a[176:179], v25, s[40:43], s72 offen offset:0 sc1
  v_mfma_f32_16x16x32_bf16 a[40:43], v[80:83], a[216:219], a[40:43]
  v_mfma_f32_16x16x32_bf16 a[40:43], v[84:87], a[232:235], a[40:43]
  v_mfma_f32_16x16x32_bf16 a[44:47], v[80:83], a[220:223], a[44:47]
  buffer_load_dwordx4 a[180:183], v25, s[40:43], s72 offen offset:1024 sc1
  v_mfma_f32_16x16x32_bf16 a[44:47], v[84:87], a[236:239], a[44:47]
  ds_read_b64_tr_b16 v[72:73], v5 offset:57344
  s_waitcnt lgkmcnt(5)
  v_mfma_f32_16x16x32_bf16 a[48:51], v[88:91], a[208:211], a[48:51]
  ds_read_b64_tr_b16 v[74:75], v5 offset:59392
  v_mfma_f32_16x16x32_bf16 a[48:51], v[92:95], a[224:227], a[48:51]
  ds_read_b64_tr_b16 v[76:77], v5 offset:61440
  v_mfma_f32_16x16x32_bf16 a[52:55], v[88:91], a[212:215], a[52:55]
  ds_read_b64_tr_b16 v[78:79], v5 offset:63488
  v_mfma_f32_16x16x32_bf16 a[52:55], v[92:95], a[228:231], a[52:55]
  buffer_load_dwordx4 a[184:187], v25, s[40:43], s72 offen offset:2048 sc1
  v_mfma_f32_16x16x32_bf16 a[56:59], v[88:91], a[216:219], a[56:59]
  v_mfma_f32_16x16x32_bf16 a[56:59], v[92:95], a[232:235], a[56:59]
  v_mfma_f32_16x16x32_bf16 a[60:63], v[88:91], a[220:223], a[60:63]
  buffer_load_dwordx4 a[188:191], v25, s[40:43], s72 offen offset:3072 sc1
  v_mfma_f32_16x16x32_bf16 a[60:63], v[92:95], a[236:239], a[60:63]
  ds_read_b64_tr_b16 v[80:81], v4 offset:57856
  s_waitcnt lgkmcnt(5)
  v_mfma_f32_16x16x32_bf16 a[64:67], v[64:67], a[208:211], a[64:67]
  ds_read_b64_tr_b16 v[82:83], v4 offset:59904
  v_mfma_f32_16x16x32_bf16 a[64:67], v[68:71], a[224:227], a[64:67]
  ds_read_b64_tr_b16 v[84:85], v4 offset:61952
  v_mfma_f32_16x16x32_bf16 a[68:71], v[64:67], a[212:215], a[68:71]
  ds_read_b64_tr_b16 v[86:87], v4 offset:64000
  v_mfma_f32_16x16x32_bf16 a[68:71], v[68:71], a[228:231], a[68:71]
  buffer_load_dwordx4 a[192:195], v26, s[40:43], s72 offen offset:0 sc1
  v_mfma_f32_16x16x32_bf16 a[72:75], v[64:67], a[216:219], a[72:75]
  v_mfma_f32_16x16x32_bf16 a[72:75], v[68:71], a[232:235], a[72:75]
  v_mfma_f32_16x16x32_bf16 a[76:79], v[64:67], a[220:223], a[76:79]
  buffer_load_dwordx4 a[196:199], v26, s[40:43], s72 offen offset:1024 sc1
  v_mfma_f32_16x16x32_bf16 a[76:79], v[68:71], a[236:239], a[76:79]
  ds_read_b64_tr_b16 v[88:89], v5 offset:57856
  s_waitcnt lgkmcnt(5)
  v_mfma_f32_16x16x32_bf16 a[80:83], v[72:75], a[208:211], a[80:83]
  ds_read_b64_tr_b16 v[90:91], v5 offset:59904
  v_mfma_f32_16x16x32_bf16 a[80:83], v[76:79], a[224:227], a[80:83]
  ds_read_b64_tr_b16 v[92:93], v5 offset:61952
  v_mfma_f32_16x16x32_bf16 a[84:87], v[72:75], a[212:215], a[84:87]
  ds_read_b64_tr_b16 v[94:95], v5 offset:64000
  buffer_store_dwordx4 v[200:203], v17, s[64:67], s58 offen offset:2048 sc1
  v_mfma_f32_16x16x32_bf16 a[84:87], v[76:79], a[228:231], a[84:87]
  buffer_load_dwordx4 a[200:203], v26, s[40:43], s72 offen offset:2048 sc1
  v_mfma_f32_16x16x32_bf16 a[88:91], v[72:75], a[216:219], a[88:91]
  v_mfma_f32_16x16x32_bf16 a[88:91], v[76:79], a[232:235], a[88:91]
  v_mfma_f32_16x16x32_bf16 a[92:95], v[72:75], a[220:223], a[92:95]
  buffer_load_dwordx4 a[204:207], v26, s[40:43], s72 offen offset:3072 sc1
  v_mfma_f32_16x16x32_bf16 a[92:95], v[76:79], a[236:239], a[92:95]
  s_waitcnt vmcnt(51)
  s_barrier
  s_waitcnt lgkmcnt(4)
  v_mfma_f32_16x16x32_bf16 a[96:99], v[80:83], a[208:211], a[96:99]
  ds_read_b64_tr_b16 v[64:65], v4 offset:0
  ds_read_b64_tr_b16 v[66:67], v4 offset:2048
  v_mfma_f32_16x16x32_bf16 a[96:99], v[84:87], a[224:227], a[96:99]
  ds_read_b64_tr_b16 v[68:69], v4 offset:4096
  s_add_u32 s72, s72, 0x2000
  v_mfma_f32_16x16x32_bf16 a[100:103], v[80:83], a[212:215], a[100:103]
  ds_read_b64_tr_b16 v[70:71], v4 offset:6144
  v_mfma_f32_16x16x32_bf16 a[100:103], v[84:87], a[228:231], a[100:103]
  v_mfma_f32_16x16x32_bf16 a[104:107], v[80:83], a[216:219], a[104:107]
  v_mfma_f32_16x16x32_bf16 a[104:107], v[84:87], a[232:235], a[104:107]
  v_mfma_f32_16x16x32_bf16 a[108:111], v[80:83], a[220:223], a[108:111]
  v_mfma_f32_16x16x32_bf16 a[108:111], v[84:87], a[236:239], a[108:111]
  ds_read_b64_tr_b16 v[72:73], v5 offset:0
  s_waitcnt lgkmcnt(5)
  v_mfma_f32_16x16x32_bf16 a[112:115], v[88:91], a[208:211], a[112:115]
  ds_read_b64_tr_b16 v[74:75], v5 offset:2048
  v_mfma_f32_16x16x32_bf16 a[112:115], v[92:95], a[224:227], a[112:115]
  ds_read_b64_tr_b16 v[76:77], v5 offset:4096
  v_mfma_f32_16x16x32_bf16 a[116:119], v[88:91], a[212:215], a[116:119]
  ds_read_b64_tr_b16 v[78:79], v5 offset:6144
  v_mfma_f32_16x16x32_bf16 a[116:119], v[92:95], a[228:231], a[116:119]
  v_mfma_f32_16x16x32_bf16 a[120:123], v[88:91], a[216:219], a[120:123]
  v_mfma_f32_16x16x32_bf16 a[120:123], v[92:95], a[232:235], a[120:123]
  v_mfma_f32_16x16x32_bf16 a[124:127], v[88:91], a[220:223], a[124:127]
  v_mfma_f32_16x16x32_bf16 a[124:127], v[92:95], a[236:239], a[124:127]
  s_waitcnt vmcnt(43)
  s_waitcnt lgkmcnt(4)
  v_mfma_f32_16x16x32_bf16 a[0:3], v[64:67], a[144:147], a[0:3]
  ds_read_b64_tr_b16 v[80:81], v4 offset:512
  ds_read_b64_tr_b16 v[82:83], v4 offset:2560
  v_mfma_f32_16x16x32_bf16 a[0:3], v[68:71], a[160:163], a[0:3]
  ds_read_b64_tr_b16 v[84:85], v4 offset:4608
  s_add_u32 m0, s5, 0xc000
  v_mfma_f32_16x16x32_bf16 a[4:7], v[64:67], a[148:151], a[4:7]
  ds_read_b64_tr_b16 v[86:87], v4 offset:6656
  buffer_store_dwordx4 v[204:207], v17, s[64:67], s58 offen offset:3072 sc1
  v_mfma_f32_16x16x32_bf16 a[4:7], v[68:71], a[164:167], a[4:7]
  buffer_load_dwordx4 v7, s[76:79], s71 offen offset:0 lds
  v_mfma_f32_16x16x32_bf16 a[8:11], v[64:67], a[152:155], a[8:11]
  v_mfma_f32_16x16x32_bf16 a[8:11], v[68:71], a[168:171], a[8:11]
  v_mfma_f32_16x16x32_bf16 a[12:15], v[64:67], a[156:159], a[12:15]
  buffer_load_dwordx4 v8, s[76:79], s71 offen offset:1024 lds
  v_mfma_f32_16x16x32_bf16 a[12:15], v[68:71], a[172:175], a[12:15]
  ds_read_b64_tr_b16 v[88:89], v5 offset:512
  s_waitcnt lgkmcnt(5)
  v_mfma_f32_16x16x32_bf16 a[16:19], v[72:75], a[144:147], a[16:19]
  ds_read_b64_tr_b16 v[90:91], v5 offset:2560
  v_mfma_f32_16x16x32_bf16 a[16:19], v[76:79], a[160:163], a[16:19]
  ds_read_b64_tr_b16 v[92:93], v5 offset:4608
  v_cvt_pk_bf16_f32 v224, v224, v225
  v_mfma_f32_16x16x32_bf16 a[20:23], v[72:75], a[148:151], a[20:23]
  ds_read_b64_tr_b16 v[94:95], v5 offset:6656
  v_cvt_pk_bf16_f32 v225, v226, v227
  v_mfma_f32_16x16x32_bf16 a[20:23], v[76:79], a[164:167], a[20:23]
  buffer_load_dwordx4 v9, s[76:79], s71 offen offset:2048 lds
  v_mfma_f32_16x16x32_bf16 a[24:27], v[72:75], a[152:155], a[24:27]
  v_cvt_pk_bf16_f32 v226, v228, v229
  v_cvt_pk_bf16_f32 v227, v230, v231
  v_mfma_f32_16x16x32_bf16 a[24:27], v[76:79], a[168:171], a[24:27]
  v_cvt_pk_bf16_f32 v228, v232, v233
  v_cvt_pk_bf16_f32 v229, v234, v235
  v_mfma_f32_16x16x32_bf16 a[28:31], v[72:75], a[156:159], a[28:31]
  buffer_load_dwordx4 v10, s[76:79], s71 offen offset:3072 lds
  v_mfma_f32_16x16x32_bf16 a[28:31], v[76:79], a[172:175], a[28:31]
  ds_read_b64_tr_b16 v[64:65], v4 offset:8192
  s_waitcnt lgkmcnt(5)
  v_mfma_f32_16x16x32_bf16 a[32:35], v[80:83], a[144:147], a[32:35]
  ds_read_b64_tr_b16 v[66:67], v4 offset:10240
  v_cvt_pk_bf16_f32 v230, v236, v237
  v_mfma_f32_16x16x32_bf16 a[32:35], v[84:87], a[160:163], a[32:35]
  ds_read_b64_tr_b16 v[68:69], v4 offset:12288
  s_add_u32 s71, s71, 0x20000
  v_mfma_f32_16x16x32_bf16 a[36:39], v[80:83], a[148:151], a[36:39]
  ds_read_b64_tr_b16 v[70:71], v4 offset:14336
  v_cvt_pk_bf16_f32 v231, v238, v239
  v_mfma_f32_16x16x32_bf16 a[36:39], v[84:87], a[164:167], a[36:39]
  buffer_load_dwordx4 a[208:211], v25, s[40:43], s72 offen offset:0 sc1
  v_mfma_f32_16x16x32_bf16 a[40:43], v[80:83], a[152:155], a[40:43]
  v_cvt_pk_bf16_f32 v232, v240, v241
  v_cvt_pk_bf16_f32 v233, v242, v243
  v_mfma_f32_16x16x32_bf16 a[40:43], v[84:87], a[168:171], a[40:43]
  v_cvt_pk_bf16_f32 v234, v244, v245
  v_cvt_pk_bf16_f32 v235, v246, v247
  v_mfma_f32_16x16x32_bf16 a[44:47], v[80:83], a[156:159], a[44:47]
  buffer_load_dwordx4 a[212:215], v25, s[40:43], s72 offen offset:1024 sc1
  v_mfma_f32_16x16x32_bf16 a[44:47], v[84:87], a[172:175], a[44:47]
  ds_read_b64_tr_b16 v[72:73], v5 offset:8192
  s_waitcnt lgkmcnt(5)
  v_mfma_f32_16x16x32_bf16 a[48:51], v[88:91], a[144:147], a[48:51]
  ds_read_b64_tr_b16 v[74:75], v5 offset:10240
  v_cvt_pk_bf16_f32 v236, v248, v249
  v_mfma_f32_16x16x32_bf16 a[48:51], v[92:95], a[160:163], a[48:51]
  ds_read_b64_tr_b16 v[76:77], v5 offset:12288
  v_cvt_pk_bf16_f32 v237, v250, v251
  v_mfma_f32_16x16x32_bf16 a[52:55], v[88:91], a[148:151], a[52:55]
  ds_read_b64_tr_b16 v[78:79], v5 offset:14336
  v_cvt_pk_bf16_f32 v238, v252, v253
  v_mfma_f32_16x16x32_bf16 a[52:55], v[92:95], a[164:167], a[52:55]
  buffer_load_dwordx4 a[216:219], v25, s[40:43], s72 offen offset:2048 sc1
  v_mfma_f32_16x16x32_bf16 a[56:59], v[88:91], a[152:155], a[56:59]
  v_cvt_pk_bf16_f32 v239, v254, v255
  s_mov_b32 s58, 0xc000
  v_mfma_f32_16x16x32_bf16 a[56:59], v[92:95], a[168:171], a[56:59]
  buffer_store_dwordx4 v[224:227], v17, s[64:67], s58 offen offset:0 sc1
  v_mfma_f32_16x16x32_bf16 a[60:63], v[88:91], a[156:159], a[60:63]
  buffer_load_dwordx4 a[220:223], v25, s[40:43], s72 offen offset:3072 sc1
  v_mfma_f32_16x16x32_bf16 a[60:63], v[92:95], a[172:175], a[60:63]
  ds_read_b64_tr_b16 v[80:81], v4 offset:8704
  s_waitcnt lgkmcnt(5)
  v_mfma_f32_16x16x32_bf16 a[64:67], v[64:67], a[144:147], a[64:67]
  ds_read_b64_tr_b16 v[82:83], v4 offset:10752
  v_mfma_f32_16x16x32_bf16 a[64:67], v[68:71], a[160:163], a[64:67]
  ds_read_b64_tr_b16 v[84:85], v4 offset:12800
  v_mfma_f32_16x16x32_bf16 a[68:71], v[64:67], a[148:151], a[68:71]
  ds_read_b64_tr_b16 v[86:87], v4 offset:14848
  v_mfma_f32_16x16x32_bf16 a[68:71], v[68:71], a[164:167], a[68:71]
  buffer_load_dwordx4 a[224:227], v26, s[40:43], s72 offen offset:0 sc1
  v_mfma_f32_16x16x32_bf16 a[72:75], v[64:67], a[152:155], a[72:75]
  v_mfma_f32_16x16x32_bf16 a[72:75], v[68:71], a[168:171], a[72:75]
  v_mfma_f32_16x16x32_bf16 a[76:79], v[64:67], a[156:159], a[76:79]
  buffer_load_dwordx4 a[228:231], v26, s[40:43], s72 offen offset:1024 sc1
  v_mfma_f32_16x16x32_bf16 a[76:79], v[68:71], a[172:175], a[76:79]
  ds_read_b64_tr_b16 v[88:89], v5 offset:8704
  s_waitcnt lgkmcnt(5)
  v_mfma_f32_16x16x32_bf16 a[80:83], v[72:75], a[144:147], a[80:83]
  ds_read_b64_tr_b16 v[90:91], v5 offset:10752
  v_mfma_f32_16x16x32_bf16 a[80:83], v[76:79], a[160:163], a[80:83]
  ds_read_b64_tr_b16 v[92:93], v5 offset:12800
  v_mfma_f32_16x16x32_bf16 a[84:87], v[72:75], a[148:151], a[84:87]
  ds_read_b64_tr_b16 v[94:95], v5 offset:14848
  v_mfma_f32_16x16x32_bf16 a[84:87], v[76:79], a[164:167], a[84:87]
  buffer_load_dwordx4 a[232:235], v26, s[40:43], s72 offen offset:2048 sc1
  v_mfma_f32_16x16x32_bf16 a[88:91], v[72:75], a[152:155], a[88:91]
  v_mfma_f32_16x16x32_bf16 a[88:91], v[76:79], a[168:171], a[88:91]
  v_mfma_f32_16x16x32_bf16 a[92:95], v[72:75], a[156:159], a[92:95]
  buffer_load_dwordx4 a[236:239], v26, s[40:43], s72 offen offset:3072 sc1
  v_mfma_f32_16x16x32_bf16 a[92:95], v[76:79], a[172:175], a[92:95]
  s_waitcnt vmcnt(53)
  s_barrier
  s_waitcnt lgkmcnt(4)
  v_mfma_f32_16x16x32_bf16 a[96:99], v[80:83], a[144:147], a[96:99]
  ds_read_b64_tr_b16 v[64:65], v2 offset:0
  ds_read_b64_tr_b16 v[66:67], v2 offset:2048
  v_mfma_f32_16x16x32_bf16 a[96:99], v[84:87], a[160:163], a[96:99]
  ds_read_b64_tr_b16 v[68:69], v2 offset:4096
  s_add_u32 s72, s72, 0x2000
  v_mfma_f32_16x16x32_bf16 a[100:103], v[80:83], a[148:151], a[100:103]
  ds_read_b64_tr_b16 v[70:71], v2 offset:6144
  v_mfma_f32_16x16x32_bf16 a[100:103], v[84:87], a[164:167], a[100:103]
  v_mfma_f32_16x16x32_bf16 a[104:107], v[80:83], a[152:155], a[104:107]
  v_mfma_f32_16x16x32_bf16 a[104:107], v[84:87], a[168:171], a[104:107]
  buffer_store_dwordx4 v[228:231], v17, s[64:67], s58 offen offset:1024 sc1
  v_mfma_f32_16x16x32_bf16 a[108:111], v[80:83], a[156:159], a[108:111]
  v_mfma_f32_16x16x32_bf16 a[108:111], v[84:87], a[172:175], a[108:111]
  ds_read_b64_tr_b16 v[72:73], v3 offset:0
  s_waitcnt lgkmcnt(5)
  v_mfma_f32_16x16x32_bf16 a[112:115], v[88:91], a[144:147], a[112:115]
  ds_read_b64_tr_b16 v[74:75], v3 offset:2048
  v_mfma_f32_16x16x32_bf16 a[112:115], v[92:95], a[160:163], a[112:115]
  ds_read_b64_tr_b16 v[76:77], v3 offset:4096
  v_mfma_f32_16x16x32_bf16 a[116:119], v[88:91], a[148:151], a[116:119]
  ds_read_b64_tr_b16 v[78:79], v3 offset:6144
  v_mfma_f32_16x16x32_bf16 a[116:119], v[92:95], a[164:167], a[116:119]
  v_mfma_f32_16x16x32_bf16 a[120:123], v[88:91], a[152:155], a[120:123]
  v_mfma_f32_16x16x32_bf16 a[120:123], v[92:95], a[168:171], a[120:123]
  v_mfma_f32_16x16x32_bf16 a[124:127], v[88:91], a[156:159], a[124:127]
  v_mfma_f32_16x16x32_bf16 a[124:127], v[92:95], a[172:175], a[124:127]
  s_waitcnt vmcnt(45)
  s_waitcnt lgkmcnt(4)
  v_mfma_f32_16x16x32_bf16 a[0:3], v[64:67], a[240:243], a[0:3]
  ds_read_b64_tr_b16 v[80:81], v2 offset:512
  ds_read_b64_tr_b16 v[82:83], v2 offset:2560
  v_mfma_f32_16x16x32_bf16 a[0:3], v[68:71], a[128:131], a[0:3]
  ds_read_b64_tr_b16 v[84:85], v2 offset:4608
  s_add_u32 m0, s5, 0x20000
  v_mfma_f32_16x16x32_bf16 a[4:7], v[64:67], a[244:247], a[4:7]
  ds_read_b64_tr_b16 v[86:87], v2 offset:6656
  v_mfma_f32_16x16x32_bf16 a[4:7], v[68:71], a[132:135], a[4:7]
  buffer_load_dwordx4 v7, s[76:79], s71 offen offset:0 lds
  v_mfma_f32_16x16x32_bf16 a[8:11], v[64:67], a[248:251], a[8:11]
  v_mfma_f32_16x16x32_bf16 a[8:11], v[68:71], a[136:139], a[8:11]
  v_mfma_f32_16x16x32_bf16 a[12:15], v[64:67], a[252:255], a[12:15]
  buffer_load_dwordx4 v8, s[76:79], s71 offen offset:1024 lds
  v_mfma_f32_16x16x32_bf16 a[12:15], v[68:71], a[140:143], a[12:15]
  ds_read_b64_tr_b16 v[88:89], v3 offset:512
  s_waitcnt lgkmcnt(5)
  v_mfma_f32_16x16x32_bf16 a[16:19], v[72:75], a[240:243], a[16:19]
  ds_read_b64_tr_b16 v[90:91], v3 offset:2560
  v_mfma_f32_16x16x32_bf16 a[16:19], v[76:79], a[128:131], a[16:19]
  ds_read_b64_tr_b16 v[92:93], v3 offset:4608
  v_mfma_f32_16x16x32_bf16 a[20:23], v[72:75], a[244:247], a[20:23]
  ds_read_b64_tr_b16 v[94:95], v3 offset:6656
  v_mfma_f32_16x16x32_bf16 a[20:23], v[76:79], a[132:135], a[20:23]
  buffer_load_dwordx4 v9, s[76:79], s71 offen offset:2048 lds
  v_mfma_f32_16x16x32_bf16 a[24:27], v[72:75], a[248:251], a[24:27]
  v_mfma_f32_16x16x32_bf16 a[24:27], v[76:79], a[136:139], a[24:27]
  buffer_store_dwordx4 v[232:235], v17, s[64:67], s58 offen offset:2048 sc1
  v_mfma_f32_16x16x32_bf16 a[28:31], v[72:75], a[252:255], a[28:31]
  buffer_load_dwordx4 v10, s[76:79], s71 offen offset:3072 lds
  v_mfma_f32_16x16x32_bf16 a[28:31], v[76:79], a[140:143], a[28:31]
  ds_read_b64_tr_b16 v[64:65], v2 offset:8192
  s_waitcnt lgkmcnt(5)
  v_mfma_f32_16x16x32_bf16 a[32:35], v[80:83], a[240:243], a[32:35]
  ds_read_b64_tr_b16 v[66:67], v2 offset:10240
  v_mfma_f32_16x16x32_bf16 a[32:35], v[84:87], a[128:131], a[32:35]
  ds_read_b64_tr_b16 v[68:69], v2 offset:12288
  s_add_u32 s71, s71, 0x20000
  v_mfma_f32_16x16x32_bf16 a[36:39], v[80:83], a[244:247], a[36:39]
  ds_read_b64_tr_b16 v[70:71], v2 offset:14336
  v_mfma_f32_16x16x32_bf16 a[36:39], v[84:87], a[132:135], a[36:39]
  buffer_load_dwordx4 a[144:147], v25, s[40:43], s72 offen offset:0 sc1
  v_mfma_f32_16x16x32_bf16 a[40:43], v[80:83], a[248:251], a[40:43]
  v_mfma_f32_16x16x32_bf16 a[40:43], v[84:87], a[136:139], a[40:43]
  v_mfma_f32_16x16x32_bf16 a[44:47], v[80:83], a[252:255], a[44:47]
  buffer_load_dwordx4 a[148:151], v25, s[40:43], s72 offen offset:1024 sc1
  v_mfma_f32_16x16x32_bf16 a[44:47], v[84:87], a[140:143], a[44:47]
  ds_read_b64_tr_b16 v[72:73], v3 offset:8192
  s_waitcnt lgkmcnt(5)
  v_mfma_f32_16x16x32_bf16 a[48:51], v[88:91], a[240:243], a[48:51]
  ds_read_b64_tr_b16 v[74:75], v3 offset:10240
  v_mfma_f32_16x16x32_bf16 a[48:51], v[92:95], a[128:131], a[48:51]
  ds_read_b64_tr_b16 v[76:77], v3 offset:12288
  v_mfma_f32_16x16x32_bf16 a[52:55], v[88:91], a[244:247], a[52:55]
  ds_read_b64_tr_b16 v[78:79], v3 offset:14336
  v_mfma_f32_16x16x32_bf16 a[52:55], v[92:95], a[132:135], a[52:55]
  buffer_load_dwordx4 a[152:155], v25, s[40:43], s72 offen offset:2048 sc1
  v_mfma_f32_16x16x32_bf16 a[56:59], v[88:91], a[248:251], a[56:59]
  v_mfma_f32_16x16x32_bf16 a[56:59], v[92:95], a[136:139], a[56:59]
  v_mfma_f32_16x16x32_bf16 a[60:63], v[88:91], a[252:255], a[60:63]
  buffer_load_dwordx4 a[156:159], v25, s[40:43], s72 offen offset:3072 sc1
  v_mfma_f32_16x16x32_bf16 a[60:63], v[92:95], a[140:143], a[60:63]
  ds_read_b64_tr_b16 v[80:81], v2 offset:8704
  s_waitcnt lgkmcnt(5)
  v_mfma_f32_16x16x32_bf16 a[64:67], v[64:67], a[240:243], a[64:67]
  ds_read_b64_tr_b16 v[82:83], v2 offset:10752
  v_mfma_f32_16x16x32_bf16 a[64:67], v[68:71], a[128:131], a[64:67]
  ds_read_b64_tr_b16 v[84:85], v2 offset:12800
  v_mfma_f32_16x16x32_bf16 a[68:71], v[64:67], a[244:247], a[68:71]
  ds_read_b64_tr_b16 v[86:87], v2 offset:14848
  v_mfma_f32_16x16x32_bf16 a[68:71], v[68:71], a[132:135], a[68:71]
  buffer_load_dwordx4 a[160:163], v26, s[40:43], s72 offen offset:0 sc1
  v_mfma_f32_16x16x32_bf16 a[72:75], v[64:67], a[248:251], a[72:75]
  v_mfma_f32_16x16x32_bf16 a[72:75], v[68:71], a[136:139], a[72:75]
  buffer_store_dwordx4 v[236:239], v17, s[64:67], s58 offen offset:3072 sc1
  v_mfma_f32_16x16x32_bf16 a[76:79], v[64:67], a[252:255], a[76:79]
  buffer_load_dwordx4 a[164:167], v26, s[40:43], s72 offen offset:1024 sc1
  v_mfma_f32_16x16x32_bf16 a[76:79], v[68:71], a[140:143], a[76:79]
  ds_read_b64_tr_b16 v[88:89], v3 offset:8704
  s_waitcnt lgkmcnt(5)
  v_mfma_f32_16x16x32_bf16 a[80:83], v[72:75], a[240:243], a[80:83]
  ds_read_b64_tr_b16 v[90:91], v3 offset:10752
  v_mfma_f32_16x16x32_bf16 a[80:83], v[76:79], a[128:131], a[80:83]
  ds_read_b64_tr_b16 v[92:93], v3 offset:12800
  v_mfma_f32_16x16x32_bf16 a[84:87], v[72:75], a[244:247], a[84:87]
  ds_read_b64_tr_b16 v[94:95], v3 offset:14848
  v_mfma_f32_16x16x32_bf16 a[84:87], v[76:79], a[132:135], a[84:87]
  buffer_load_dwordx4 a[168:171], v26, s[40:43], s72 offen offset:2048 sc1
  v_mfma_f32_16x16x32_bf16 a[88:91], v[72:75], a[248:251], a[88:91]
  v_mfma_f32_16x16x32_bf16 a[88:91], v[76:79], a[136:139], a[88:91]
  v_mfma_f32_16x16x32_bf16 a[92:95], v[72:75], a[252:255], a[92:95]
  buffer_load_dwordx4 a[172:175], v26, s[40:43], s72 offen offset:3072 sc1
  v_mfma_f32_16x16x32_bf16 a[92:95], v[76:79], a[140:143], a[92:95]
  s_waitcnt vmcnt(53)
  s_barrier
  s_waitcnt lgkmcnt(4)
  v_mfma_f32_16x16x32_bf16 a[96:99], v[80:83], a[240:243], a[96:99]
  ds_read_b64_tr_b16 v[64:65], v2 offset:16384
  ds_read_b64_tr_b16 v[66:67], v2 offset:18432
  v_mfma_f32_16x16x32_bf16 a[96:99], v[84:87], a[128:131], a[96:99]
  ds_read_b64_tr_b16 v[68:69], v2 offset:20480
  s_add_u32 s72, s72, 0x2000
  v_mfma_f32_16x16x32_bf16 a[100:103], v[80:83], a[244:247], a[100:103]
  ds_read_b64_tr_b16 v[70:71], v2 offset:22528
  v_mfma_f32_16x16x32_bf16 a[100:103], v[84:87], a[132:135], a[100:103]
  v_mfma_f32_16x16x32_bf16 a[104:107], v[80:83], a[248:251], a[104:107]
  v_mfma_f32_16x16x32_bf16 a[104:107], v[84:87], a[136:139], a[104:107]
  v_mfma_f32_16x16x32_bf16 a[108:111], v[80:83], a[252:255], a[108:111]
  v_mfma_f32_16x16x32_bf16 a[108:111], v[84:87], a[140:143], a[108:111]
  ds_read_b64_tr_b16 v[72:73], v3 offset:16384
  s_waitcnt lgkmcnt(5)
  v_mfma_f32_16x16x32_bf16 a[112:115], v[88:91], a[240:243], a[112:115]
  ds_read_b64_tr_b16 v[74:75], v3 offset:18432
  v_mfma_f32_16x16x32_bf16 a[112:115], v[92:95], a[128:131], a[112:115]
  ds_read_b64_tr_b16 v[76:77], v3 offset:20480
  v_mfma_f32_16x16x32_bf16 a[116:119], v[88:91], a[244:247], a[116:119]
  ds_read_b64_tr_b16 v[78:79], v3 offset:22528
  v_mfma_f32_16x16x32_bf16 a[116:119], v[92:95], a[132:135], a[116:119]
  v_mfma_f32_16x16x32_bf16 a[120:123], v[88:91], a[248:251], a[120:123]
  v_mfma_f32_16x16x32_bf16 a[120:123], v[92:95], a[136:139], a[120:123]
  v_mfma_f32_16x16x32_bf16 a[124:127], v[88:91], a[252:255], a[124:127]
  v_mfma_f32_16x16x32_bf16 a[124:127], v[92:95], a[140:143], a[124:127]
  s_waitcnt vmcnt(44)
  s_waitcnt lgkmcnt(4)
  v_mfma_f32_16x16x32_bf16 a[0:3], v[64:67], v[32:35], a[0:3]
  ds_read_b64_tr_b16 v[80:81], v2 offset:16896
  ds_read_b64_tr_b16 v[82:83], v2 offset:18944
  v_mfma_f32_16x16x32_bf16 a[0:3], v[68:71], v[48:51], a[0:3]
  ds_read_b64_tr_b16 v[84:85], v2 offset:20992
  s_add_u32 m0, s5, 0x24000
  v_mfma_f32_16x16x32_bf16 a[4:7], v[64:67], v[36:39], a[4:7]
  ds_read_b64_tr_b16 v[86:87], v2 offset:23040
  v_mfma_f32_16x16x32_bf16 a[4:7], v[68:71], v[52:55], a[4:7]
  buffer_load_dwordx4 v7, s[76:79], s71 offen offset:0 lds
  v_mfma_f32_16x16x32_bf16 a[8:11], v[64:67], v[40:43], a[8:11]
  v_mfma_f32_16x16x32_bf16 a[8:11], v[68:71], v[56:59], a[8:11]
  v_mfma_f32_16x16x32_bf16 a[12:15], v[64:67], v[44:47], a[12:15]
  buffer_load_dwordx4 v8, s[76:79], s71 offen offset:1024 lds
  v_mfma_f32_16x16x32_bf16 a[12:15], v[68:71], v[60:63], a[12:15]
  ds_read_b64_tr_b16 v[88:89], v3 offset:16896
  s_waitcnt lgkmcnt(5)
  v_mfma_f32_16x16x32_bf16 a[16:19], v[72:75], v[32:35], a[16:19]
  ds_read_b64_tr_b16 v[90:91], v3 offset:18944
  v_mfma_f32_16x16x32_bf16 a[16:19], v[76:79], v[48:51], a[16:19]
  ds_read_b64_tr_b16 v[92:93], v3 offset:20992
  v_mfma_f32_16x16x32_bf16 a[20:23], v[72:75], v[36:39], a[20:23]
  ds_read_b64_tr_b16 v[94:95], v3 offset:23040
  v_mfma_f32_16x16x32_bf16 a[20:23], v[76:79], v[52:55], a[20:23]
  buffer_load_dwordx4 v9, s[76:79], s71 offen offset:2048 lds
  v_mfma_f32_16x16x32_bf16 a[24:27], v[72:75], v[40:43], a[24:27]
  v_mfma_f32_16x16x32_bf16 a[24:27], v[76:79], v[56:59], a[24:27]
  v_mfma_f32_16x16x32_bf16 a[28:31], v[72:75], v[44:47], a[28:31]
  buffer_load_dwordx4 v10, s[76:79], s71 offen offset:3072 lds
  v_mfma_f32_16x16x32_bf16 a[28:31], v[76:79], v[60:63], a[28:31]
  ds_read_b64_tr_b16 v[64:65], v2 offset:24576
  s_waitcnt lgkmcnt(5)
  v_mfma_f32_16x16x32_bf16 a[32:35], v[80:83], v[32:35], a[32:35]
  ds_read_b64_tr_b16 v[66:67], v2 offset:26624
  v_mfma_f32_16x16x32_bf16 a[32:35], v[84:87], v[48:51], a[32:35]
  ds_read_b64_tr_b16 v[68:69], v2 offset:28672
  s_add_u32 s71, s71, 0x20000
  v_mfma_f32_16x16x32_bf16 a[36:39], v[80:83], v[36:39], a[36:39]
  ds_read_b64_tr_b16 v[70:71], v2 offset:30720
  v_mfma_f32_16x16x32_bf16 a[36:39], v[84:87], v[52:55], a[36:39]
  buffer_load_dwordx4 a[240:243], v25, s[40:43], s72 offen offset:0 sc1
  v_mfma_f32_16x16x32_bf16 a[40:43], v[80:83], v[40:43], a[40:43]
  v_mfma_f32_16x16x32_bf16 a[40:43], v[84:87], v[56:59], a[40:43]
  v_mfma_f32_16x16x32_bf16 a[44:47], v[80:83], v[44:47], a[44:47]
  buffer_load_dwordx4 a[244:247], v25, s[40:43], s72 offen offset:1024 sc1
  v_mfma_f32_16x16x32_bf16 a[44:47], v[84:87], v[60:63], a[44:47]
  ds_read_b64_tr_b16 v[72:73], v3 offset:24576
  s_waitcnt lgkmcnt(5)
  v_mfma_f32_16x16x32_bf16 a[48:51], v[88:91], v[32:35], a[48:51]
  ds_read_b64_tr_b16 v[74:75], v3 offset:26624
  v_mfma_f32_16x16x32_bf16 a[48:51], v[92:95], v[48:51], a[48:51]
  ds_read_b64_tr_b16 v[76:77], v3 offset:28672
  v_mfma_f32_16x16x32_bf16 a[52:55], v[88:91], v[36:39], a[52:55]
  ds_read_b64_tr_b16 v[78:79], v3 offset:30720
  v_mfma_f32_16x16x32_bf16 a[52:55], v[92:95], v[52:55], a[52:55]
  buffer_load_dwordx4 a[248:251], v25, s[40:43], s72 offen offset:2048 sc1
  v_mfma_f32_16x16x32_bf16 a[56:59], v[88:91], v[40:43], a[56:59]
  v_mfma_f32_16x16x32_bf16 a[56:59], v[92:95], v[56:59], a[56:59]
  v_mfma_f32_16x16x32_bf16 a[60:63], v[88:91], v[44:47], a[60:63]
  buffer_load_dwordx4 a[252:255], v25, s[40:43], s72 offen offset:3072 sc1
  v_mfma_f32_16x16x32_bf16 a[60:63], v[92:95], v[60:63], a[60:63]
  ds_read_b64_tr_b16 v[80:81], v2 offset:25088
  s_waitcnt lgkmcnt(5)
  v_mfma_f32_16x16x32_bf16 a[64:67], v[64:67], v[32:35], a[64:67]
  ds_read_b64_tr_b16 v[82:83], v2 offset:27136
  v_mfma_f32_16x16x32_bf16 a[64:67], v[68:71], v[48:51], a[64:67]
  ds_read_b64_tr_b16 v[84:85], v2 offset:29184
  v_mfma_f32_16x16x32_bf16 a[68:71], v[64:67], v[36:39], a[68:71]
  ds_read_b64_tr_b16 v[86:87], v2 offset:31232
  v_mfma_f32_16x16x32_bf16 a[68:71], v[68:71], v[52:55], a[68:71]
  buffer_load_dwordx4 a[128:131], v26, s[40:43], s72 offen offset:0 sc1
  v_mfma_f32_16x16x32_bf16 a[72:75], v[64:67], v[40:43], a[72:75]
  v_mfma_f32_16x16x32_bf16 a[72:75], v[68:71], v[56:59], a[72:75]
  v_mfma_f32_16x16x32_bf16 a[76:79], v[64:67], v[44:47], a[76:79]
  buffer_load_dwordx4 a[132:135], v26, s[40:43], s72 offen offset:1024 sc1
  v_mfma_f32_16x16x32_bf16 a[76:79], v[68:71], v[60:63], a[76:79]
  ds_read_b64_tr_b16 v[88:89], v3 offset:25088
  s_waitcnt lgkmcnt(5)
  v_mfma_f32_16x16x32_bf16 a[80:83], v[72:75], v[32:35], a[80:83]
  ds_read_b64_tr_b16 v[90:91], v3 offset:27136
  v_mfma_f32_16x16x32_bf16 a[80:83], v[76:79], v[48:51], a[80:83]
  ds_read_b64_tr_b16 v[92:93], v3 offset:29184
  v_mfma_f32_16x16x32_bf16 a[84:87], v[72:75], v[36:39], a[84:87]
  ds_read_b64_tr_b16 v[94:95], v3 offset:31232
  v_mfma_f32_16x16x32_bf16 a[84:87], v[76:79], v[52:55], a[84:87]
  buffer_load_dwordx4 a[136:139], v26, s[40:43], s72 offen offset:2048 sc1
  v_mfma_f32_16x16x32_bf16 a[88:91], v[72:75], v[40:43], a[88:91]
  v_mfma_f32_16x16x32_bf16 a[88:91], v[76:79], v[56:59], a[88:91]
  v_mfma_f32_16x16x32_bf16 a[92:95], v[72:75], v[44:47], a[92:95]
  buffer_load_dwordx4 a[140:143], v26, s[40:43], s72 offen offset:3072 sc1
  v_mfma_f32_16x16x32_bf16 a[92:95], v[76:79], v[60:63], a[92:95]
  s_waitcnt vmcnt(51)
  s_barrier
  s_waitcnt lgkmcnt(4)
  v_mfma_f32_16x16x32_bf16 a[96:99], v[80:83], v[32:35], a[96:99]
  ds_read_b64_tr_b16 v[64:65], v2 offset:32768
  ds_read_b64_tr_b16 v[66:67], v2 offset:34816
  v_mfma_f32_16x16x32_bf16 a[96:99], v[84:87], v[48:51], a[96:99]
  ds_read_b64_tr_b16 v[68:69], v2 offset:36864
  s_add_u32 s72, s72, 0x2000
  v_mfma_f32_16x16x32_bf16 a[100:103], v[80:83], v[36:39], a[100:103]
  ds_read_b64_tr_b16 v[70:71], v2 offset:38912
  v_mfma_f32_16x16x32_bf16 a[100:103], v[84:87], v[52:55], a[100:103]
  v_mfma_f32_16x16x32_bf16 a[104:107], v[80:83], v[40:43], a[104:107]
  v_mfma_f32_16x16x32_bf16 a[104:107], v[84:87], v[56:59], a[104:107]
  v_mfma_f32_16x16x32_bf16 a[108:111], v[80:83], v[44:47], a[108:111]
  v_mfma_f32_16x16x32_bf16 a[108:111], v[84:87], v[60:63], a[108:111]
  ds_read_b64_tr_b16 v[72:73], v3 offset:32768
  s_waitcnt lgkmcnt(5)
  v_mfma_f32_16x16x32_bf16 a[112:115], v[88:91], v[32:35], a[112:115]
  ds_read_b64_tr_b16 v[74:75], v3 offset:34816
  v_mfma_f32_16x16x32_bf16 a[112:115], v[92:95], v[48:51], a[112:115]
  ds_read_b64_tr_b16 v[76:77], v3 offset:36864
  v_mfma_f32_16x16x32_bf16 a[116:119], v[88:91], v[36:39], a[116:119]
  ds_read_b64_tr_b16 v[78:79], v3 offset:38912
  v_mfma_f32_16x16x32_bf16 a[116:119], v[92:95], v[52:55], a[116:119]
  v_mfma_f32_16x16x32_bf16 a[120:123], v[88:91], v[40:43], a[120:123]
  v_mfma_f32_16x16x32_bf16 a[120:123], v[92:95], v[56:59], a[120:123]
  v_mfma_f32_16x16x32_bf16 a[124:127], v[88:91], v[44:47], a[124:127]
  v_mfma_f32_16x16x32_bf16 a[124:127], v[92:95], v[60:63], a[124:127]
  s_waitcnt vmcnt(41)
  s_waitcnt lgkmcnt(4)
  v_mfma_f32_16x16x32_bf16 a[0:3], v[64:67], a[176:179], a[0:3]
  ds_read_b64_tr_b16 v[80:81], v2 offset:33280
  ds_read_b64_tr_b16 v[82:83], v2 offset:35328
  v_mfma_f32_16x16x32_bf16 a[0:3], v[68:71], a[192:195], a[0:3]
  ds_read_b64_tr_b16 v[84:85], v2 offset:37376
  s_add_u32 m0, s5, 0x18000
  v_mfma_f32_16x16x32_bf16 a[4:7], v[64:67], a[180:183], a[4:7]
  ds_read_b64_tr_b16 v[86:87], v2 offset:39424
  v_mfma_f32_16x16x32_bf16 a[4:7], v[68:71], a[196:199], a[4:7]
  buffer_load_dwordx4 v7, s[76:79], s71 offen offset:0 lds
  v_mfma_f32_16x16x32_bf16 a[8:11], v[64:67], a[184:187], a[8:11]
  v_mfma_f32_16x16x32_bf16 a[8:11], v[68:71], a[200:203], a[8:11]
  v_mfma_f32_16x16x32_bf16 a[12:15], v[64:67], a[188:191], a[12:15]
  buffer_load_dwordx4 v8, s[76:79], s71 offen offset:1024 lds
  v_mfma_f32_16x16x32_bf16 a[12:15], v[68:71], a[204:207], a[12:15]
  ds_read_b64_tr_b16 v[88:89], v3 offset:33280
  s_waitcnt lgkmcnt(5)
  v_mfma_f32_16x16x32_bf16 a[16:19], v[72:75], a[176:179], a[16:19]
  ds_read_b64_tr_b16 v[90:91], v3 offset:35328
  v_mfma_f32_16x16x32_bf16 a[16:19], v[76:79], a[192:195], a[16:19]
  ds_read_b64_tr_b16 v[92:93], v3 offset:37376
  v_mfma_f32_16x16x32_bf16 a[20:23], v[72:75], a[180:183], a[20:23]
  ds_read_b64_tr_b16 v[94:95], v3 offset:39424
  v_mfma_f32_16x16x32_bf16 a[20:23], v[76:79], a[196:199], a[20:23]
  buffer_load_dwordx4 v9, s[76:79], s71 offen offset:2048 lds
  v_mfma_f32_16x16x32_bf16 a[24:27], v[72:75], a[184:187], a[24:27]
  v_mfma_f32_16x16x32_bf16 a[24:27], v[76:79], a[200:203], a[24:27]
  v_mfma_f32_16x16x32_bf16 a[28:31], v[72:75], a[188:191], a[28:31]
  buffer_load_dwordx4 v10, s[76:79], s71 offen offset:3072 lds
  v_mfma_f32_16x16x32_bf16 a[28:31], v[76:79], a[204:207], a[28:31]
  ds_read_b64_tr_b16 v[64:65], v2 offset:40960
  s_waitcnt lgkmcnt(5)
  v_mfma_f32_16x16x32_bf16 a[32:35], v[80:83], a[176:179], a[32:35]
  ds_read_b64_tr_b16 v[66:67], v2 offset:43008
  v_mfma_f32_16x16x32_bf16 a[32:35], v[84:87], a[192:195], a[32:35]
  ds_read_b64_tr_b16 v[68:69], v2 offset:45056
  s_add_u32 s71, s71, 0x20000
  v_mfma_f32_16x16x32_bf16 a[36:39], v[80:83], a[180:183], a[36:39]
  ds_read_b64_tr_b16 v[70:71], v2 offset:47104
  v_mfma_f32_16x16x32_bf16 a[36:39], v[84:87], a[196:199], a[36:39]
  buffer_load_dwordx4 v[32:35], v25, s[40:43], s72 offen offset:0 sc1
  v_mfma_f32_16x16x32_bf16 a[40:43], v[80:83], a[184:187], a[40:43]
  v_mfma_f32_16x16x32_bf16 a[40:43], v[84:87], a[200:203], a[40:43]
  v_mfma_f32_16x16x32_bf16 a[44:47], v[80:83], a[188:191], a[44:47]
  buffer_load_dwordx4 v[36:39], v25, s[40:43], s72 offen offset:1024 sc1
  v_mfma_f32_16x16x32_bf16 a[44:47], v[84:87], a[204:207], a[44:47]
  ds_read_b64_tr_b16 v[72:73], v3 offset:40960
  s_waitcnt lgkmcnt(5)
  v_mfma_f32_16x16x32_bf16 a[48:51], v[88:91], a[176:179], a[48:51]
  ds_read_b64_tr_b16 v[74:75], v3 offset:43008
  v_mfma_f32_16x16x32_bf16 a[48:51], v[92:95], a[192:195], a[48:51]
  ds_read_b64_tr_b16 v[76:77], v3 offset:45056
  v_mfma_f32_16x16x32_bf16 a[52:55], v[88:91], a[180:183], a[52:55]
  ds_read_b64_tr_b16 v[78:79], v3 offset:47104
  v_mfma_f32_16x16x32_bf16 a[52:55], v[92:95], a[196:199], a[52:55]
  buffer_load_dwordx4 v[40:43], v25, s[40:43], s72 offen offset:2048 sc1
  v_mfma_f32_16x16x32_bf16 a[56:59], v[88:91], a[184:187], a[56:59]
  v_mfma_f32_16x16x32_bf16 a[56:59], v[92:95], a[200:203], a[56:59]
  v_mfma_f32_16x16x32_bf16 a[60:63], v[88:91], a[188:191], a[60:63]
  buffer_load_dwordx4 v[44:47], v25, s[40:43], s72 offen offset:3072 sc1
  v_mfma_f32_16x16x32_bf16 a[60:63], v[92:95], a[204:207], a[60:63]
  ds_read_b64_tr_b16 v[80:81], v2 offset:41472
  s_waitcnt lgkmcnt(5)
  v_mfma_f32_16x16x32_bf16 a[64:67], v[64:67], a[176:179], a[64:67]
  ds_read_b64_tr_b16 v[82:83], v2 offset:43520
  v_mfma_f32_16x16x32_bf16 a[64:67], v[68:71], a[192:195], a[64:67]
  ds_read_b64_tr_b16 v[84:85], v2 offset:45568
  v_mfma_f32_16x16x32_bf16 a[68:71], v[64:67], a[180:183], a[68:71]
  ds_read_b64_tr_b16 v[86:87], v2 offset:47616
  v_mfma_f32_16x16x32_bf16 a[68:71], v[68:71], a[196:199], a[68:71]
  buffer_load_dwordx4 v[48:51], v26, s[40:43], s72 offen offset:0 sc1
  v_mfma_f32_16x16x32_bf16 a[72:75], v[64:67], a[184:187], a[72:75]
  v_mfma_f32_16x16x32_bf16 a[72:75], v[68:71], a[200:203], a[72:75]
  v_mfma_f32_16x16x32_bf16 a[76:79], v[64:67], a[188:191], a[76:79]
  buffer_load_dwordx4 v[52:55], v26, s[40:43], s72 offen offset:1024 sc1
  v_mfma_f32_16x16x32_bf16 a[76:79], v[68:71], a[204:207], a[76:79]
  ds_read_b64_tr_b16 v[88:89], v3 offset:41472
  s_waitcnt lgkmcnt(5)
  v_mfma_f32_16x16x32_bf16 a[80:83], v[72:75], a[176:179], a[80:83]
  ds_read_b64_tr_b16 v[90:91], v3 offset:43520
  v_mfma_f32_16x16x32_bf16 a[80:83], v[76:79], a[192:195], a[80:83]
  ds_read_b64_tr_b16 v[92:93], v3 offset:45568
  v_mfma_f32_16x16x32_bf16 a[84:87], v[72:75], a[180:183], a[84:87]
  ds_read_b64_tr_b16 v[94:95], v3 offset:47616
  v_mfma_f32_16x16x32_bf16 a[84:87], v[76:79], a[196:199], a[84:87]
  buffer_load_dwordx4 v[56:59], v26, s[40:43], s72 offen offset:2048 sc1
  v_mfma_f32_16x16x32_bf16 a[88:91], v[72:75], a[184:187], a[88:91]
  v_mfma_f32_16x16x32_bf16 a[88:91], v[76:79], a[200:203], a[88:91]
  v_mfma_f32_16x16x32_bf16 a[92:95], v[72:75], a[188:191], a[92:95]
  buffer_load_dwordx4 v[60:63], v26, s[40:43], s72 offen offset:3072 sc1
  v_mfma_f32_16x16x32_bf16 a[92:95], v[76:79], a[204:207], a[92:95]
  s_waitcnt vmcnt(48)
  s_barrier
  s_waitcnt lgkmcnt(4)
  v_mfma_f32_16x16x32_bf16 a[96:99], v[80:83], a[176:179], a[96:99]
  ds_read_b64_tr_b16 v[64:65], v2 offset:49152
  ds_read_b64_tr_b16 v[66:67], v2 offset:51200
  v_mfma_f32_16x16x32_bf16 a[96:99], v[84:87], a[192:195], a[96:99]
  ds_read_b64_tr_b16 v[68:69], v2 offset:53248
  s_add_u32 s72, s72, 0x2000
  v_mfma_f32_16x16x32_bf16 a[100:103], v[80:83], a[180:183], a[100:103]
  ds_read_b64_tr_b16 v[70:71], v2 offset:55296
  v_mfma_f32_16x16x32_bf16 a[100:103], v[84:87], a[196:199], a[100:103]
  v_mfma_f32_16x16x32_bf16 a[104:107], v[80:83], a[184:187], a[104:107]
  v_mfma_f32_16x16x32_bf16 a[104:107], v[84:87], a[200:203], a[104:107]
  v_mfma_f32_16x16x32_bf16 a[108:111], v[80:83], a[188:191], a[108:111]
  v_mfma_f32_16x16x32_bf16 a[108:111], v[84:87], a[204:207], a[108:111]
  ds_read_b64_tr_b16 v[72:73], v3 offset:49152
  s_waitcnt lgkmcnt(5)
  v_mfma_f32_16x16x32_bf16 a[112:115], v[88:91], a[176:179], a[112:115]
  ds_read_b64_tr_b16 v[74:75], v3 offset:51200
  v_mfma_f32_16x16x32_bf16 a[112:115], v[92:95], a[192:195], a[112:115]
  ds_read_b64_tr_b16 v[76:77], v3 offset:53248
  v_mfma_f32_16x16x32_bf16 a[116:119], v[88:91], a[180:183], a[116:119]
  ds_read_b64_tr_b16 v[78:79], v3 offset:55296
  v_mfma_f32_16x16x32_bf16 a[116:119], v[92:95], a[196:199], a[116:119]
  v_mfma_f32_16x16x32_bf16 a[120:123], v[88:91], a[184:187], a[120:123]
  v_mfma_f32_16x16x32_bf16 a[120:123], v[92:95], a[200:203], a[120:123]
  s_add_u32 m0, s5, 0x14000
  s_nop 0
  buffer_load_dwordx4 v21, s[92:95], s8 offen offset:0 lds
  v_mfma_f32_16x16x32_bf16 a[124:127], v[88:91], a[188:191], a[124:127]
  v_mfma_f32_16x16x32_bf16 a[124:127], v[92:95], a[204:207], a[124:127]
  s_waitcnt vmcnt(40)
  s_waitcnt lgkmcnt(4)
  v_mfma_f32_16x16x32_bf16 a[0:3], v[64:67], a[208:211], a[0:3]
  ds_read_b64_tr_b16 v[80:81], v2 offset:49664
  ds_read_b64_tr_b16 v[82:83], v2 offset:51712
  v_mfma_f32_16x16x32_bf16 a[0:3], v[68:71], a[224:227], a[0:3]
  ds_read_b64_tr_b16 v[84:85], v2 offset:53760
  s_add_u32 m0, s5, 0x1c000
  v_mfma_f32_16x16x32_bf16 a[4:7], v[64:67], a[212:215], a[4:7]
  ds_read_b64_tr_b16 v[86:87], v2 offset:55808
  v_mfma_f32_16x16x32_bf16 a[4:7], v[68:71], a[228:231], a[4:7]
  buffer_load_dwordx4 v7, s[76:79], s71 offen offset:0 lds
  v_mfma_f32_16x16x32_bf16 a[8:11], v[64:67], a[216:219], a[8:11]
  v_mfma_f32_16x16x32_bf16 a[8:11], v[68:71], a[232:235], a[8:11]
  v_mfma_f32_16x16x32_bf16 a[12:15], v[64:67], a[220:223], a[12:15]
  buffer_load_dwordx4 v8, s[76:79], s71 offen offset:1024 lds
  v_mfma_f32_16x16x32_bf16 a[12:15], v[68:71], a[236:239], a[12:15]
  ds_read_b64_tr_b16 v[88:89], v3 offset:49664
  s_waitcnt lgkmcnt(5)
  v_mfma_f32_16x16x32_bf16 a[16:19], v[72:75], a[208:211], a[16:19]
  ds_read_b64_tr_b16 v[90:91], v3 offset:51712
  v_mfma_f32_16x16x32_bf16 a[16:19], v[76:79], a[224:227], a[16:19]
  ds_read_b64_tr_b16 v[92:93], v3 offset:53760
  v_mfma_f32_16x16x32_bf16 a[20:23], v[72:75], a[212:215], a[20:23]
  ds_read_b64_tr_b16 v[94:95], v3 offset:55808
  v_mfma_f32_16x16x32_bf16 a[20:23], v[76:79], a[228:231], a[20:23]
  buffer_load_dwordx4 v9, s[76:79], s71 offen offset:2048 lds
  v_mfma_f32_16x16x32_bf16 a[24:27], v[72:75], a[216:219], a[24:27]
  v_mfma_f32_16x16x32_bf16 a[24:27], v[76:79], a[232:235], a[24:27]
  v_mfma_f32_16x16x32_bf16 a[28:31], v[72:75], a[220:223], a[28:31]
  buffer_load_dwordx4 v10, s[76:79], s71 offen offset:3072 lds
  v_mfma_f32_16x16x32_bf16 a[28:31], v[76:79], a[236:239], a[28:31]
  ds_read_b64_tr_b16 v[64:65], v2 offset:57344
  s_waitcnt lgkmcnt(5)
  v_mfma_f32_16x16x32_bf16 a[32:35], v[80:83], a[208:211], a[32:35]
  ds_read_b64_tr_b16 v[66:67], v2 offset:59392
  v_mfma_f32_16x16x32_bf16 a[32:35], v[84:87], a[224:227], a[32:35]
  ds_read_b64_tr_b16 v[68:69], v2 offset:61440
  s_add_u32 s71, s71, 0x20000
  v_mfma_f32_16x16x32_bf16 a[36:39], v[80:83], a[212:215], a[36:39]
  ds_read_b64_tr_b16 v[70:71], v2 offset:63488
  v_mfma_f32_16x16x32_bf16 a[36:39], v[84:87], a[228:231], a[36:39]
  buffer_load_dwordx4 a[176:179], v25, s[40:43], s72 offen offset:0 sc1
  v_mfma_f32_16x16x32_bf16 a[40:43], v[80:83], a[216:219], a[40:43]
  v_mfma_f32_16x16x32_bf16 a[40:43], v[84:87], a[232:235], a[40:43]
  v_mfma_f32_16x16x32_bf16 a[44:47], v[80:83], a[220:223], a[44:47]
  buffer_load_dwordx4 a[180:183], v25, s[40:43], s72 offen offset:1024 sc1
  v_mfma_f32_16x16x32_bf16 a[44:47], v[84:87], a[236:239], a[44:47]
  ds_read_b64_tr_b16 v[72:73], v3 offset:57344
  s_waitcnt lgkmcnt(5)
  v_mfma_f32_16x16x32_bf16 a[48:51], v[88:91], a[208:211], a[48:51]
  ds_read_b64_tr_b16 v[74:75], v3 offset:59392
  v_mfma_f32_16x16x32_bf16 a[48:51], v[92:95], a[224:227], a[48:51]
  ds_read_b64_tr_b16 v[76:77], v3 offset:61440
  v_mfma_f32_16x16x32_bf16 a[52:55], v[88:91], a[212:215], a[52:55]
  ds_read_b64_tr_b16 v[78:79], v3 offset:63488
  v_mfma_f32_16x16x32_bf16 a[52:55], v[92:95], a[228:231], a[52:55]
  buffer_load_dwordx4 a[184:187], v25, s[40:43], s72 offen offset:2048 sc1
  v_mfma_f32_16x16x32_bf16 a[56:59], v[88:91], a[216:219], a[56:59]
  v_mfma_f32_16x16x32_bf16 a[56:59], v[92:95], a[232:235], a[56:59]
  v_mov_b32 v126, 1
  s_waitcnt vmcnt(35)
  v_mfma_f32_16x16x32_bf16 a[60:63], v[88:91], a[220:223], a[60:63]
  buffer_load_dwordx4 a[188:191], v25, s[40:43], s72 offen offset:3072 sc1
  v_mfma_f32_16x16x32_bf16 a[60:63], v[92:95], a[236:239], a[60:63]
  ds_read_b64_tr_b16 v[80:81], v2 offset:57856
  s_waitcnt lgkmcnt(5)
  v_mfma_f32_16x16x32_bf16 a[64:67], v[64:67], a[208:211], a[64:67]
  ds_read_b64_tr_b16 v[82:83], v2 offset:59904
  buffer_store_byte v126, v23, s[64:67], s16 offen sc1
  v_mfma_f32_16x16x32_bf16 a[64:67], v[68:71], a[224:227], a[64:67]
  ds_read_b64_tr_b16 v[84:85], v2 offset:61952
  buffer_store_byte v126, v23, s[64:67], s17 offen sc1
  v_mfma_f32_16x16x32_bf16 a[68:71], v[64:67], a[212:215], a[68:71]
  ds_read_b64_tr_b16 v[86:87], v2 offset:64000
  buffer_store_byte v126, v23, s[64:67], s18 offen sc1
  v_mfma_f32_16x16x32_bf16 a[68:71], v[68:71], a[228:231], a[68:71]
  buffer_load_dwordx4 a[192:195], v26, s[40:43], s72 offen offset:0 sc1
  v_mfma_f32_16x16x32_bf16 a[72:75], v[64:67], a[216:219], a[72:75]
  v_mfma_f32_16x16x32_bf16 a[72:75], v[68:71], a[232:235], a[72:75]
  v_mfma_f32_16x16x32_bf16 a[76:79], v[64:67], a[220:223], a[76:79]
  buffer_load_dwordx4 a[196:199], v26, s[40:43], s72 offen offset:1024 sc1
  v_mfma_f32_16x16x32_bf16 a[76:79], v[68:71], a[236:239], a[76:79]
  ds_read_b64_tr_b16 v[88:89], v3 offset:57856
  s_waitcnt lgkmcnt(5)
  v_mfma_f32_16x16x32_bf16 a[80:83], v[72:75], a[208:211], a[80:83]
  ds_read_b64_tr_b16 v[90:91], v3 offset:59904
  v_mfma_f32_16x16x32_bf16 a[80:83], v[76:79], a[224:227], a[80:83]
  ds_read_b64_tr_b16 v[92:93], v3 offset:61952
  v_mfma_f32_16x16x32_bf16 a[84:87], v[72:75], a[212:215], a[84:87]
  ds_read_b64_tr_b16 v[94:95], v3 offset:64000
  v_mfma_f32_16x16x32_bf16 a[84:87], v[76:79], a[228:231], a[84:87]
  buffer_load_dwordx4 a[200:203], v26, s[40:43], s72 offen offset:2048 sc1
  v_mfma_f32_16x16x32_bf16 a[88:91], v[72:75], a[216:219], a[88:91]
  v_mfma_f32_16x16x32_bf16 a[88:91], v[76:79], a[232:235], a[88:91]
  v_mfma_f32_16x16x32_bf16 a[92:95], v[72:75], a[220:223], a[92:95]
  buffer_load_dwordx4 a[204:207], v26, s[40:43], s72 offen offset:3072 sc1
  v_mfma_f32_16x16x32_bf16 a[92:95], v[76:79], a[236:239], a[92:95]
  s_barrier
  s_waitcnt lgkmcnt(4)
  v_mfma_f32_16x16x32_bf16 a[96:99], v[80:83], a[208:211], a[96:99]
  ds_read_b64_tr_b16 v[64:65], v6 offset:0
  ds_read_b64_tr_b16 v[66:67], v6 offset:2048
  v_mfma_f32_16x16x32_bf16 a[96:99], v[84:87], a[224:227], a[96:99]
  ds_read_b64_tr_b16 v[68:69], v6 offset:4096
  s_add_u32 s72, s72, 0x2000
  v_mfma_f32_16x16x32_bf16 a[100:103], v[80:83], a[212:215], a[100:103]
  ds_read_b64_tr_b16 v[70:71], v6 offset:6144
  v_mfma_f32_16x16x32_bf16 a[100:103], v[84:87], a[228:231], a[100:103]
  v_mfma_f32_16x16x32_bf16 a[104:107], v[80:83], a[216:219], a[104:107]
  v_mfma_f32_16x16x32_bf16 a[104:107], v[84:87], a[232:235], a[104:107]
  v_mfma_f32_16x16x32_bf16 a[108:111], v[80:83], a[220:223], a[108:111]
  v_mfma_f32_16x16x32_bf16 a[108:111], v[84:87], a[236:239], a[108:111]
  ds_read_b64_tr_b16 v[72:73], v30 offset:0
  s_waitcnt lgkmcnt(5)
  v_mfma_f32_16x16x32_bf16 a[112:115], v[88:91], a[208:211], a[112:115]
  ds_read_b64_tr_b16 v[74:75], v30 offset:2048
  v_mfma_f32_16x16x32_bf16 a[112:115], v[92:95], a[224:227], a[112:115]
  ds_read_b64_tr_b16 v[76:77], v30 offset:4096
  v_mfma_f32_16x16x32_bf16 a[116:119], v[88:91], a[212:215], a[116:119]
  ds_read_b64_tr_b16 v[78:79], v30 offset:6144
  v_mfma_f32_16x16x32_bf16 a[116:119], v[92:95], a[228:231], a[116:119]
  v_mfma_f32_16x16x32_bf16 a[120:123], v[88:91], a[216:219], a[120:123]
  v_mfma_f32_16x16x32_bf16 a[120:123], v[92:95], a[232:235], a[120:123]
  s_add_u32 m0, s5, 0x14000
  s_nop 0
  buffer_load_dwordx4 v21, s[92:95], s9 offen offset:1024 lds
  v_mfma_f32_16x16x32_bf16 a[124:127], v[88:91], a[220:223], a[124:127]
  v_mfma_f32_16x16x32_bf16 a[124:127], v[92:95], a[236:239], a[124:127]
  s_waitcnt vmcnt(41)
  s_waitcnt lgkmcnt(4)
  v_mfma_f32_16x16x32_bf16 a[0:3], v[64:67], a[144:147], a[0:3]
  ds_read_b64_tr_b16 v[80:81], v6 offset:512
  ds_read_b64_tr_b16 v[82:83], v6 offset:2560
  v_mfma_f32_16x16x32_bf16 a[0:3], v[68:71], a[160:163], a[0:3]
  ds_read_b64_tr_b16 v[84:85], v6 offset:4608
  s_add_u32 m0, s5, 0x10000
  v_mfma_f32_16x16x32_bf16 a[4:7], v[64:67], a[148:151], a[4:7]
  ds_read_b64_tr_b16 v[86:87], v6 offset:6656
  v_mfma_f32_16x16x32_bf16 a[4:7], v[68:71], a[164:167], a[4:7]
  buffer_load_dwordx4 v7, s[76:79], s71 offen offset:0 lds
  v_mfma_f32_16x16x32_bf16 a[8:11], v[64:67], a[152:155], a[8:11]
  v_mfma_f32_16x16x32_bf16 a[8:11], v[68:71], a[168:171], a[8:11]
  v_mfma_f32_16x16x32_bf16 a[12:15], v[64:67], a[156:159], a[12:15]
  buffer_load_dwordx4 v8, s[76:79], s71 offen offset:1024 lds
  v_mfma_f32_16x16x32_bf16 a[12:15], v[68:71], a[172:175], a[12:15]
  ds_read_b64_tr_b16 v[88:89], v30 offset:512
  s_waitcnt lgkmcnt(5)
  v_mfma_f32_16x16x32_bf16 a[16:19], v[72:75], a[144:147], a[16:19]
  ds_read_b64_tr_b16 v[90:91], v30 offset:2560
  v_mfma_f32_16x16x32_bf16 a[16:19], v[76:79], a[160:163], a[16:19]
  ds_read_b64_tr_b16 v[92:93], v30 offset:4608
  v_mfma_f32_16x16x32_bf16 a[20:23], v[72:75], a[148:151], a[20:23]
  ds_read_b64_tr_b16 v[94:95], v30 offset:6656
  v_mfma_f32_16x16x32_bf16 a[20:23], v[76:79], a[164:167], a[20:23]
  buffer_load_dwordx4 v9, s[76:79], s71 offen offset:2048 lds
  v_mfma_f32_16x16x32_bf16 a[24:27], v[72:75], a[152:155], a[24:27]
  v_mfma_f32_16x16x32_bf16 a[24:27], v[76:79], a[168:171], a[24:27]
  v_mfma_f32_16x16x32_bf16 a[28:31], v[72:75], a[156:159], a[28:31]
  buffer_load_dwordx4 v10, s[76:79], s71 offen offset:3072 lds
  v_mfma_f32_16x16x32_bf16 a[28:31], v[76:79], a[172:175], a[28:31]
  ds_read_b64_tr_b16 v[64:65], v6 offset:8192
  s_waitcnt lgkmcnt(5)
  v_mfma_f32_16x16x32_bf16 a[32:35], v[80:83], a[144:147], a[32:35]
  ds_read_b64_tr_b16 v[66:67], v6 offset:10240
  v_mfma_f32_16x16x32_bf16 a[32:35], v[84:87], a[160:163], a[32:35]
  ds_read_b64_tr_b16 v[68:69], v6 offset:12288
  s_add_u32 s71, s71, 0x20000
  v_mfma_f32_16x16x32_bf16 a[36:39], v[80:83], a[148:151], a[36:39]
  ds_read_b64_tr_b16 v[70:71], v6 offset:14336
  v_mfma_f32_16x16x32_bf16 a[36:39], v[84:87], a[164:167], a[36:39]
  buffer_load_dwordx4 a[208:211], v25, s[40:43], s72 offen offset:0 sc1
  v_mfma_f32_16x16x32_bf16 a[40:43], v[80:83], a[152:155], a[40:43]
  v_mfma_f32_16x16x32_bf16 a[40:43], v[84:87], a[168:171], a[40:43]
  v_mfma_f32_16x16x32_bf16 a[44:47], v[80:83], a[156:159], a[44:47]
  buffer_load_dwordx4 a[212:215], v25, s[40:43], s72 offen offset:1024 sc1
  v_mfma_f32_16x16x32_bf16 a[44:47], v[84:87], a[172:175], a[44:47]
  ds_read_b64_tr_b16 v[72:73], v30 offset:8192
  s_waitcnt lgkmcnt(5)
  v_mfma_f32_16x16x32_bf16 a[48:51], v[88:91], a[144:147], a[48:51]
  ds_read_b64_tr_b16 v[74:75], v30 offset:10240
  v_mfma_f32_16x16x32_bf16 a[48:51], v[92:95], a[160:163], a[48:51]
  ds_read_b64_tr_b16 v[76:77], v30 offset:12288
  v_mfma_f32_16x16x32_bf16 a[52:55], v[88:91], a[148:151], a[52:55]
  ds_read_b64_tr_b16 v[78:79], v30 offset:14336
  v_mfma_f32_16x16x32_bf16 a[52:55], v[92:95], a[164:167], a[52:55]
  buffer_load_dwordx4 a[216:219], v25, s[40:43], s72 offen offset:2048 sc1
  v_mfma_f32_16x16x32_bf16 a[56:59], v[88:91], a[152:155], a[56:59]
  v_mfma_f32_16x16x32_bf16 a[56:59], v[92:95], a[168:171], a[56:59]
  v_mfma_f32_16x16x32_bf16 a[60:63], v[88:91], a[156:159], a[60:63]
  buffer_load_dwordx4 a[220:223], v25, s[40:43], s72 offen offset:3072 sc1
  v_mfma_f32_16x16x32_bf16 a[60:63], v[92:95], a[172:175], a[60:63]
  ds_read_b64_tr_b16 v[80:81], v6 offset:8704
  s_waitcnt lgkmcnt(5)
  v_mfma_f32_16x16x32_bf16 a[64:67], v[64:67], a[144:147], a[64:67]
  ds_read_b64_tr_b16 v[82:83], v6 offset:10752
  v_mfma_f32_16x16x32_bf16 a[64:67], v[68:71], a[160:163], a[64:67]
  ds_read_b64_tr_b16 v[84:85], v6 offset:12800
  v_mfma_f32_16x16x32_bf16 a[68:71], v[64:67], a[148:151], a[68:71]
  ds_read_b64_tr_b16 v[86:87], v6 offset:14848
  v_mfma_f32_16x16x32_bf16 a[68:71], v[68:71], a[164:167], a[68:71]
  buffer_load_dwordx4 a[224:227], v26, s[40:43], s72 offen offset:0 sc1
  v_mfma_f32_16x16x32_bf16 a[72:75], v[64:67], a[152:155], a[72:75]
  v_mfma_f32_16x16x32_bf16 a[72:75], v[68:71], a[168:171], a[72:75]
  v_mfma_f32_16x16x32_bf16 a[76:79], v[64:67], a[156:159], a[76:79]
  buffer_load_dwordx4 a[228:231], v26, s[40:43], s72 offen offset:1024 sc1
  v_mfma_f32_16x16x32_bf16 a[76:79], v[68:71], a[172:175], a[76:79]
  ds_read_b64_tr_b16 v[88:89], v30 offset:8704
  s_waitcnt lgkmcnt(5)
  v_mfma_f32_16x16x32_bf16 a[80:83], v[72:75], a[144:147], a[80:83]
  ds_read_b64_tr_b16 v[90:91], v30 offset:10752
  v_mfma_f32_16x16x32_bf16 a[80:83], v[76:79], a[160:163], a[80:83]
  ds_read_b64_tr_b16 v[92:93], v30 offset:12800
  v_mfma_f32_16x16x32_bf16 a[84:87], v[72:75], a[148:151], a[84:87]
  ds_read_b64_tr_b16 v[94:95], v30 offset:14848
  v_mfma_f32_16x16x32_bf16 a[84:87], v[76:79], a[164:167], a[84:87]
  buffer_load_dwordx4 a[232:235], v26, s[40:43], s72 offen offset:2048 sc1
  v_mfma_f32_16x16x32_bf16 a[88:91], v[72:75], a[152:155], a[88:91]
  v_mfma_f32_16x16x32_bf16 a[88:91], v[76:79], a[168:171], a[88:91]
  v_mfma_f32_16x16x32_bf16 a[92:95], v[72:75], a[156:159], a[92:95]
  buffer_load_dwordx4 a[236:239], v26, s[40:43], s72 offen offset:3072 sc1
  v_mfma_f32_16x16x32_bf16 a[92:95], v[76:79], a[172:175], a[92:95]
  s_waitcnt vmcnt(49)
  s_barrier
  s_waitcnt lgkmcnt(4)
  v_mfma_f32_16x16x32_bf16 a[96:99], v[80:83], a[144:147], a[96:99]
  ds_read_b64_tr_b16 v[64:65], v6 offset:16384
  ds_read_b64_tr_b16 v[66:67], v6 offset:18432
  v_mfma_f32_16x16x32_bf16 a[96:99], v[84:87], a[160:163], a[96:99]
  ds_read_b64_tr_b16 v[68:69], v6 offset:20480
  s_add_u32 s72, s72, 0x2000
  v_mfma_f32_16x16x32_bf16 a[100:103], v[80:83], a[148:151], a[100:103]
  ds_read_b64_tr_b16 v[70:71], v6 offset:22528
  v_mfma_f32_16x16x32_bf16 a[100:103], v[84:87], a[164:167], a[100:103]
  v_mfma_f32_16x16x32_bf16 a[104:107], v[80:83], a[152:155], a[104:107]
  v_mfma_f32_16x16x32_bf16 a[104:107], v[84:87], a[168:171], a[104:107]
  v_mfma_f32_16x16x32_bf16 a[108:111], v[80:83], a[156:159], a[108:111]
  v_mfma_f32_16x16x32_bf16 a[108:111], v[84:87], a[172:175], a[108:111]
  ds_read_b64_tr_b16 v[72:73], v30 offset:16384
  s_waitcnt lgkmcnt(5)
  v_mfma_f32_16x16x32_bf16 a[112:115], v[88:91], a[144:147], a[112:115]
  ds_read_b64_tr_b16 v[74:75], v30 offset:18432
  v_mfma_f32_16x16x32_bf16 a[112:115], v[92:95], a[160:163], a[112:115]
  ds_read_b64_tr_b16 v[76:77], v30 offset:20480
  v_mfma_f32_16x16x32_bf16 a[116:119], v[88:91], a[148:151], a[116:119]
  ds_read_b64_tr_b16 v[78:79], v30 offset:22528
  v_mfma_f32_16x16x32_bf16 a[116:119], v[92:95], a[164:167], a[116:119]
  v_mfma_f32_16x16x32_bf16 a[120:123], v[88:91], a[152:155], a[120:123]
  v_mfma_f32_16x16x32_bf16 a[120:123], v[92:95], a[168:171], a[120:123]
  s_add_u32 m0, s5, 0x14000
  s_nop 0
  buffer_load_dwordx4 v21, s[92:95], s10 offen offset:2048 lds
  v_mfma_f32_16x16x32_bf16 a[124:127], v[88:91], a[156:159], a[124:127]
  v_mfma_f32_16x16x32_bf16 a[124:127], v[92:95], a[172:175], a[124:127]
  s_waitcnt vmcnt(42)
  s_waitcnt lgkmcnt(4)
  v_mfma_f32_16x16x32_bf16 a[0:3], v[64:67], a[240:243], a[0:3]
  ds_read_b64_tr_b16 v[80:81], v6 offset:16896
  ds_read_b64_tr_b16 v[82:83], v6 offset:18944
  v_mfma_f32_16x16x32_bf16 a[0:3], v[68:71], a[128:131], a[0:3]
  ds_read_b64_tr_b16 v[84:85], v6 offset:20992
  s_add_u32 m0, s5, 0x0
  v_mfma_f32_16x16x32_bf16 a[4:7], v[64:67], a[244:247], a[4:7]
  ds_read_b64_tr_b16 v[86:87], v6 offset:23040
  v_mfma_f32_16x16x32_bf16 a[4:7], v[68:71], a[132:135], a[4:7]
  buffer_load_dwordx4 v7, s[76:79], s71 offen offset:0 lds
  v_mfma_f32_16x16x32_bf16 a[8:11], v[64:67], a[248:251], a[8:11]
  v_mfma_f32_16x16x32_bf16 a[8:11], v[68:71], a[136:139], a[8:11]
  v_mfma_f32_16x16x32_bf16 a[12:15], v[64:67], a[252:255], a[12:15]
  buffer_load_dwordx4 v8, s[76:79], s71 offen offset:1024 lds
  v_mfma_f32_16x16x32_bf16 a[12:15], v[68:71], a[140:143], a[12:15]
  ds_read_b64_tr_b16 v[88:89], v30 offset:16896
  s_waitcnt lgkmcnt(5)
  v_mfma_f32_16x16x32_bf16 a[16:19], v[72:75], a[240:243], a[16:19]
  ds_read_b64_tr_b16 v[90:91], v30 offset:18944
  v_mfma_f32_16x16x32_bf16 a[16:19], v[76:79], a[128:131], a[16:19]
  ds_read_b64_tr_b16 v[92:93], v30 offset:20992
  buffer_load_dword v125, v22, s[64:67], 0 offen sc1
  v_mfma_f32_16x16x32_bf16 a[20:23], v[72:75], a[244:247], a[20:23]
  ds_read_b64_tr_b16 v[94:95], v30 offset:23040
  v_mfma_f32_16x16x32_bf16 a[20:23], v[76:79], a[132:135], a[20:23]
  buffer_load_dwordx4 v9, s[76:79], s71 offen offset:2048 lds
  v_mfma_f32_16x16x32_bf16 a[24:27], v[72:75], a[248:251], a[24:27]
  v_mfma_f32_16x16x32_bf16 a[24:27], v[76:79], a[136:139], a[24:27]
  v_mfma_f32_16x16x32_bf16 a[28:31], v[72:75], a[252:255], a[28:31]
  buffer_load_dwordx4 v10, s[76:79], s71 offen offset:3072 lds
  v_mfma_f32_16x16x32_bf16 a[28:31], v[76:79], a[140:143], a[28:31]
  ds_read_b64_tr_b16 v[64:65], v6 offset:24576
  s_waitcnt lgkmcnt(5)
  v_mfma_f32_16x16x32_bf16 a[32:35], v[80:83], a[240:243], a[32:35]
  ds_read_b64_tr_b16 v[66:67], v6 offset:26624
  v_mfma_f32_16x16x32_bf16 a[32:35], v[84:87], a[128:131], a[32:35]
  ds_read_b64_tr_b16 v[68:69], v6 offset:28672
  s_add_u32 s71, s71, 0x20000
  v_mfma_f32_16x16x32_bf16 a[36:39], v[80:83], a[244:247], a[36:39]
  ds_read_b64_tr_b16 v[70:71], v6 offset:30720
  v_mfma_f32_16x16x32_bf16 a[36:39], v[84:87], a[132:135], a[36:39]
  buffer_load_dwordx4 a[144:147], v25, s[40:43], s72 offen offset:0 sc1
  v_mfma_f32_16x16x32_bf16 a[40:43], v[80:83], a[248:251], a[40:43]
  v_mfma_f32_16x16x32_bf16 a[40:43], v[84:87], a[136:139], a[40:43]
  v_mfma_f32_16x16x32_bf16 a[44:47], v[80:83], a[252:255], a[44:47]
  buffer_load_dwordx4 a[148:151], v25, s[40:43], s72 offen offset:1024 sc1
  v_mfma_f32_16x16x32_bf16 a[44:47], v[84:87], a[140:143], a[44:47]
  ds_read_b64_tr_b16 v[72:73], v30 offset:24576
  s_waitcnt lgkmcnt(5)
  v_mfma_f32_16x16x32_bf16 a[48:51], v[88:91], a[240:243], a[48:51]
  ds_read_b64_tr_b16 v[74:75], v30 offset:26624
  v_mfma_f32_16x16x32_bf16 a[48:51], v[92:95], a[128:131], a[48:51]
  ds_read_b64_tr_b16 v[76:77], v30 offset:28672
  v_mfma_f32_16x16x32_bf16 a[52:55], v[88:91], a[244:247], a[52:55]
  ds_read_b64_tr_b16 v[78:79], v30 offset:30720
  v_mfma_f32_16x16x32_bf16 a[52:55], v[92:95], a[132:135], a[52:55]
  buffer_load_dwordx4 a[152:155], v25, s[40:43], s72 offen offset:2048 sc1
  v_mfma_f32_16x16x32_bf16 a[56:59], v[88:91], a[248:251], a[56:59]
  v_mfma_f32_16x16x32_bf16 a[56:59], v[92:95], a[136:139], a[56:59]
  v_mfma_f32_16x16x32_bf16 a[60:63], v[88:91], a[252:255], a[60:63]
  buffer_load_dwordx4 a[156:159], v25, s[40:43], s72 offen offset:3072 sc1
  v_mfma_f32_16x16x32_bf16 a[60:63], v[92:95], a[140:143], a[60:63]
  ds_read_b64_tr_b16 v[80:81], v6 offset:25088
  s_waitcnt lgkmcnt(5)
  v_mfma_f32_16x16x32_bf16 a[64:67], v[64:67], a[240:243], a[64:67]
  ds_read_b64_tr_b16 v[82:83], v6 offset:27136
  v_mfma_f32_16x16x32_bf16 a[64:67], v[68:71], a[128:131], a[64:67]
  ds_read_b64_tr_b16 v[84:85], v6 offset:29184
  v_mfma_f32_16x16x32_bf16 a[68:71], v[64:67], a[244:247], a[68:71]
  ds_read_b64_tr_b16 v[86:87], v6 offset:31232
  v_mfma_f32_16x16x32_bf16 a[68:71], v[68:71], a[132:135], a[68:71]
  buffer_load_dwordx4 a[160:163], v26, s[40:43], s72 offen offset:0 sc1
  v_mfma_f32_16x16x32_bf16 a[72:75], v[64:67], a[248:251], a[72:75]
  v_mfma_f32_16x16x32_bf16 a[72:75], v[68:71], a[136:139], a[72:75]
  v_mfma_f32_16x16x32_bf16 a[76:79], v[64:67], a[252:255], a[76:79]
  buffer_load_dwordx4 a[164:167], v26, s[40:43], s72 offen offset:1024 sc1
  v_mfma_f32_16x16x32_bf16 a[76:79], v[68:71], a[140:143], a[76:79]
  ds_read_b64_tr_b16 v[88:89], v30 offset:25088
  s_waitcnt lgkmcnt(5)
  v_mfma_f32_16x16x32_bf16 a[80:83], v[72:75], a[240:243], a[80:83]
  ds_read_b64_tr_b16 v[90:91], v30 offset:27136
  v_mfma_f32_16x16x32_bf16 a[80:83], v[76:79], a[128:131], a[80:83]
  ds_read_b64_tr_b16 v[92:93], v30 offset:29184
  v_mfma_f32_16x16x32_bf16 a[84:87], v[72:75], a[244:247], a[84:87]
  ds_read_b64_tr_b16 v[94:95], v30 offset:31232
  v_mfma_f32_16x16x32_bf16 a[84:87], v[76:79], a[132:135], a[84:87]
  buffer_load_dwordx4 a[168:171], v26, s[40:43], s72 offen offset:2048 sc1
  v_mfma_f32_16x16x32_bf16 a[88:91], v[72:75], a[248:251], a[88:91]
  v_mfma_f32_16x16x32_bf16 a[88:91], v[76:79], a[136:139], a[88:91]
  v_mfma_f32_16x16x32_bf16 a[92:95], v[72:75], a[252:255], a[92:95]
  buffer_load_dwordx4 a[172:175], v26, s[40:43], s72 offen offset:3072 sc1
  v_mfma_f32_16x16x32_bf16 a[92:95], v[76:79], a[140:143], a[92:95]
  s_waitcnt vmcnt(51)
  s_barrier
  s_waitcnt lgkmcnt(4)
  v_mfma_f32_16x16x32_bf16 a[96:99], v[80:83], a[240:243], a[96:99]
  ds_read_b64_tr_b16 v[64:65], v4 offset:32768
  ds_read_b64_tr_b16 v[66:67], v4 offset:34816
  v_mfma_f32_16x16x32_bf16 a[96:99], v[84:87], a[128:131], a[96:99]
  ds_read_b64_tr_b16 v[68:69], v4 offset:36864
  s_add_u32 s72, s72, 0x2000
  v_mfma_f32_16x16x32_bf16 a[100:103], v[80:83], a[244:247], a[100:103]
  ds_read_b64_tr_b16 v[70:71], v4 offset:38912
  v_mfma_f32_16x16x32_bf16 a[100:103], v[84:87], a[132:135], a[100:103]
  v_mfma_f32_16x16x32_bf16 a[104:107], v[80:83], a[248:251], a[104:107]
  v_mfma_f32_16x16x32_bf16 a[104:107], v[84:87], a[136:139], a[104:107]
  v_mfma_f32_16x16x32_bf16 a[108:111], v[80:83], a[252:255], a[108:111]
  v_mfma_f32_16x16x32_bf16 a[108:111], v[84:87], a[140:143], a[108:111]
  ds_read_b64_tr_b16 v[72:73], v5 offset:32768
  s_waitcnt lgkmcnt(5)
  v_mfma_f32_16x16x32_bf16 a[112:115], v[88:91], a[240:243], a[112:115]
  ds_read_b64_tr_b16 v[74:75], v5 offset:34816
  v_mfma_f32_16x16x32_bf16 a[112:115], v[92:95], a[128:131], a[112:115]
  ds_read_b64_tr_b16 v[76:77], v5 offset:36864
  v_mfma_f32_16x16x32_bf16 a[116:119], v[88:91], a[244:247], a[116:119]
  ds_read_b64_tr_b16 v[78:79], v5 offset:38912
  v_mfma_f32_16x16x32_bf16 a[116:119], v[92:95], a[132:135], a[116:119]
  v_mfma_f32_16x16x32_bf16 a[120:123], v[88:91], a[248:251], a[120:123]
  v_mfma_f32_16x16x32_bf16 a[120:123], v[92:95], a[136:139], a[120:123]
  s_add_u32 m0, s5, 0x14000
  s_nop 0
  buffer_load_dwordx4 v21, s[92:95], s11 offen offset:3072 lds
  v_mfma_f32_16x16x32_bf16 a[124:127], v[88:91], a[252:255], a[124:127]
  v_mfma_f32_16x16x32_bf16 a[124:127], v[92:95], a[140:143], a[124:127]
  s_waitcnt vmcnt(44)
  s_waitcnt lgkmcnt(4)
  v_mfma_f32_16x16x32_bf16 a[0:3], v[64:67], v[32:35], a[0:3]
  ds_read_b64_tr_b16 v[80:81], v4 offset:33280
  ds_read_b64_tr_b16 v[82:83], v4 offset:35328
  v_mfma_f32_16x16x32_bf16 a[0:3], v[68:71], v[48:51], a[0:3]
  ds_read_b64_tr_b16 v[84:85], v4 offset:37376
  s_add_u32 m0, s5, 0x4000
  v_mfma_f32_16x16x32_bf16 a[4:7], v[64:67], v[36:39], a[4:7]
  ds_read_b64_tr_b16 v[86:87], v4 offset:39424
  v_mfma_f32_16x16x32_bf16 a[4:7], v[68:71], v[52:55], a[4:7]
  buffer_load_dwordx4 v7, s[76:79], s71 offen offset:0 lds
  v_mfma_f32_16x16x32_bf16 a[8:11], v[64:67], v[40:43], a[8:11]
  v_mfma_f32_16x16x32_bf16 a[8:11], v[68:71], v[56:59], a[8:11]
  v_mfma_f32_16x16x32_bf16 a[12:15], v[64:67], v[44:47], a[12:15]
  buffer_load_dwordx4 v8, s[76:79], s71 offen offset:1024 lds
  v_mfma_f32_16x16x32_bf16 a[12:15], v[68:71], v[60:63], a[12:15]
  ds_read_b64_tr_b16 v[88:89], v5 offset:33280
  s_waitcnt lgkmcnt(5)
  v_mfma_f32_16x16x32_bf16 a[16:19], v[72:75], v[32:35], a[16:19]
  ds_read_b64_tr_b16 v[90:91], v5 offset:35328
  v_mfma_f32_16x16x32_bf16 a[16:19], v[76:79], v[48:51], a[16:19]
  ds_read_b64_tr_b16 v[92:93], v5 offset:37376
  v_mfma_f32_16x16x32_bf16 a[20:23], v[72:75], v[36:39], a[20:23]
  ds_read_b64_tr_b16 v[94:95], v5 offset:39424
  v_mfma_f32_16x16x32_bf16 a[20:23], v[76:79], v[52:55], a[20:23]
  buffer_load_dwordx4 v9, s[76:79], s71 offen offset:2048 lds
  v_mfma_f32_16x16x32_bf16 a[24:27], v[72:75], v[40:43], a[24:27]
  v_mfma_f32_16x16x32_bf16 a[24:27], v[76:79], v[56:59], a[24:27]
  v_mfma_f32_16x16x32_bf16 a[28:31], v[72:75], v[44:47], a[28:31]
  buffer_load_dwordx4 v10, s[76:79], s71 offen offset:3072 lds
  v_mfma_f32_16x16x32_bf16 a[28:31], v[76:79], v[60:63], a[28:31]
  ds_read_b64_tr_b16 v[64:65], v4 offset:40960
  s_waitcnt lgkmcnt(5)
  v_mfma_f32_16x16x32_bf16 a[32:35], v[80:83], v[32:35], a[32:35]
  ds_read_b64_tr_b16 v[66:67], v4 offset:43008
  v_mfma_f32_16x16x32_bf16 a[32:35], v[84:87], v[48:51], a[32:35]
  ds_read_b64_tr_b16 v[68:69], v4 offset:45056
  s_add_u32 s71, s71, 0x20000
  v_mfma_f32_16x16x32_bf16 a[36:39], v[80:83], v[36:39], a[36:39]
  ds_read_b64_tr_b16 v[70:71], v4 offset:47104
  v_mfma_f32_16x16x32_bf16 a[36:39], v[84:87], v[52:55], a[36:39]
  buffer_load_dwordx4 a[240:243], v25, s[40:43], s72 offen offset:0 sc1
  v_mfma_f32_16x16x32_bf16 a[40:43], v[80:83], v[40:43], a[40:43]
  v_mfma_f32_16x16x32_bf16 a[40:43], v[84:87], v[56:59], a[40:43]
  v_mfma_f32_16x16x32_bf16 a[44:47], v[80:83], v[44:47], a[44:47]
  buffer_load_dwordx4 a[244:247], v25, s[40:43], s72 offen offset:1024 sc1
  v_mfma_f32_16x16x32_bf16 a[44:47], v[84:87], v[60:63], a[44:47]
  ds_read_b64_tr_b16 v[72:73], v5 offset:40960
  s_waitcnt lgkmcnt(5)
  v_mfma_f32_16x16x32_bf16 a[48:51], v[88:91], v[32:35], a[48:51]
  ds_read_b64_tr_b16 v[74:75], v5 offset:43008
  v_mfma_f32_16x16x32_bf16 a[48:51], v[92:95], v[48:51], a[48:51]
  ds_read_b64_tr_b16 v[76:77], v5 offset:45056
  v_mfma_f32_16x16x32_bf16 a[52:55], v[88:91], v[36:39], a[52:55]
  ds_read_b64_tr_b16 v[78:79], v5 offset:47104
  v_mfma_f32_16x16x32_bf16 a[52:55], v[92:95], v[52:55], a[52:55]
  buffer_load_dwordx4 a[248:251], v25, s[40:43], s72 offen offset:2048 sc1
  v_mfma_f32_16x16x32_bf16 a[56:59], v[88:91], v[40:43], a[56:59]
  v_mfma_f32_16x16x32_bf16 a[56:59], v[92:95], v[56:59], a[56:59]
  v_mfma_f32_16x16x32_bf16 a[60:63], v[88:91], v[44:47], a[60:63]
  buffer_load_dwordx4 a[252:255], v25, s[40:43], s72 offen offset:3072 sc1
  v_mfma_f32_16x16x32_bf16 a[60:63], v[92:95], v[60:63], a[60:63]
  ds_read_b64_tr_b16 v[80:81], v4 offset:41472
  s_waitcnt lgkmcnt(5)
  v_mfma_f32_16x16x32_bf16 a[64:67], v[64:67], v[32:35], a[64:67]
  ds_read_b64_tr_b16 v[82:83], v4 offset:43520
  v_mfma_f32_16x16x32_bf16 a[64:67], v[68:71], v[48:51], a[64:67]
  ds_read_b64_tr_b16 v[84:85], v4 offset:45568
  v_mfma_f32_16x16x32_bf16 a[68:71], v[64:67], v[36:39], a[68:71]
  ds_read_b64_tr_b16 v[86:87], v4 offset:47616
  v_mfma_f32_16x16x32_bf16 a[68:71], v[68:71], v[52:55], a[68:71]
  buffer_load_dwordx4 a[128:131], v26, s[40:43], s72 offen offset:0 sc1
  v_mfma_f32_16x16x32_bf16 a[72:75], v[64:67], v[40:43], a[72:75]
  v_mfma_f32_16x16x32_bf16 a[72:75], v[68:71], v[56:59], a[72:75]
  v_mfma_f32_16x16x32_bf16 a[76:79], v[64:67], v[44:47], a[76:79]
  buffer_load_dwordx4 a[132:135], v26, s[40:43], s72 offen offset:1024 sc1
  v_mfma_f32_16x16x32_bf16 a[76:79], v[68:71], v[60:63], a[76:79]
  ds_read_b64_tr_b16 v[88:89], v5 offset:41472
  s_waitcnt lgkmcnt(5)
  v_mfma_f32_16x16x32_bf16 a[80:83], v[72:75], v[32:35], a[80:83]
  ds_read_b64_tr_b16 v[90:91], v5 offset:43520
  v_mfma_f32_16x16x32_bf16 a[80:83], v[76:79], v[48:51], a[80:83]
  ds_read_b64_tr_b16 v[92:93], v5 offset:45568
  v_mfma_f32_16x16x32_bf16 a[84:87], v[72:75], v[36:39], a[84:87]
  ds_read_b64_tr_b16 v[94:95], v5 offset:47616
  v_mfma_f32_16x16x32_bf16 a[84:87], v[76:79], v[52:55], a[84:87]
  buffer_load_dwordx4 a[136:139], v26, s[40:43], s72 offen offset:2048 sc1
  v_mfma_f32_16x16x32_bf16 a[88:91], v[72:75], v[40:43], a[88:91]
  v_mfma_f32_16x16x32_bf16 a[88:91], v[76:79], v[56:59], a[88:91]
  v_mfma_f32_16x16x32_bf16 a[92:95], v[72:75], v[44:47], a[92:95]
  buffer_load_dwordx4 a[140:143], v26, s[40:43], s72 offen offset:3072 sc1
  v_mfma_f32_16x16x32_bf16 a[92:95], v[76:79], v[60:63], a[92:95]
  s_waitcnt vmcnt(51)
  s_barrier
  s_waitcnt lgkmcnt(4)
  v_mfma_f32_16x16x32_bf16 a[96:99], v[80:83], v[32:35], a[96:99]
  ds_read_b64_tr_b16 v[64:65], v4 offset:49664
  ds_read_b64_tr_b16 v[66:67], v4 offset:51712
  v_mfma_f32_16x16x32_bf16 a[96:99], v[84:87], v[48:51], a[96:99]
  ds_read_b64_tr_b16 v[68:69], v4 offset:53760
  s_add_u32 s72, s72, 0x2000
  v_mfma_f32_16x16x32_bf16 a[100:103], v[80:83], v[36:39], a[100:103]
  ds_read_b64_tr_b16 v[70:71], v4 offset:55808
  v_mfma_f32_16x16x32_bf16 a[100:103], v[84:87], v[52:55], a[100:103]
  v_mfma_f32_16x16x32_bf16 a[104:107], v[80:83], v[40:43], a[104:107]
  v_mfma_f32_16x16x32_bf16 a[104:107], v[84:87], v[56:59], a[104:107]
  v_mfma_f32_16x16x32_bf16 a[108:111], v[80:83], v[44:47], a[108:111]
  v_mfma_f32_16x16x32_bf16 a[108:111], v[84:87], v[60:63], a[108:111]
  ds_read_b64_tr_b16 v[72:73], v5 offset:49664
  s_waitcnt lgkmcnt(5)
  v_mfma_f32_16x16x32_bf16 a[112:115], v[88:91], v[32:35], a[112:115]
  ds_read_b64_tr_b16 v[74:75], v5 offset:51712
  v_mfma_f32_16x16x32_bf16 a[112:115], v[92:95], v[48:51], a[112:115]
  ds_read_b64_tr_b16 v[76:77], v5 offset:53760
  v_mfma_f32_16x16x32_bf16 a[116:119], v[88:91], v[36:39], a[116:119]
  ds_read_b64_tr_b16 v[78:79], v5 offset:55808
  v_mfma_f32_16x16x32_bf16 a[116:119], v[92:95], v[52:55], a[116:119]
  v_mfma_f32_16x16x32_bf16 a[120:123], v[88:91], v[40:43], a[120:123]
  v_mfma_f32_16x16x32_bf16 a[120:123], v[92:95], v[56:59], a[120:123]
  v_mfma_f32_16x16x32_bf16 a[124:127], v[88:91], v[44:47], a[124:127]
  v_mfma_f32_16x16x32_bf16 a[124:127], v[92:95], v[60:63], a[124:127]
  s_waitcnt vmcnt(40)
  s_waitcnt lgkmcnt(4)
  v_mfma_f32_16x16x32_bf16 a[32:35], v[64:67], a[176:179], a[32:35]
  ds_read_b64_tr_b16 v[80:81], v4 offset:57344
  ds_read_b64_tr_b16 v[82:83], v4 offset:59392
  v_mfma_f32_16x16x32_bf16 a[32:35], v[68:71], a[192:195], a[32:35]
  ds_read_b64_tr_b16 v[84:85], v4 offset:61440
  s_add_u32 m0, s5, 0x8000
  v_mfma_f32_16x16x32_bf16 a[36:39], v[64:67], a[180:183], a[36:39]
  ds_read_b64_tr_b16 v[86:87], v4 offset:63488
  v_mfma_f32_16x16x32_bf16 a[36:39], v[68:71], a[196:199], a[36:39]
  buffer_load_dwordx4 v7, s[76:79], s71 offen offset:0 lds
  v_mfma_f32_16x16x32_bf16 a[40:43], v[64:67], a[184:187], a[40:43]
  v_mfma_f32_16x16x32_bf16 a[40:43], v[68:71], a[200:203], a[40:43]
  v_mfma_f32_16x16x32_bf16 a[44:47], v[64:67], a[188:191], a[44:47]
  buffer_load_dwordx4 v8, s[76:79], s71 offen offset:1024 lds
  v_mfma_f32_16x16x32_bf16 a[44:47], v[68:71], a[204:207], a[44:47]
  ds_read_b64_tr_b16 v[88:89], v5 offset:57344
  s_waitcnt lgkmcnt(5)
  v_mfma_f32_16x16x32_bf16 a[48:51], v[72:75], a[176:179], a[48:51]
  ds_read_b64_tr_b16 v[90:91], v5 offset:59392
  v_mfma_f32_16x16x32_bf16 a[48:51], v[76:79], a[192:195], a[48:51]
  ds_read_b64_tr_b16 v[92:93], v5 offset:61440
  v_mfma_f32_16x16x32_bf16 a[52:55], v[72:75], a[180:183], a[52:55]
  ds_read_b64_tr_b16 v[94:95], v5 offset:63488
  v_mfma_f32_16x16x32_bf16 a[52:55], v[76:79], a[196:199], a[52:55]
  buffer_load_dwordx4 v9, s[76:79], s71 offen offset:2048 lds
  v_mfma_f32_16x16x32_bf16 a[56:59], v[72:75], a[184:187], a[56:59]
  v_mfma_f32_16x16x32_bf16 a[56:59], v[76:79], a[200:203], a[56:59]
  v_mfma_f32_16x16x32_bf16 a[60:63], v[72:75], a[188:191], a[60:63]
  buffer_load_dwordx4 v10, s[76:79], s71 offen offset:3072 lds
  v_mfma_f32_16x16x32_bf16 a[60:63], v[76:79], a[204:207], a[60:63]
  ds_read_b64_tr_b16 v[64:65], v4 offset:57856
  s_waitcnt lgkmcnt(5)
  v_mfma_f32_16x16x32_bf16 a[64:67], v[80:83], a[176:179], a[64:67]
  ds_read_b64_tr_b16 v[66:67], v4 offset:59904
  v_mfma_f32_16x16x32_bf16 a[64:67], v[84:87], a[192:195], a[64:67]
  ds_read_b64_tr_b16 v[68:69], v4 offset:61952
  s_add_u32 s71, s71, 0x20000
  v_mfma_f32_16x16x32_bf16 a[68:71], v[80:83], a[180:183], a[68:71]
  ds_read_b64_tr_b16 v[70:71], v4 offset:64000
  v_mfma_f32_16x16x32_bf16 a[68:71], v[84:87], a[196:199], a[68:71]
  buffer_load_dwordx4 v[32:35], v25, s[40:43], s72 offen offset:0 sc1
  v_mfma_f32_16x16x32_bf16 a[72:75], v[80:83], a[184:187], a[72:75]
  v_mfma_f32_16x16x32_bf16 a[72:75], v[84:87], a[200:203], a[72:75]
  v_mfma_f32_16x16x32_bf16 a[76:79], v[80:83], a[188:191], a[76:79]
  buffer_load_dwordx4 v[36:39], v25, s[40:43], s72 offen offset:1024 sc1
  v_mfma_f32_16x16x32_bf16 a[76:79], v[84:87], a[204:207], a[76:79]
  ds_read_b64_tr_b16 v[72:73], v5 offset:57856
  s_waitcnt lgkmcnt(5)
  v_mfma_f32_16x16x32_bf16 a[80:83], v[88:91], a[176:179], a[80:83]
  ds_read_b64_tr_b16 v[74:75], v5 offset:59904
  v_mfma_f32_16x16x32_bf16 a[80:83], v[92:95], a[192:195], a[80:83]
  ds_read_b64_tr_b16 v[76:77], v5 offset:61952
  v_mfma_f32_16x16x32_bf16 a[84:87], v[88:91], a[180:183], a[84:87]
  ds_read_b64_tr_b16 v[78:79], v5 offset:64000
  v_mfma_f32_16x16x32_bf16 a[84:87], v[92:95], a[196:199], a[84:87]
  buffer_load_dwordx4 v[40:43], v25, s[40:43], s72 offen offset:2048 sc1
  v_mfma_f32_16x16x32_bf16 a[88:91], v[88:91], a[184:187], a[88:91]
  v_mfma_f32_16x16x32_bf16 a[88:91], v[92:95], a[200:203], a[88:91]
  v_mfma_f32_16x16x32_bf16 a[92:95], v[88:91], a[188:191], a[92:95]
  buffer_load_dwordx4 v[44:47], v25, s[40:43], s72 offen offset:3072 sc1
  v_mfma_f32_16x16x32_bf16 a[92:95], v[92:95], a[204:207], a[92:95]
  s_waitcnt vmcnt(43)
  s_barrier
  s_waitcnt lgkmcnt(4)
  v_mfma_f32_16x16x32_bf16 a[96:99], v[64:67], a[176:179], a[96:99]
  ds_read_b64_tr_b16 v[80:81], v4 offset:512
  ds_read_b64_tr_b16 v[82:83], v4 offset:2560
  v_mfma_f32_16x16x32_bf16 a[96:99], v[68:71], a[192:195], a[96:99]
  ds_read_b64_tr_b16 v[84:85], v4 offset:4608
  v_mfma_f32_16x16x32_bf16 a[100:103], v[64:67], a[180:183], a[100:103]
  ds_read_b64_tr_b16 v[86:87], v4 offset:6656
  v_mfma_f32_16x16x32_bf16 a[100:103], v[68:71], a[196:199], a[100:103]
  buffer_load_dwordx4 v[48:51], v26, s[40:43], s72 offen offset:0 sc1
  v_mfma_f32_16x16x32_bf16 a[104:107], v[64:67], a[184:187], a[104:107]
  v_mfma_f32_16x16x32_bf16 a[104:107], v[68:71], a[200:203], a[104:107]
  v_mfma_f32_16x16x32_bf16 a[108:111], v[64:67], a[188:191], a[108:111]
  buffer_load_dwordx4 v[52:55], v26, s[40:43], s72 offen offset:1024 sc1
  v_mfma_f32_16x16x32_bf16 a[108:111], v[68:71], a[204:207], a[108:111]
  ds_read_b64_tr_b16 v[88:89], v5 offset:512
  s_waitcnt lgkmcnt(5)
  v_mfma_f32_16x16x32_bf16 a[112:115], v[72:75], a[176:179], a[112:115]
  ds_read_b64_tr_b16 v[90:91], v5 offset:2560
  v_mfma_f32_16x16x32_bf16 a[112:115], v[76:79], a[192:195], a[112:115]
  ds_read_b64_tr_b16 v[92:93], v5 offset:4608
  v_mfma_f32_16x16x32_bf16 a[116:119], v[72:75], a[180:183], a[116:119]
  ds_read_b64_tr_b16 v[94:95], v5 offset:6656
  v_mfma_f32_16x16x32_bf16 a[116:119], v[76:79], a[196:199], a[116:119]
  buffer_load_dwordx4 v[56:59], v26, s[40:43], s72 offen offset:2048 sc1
  v_mfma_f32_16x16x32_bf16 a[120:123], v[72:75], a[184:187], a[120:123]
  v_mfma_f32_16x16x32_bf16 a[120:123], v[76:79], a[200:203], a[120:123]
  v_mfma_f32_16x16x32_bf16 a[124:127], v[72:75], a[188:191], a[124:127]
  buffer_load_dwordx4 v[60:63], v26, s[40:43], s72 offen offset:3072 sc1
  s_add_u32 s72, s72, 0x2000
  v_mfma_f32_16x16x32_bf16 a[124:127], v[76:79], a[204:207], a[124:127]
  s_waitcnt vmcnt(35)
  v_readfirstlane_b32 s62, v125
  s_and_b32 s62, s62, 0x1010100
  s_cmp_lg_u32 s62, 0x1010100
  s_cbranch_scc1 L_spin2
L_spin2_ret:
  s_waitcnt lgkmcnt(4)
  v_mfma_f32_16x16x32_bf16 a[32:35], v[80:83], a[208:211], a[32:35]
  ds_read_b64_tr_b16 v[64:65], v4 offset:8192
  ds_read_b64_tr_b16 v[66:67], v4 offset:10240
  s_mov_b32 s58, 0x4000
  v_mfma_f32_16x16x32_bf16 a[32:35], v[84:87], a[224:227], a[32:35]
  ds_read_b64_tr_b16 v[68:69], v4 offset:12288
  buffer_load_dwordx4 v[176:179], v18, s[64:67], s58 offen offset:0 sc1
  v_mfma_f32_16x16x32_bf16 a[36:39], v[80:83], a[212:215], a[36:39]
  ds_read_b64_tr_b16 v[70:71], v4 offset:14336
  v_mfma_f32_16x16x32_bf16 a[36:39], v[84:87], a[228:231], a[36:39]
  v_mfma_f32_16x16x32_bf16 a[40:43], v[80:83], a[216:219], a[40:43]
  v_mfma_f32_16x16x32_bf16 a[40:43], v[84:87], a[232:235], a[40:43]
  v_mfma_f32_16x16x32_bf16 a[44:47], v[80:83], a[220:223], a[44:47]
  buffer_load_dwordx4 v[180:183], v18, s[64:67], s58 offen offset:1024 sc1
  v_mfma_f32_16x16x32_bf16 a[44:47], v[84:87], a[236:239], a[44:47]
  ds_read_b64_tr_b16 v[72:73], v5 offset:8192
  s_waitcnt lgkmcnt(5)
  v_mfma_f32_16x16x32_bf16 a[48:51], v[88:91], a[208:211], a[48:51]
  ds_read_b64_tr_b16 v[74:75], v5 offset:10240
  v_mfma_f32_16x16x32_bf16 a[48:51], v[92:95], a[224:227], a[48:51]
  ds_read_b64_tr_b16 v[76:77], v5 offset:12288
  v_mfma_f32_16x16x32_bf16 a[52:55], v[88:91], a[212:215], a[52:55]
  ds_read_b64_tr_b16 v[78:79], v5 offset:14336
  v_mfma_f32_16x16x32_bf16 a[52:55], v[92:95], a[228:231], a[52:55]
  buffer_load_dwordx4 v[184:187], v18, s[64:67], s58 offen offset:2048 sc1
  v_mfma_f32_16x16x32_bf16 a[56:59], v[88:91], a[216:219], a[56:59]
  v_mfma_f32_16x16x32_bf16 a[56:59], v[92:95], a[232:235], a[56:59]
  v_mfma_f32_16x16x32_bf16 a[60:63], v[88:91], a[220:223], a[60:63]
  v_mfma_f32_16x16x32_bf16 a[60:63], v[92:95], a[236:239], a[60:63]
  ds_read_b64_tr_b16 v[80:81], v4 offset:8704
  s_waitcnt lgkmcnt(5)
  v_mfma_f32_16x16x32_bf16 a[64:67], v[64:67], a[208:211], a[64:67]
  ds_read_b64_tr_b16 v[82:83], v4 offset:10752
  buffer_load_dwordx4 v[188:191], v18, s[64:67], s58 offen offset:3072 sc1
  v_mfma_f32_16x16x32_bf16 a[64:67], v[68:71], a[224:227], a[64:67]
  ds_read_b64_tr_b16 v[84:85], v4 offset:12800
  v_mfma_f32_16x16x32_bf16 a[68:71], v[64:67], a[212:215], a[68:71]
  ds_read_b64_tr_b16 v[86:87], v4 offset:14848
  v_mfma_f32_16x16x32_bf16 a[68:71], v[68:71], a[228:231], a[68:71]
  v_mfma_f32_16x16x32_bf16 a[72:75], v[64:67], a[216:219], a[72:75]
  v_mfma_f32_16x16x32_bf16 a[72:75], v[68:71], a[232:235], a[72:75]
  s_mov_b32 s58, 0x8000
  buffer_load_dwordx4 v[208:211], v19, s[64:67], s58 offen offset:0 sc1
  v_mfma_f32_16x16x32_bf16 a[76:79], v[64:67], a[220:223], a[76:79]
  v_mfma_f32_16x16x32_bf16 a[76:79], v[68:71], a[236:239], a[76:79]
  ds_read_b64_tr_b16 v[88:89], v5 offset:8704
  s_waitcnt lgkmcnt(5)
  v_mfma_f32_16x16x32_bf16 a[80:83], v[72:75], a[208:211], a[80:83]
  ds_read_b64_tr_b16 v[90:91], v5 offset:10752
  v_mfma_f32_16x16x32_bf16 a[80:83], v[76:79], a[224:227], a[80:83]
  ds_read_b64_tr_b16 v[92:93], v5 offset:12800
  v_mfma_f32_16x16x32_bf16 a[84:87], v[72:75], a[212:215], a[84:87]
  ds_read_b64_tr_b16 v[94:95], v5 offset:14848
  buffer_load_dwordx4 v[212:215], v19, s[64:67], s58 offen offset:1024 sc1
  v_mfma_f32_16x16x32_bf16 a[84:87], v[76:79], a[228:231], a[84:87]
  v_mfma_f32_16x16x32_bf16 a[88:91], v[72:75], a[216:219], a[88:91]
  v_mfma_f32_16x16x32_bf16 a[88:91], v[76:79], a[232:235], a[88:91]
  v_mfma_f32_16x16x32_bf16 a[92:95], v[72:75], a[220:223], a[92:95]
  v_mfma_f32_16x16x32_bf16 a[92:95], v[76:79], a[236:239], a[92:95]
  s_waitcnt vmcnt(39)
  s_barrier
  s_waitcnt lgkmcnt(4)
  v_mfma_f32_16x16x32_bf16 a[96:99], v[80:83], a[208:211], a[96:99]
  ds_read_b64_tr_b16 v[64:65], v2 offset:512
  ds_read_b64_tr_b16 v[66:67], v2 offset:2560
  buffer_load_dwordx4 v[216:219], v19, s[64:67], s58 offen offset:2048 sc1
  v_mfma_f32_16x16x32_bf16 a[96:99], v[84:87], a[224:227], a[96:99]
  ds_read_b64_tr_b16 v[68:69], v2 offset:4608
  v_mfma_f32_16x16x32_bf16 a[100:103], v[80:83], a[212:215], a[100:103]
  ds_read_b64_tr_b16 v[70:71], v2 offset:6656
  v_mfma_f32_16x16x32_bf16 a[100:103], v[84:87], a[228:231], a[100:103]
  v_mfma_f32_16x16x32_bf16 a[104:107], v[80:83], a[216:219], a[104:107]
  v_mfma_f32_16x16x32_bf16 a[104:107], v[84:87], a[232:235], a[104:107]
  buffer_load_dwordx4 v[220:223], v19, s[64:67], s58 offen offset:3072 sc1
  v_mfma_f32_16x16x32_bf16 a[108:111], v[80:83], a[220:223], a[108:111]
  v_mfma_f32_16x16x32_bf16 a[108:111], v[84:87], a[236:239], a[108:111]
  ds_read_b64_tr_b16 v[72:73], v3 offset:512
  s_waitcnt lgkmcnt(5)
  v_mfma_f32_16x16x32_bf16 a[112:115], v[88:91], a[208:211], a[112:115]
  ds_read_b64_tr_b16 v[74:75], v3 offset:2560
  v_mfma_f32_16x16x32_bf16 a[112:115], v[92:95], a[224:227], a[112:115]
  ds_read_b64_tr_b16 v[76:77], v3 offset:4608
  v_mfma_f32_16x16x32_bf16 a[116:119], v[88:91], a[212:215], a[116:119]
  ds_read_b64_tr_b16 v[78:79], v3 offset:6656
  s_mov_b32 s58, 0xc000
  buffer_load_dwordx4 v[240:243], v20, s[64:67], s58 offen offset:0 sc1
  v_mfma_f32_16x16x32_bf16 a[116:119], v[92:95], a[228:231], a[116:119]
  v_mfma_f32_16x16x32_bf16 a[120:123], v[88:91], a[216:219], a[120:123]
  v_mfma_f32_16x16x32_bf16 a[120:123], v[92:95], a[232:235], a[120:123]
  v_mfma_f32_16x16x32_bf16 a[124:127], v[88:91], a[220:223], a[124:127]
  v_mfma_f32_16x16x32_bf16 a[124:127], v[92:95], a[236:239], a[124:127]
  buffer_load_dwordx4 v[244:247], v20, s[64:67], s58 offen offset:1024 sc1
  s_waitcnt vmcnt(35)
  s_waitcnt lgkmcnt(4)
  v_mfma_f32_16x16x32_bf16 a[32:35], v[64:67], a[144:147], a[32:35]
  ds_read_b64_tr_b16 v[80:81], v2 offset:8192
  ds_read_b64_tr_b16 v[82:83], v2 offset:10240
  v_mfma_f32_16x16x32_bf16 a[32:35], v[68:71], a[160:163], a[32:35]
  ds_read_b64_tr_b16 v[84:85], v2 offset:12288
  v_mfma_f32_16x16x32_bf16 a[36:39], v[64:67], a[148:151], a[36:39]
  ds_read_b64_tr_b16 v[86:87], v2 offset:14336
  v_mfma_f32_16x16x32_bf16 a[36:39], v[68:71], a[164:167], a[36:39]
  v_mfma_f32_16x16x32_bf16 a[40:43], v[64:67], a[152:155], a[40:43]
  buffer_load_dwordx4 v[248:251], v20, s[64:67], s58 offen offset:2048 sc1
  v_mfma_f32_16x16x32_bf16 a[40:43], v[68:71], a[168:171], a[40:43]
  v_mfma_f32_16x16x32_bf16 a[44:47], v[64:67], a[156:159], a[44:47]
  v_mfma_f32_16x16x32_bf16 a[44:47], v[68:71], a[172:175], a[44:47]
  ds_read_b64_tr_b16 v[88:89], v3 offset:8192
  s_waitcnt lgkmcnt(5)
  v_mfma_f32_16x16x32_bf16 a[48:51], v[72:75], a[144:147], a[48:51]
  ds_read_b64_tr_b16 v[90:91], v3 offset:10240
  v_mfma_f32_16x16x32_bf16 a[48:51], v[76:79], a[160:163], a[48:51]
  ds_read_b64_tr_b16 v[92:93], v3 offset:12288
  buffer_load_dwordx4 v[252:255], v20, s[64:67], s58 offen offset:3072 sc1
  v_mfma_f32_16x16x32_bf16 a[52:55], v[72:75], a[148:151], a[52:55]
  ds_read_b64_tr_b16 v[94:95], v3 offset:14336
  v_mfma_f32_16x16x32_bf16 a[52:55], v[76:79], a[164:167], a[52:55]
  v_mfma_f32_16x16x32_bf16 a[56:59], v[72:75], a[152:155], a[56:59]
  v_mfma_f32_16x16x32_bf16 a[56:59], v[76:79], a[168:171], a[56:59]
  v_mfma_f32_16x16x32_bf16 a[60:63], v[72:75], a[156:159], a[60:63]
  v_mfma_f32_16x16x32_bf16 a[60:63], v[76:79], a[172:175], a[60:63]
  ds_read_b64_tr_b16 v[64:65], v2 offset:8704
  s_waitcnt lgkmcnt(5)
  v_mfma_f32_16x16x32_bf16 a[64:67], v[80:83], a[144:147], a[64:67]
  ds_read_b64_tr_b16 v[66:67], v2 offset:10752
  v_mfma_f32_16x16x32_bf16 a[64:67], v[84:87], a[160:163], a[64:67]
  ds_read_b64_tr_b16 v[68:69], v2 offset:12800
  v_mfma_f32_16x16x32_bf16 a[68:71], v[80:83], a[148:151], a[68:71]
  ds_read_b64_tr_b16 v[70:71], v2 offset:14848
  v_mfma_f32_16x16x32_bf16 a[68:71], v[84:87], a[164:167], a[68:71]
  v_mfma_f32_16x16x32_bf16 a[72:75], v[80:83], a[152:155], a[72:75]
  v_mfma_f32_16x16x32_bf16 a[72:75], v[84:87], a[168:171], a[72:75]
  v_mfma_f32_16x16x32_bf16 a[76:79], v[80:83], a[156:159], a[76:79]
  v_mfma_f32_16x16x32_bf16 a[76:79], v[84:87], a[172:175], a[76:79]
  ds_read_b64_tr_b16 v[72:73], v3 offset:8704
  s_waitcnt lgkmcnt(5)
  v_mfma_f32_16x16x32_bf16 a[80:83], v[88:91], a[144:147], a[80:83]
  ds_read_b64_tr_b16 v[74:75], v3 offset:10752
  v_mfma_f32_16x16x32_bf16 a[80:83], v[92:95], a[160:163], a[80:83]
  ds_read_b64_tr_b16 v[76:77], v3 offset:12800
  v_mfma_f32_16x16x32_bf16 a[84:87], v[88:91], a[148:151], a[84:87]
  ds_read_b64_tr_b16 v[78:79], v3 offset:14848
  v_mfma_f32_16x16x32_bf16 a[84:87], v[92:95], a[164:167], a[84:87]
  v_mfma_f32_16x16x32_bf16 a[88:91], v[88:91], a[152:155], a[88:91]
  v_mfma_f32_16x16x32_bf16 a[88:91], v[92:95], a[168:171], a[88:91]
  v_mfma_f32_16x16x32_bf16 a[92:95], v[88:91], a[156:159], a[92:95]
  v_mfma_f32_16x16x32_bf16 a[92:95], v[92:95], a[172:175], a[92:95]
  s_waitcnt vmcnt(32)
  s_barrier
  s_waitcnt lgkmcnt(4)
  v_mfma_f32_16x16x32_bf16 a[96:99], v[64:67], a[144:147], a[96:99]
  ds_read_b64_tr_b16 v[80:81], v2 offset:16896
  ds_read_b64_tr_b16 v[82:83], v2 offset:18944
  v_mfma_f32_16x16x32_bf16 a[96:99], v[68:71], a[160:163], a[96:99]
  ds_read_b64_tr_b16 v[84:85], v2 offset:20992
  v_mfma_f32_16x16x32_bf16 a[100:103], v[64:67], a[148:151], a[100:103]
  ds_read_b64_tr_b16 v[86:87], v2 offset:23040
  v_mfma_f32_16x16x32_bf16 a[100:103], v[68:71], a[164:167], a[100:103]
  v_mfma_f32_16x16x32_bf16 a[104:107], v[64:67], a[152:155], a[104:107]
  v_mfma_f32_16x16x32_bf16 a[104:107], v[68:71], a[168:171], a[104:107]
  v_mfma_f32_16x16x32_bf16 a[108:111], v[64:67], a[156:159], a[108:111]
  v_mfma_f32_16x16x32_bf16 a[108:111], v[68:71], a[172:175], a[108:111]
  ds_read_b64_tr_b16 v[88:89], v3 offset:16896
  s_waitcnt lgkmcnt(5)
  v_mfma_f32_16x16x32_bf16 a[112:115], v[72:75], a[144:147], a[112:115]
  ds_read_b64_tr_b16 v[90:91], v3 offset:18944
  v_mfma_f32_16x16x32_bf16 a[112:115], v[76:79], a[160:163], a[112:115]
  ds_read_b64_tr_b16 v[92:93], v3 offset:20992
  v_mfma_f32_16x16x32_bf16 a[116:119], v[72:75], a[148:151], a[116:119]
  ds_read_b64_tr_b16 v[94:95], v3 offset:23040
  v_mfma_f32_16x16x32_bf16 a[116:119], v[76:79], a[164:167], a[116:119]
  v_mfma_f32_16x16x32_bf16 a[120:123], v[72:75], a[152:155], a[120:123]
  v_mfma_f32_16x16x32_bf16 a[120:123], v[76:79], a[168:171], a[120:123]
  v_mfma_f32_16x16x32_bf16 a[124:127], v[72:75], a[156:159], a[124:127]
  v_mfma_f32_16x16x32_bf16 a[124:127], v[76:79], a[172:175], a[124:127]
  s_waitcnt vmcnt(20)
  s_barrier
  s_waitcnt lgkmcnt(4)
  v_mfma_f32_16x16x32_bf16 a[32:35], v[80:83], a[240:243], a[32:35]
  ds_read_b64_tr_b16 v[64:65], v2 offset:33280
  ds_read_b64_tr_b16 v[66:67], v2 offset:35328
  v_mfma_f32_16x16x32_bf16 a[32:35], v[84:87], a[128:131], a[32:35]
  ds_read_b64_tr_b16 v[68:69], v2 offset:37376
  v_mfma_f32_16x16x32_bf16 a[36:39], v[80:83], a[244:247], a[36:39]
  ds_read_b64_tr_b16 v[70:71], v2 offset:39424
  v_mfma_f32_16x16x32_bf16 a[36:39], v[84:87], a[132:135], a[36:39]
  v_mfma_f32_16x16x32_bf16 a[40:43], v[80:83], a[248:251], a[40:43]
  v_mfma_f32_16x16x32_bf16 a[40:43], v[84:87], a[136:139], a[40:43]
  v_mfma_f32_16x16x32_bf16 a[44:47], v[80:83], a[252:255], a[44:47]
  v_mfma_f32_16x16x32_bf16 a[44:47], v[84:87], a[140:143], a[44:47]
  ds_read_b64_tr_b16 v[72:73], v3 offset:33280
  s_waitcnt lgkmcnt(5)
  v_mfma_f32_16x16x32_bf16 a[48:51], v[88:91], a[240:243], a[48:51]
  ds_read_b64_tr_b16 v[74:75], v3 offset:35328
  v_mfma_f32_16x16x32_bf16 a[48:51], v[92:95], a[128:131], a[48:51]
  ds_read_b64_tr_b16 v[76:77], v3 offset:37376
  v_mfma_f32_16x16x32_bf16 a[52:55], v[88:91], a[244:247], a[52:55]
  ds_read_b64_tr_b16 v[78:79], v3 offset:39424
  v_mfma_f32_16x16x32_bf16 a[52:55], v[92:95], a[132:135], a[52:55]
  v_mfma_f32_16x16x32_bf16 a[56:59], v[88:91], a[248:251], a[56:59]
  v_mfma_f32_16x16x32_bf16 a[56:59], v[92:95], a[136:139], a[56:59]
  v_mfma_f32_16x16x32_bf16 a[60:63], v[88:91], a[252:255], a[60:63]
  v_mfma_f32_16x16x32_bf16 a[60:63], v[92:95], a[140:143], a[60:63]
  s_waitcnt vmcnt(12)
  s_waitcnt lgkmcnt(4)
  v_mfma_f32_16x16x32_bf16 a[32:35], v[64:67], v[32:35], a[32:35]
  ds_read_b64_tr_b16 v[80:81], v2 offset:24576
  ds_read_b64_tr_b16 v[82:83], v2 offset:26624
  v_mfma_f32_16x16x32_bf16 a[32:35], v[68:71], v[48:51], a[32:35]
  ds_read_b64_tr_b16 v[84:85], v2 offset:28672
  v_mfma_f32_16x16x32_bf16 a[36:39], v[64:67], v[36:39], a[36:39]
  ds_read_b64_tr_b16 v[86:87], v2 offset:30720
  v_mfma_f32_16x16x32_bf16 a[36:39], v[68:71], v[52:55], a[36:39]
  v_mfma_f32_16x16x32_bf16 a[40:43], v[64:67], v[40:43], a[40:43]
  v_mfma_f32_16x16x32_bf16 a[40:43], v[68:71], v[56:59], a[40:43]
  v_mfma_f32_16x16x32_bf16 a[44:47], v[64:67], v[44:47], a[44:47]
  v_mfma_f32_16x16x32_bf16 a[44:47], v[68:71], v[60:63], a[44:47]
  ds_read_b64_tr_b16 v[88:89], v3 offset:24576
  s_waitcnt lgkmcnt(5)
  v_mfma_f32_16x16x32_bf16 a[48:51], v[72:75], v[32:35], a[48:51]
  ds_read_b64_tr_b16 v[90:91], v3 offset:26624
  v_mfma_f32_16x16x32_bf16 a[48:51], v[76:79], v[48:51], a[48:51]
  ds_read_b64_tr_b16 v[92:93], v3 offset:28672
  v_mfma_f32_16x16x32_bf16 a[52:55], v[72:75], v[36:39], a[52:55]
  ds_read_b64_tr_b16 v[94:95], v3 offset:30720
  v_mfma_f32_16x16x32_bf16 a[52:55], v[76:79], v[52:55], a[52:55]
  v_mfma_f32_16x16x32_bf16 a[56:59], v[72:75], v[40:43], a[56:59]
  v_mfma_f32_16x16x32_bf16 a[56:59], v[76:79], v[56:59], a[56:59]
  v_mfma_f32_16x16x32_bf16 a[60:63], v[72:75], v[44:47], a[60:63]
  v_mfma_f32_16x16x32_bf16 a[60:63], v[76:79], v[60:63], a[60:63]
  ds_read_b64_tr_b16 v[64:65], v2 offset:40960
  s_waitcnt lgkmcnt(5)
  v_mfma_f32_16x16x32_bf16 a[64:67], v[80:83], a[240:243], a[64:67]
  ds_read_b64_tr_b16 v[66:67], v2 offset:43008
  v_mfma_f32_16x16x32_bf16 a[64:67], v[84:87], a[128:131], a[64:67]
  ds_read_b64_tr_b16 v[68:69], v2 offset:45056
  v_mfma_f32_16x16x32_bf16 a[68:71], v[80:83], a[244:247], a[68:71]
  ds_read_b64_tr_b16 v[70:71], v2 offset:47104
  v_mfma_f32_16x16x32_bf16 a[68:71], v[84:87], a[132:135], a[68:71]
  v_mfma_f32_16x16x32_bf16 a[72:75], v[80:83], a[248:251], a[72:75]
  v_accvgpr_read_b32 v112, a32
  v_accvgpr_read_b32 v113, a33
  v_accvgpr_read_b32 v114, a34
  v_mfma_f32_16x16x32_bf16 a[72:75], v[84:87], a[136:139], a[72:75]
  v_accvgpr_read_b32 v115, a35
  v_accvgpr_read_b32 v116, a36
  v_accvgpr_read_b32 v117, a37
  v_mfma_f32_16x16x32_bf16 a[76:79], v[80:83], a[252:255], a[76:79]
  v_accvgpr_read_b32 v118, a38
  v_accvgpr_read_b32 v119, a39
  v_cvt_pk_bf16_f32 v160, v112, v113
  v_mfma_f32_16x16x32_bf16 a[76:79], v[84:87], a[140:143], a[76:79]
  ds_read_b64_tr_b16 v[72:73], v3 offset:40960
  v_cvt_pk_bf16_f32 v161, v114, v115
  s_waitcnt lgkmcnt(5)
  v_mfma_f32_16x16x32_bf16 a[80:83], v[88:91], a[240:243], a[80:83]
  ds_read_b64_tr_b16 v[74:75], v3 offset:43008
  v_cvt_pk_bf16_f32 v162, v116, v117
  v_cvt_pk_bf16_f32 v163, v118, v119
  v_mfma_f32_16x16x32_bf16 a[80:83], v[92:95], a[128:131], a[80:83]
  ds_read_b64_tr_b16 v[76:77], v3 offset:45056
  v_accvgpr_read_b32 v112, a40
  v_accvgpr_read_b32 v113, a41
  v_mfma_f32_16x16x32_bf16 a[84:87], v[88:91], a[244:247], a[84:87]
  ds_read_b64_tr_b16 v[78:79], v3 offset:47104
  v_accvgpr_read_b32 v114, a42
  v_accvgpr_read_b32 v115, a43
  v_mfma_f32_16x16x32_bf16 a[84:87], v[92:95], a[132:135], a[84:87]
  v_accvgpr_read_b32 v116, a44
  v_accvgpr_read_b32 v117, a45
  v_accvgpr_read_b32 v118, a46
  v_mfma_f32_16x16x32_bf16 a[88:91], v[88:91], a[248:251], a[88:91]
  v_accvgpr_read_b32 v119, a47
  v_cvt_pk_bf16_f32 v164, v112, v113
  v_cvt_pk_bf16_f32 v165, v114, v115
  v_mfma_f32_16x16x32_bf16 a[88:91], v[92:95], a[136:139], a[88:91]
  v_cvt_pk_bf16_f32 v166, v116, v117
  v_cvt_pk_bf16_f32 v167, v118, v119
  v_accvgpr_read_b32 v112, a48
  v_mfma_f32_16x16x32_bf16 a[92:95], v[88:91], a[252:255], a[92:95]
  v_accvgpr_read_b32 v113, a49
  v_accvgpr_read_b32 v114, a50
  v_accvgpr_read_b32 v115, a51
  v_mfma_f32_16x16x32_bf16 a[92:95], v[92:95], a[140:143], a[92:95]
  ds_read_b64_tr_b16 v[80:81], v2 offset:25088
  v_accvgpr_read_b32 v116, a52
  s_waitcnt lgkmcnt(5)
  v_mfma_f32_16x16x32_bf16 a[64:67], v[64:67], v[32:35], a[64:67]
  ds_read_b64_tr_b16 v[82:83], v2 offset:27136
  v_accvgpr_read_b32 v117, a53
  v_accvgpr_read_b32 v118, a54
  v_mfma_f32_16x16x32_bf16 a[64:67], v[68:71], v[48:51], a[64:67]
  ds_read_b64_tr_b16 v[84:85], v2 offset:29184
  v_accvgpr_read_b32 v119, a55
  v_cvt_pk_bf16_f32 v168, v112, v113
  v_mfma_f32_16x16x32_bf16 a[68:71], v[64:67], v[36:39], a[68:71]
  ds_read_b64_tr_b16 v[86:87], v2 offset:31232
  v_cvt_pk_bf16_f32 v169, v114, v115
  v_cvt_pk_bf16_f32 v170, v116, v117
  v_mfma_f32_16x16x32_bf16 a[68:71], v[68:71], v[52:55], a[68:71]
  v_cvt_pk_bf16_f32 v171, v118, v119
  v_accvgpr_read_b32 v112, a56
  v_accvgpr_read_b32 v113, a57
  v_mfma_f32_16x16x32_bf16 a[72:75], v[64:67], v[40:43], a[72:75]
  v_accvgpr_read_b32 v114, a58
  v_accvgpr_read_b32 v115, a59
  v_accvgpr_read_b32 v116, a60
  v_mfma_f32_16x16x32_bf16 a[72:75], v[68:71], v[56:59], a[72:75]
  v_accvgpr_read_b32 v117, a61
  v_accvgpr_read_b32 v118, a62
  v_accvgpr_read_b32 v119, a63
  v_mfma_f32_16x16x32_bf16 a[76:79], v[64:67], v[44:47], a[76:79]
  v_cvt_pk_bf16_f32 v172, v112, v113
  v_cvt_pk_bf16_f32 v173, v114, v115
  v_cvt_pk_bf16_f32 v174, v116, v117
  v_mfma_f32_16x16x32_bf16 a[76:79], v[68:71], v[60:63], a[76:79]
  ds_read_b64_tr_b16 v[88:89], v3 offset:25088
  v_cvt_pk_bf16_f32 v175, v118, v119
  s_waitcnt lgkmcnt(5)
  v_mfma_f32_16x16x32_bf16 a[80:83], v[72:75], v[32:35], a[80:83]
  ds_read_b64_tr_b16 v[90:91], v3 offset:27136
  s_mov_b32 s58, 0x14000
  buffer_store_dwordx4 v[160:163], v17, s[64:67], s58 offen offset:0 sc1
  v_mfma_f32_16x16x32_bf16 a[80:83], v[76:79], v[48:51], a[80:83]
  ds_read_b64_tr_b16 v[92:93], v3 offset:29184
  v_mfma_f32_16x16x32_bf16 a[84:87], v[72:75], v[36:39], a[84:87]
  ds_read_b64_tr_b16 v[94:95], v3 offset:31232
  buffer_store_dwordx4 v[164:167], v17, s[64:67], s58 offen offset:1024 sc1
  v_mfma_f32_16x16x32_bf16 a[84:87], v[76:79], v[52:55], a[84:87]
  v_mfma_f32_16x16x32_bf16 a[88:91], v[72:75], v[40:43], a[88:91]
  buffer_store_dwordx4 v[168:171], v17, s[64:67], s58 offen offset:2048 sc1
  v_mfma_f32_16x16x32_bf16 a[88:91], v[76:79], v[56:59], a[88:91]
  v_mfma_f32_16x16x32_bf16 a[92:95], v[72:75], v[44:47], a[92:95]
  buffer_store_dwordx4 v[172:175], v17, s[64:67], s58 offen offset:3072 sc1
  v_mfma_f32_16x16x32_bf16 a[92:95], v[76:79], v[60:63], a[92:95]
  ds_read_b64_tr_b16 v[64:65], v2 offset:41472
  s_waitcnt lgkmcnt(5)
  v_mfma_f32_16x16x32_bf16 a[96:99], v[80:83], a[240:243], a[96:99]
  ds_read_b64_tr_b16 v[66:67], v2 offset:43520
  v_mfma_f32_16x16x32_bf16 a[96:99], v[84:87], a[128:131], a[96:99]
  ds_read_b64_tr_b16 v[68:69], v2 offset:45568
  v_mfma_f32_16x16x32_bf16 a[100:103], v[80:83], a[244:247], a[100:103]
  ds_read_b64_tr_b16 v[70:71], v2 offset:47616
  v_mfma_f32_16x16x32_bf16 a[100:103], v[84:87], a[132:135], a[100:103]
  v_mfma_f32_16x16x32_bf16 a[104:107], v[80:83], a[248:251], a[104:107]
  v_accvgpr_read_b32 v112, a64
  v_accvgpr_read_b32 v113, a65
  v_accvgpr_read_b32 v114, a66
  v_mfma_f32_16x16x32_bf16 a[104:107], v[84:87], a[136:139], a[104:107]
  v_accvgpr_read_b32 v115, a67
  v_accvgpr_read_b32 v116, a68
  v_accvgpr_read_b32 v117, a69
  v_mfma_f32_16x16x32_bf16 a[108:111], v[80:83], a[252:255], a[108:111]
  v_accvgpr_read_b32 v118, a70
  v_accvgpr_read_b32 v119, a71
  v_cvt_pk_bf16_f32 v192, v112, v113
  v_mfma_f32_16x16x32_bf16 a[108:111], v[84:87], a[140:143], a[108:111]
  ds_read_b64_tr_b16 v[72:73], v3 offset:41472
  v_cvt_pk_bf16_f32 v193, v114, v115
  s_waitcnt lgkmcnt(5)
  v_mfma_f32_16x16x32_bf16 a[112:115], v[88:91], a[240:243], a[112:115]
  ds_read_b64_tr_b16 v[74:75], v3 offset:43520
  v_cvt_pk_bf16_f32 v194, v116, v117
  v_cvt_pk_bf16_f32 v195, v118, v119
  v_mfma_f32_16x16x32_bf16 a[112:115], v[92:95], a[128:131], a[112:115]
  ds_read_b64_tr_b16 v[76:77], v3 offset:45568
  v_accvgpr_read_b32 v112, a72
  v_accvgpr_read_b32 v113, a73
  v_mfma_f32_16x16x32_bf16 a[116:119], v[88:91], a[244:247], a[116:119]
  ds_read_b64_tr_b16 v[78:79], v3 offset:47616
  v_accvgpr_read_b32 v114, a74
  v_accvgpr_read_b32 v115, a75
  v_mfma_f32_16x16x32_bf16 a[116:119], v[92:95], a[132:135], a[116:119]
  v_accvgpr_read_b32 v116, a76
  v_accvgpr_read_b32 v117, a77
  v_accvgpr_read_b32 v118, a78
  v_mfma_f32_16x16x32_bf16 a[120:123], v[88:91], a[248:251], a[120:123]
  v_accvgpr_read_b32 v119, a79
  v_cvt_pk_bf16_f32 v196, v112, v113
  v_cvt_pk_bf16_f32 v197, v114, v115
  v_mfma_f32_16x16x32_bf16 a[120:123], v[92:95], a[136:139], a[120:123]
  v_cvt_pk_bf16_f32 v198, v116, v117
  v_cvt_pk_bf16_f32 v199, v118, v119
  v_accvgpr_read_b32 v112, a80
  v_mfma_f32_16x16x32_bf16 a[124:127], v[88:91], a[252:255], a[124:127]
  v_accvgpr_read_b32 v113, a81
  v_accvgpr_read_b32 v114, a82
  v_accvgpr_read_b32 v115, a83
  v_mfma_f32_16x16x32_bf16 a[124:127], v[92:95], a[140:143], a[124:127]
  ds_read_b64_tr_b16 v[80:81], v4 offset:49152
  v_accvgpr_read_b32 v116, a84
  s_waitcnt lgkmcnt(5)
  v_mfma_f32_16x16x32_bf16 a[96:99], v[64:67], v[32:35], a[96:99]
  ds_read_b64_tr_b16 v[82:83], v4 offset:51200
  v_accvgpr_read_b32 v117, a85
  v_accvgpr_read_b32 v118, a86
  v_mfma_f32_16x16x32_bf16 a[96:99], v[68:71], v[48:51], a[96:99]
  ds_read_b64_tr_b16 v[84:85], v4 offset:53248
  v_accvgpr_read_b32 v119, a87
  v_cvt_pk_bf16_f32 v200, v112, v113
  v_mfma_f32_16x16x32_bf16 a[100:103], v[64:67], v[36:39], a[100:103]
  ds_read_b64_tr_b16 v[86:87], v4 offset:55296
  v_cvt_pk_bf16_f32 v201, v114, v115
  v_cvt_pk_bf16_f32 v202, v116, v117
  v_mfma_f32_16x16x32_bf16 a[100:103], v[68:71], v[52:55], a[100:103]
  v_cvt_pk_bf16_f32 v203, v118, v119
  v_accvgpr_read_b32 v112, a88
  v_accvgpr_read_b32 v113, a89
  v_mfma_f32_16x16x32_bf16 a[104:107], v[64:67], v[40:43], a[104:107]
  v_accvgpr_read_b32 v114, a90
  v_accvgpr_read_b32 v115, a91
  v_accvgpr_read_b32 v116, a92
  v_mfma_f32_16x16x32_bf16 a[104:107], v[68:71], v[56:59], a[104:107]
  v_accvgpr_read_b32 v117, a93
  v_accvgpr_read_b32 v118, a94
  v_accvgpr_read_b32 v119, a95
  v_mfma_f32_16x16x32_bf16 a[108:111], v[64:67], v[44:47], a[108:111]
  v_cvt_pk_bf16_f32 v204, v112, v113
  v_cvt_pk_bf16_f32 v205, v114, v115
  v_cvt_pk_bf16_f32 v206, v116, v117
  v_mfma_f32_16x16x32_bf16 a[108:111], v[68:71], v[60:63], a[108:111]
  ds_read_b64_tr_b16 v[88:89], v5 offset:49152
  v_cvt_pk_bf16_f32 v207, v118, v119
  s_waitcnt lgkmcnt(5)
  v_mfma_f32_16x16x32_bf16 a[112:115], v[72:75], v[32:35], a[112:115]
  ds_read_b64_tr_b16 v[90:91], v5 offset:51200
  s_mov_b32 s58, 0x18000
  buffer_store_dwordx4 v[192:195], v17, s[64:67], s58 offen offset:0 sc1
  v_mfma_f32_16x16x32_bf16 a[112:115], v[76:79], v[48:51], a[112:115]
  ds_read_b64_tr_b16 v[92:93], v5 offset:53248
  v_mfma_f32_16x16x32_bf16 a[116:119], v[72:75], v[36:39], a[116:119]
  ds_read_b64_tr_b16 v[94:95], v5 offset:55296
  buffer_store_dwordx4 v[196:199], v17, s[64:67], s58 offen offset:1024 sc1
  v_mfma_f32_16x16x32_bf16 a[116:119], v[76:79], v[52:55], a[116:119]
  v_mfma_f32_16x16x32_bf16 a[120:123], v[72:75], v[40:43], a[120:123]
  buffer_store_dwordx4 v[200:203], v17, s[64:67], s58 offen offset:2048 sc1
  v_mfma_f32_16x16x32_bf16 a[120:123], v[76:79], v[56:59], a[120:123]
  v_mfma_f32_16x16x32_bf16 a[124:127], v[72:75], v[44:47], a[124:127]
  buffer_store_dwordx4 v[204:207], v17, s[64:67], s58 offen offset:3072 sc1
  v_mfma_f32_16x16x32_bf16 a[124:127], v[76:79], v[60:63], a[124:127]
  ds_read_b64_tr_b16 v[64:65], v4 offset:0
  s_waitcnt lgkmcnt(5)
  v_mfma_f32_16x16x32_bf16 a[0:3], v[80:83], a[176:179], a[0:3]
  ds_read_b64_tr_b16 v[66:67], v4 offset:2048
  v_mfma_f32_16x16x32_bf16 a[0:3], v[84:87], a[192:195], a[0:3]
  ds_read_b64_tr_b16 v[68:69], v4 offset:4096
  v_mfma_f32_16x16x32_bf16 a[4:7], v[80:83], a[180:183], a[4:7]
  ds_read_b64_tr_b16 v[70:71], v4 offset:6144
  v_mfma_f32_16x16x32_bf16 a[4:7], v[84:87], a[196:199], a[4:7]
  v_mfma_f32_16x16x32_bf16 a[8:11], v[80:83], a[184:187], a[8:11]
  v_accvgpr_read_b32 v112, a96
  v_accvgpr_read_b32 v113, a97
  v_accvgpr_read_b32 v114, a98
  v_mfma_f32_16x16x32_bf16 a[8:11], v[84:87], a[200:203], a[8:11]
  v_accvgpr_read_b32 v115, a99
  v_accvgpr_read_b32 v116, a100
  v_accvgpr_read_b32 v117, a101
  v_mfma_f32_16x16x32_bf16 a[12:15], v[80:83], a[188:191], a[12:15]
  v_accvgpr_read_b32 v118, a102
  v_accvgpr_read_b32 v119, a103
  v_cvt_pk_bf16_f32 v224, v112, v113
  v_mfma_f32_16x16x32_bf16 a[12:15], v[84:87], a[204:207], a[12:15]
  ds_read_b64_tr_b16 v[72:73], v5 offset:0
  v_cvt_pk_bf16_f32 v225, v114, v115
  s_waitcnt lgkmcnt(5)
  v_mfma_f32_16x16x32_bf16 a[16:19], v[88:91], a[176:179], a[16:19]
  ds_read_b64_tr_b16 v[74:75], v5 offset:2048
  v_cvt_pk_bf16_f32 v226, v116, v117
  v_cvt_pk_bf16_f32 v227, v118, v119
  v_mfma_f32_16x16x32_bf16 a[16:19], v[92:95], a[192:195], a[16:19]
  ds_read_b64_tr_b16 v[76:77], v5 offset:4096
  v_accvgpr_read_b32 v112, a104
  v_accvgpr_read_b32 v113, a105
  v_mfma_f32_16x16x32_bf16 a[20:23], v[88:91], a[180:183], a[20:23]
  ds_read_b64_tr_b16 v[78:79], v5 offset:6144
  v_accvgpr_read_b32 v114, a106
  v_accvgpr_read_b32 v115, a107
  v_mfma_f32_16x16x32_bf16 a[20:23], v[92:95], a[196:199], a[20:23]
  v_accvgpr_read_b32 v116, a108
  v_accvgpr_read_b32 v117, a109
  v_accvgpr_read_b32 v118, a110
  v_mfma_f32_16x16x32_bf16 a[24:27], v[88:91], a[184:187], a[24:27]
  v_accvgpr_read_b32 v119, a111
  v_cvt_pk_bf16_f32 v228, v112, v113
  v_cvt_pk_bf16_f32 v229, v114, v115
  v_mfma_f32_16x16x32_bf16 a[24:27], v[92:95], a[200:203], a[24:27]
  v_cvt_pk_bf16_f32 v230, v116, v117
  v_cvt_pk_bf16_f32 v231, v118, v119
  v_accvgpr_read_b32 v112, a112
  v_mfma_f32_16x16x32_bf16 a[28:31], v[88:91], a[188:191], a[28:31]
  v_accvgpr_read_b32 v113, a113
  v_accvgpr_read_b32 v114, a114
  v_accvgpr_read_b32 v115, a115
  v_mfma_f32_16x16x32_bf16 a[28:31], v[92:95], a[204:207], a[28:31]
  ds_read_b64_tr_b16 v[80:81], v2 offset:0
  v_accvgpr_read_b32 v116, a116
  s_waitcnt lgkmcnt(5)
  v_mfma_f32_16x16x32_bf16 a[0:3], v[64:67], a[208:211], a[0:3]
  ds_read_b64_tr_b16 v[82:83], v2 offset:2048
  v_accvgpr_read_b32 v117, a117
  v_accvgpr_read_b32 v118, a118
  v_mfma_f32_16x16x32_bf16 a[0:3], v[68:71], a[224:227], a[0:3]
  ds_read_b64_tr_b16 v[84:85], v2 offset:4096
  v_accvgpr_read_b32 v119, a119
  v_cvt_pk_bf16_f32 v232, v112, v113
  v_mfma_f32_16x16x32_bf16 a[4:7], v[64:67], a[212:215], a[4:7]
  ds_read_b64_tr_b16 v[86:87], v2 offset:6144
  v_cvt_pk_bf16_f32 v233, v114, v115
  v_cvt_pk_bf16_f32 v234, v116, v117
  v_mfma_f32_16x16x32_bf16 a[4:7], v[68:71], a[228:231], a[4:7]
  v_cvt_pk_bf16_f32 v235, v118, v119
  v_accvgpr_read_b32 v112, a120
  v_accvgpr_read_b32 v113, a121
  v_mfma_f32_16x16x32_bf16 a[8:11], v[64:67], a[216:219], a[8:11]
  v_accvgpr_read_b32 v114, a122
  v_accvgpr_read_b32 v115, a123
  v_accvgpr_read_b32 v116, a124
  v_mfma_f32_16x16x32_bf16 a[8:11], v[68:71], a[232:235], a[8:11]
  v_accvgpr_read_b32 v117, a125
  v_accvgpr_read_b32 v118, a126
  v_accvgpr_read_b32 v119, a127
  v_mfma_f32_16x16x32_bf16 a[12:15], v[64:67], a[220:223], a[12:15]
  v_cvt_pk_bf16_f32 v236, v112, v113
  v_cvt_pk_bf16_f32 v237, v114, v115
  v_cvt_pk_bf16_f32 v238, v116, v117
  v_mfma_f32_16x16x32_bf16 a[12:15], v[68:71], a[236:239], a[12:15]
  ds_read_b64_tr_b16 v[88:89], v3 offset:0
  v_cvt_pk_bf16_f32 v239, v118, v119
  s_waitcnt lgkmcnt(5)
  v_mfma_f32_16x16x32_bf16 a[16:19], v[72:75], a[208:211], a[16:19]
  ds_read_b64_tr_b16 v[90:91], v3 offset:2048
  s_mov_b32 s58, 0x1c000
  buffer_store_dwordx4 v[224:227], v17, s[64:67], s58 offen offset:0 sc1
  v_mfma_f32_16x16x32_bf16 a[16:19], v[76:79], a[224:227], a[16:19]
  ds_read_b64_tr_b16 v[92:93], v3 offset:4096
  v_mov_b32 v126, 3
  s_waitcnt vmcnt(5)
  v_mfma_f32_16x16x32_bf16 a[20:23], v[72:75], a[212:215], a[20:23]
  ds_read_b64_tr_b16 v[94:95], v3 offset:6144
  buffer_store_dwordx4 v[228:231], v17, s[64:67], s58 offen offset:1024 sc1
  buffer_store_byte v126, v23, s[64:67], s16 offen sc1
  v_mfma_f32_16x16x32_bf16 a[20:23], v[76:79], a[228:231], a[20:23]
  v_mfma_f32_16x16x32_bf16 a[24:27], v[72:75], a[216:219], a[24:27]
  buffer_store_dwordx4 v[232:235], v17, s[64:67], s58 offen offset:2048 sc1
  v_mfma_f32_16x16x32_bf16 a[24:27], v[76:79], a[232:235], a[24:27]
  v_mfma_f32_16x16x32_bf16 a[28:31], v[72:75], a[220:223], a[28:31]
  buffer_store_dwordx4 v[236:239], v17, s[64:67], s58 offen offset:3072 sc1
  v_mfma_f32_16x16x32_bf16 a[28:31], v[76:79], a[236:239], a[28:31]
  ds_read_b64_tr_b16 v[64:65], v2 offset:16384
  s_waitcnt lgkmcnt(5)
  v_mfma_f32_16x16x32_bf16 a[0:3], v[80:83], a[144:147], a[0:3]
  ds_read_b64_tr_b16 v[66:67], v2 offset:18432
  v_mfma_f32_16x16x32_bf16 a[0:3], v[84:87], a[160:163], a[0:3]
  ds_read_b64_tr_b16 v[68:69], v2 offset:20480
  v_mfma_f32_16x16x32_bf16 a[4:7], v[80:83], a[148:151], a[4:7]
  ds_read_b64_tr_b16 v[70:71], v2 offset:22528
  v_mfma_f32_16x16x32_bf16 a[4:7], v[84:87], a[164:167], a[4:7]
  v_mfma_f32_16x16x32_bf16 a[8:11], v[80:83], a[152:155], a[8:11]
  v_mfma_f32_16x16x32_bf16 a[8:11], v[84:87], a[168:171], a[8:11]
  v_mfma_f32_16x16x32_bf16 a[12:15], v[80:83], a[156:159], a[12:15]
  v_mfma_f32_16x16x32_bf16 a[12:15], v[84:87], a[172:175], a[12:15]
  ds_read_b64_tr_b16 v[72:73], v3 offset:16384
  s_waitcnt lgkmcnt(5)
  v_mfma_f32_16x16x32_bf16 a[16:19], v[88:91], a[144:147], a[16:19]
  ds_read_b64_tr_b16 v[74:75], v3 offset:18432
  v_mfma_f32_16x16x32_bf16 a[16:19], v[92:95], a[160:163], a[16:19]
  ds_read_b64_tr_b16 v[76:77], v3 offset:20480
  v_mfma_f32_16x16x32_bf16 a[20:23], v[88:91], a[148:151], a[20:23]
  ds_read_b64_tr_b16 v[78:79], v3 offset:22528
  v_mfma_f32_16x16x32_bf16 a[20:23], v[92:95], a[164:167], a[20:23]
  v_mfma_f32_16x16x32_bf16 a[24:27], v[88:91], a[152:155], a[24:27]
  v_mfma_f32_16x16x32_bf16 a[24:27], v[92:95], a[168:171], a[24:27]
  v_mov_b32 v126, 3
  s_waitcnt vmcnt(5)
  buffer_store_byte v126, v23, s[64:67], s17 offen sc1
  v_mfma_f32_16x16x32_bf16 a[28:31], v[88:91], a[156:159], a[28:31]
  v_mfma_f32_16x16x32_bf16 a[28:31], v[92:95], a[172:175], a[28:31]
  ds_read_b64_tr_b16 v[80:81], v2 offset:32768
  s_waitcnt lgkmcnt(5)
  v_mfma_f32_16x16x32_bf16 a[0:3], v[64:67], a[240:243], a[0:3]
  ds_read_b64_tr_b16 v[82:83], v2 offset:34816
  v_mfma_f32_16x16x32_bf16 a[0:3], v[68:71], a[128:131], a[0:3]
  ds_read_b64_tr_b16 v[84:85], v2 offset:36864
  v_mfma_f32_16x16x32_bf16 a[4:7], v[64:67], a[244:247], a[4:7]
  ds_read_b64_tr_b16 v[86:87], v2 offset:38912
  v_mfma_f32_16x16x32_bf16 a[4:7], v[68:71], a[132:135], a[4:7]
  v_mfma_f32_16x16x32_bf16 a[8:11], v[64:67], a[248:251], a[8:11]
  v_mfma_f32_16x16x32_bf16 a[8:11], v[68:71], a[136:139], a[8:11]
  v_mfma_f32_16x16x32_bf16 a[12:15], v[64:67], a[252:255], a[12:15]
  v_mfma_f32_16x16x32_bf16 a[12:15], v[68:71], a[140:143], a[12:15]
  ds_read_b64_tr_b16 v[88:89], v3 offset:32768
  s_waitcnt lgkmcnt(5)
  v_mfma_f32_16x16x32_bf16 a[16:19], v[72:75], a[240:243], a[16:19]
  ds_read_b64_tr_b16 v[90:91], v3 offset:34816
  v_mfma_f32_16x16x32_bf16 a[16:19], v[76:79], a[128:131], a[16:19]
  ds_read_b64_tr_b16 v[92:93], v3 offset:36864
  v_mfma_f32_16x16x32_bf16 a[20:23], v[72:75], a[244:247], a[20:23]
  ds_read_b64_tr_b16 v[94:95], v3 offset:38912
  v_mfma_f32_16x16x32_bf16 a[20:23], v[76:79], a[132:135], a[20:23]
  v_mfma_f32_16x16x32_bf16 a[24:27], v[72:75], a[248:251], a[24:27]
  v_mfma_f32_16x16x32_bf16 a[24:27], v[76:79], a[136:139], a[24:27]
  v_mfma_f32_16x16x32_bf16 a[28:31], v[72:75], a[252:255], a[28:31]
  v_mfma_f32_16x16x32_bf16 a[28:31], v[76:79], a[140:143], a[28:31]
  s_waitcnt lgkmcnt(4)
  v_mfma_f32_16x16x32_bf16 a[0:3], v[80:83], v[32:35], a[0:3]
  v_mfma_f32_16x16x32_bf16 a[0:3], v[84:87], v[48:51], a[0:3]
  v_mfma_f32_16x16x32_bf16 a[4:7], v[80:83], v[36:39], a[4:7]
  v_mfma_f32_16x16x32_bf16 a[4:7], v[84:87], v[52:55], a[4:7]
  v_mfma_f32_16x16x32_bf16 a[8:11], v[80:83], v[40:43], a[8:11]
  v_mfma_f32_16x16x32_bf16 a[8:11], v[84:87], v[56:59], a[8:11]
  v_mfma_f32_16x16x32_bf16 a[12:15], v[80:83], v[44:47], a[12:15]
  v_mfma_f32_16x16x32_bf16 a[12:15], v[84:87], v[60:63], a[12:15]
  s_waitcnt lgkmcnt(0)
  v_mfma_f32_16x16x32_bf16 a[16:19], v[88:91], v[32:35], a[16:19]
  v_mfma_f32_16x16x32_bf16 a[16:19], v[92:95], v[48:51], a[16:19]
  v_mfma_f32_16x16x32_bf16 a[20:23], v[88:91], v[36:39], a[20:23]
  v_mfma_f32_16x16x32_bf16 a[20:23], v[92:95], v[52:55], a[20:23]
  v_mfma_f32_16x16x32_bf16 a[24:27], v[88:91], v[40:43], a[24:27]
  buffer_load_dword v125, v22, s[64:67], 0 offen sc1
  v_mfma_f32_16x16x32_bf16 a[24:27], v[92:95], v[56:59], a[24:27]
  v_mov_b32 v126, 3
  s_waitcnt vmcnt(2)
  buffer_store_byte v126, v23, s[64:67], s18 offen sc1
  v_mfma_f32_16x16x32_bf16 a[28:31], v[88:91], v[44:47], a[28:31]
  v_mfma_f32_16x16x32_bf16 a[28:31], v[92:95], v[60:63], a[28:31]
  s_nop 7
  s_mov_b32 s16, s68
  s_mov_b32 s17, s68
  ds_read_b128 v[96:99], v24 offset:0
  ds_read_b128 v[100:103], v24 offset:1024
  ds_read_b128 v[104:107], v24 offset:2048
  ds_read_b128 v[108:111], v24 offset:3072
  v_lshlrev_b32 v32, 16, v176
  v_and_b32 v33, s69, v176
  v_lshlrev_b32 v34, 16, v177
  v_and_b32 v35, s69, v177
  v_lshlrev_b32 v36, 16, v178
  v_and_b32 v37, s69, v178
  v_lshlrev_b32 v38, 16, v179
  v_and_b32 v39, s69, v179
  v_lshlrev_b32 v40, 16, v180
  v_and_b32 v41, s69, v180
  v_lshlrev_b32 v42, 16, v181
  v_and_b32 v43, s69, v181
  v_lshlrev_b32 v44, 16, v182
  v_and_b32 v45, s69, v182
  v_lshlrev_b32 v46, 16, v183
  v_and_b32 v47, s69, v183
  v_lshlrev_b32 v48, 16, v184
  v_and_b32 v49, s69, v184
  v_lshlrev_b32 v50, 16, v185
  v_and_b32 v51, s69, v185
  v_lshlrev_b32 v52, 16, v186
  v_and_b32 v53, s69, v186
  v_lshlrev_b32 v54, 16, v187
  v_and_b32 v55, s69, v187
  v_lshlrev_b32 v56, 16, v188
  v_and_b32 v57, s69, v188
  v_lshlrev_b32 v58, 16, v189
  v_and_b32 v59, s69, v189
  v_lshlrev_b32 v60, 16, v190
  v_and_b32 v61, s69, v190
  v_lshlrev_b32 v62, 16, v191
  v_and_b32 v63, s69, v191
  v_pk_add_f32 v[128:129], v[128:129], v[32:33]
  v_pk_add_f32 v[130:131], v[130:131], v[34:35]
  v_pk_add_f32 v[132:133], v[132:133], v[36:37]
  v_pk_add_f32 v[134:135], v[134:135], v[38:39]
  v_pk_add_f32 v[136:137], v[136:137], v[40:41]
  v_pk_add_f32 v[138:139], v[138:139], v[42:43]
  v_pk_add_f32 v[140:141], v[140:141], v[44:45]
  v_pk_add_f32 v[142:143], v[142:143], v[46:47]
  v_pk_add_f32 v[144:145], v[144:145], v[48:49]
  v_pk_add_f32 v[146:147], v[146:147], v[50:51]
  v_pk_add_f32 v[148:149], v[148:149], v[52:53]
  v_pk_add_f32 v[150:151], v[150:151], v[54:55]
  v_pk_add_f32 v[152:153], v[152:153], v[56:57]
  v_pk_add_f32 v[154:155], v[154:155], v[58:59]
  v_pk_add_f32 v[156:157], v[156:157], v[60:61]
  v_pk_add_f32 v[158:159], v[158:159], v[62:63]
  v_lshlrev_b32 v32, 16, v208
  v_and_b32 v33, s69, v208
  v_lshlrev_b32 v34, 16, v209
  v_and_b32 v35, s69, v209
  v_lshlrev_b32 v36, 16, v210
  v_and_b32 v37, s69, v210
  v_lshlrev_b32 v38, 16, v211
  v_and_b32 v39, s69, v211
  v_lshlrev_b32 v40, 16, v212
  v_and_b32 v41, s69, v212
  v_lshlrev_b32 v42, 16, v213
  v_and_b32 v43, s69, v213
  v_lshlrev_b32 v44, 16, v214
  v_and_b32 v45, s69, v214
  v_lshlrev_b32 v46, 16, v215
  v_and_b32 v47, s69, v215
  v_lshlrev_b32 v48, 16, v216
  v_and_b32 v49, s69, v216
  v_lshlrev_b32 v50, 16, v217
  v_and_b32 v51, s69, v217
  v_lshlrev_b32 v52, 16, v218
  v_and_b32 v53, s69, v218
  v_lshlrev_b32 v54, 16, v219
  v_and_b32 v55, s69, v219
  v_lshlrev_b32 v56, 16, v220
  v_and_b32 v57, s69, v220
  v_lshlrev_b32 v58, 16, v221
  v_and_b32 v59, s69, v221
  v_lshlrev_b32 v60, 16, v222
  v_and_b32 v61, s69, v222
  v_lshlrev_b32 v62, 16, v223
  v_and_b32 v63, s69, v223
  v_pk_add_f32 v[128:129], v[128:129], v[32:33]
  v_pk_add_f32 v[130:131], v[130:131], v[34:35]
  v_pk_add_f32 v[132:133], v[132:133], v[36:37]
  v_pk_add_f32 v[134:135], v[134:135], v[38:39]
  v_pk_add_f32 v[136:137], v[136:137], v[40:41]
  v_pk_add_f32 v[138:139], v[138:139], v[42:43]
  v_pk_add_f32 v[140:141], v[140:141], v[44:45]
  v_pk_add_f32 v[142:143], v[142:143], v[46:47]
  v_pk_add_f32 v[144:145], v[144:145], v[48:49]
  v_pk_add_f32 v[146:147], v[146:147], v[50:51]
  v_pk_add_f32 v[148:149], v[148:149], v[52:53]
  v_pk_add_f32 v[150:151], v[150:151], v[54:55]
  s_waitcnt vmcnt(1)
  v_readfirstlane_b32 s62, v125
  s_and_b32 s62, s62, 0x20200
  s_cmp_lg_u32 s62, 0x20200
  s_cbranch_scc1 L_spin3
L_spin3_ret:
  s_mov_b32 s58, 0x14000
  buffer_load_dwordx4 v[192:195], v18, s[64:67], s58 offen offset:0 sc1
  buffer_load_dwordx4 v[196:199], v18, s[64:67], s58 offen offset:1024 sc1
  buffer_load_dwordx4 v[200:203], v18, s[64:67], s58 offen offset:2048 sc1
  buffer_load_dwordx4 v[204:207], v18, s[64:67], s58 offen offset:3072 sc1
  s_mov_b32 s58, 0x18000
  buffer_load_dwordx4 v[224:227], v19, s[64:67], s58 offen offset:0 sc1
  buffer_load_dwordx4 v[228:231], v19, s[64:67], s58 offen offset:1024 sc1
  buffer_load_dwordx4 v[232:235], v19, s[64:67], s58 offen offset:2048 sc1
  buffer_load_dwordx4 v[236:239], v19, s[64:67], s58 offen offset:3072 sc1
  v_pk_add_f32 v[152:153], v[152:153], v[56:57]
  v_pk_add_f32 v[154:155], v[154:155], v[58:59]
  v_pk_add_f32 v[156:157], v[156:157], v[60:61]
  v_pk_add_f32 v[158:159], v[158:159], v[62:63]
  v_lshlrev_b32 v32, 16, v240
  v_and_b32 v33, s69, v240
  v_lshlrev_b32 v34, 16, v241
  v_and_b32 v35, s69, v241
  v_lshlrev_b32 v36, 16, v242
  v_and_b32 v37, s69, v242
  v_lshlrev_b32 v38, 16, v243
  v_and_b32 v39, s69, v243
  v_lshlrev_b32 v40, 16, v244
  v_and_b32 v41, s69, v244
  v_lshlrev_b32 v42, 16, v245
  v_and_b32 v43, s69, v245
  v_lshlrev_b32 v44, 16, v246
  v_and_b32 v45, s69, v246
  v_lshlrev_b32 v46, 16, v247
  v_and_b32 v47, s69, v247
  v_lshlrev_b32 v48, 16, v248
  v_and_b32 v49, s69, v248
  v_lshlrev_b32 v50, 16, v249
  v_and_b32 v51, s69, v249
  v_lshlrev_b32 v52, 16, v250
  v_and_b32 v53, s69, v250
  v_lshlrev_b32 v54, 16, v251
  v_and_b32 v55, s69, v251
  v_lshlrev_b32 v56, 16, v252
  v_and_b32 v57, s69, v252
  v_lshlrev_b32 v58, 16, v253
  v_and_b32 v59, s69, v253
  v_lshlrev_b32 v60, 16, v254
  v_and_b32 v61, s69, v254
  v_lshlrev_b32 v62, 16, v255
  v_and_b32 v63, s69, v255
  v_pk_add_f32 v[128:129], v[128:129], v[32:33]
  v_pk_add_f32 v[130:131], v[130:131], v[34:35]
  v_pk_add_f32 v[132:133], v[132:133], v[36:37]
  v_pk_add_f32 v[134:135], v[134:135], v[38:39]
  v_pk_add_f32 v[136:137], v[136:137], v[40:41]
  v_pk_add_f32 v[138:139], v[138:139], v[42:43]
  v_pk_add_f32 v[140:141], v[140:141], v[44:45]
  v_pk_add_f32 v[142:143], v[142:143], v[46:47]
  v_pk_add_f32 v[144:145], v[144:145], v[48:49]
  v_pk_add_f32 v[146:147], v[146:147], v[50:51]
  v_pk_add_f32 v[148:149], v[148:149], v[52:53]
  v_pk_add_f32 v[150:151], v[150:151], v[54:55]
  v_pk_add_f32 v[152:153], v[152:153], v[56:57]
  v_pk_add_f32 v[154:155], v[154:155], v[58:59]
  v_pk_add_f32 v[156:157], v[156:157], v[60:61]
  v_pk_add_f32 v[158:159], v[158:159], v[62:63]
  v_pk_mul_f32 v[112:113], v[128:129], s[16:17]
  v_pk_mul_f32 v[114:115], v[130:131], s[16:17]
  v_exp_f32 v112, v112
  v_exp_f32 v113, v113
  v_exp_f32 v114, v114
  v_exp_f32 v115, v115
  v_add_f32 v112, 1.0, v112
  v_add_f32 v113, 1.0, v113
  v_add_f32 v114, 1.0, v114
  v_add_f32 v115, 1.0, v115
  v_rcp_f32 v112, v112
  v_rcp_f32 v113, v113
  v_rcp_f32 v114, v114
  v_rcp_f32 v115, v115
  s_nop 0
  v_pk_mul_f32 v[128:129], v[128:129], v[112:113]
  v_pk_mul_f32 v[130:131], v[130:131], v[114:115]
  v_pk_mul_f32 v[116:117], v[132:133], s[16:17]
  v_pk_mul_f32 v[118:119], v[134:135], s[16:17]
  v_exp_f32 v116, v116
  v_exp_f32 v117, v117
  v_exp_f32 v118, v118
  v_exp_f32 v119, v119
  v_add_f32 v116, 1.0, v116
  v_add_f32 v117, 1.0, v117
  v_add_f32 v118, 1.0, v118
  v_add_f32 v119, 1.0, v119
  v_rcp_f32 v116, v116
  v_rcp_f32 v117, v117
  v_rcp_f32 v118, v118
  v_rcp_f32 v119, v119
  s_nop 0
  v_pk_mul_f32 v[132:133], v[132:133], v[116:117]
  v_pk_mul_f32 v[134:135], v[134:135], v[118:119]
  v_pk_mul_f32 v[112:113], v[136:137], s[16:17]
  v_pk_mul_f32 v[114:115], v[138:139], s[16:17]
  v_exp_f32 v112, v112
  v_exp_f32 v113, v113
  v_exp_f32 v114, v114
  v_exp_f32 v115, v115
  v_add_f32 v112, 1.0, v112
  v_add_f32 v113, 1.0, v113
  v_add_f32 v114, 1.0, v114
  v_add_f32 v115, 1.0, v115
  v_rcp_f32 v112, v112
  v_rcp_f32 v113, v113
  v_rcp_f32 v114, v114
  v_rcp_f32 v115, v115
  buffer_load_dword v125, v22, s[64:67], 0 offen sc1
  s_nop 0
  v_pk_mul_f32 v[136:137], v[136:137], v[112:113]
  v_pk_mul_f32 v[138:139], v[138:139], v[114:115]
  v_pk_mul_f32 v[116:117], v[140:141], s[16:17]
  v_pk_mul_f32 v[118:119], v[142:143], s[16:17]
  v_exp_f32 v116, v116
  v_exp_f32 v117, v117
  v_exp_f32 v118, v118
  v_exp_f32 v119, v119
  v_add_f32 v116, 1.0, v116
  v_add_f32 v117, 1.0, v117
  v_add_f32 v118, 1.0, v118
  v_add_f32 v119, 1.0, v119
  v_rcp_f32 v116, v116
  v_rcp_f32 v117, v117
  v_rcp_f32 v118, v118
  v_rcp_f32 v119, v119
  s_nop 0
  v_pk_mul_f32 v[140:141], v[140:141], v[116:117]
  v_pk_mul_f32 v[142:143], v[142:143], v[118:119]
  v_pk_mul_f32 v[112:113], v[144:145], s[16:17]
  v_pk_mul_f32 v[114:115], v[146:147], s[16:17]
  v_exp_f32 v112, v112
  v_exp_f32 v113, v113
  v_exp_f32 v114, v114
  v_exp_f32 v115, v115
  v_add_f32 v112, 1.0, v112
  v_add_f32 v113, 1.0, v113
  v_add_f32 v114, 1.0, v114
  v_add_f32 v115, 1.0, v115
  v_rcp_f32 v112, v112
  v_rcp_f32 v113, v113
  v_rcp_f32 v114, v114
  v_rcp_f32 v115, v115
  s_nop 0
  v_pk_mul_f32 v[144:145], v[144:145], v[112:113]
  v_pk_mul_f32 v[146:147], v[146:147], v[114:115]
  v_pk_mul_f32 v[116:117], v[148:149], s[16:17]
  v_pk_mul_f32 v[118:119], v[150:151], s[16:17]
  v_exp_f32 v116, v116
  v_exp_f32 v117, v117
  v_exp_f32 v118, v118
  v_exp_f32 v119, v119
  v_add_f32 v116, 1.0, v116
  v_add_f32 v117, 1.0, v117
  v_add_f32 v118, 1.0, v118
  v_add_f32 v119, 1.0, v119
  v_rcp_f32 v116, v116
  v_rcp_f32 v117, v117
  v_rcp_f32 v118, v118
  v_rcp_f32 v119, v119
  s_nop 0
  v_pk_mul_f32 v[148:149], v[148:149], v[116:117]
  v_pk_mul_f32 v[150:151], v[150:151], v[118:119]
  v_pk_mul_f32 v[112:113], v[152:153], s[16:17]
  v_pk_mul_f32 v[114:115], v[154:155], s[16:17]
  v_exp_f32 v112, v112
  v_exp_f32 v113, v113
  v_exp_f32 v114, v114
  v_exp_f32 v115, v115
  v_add_f32 v112, 1.0, v112
  v_add_f32 v113, 1.0, v113
  v_add_f32 v114, 1.0, v114
  v_add_f32 v115, 1.0, v115
  v_rcp_f32 v112, v112
  v_rcp_f32 v113, v113
  v_rcp_f32 v114, v114
  v_rcp_f32 v115, v115
  s_nop 0
  v_pk_mul_f32 v[152:153], v[152:153], v[112:113]
  v_pk_mul_f32 v[154:155], v[154:155], v[114:115]
  v_pk_mul_f32 v[116:117], v[156:157], s[16:17]
  v_pk_mul_f32 v[118:119], v[158:159], s[16:17]
  v_exp_f32 v116, v116
  v_exp_f32 v117, v117
  v_exp_f32 v118, v118
  v_exp_f32 v119, v119
  v_add_f32 v116, 1.0, v116
  v_add_f32 v117, 1.0, v117
  v_add_f32 v118, 1.0, v118
  v_add_f32 v119, 1.0, v119
  v_rcp_f32 v116, v116
  v_rcp_f32 v117, v117
  v_rcp_f32 v118, v118
  v_rcp_f32 v119, v119
  s_nop 0
  v_pk_mul_f32 v[156:157], v[156:157], v[116:117]
  v_pk_mul_f32 v[158:159], v[158:159], v[118:119]
  s_waitcnt lgkmcnt(0)
  s_mov_b64 exec, s[56:57]
  v_swap_b32 v96, v98
  v_swap_b32 v97, v99
  v_swap_b32 v100, v102
  v_swap_b32 v101, v103
  v_swap_b32 v104, v106
  v_swap_b32 v105, v107
  v_swap_b32 v108, v110
  v_swap_b32 v109, v111
  s_mov_b64 exec, -1
  v_lshlrev_b32 v160, 16, v96
  v_and_b32 v161, s69, v96
  v_lshlrev_b32 v162, 16, v97
  v_and_b32 v163, s69, v97
  v_lshlrev_b32 v176, 16, v98
  v_and_b32 v177, s69, v98
  v_lshlrev_b32 v178, 16, v99
  v_and_b32 v179, s69, v99
  v_lshlrev_b32 v164, 16, v100
  v_and_b32 v165, s69, v100
  v_lshlrev_b32 v166, 16, v101
  v_and_b32 v167, s69, v101
  v_lshlrev_b32 v180, 16, v102
  v_and_b32 v181, s69, v102
  v_lshlrev_b32 v182, 16, v103
  v_and_b32 v183, s69, v103
  v_lshlrev_b32 v168, 16, v104
  v_and_b32 v169, s69, v104
  v_lshlrev_b32 v170, 16, v105
  v_and_b32 v171, s69, v105
  v_lshlrev_b32 v184, 16, v106
  v_and_b32 v185, s69, v106
  v_lshlrev_b32 v186, 16, v107
  v_and_b32 v187, s69, v107
  v_lshlrev_b32 v172, 16, v108
  v_and_b32 v173, s69, v108
  v_lshlrev_b32 v174, 16, v109
  v_and_b32 v175, s69, v109
  v_lshlrev_b32 v188, 16, v110
  v_and_b32 v189, s69, v110
  v_lshlrev_b32 v190, 16, v111
  v_and_b32 v191, s69, v111
  s_waitcnt vmcnt(0)
  v_readfirstlane_b32 s62, v125
  s_and_b32 s62, s62, 0x2000000
  s_cmp_lg_u32 s62, 0x2000000
  s_cbranch_scc1 L_spin4
L_spin4_ret:
  s_mov_b32 s58, 0x1c000
  buffer_load_dwordx4 v[208:211], v20, s[64:67], s58 offen offset:0 sc1
  buffer_load_dwordx4 v[212:215], v20, s[64:67], s58 offen offset:1024 sc1
  buffer_load_dwordx4 v[216:219], v20, s[64:67], s58 offen offset:2048 sc1
  buffer_load_dwordx4 v[220:223], v20, s[64:67], s58 offen offset:3072 sc1
  v_accvgpr_read_b32 v64, a0
  v_accvgpr_read_b32 v65, a1
  v_accvgpr_read_b32 v66, a2
  v_accvgpr_read_b32 v67, a3
  v_accvgpr_read_b32 v68, a4
  v_accvgpr_read_b32 v69, a5
  v_accvgpr_read_b32 v70, a6
  v_accvgpr_read_b32 v71, a7
  v_accvgpr_read_b32 v72, a8
  v_accvgpr_read_b32 v73, a9
  v_accvgpr_read_b32 v74, a10
  v_accvgpr_read_b32 v75, a11
  v_accvgpr_read_b32 v76, a12
  v_accvgpr_read_b32 v77, a13
  v_accvgpr_read_b32 v78, a14
  v_accvgpr_read_b32 v79, a15
  v_accvgpr_read_b32 v80, a16
  v_accvgpr_read_b32 v81, a17
  v_accvgpr_read_b32 v82, a18
  v_accvgpr_read_b32 v83, a19
  v_accvgpr_read_b32 v84, a20
  v_accvgpr_read_b32 v85, a21
  v_accvgpr_read_b32 v86, a22
  v_accvgpr_read_b32 v87, a23
  v_accvgpr_read_b32 v88, a24
  v_accvgpr_read_b32 v89, a25
  v_accvgpr_read_b32 v90, a26
  v_accvgpr_read_b32 v91, a27
  v_accvgpr_read_b32 v92, a28
  v_accvgpr_read_b32 v93, a29
  v_accvgpr_read_b32 v94, a30
  v_accvgpr_read_b32 v95, a31
  v_lshlrev_b32 v32, 16, v192
  v_and_b32 v33, s69, v192
  v_lshlrev_b32 v34, 16, v193
  v_and_b32 v35, s69, v193
  v_lshlrev_b32 v36, 16, v194
  v_and_b32 v37, s69, v194
  v_lshlrev_b32 v38, 16, v195
  v_and_b32 v39, s69, v195
  v_lshlrev_b32 v40, 16, v196
  v_and_b32 v41, s69, v196
  v_lshlrev_b32 v42, 16, v197
  v_and_b32 v43, s69, v197
  v_lshlrev_b32 v44, 16, v198
  v_and_b32 v45, s69, v198
  v_lshlrev_b32 v46, 16, v199
  v_and_b32 v47, s69, v199
  v_lshlrev_b32 v48, 16, v200
  v_and_b32 v49, s69, v200
  v_lshlrev_b32 v50, 16, v201
  v_and_b32 v51, s69, v201
  v_lshlrev_b32 v52, 16, v202
  v_and_b32 v53, s69, v202
  v_lshlrev_b32 v54, 16, v203
  v_and_b32 v55, s69, v203
  v_lshlrev_b32 v56, 16, v204
  v_and_b32 v57, s69, v204
  v_lshlrev_b32 v58, 16, v205
  v_and_b32 v59, s69, v205
  v_lshlrev_b32 v60, 16, v206
  v_and_b32 v61, s69, v206
  v_lshlrev_b32 v62, 16, v207
  v_and_b32 v63, s69, v207
  v_pk_add_f32 v[64:65], v[64:65], v[32:33]
  v_pk_add_f32 v[66:67], v[66:67], v[34:35]
  v_pk_add_f32 v[68:69], v[68:69], v[36:37]
  v_pk_add_f32 v[70:71], v[70:71], v[38:39]
  v_pk_add_f32 v[72:73], v[72:73], v[40:41]
  v_pk_add_f32 v[74:75], v[74:75], v[42:43]
  v_pk_add_f32 v[76:77], v[76:77], v[44:45]
  v_pk_add_f32 v[78:79], v[78:79], v[46:47]
  v_pk_add_f32 v[80:81], v[80:81], v[48:49]
  v_pk_add_f32 v[82:83], v[82:83], v[50:51]
  v_pk_add_f32 v[84:85], v[84:85], v[52:53]
  v_pk_add_f32 v[86:87], v[86:87], v[54:55]
  v_pk_add_f32 v[88:89], v[88:89], v[56:57]
  v_pk_add_f32 v[90:91], v[90:91], v[58:59]
  v_pk_add_f32 v[92:93], v[92:93], v[60:61]
  v_pk_add_f32 v[94:95], v[94:95], v[62:63]
  v_lshlrev_b32 v32, 16, v224
  v_and_b32 v33, s69, v224
  v_lshlrev_b32 v34, 16, v225
  v_and_b32 v35, s69, v225
  v_lshlrev_b32 v36, 16, v226
  v_and_b32 v37, s69, v226
  v_lshlrev_b32 v38, 16, v227
  v_and_b32 v39, s69, v227
  v_lshlrev_b32 v40, 16, v228
  v_and_b32 v41, s69, v228
  v_lshlrev_b32 v42, 16, v229
  v_and_b32 v43, s69, v229
  v_lshlrev_b32 v44, 16, v230
  v_and_b32 v45, s69, v230
  v_lshlrev_b32 v46, 16, v231
  v_and_b32 v47, s69, v231
  v_lshlrev_b32 v48, 16, v232
  v_and_b32 v49, s69, v232
  v_lshlrev_b32 v50, 16, v233
  v_and_b32 v51, s69, v233
  v_lshlrev_b32 v52, 16, v234
  v_and_b32 v53, s69, v234
  v_lshlrev_b32 v54, 16, v235
  v_and_b32 v55, s69, v235
  v_lshlrev_b32 v56, 16, v236
  v_and_b32 v57, s69, v236
  v_lshlrev_b32 v58, 16, v237
  v_and_b32 v59, s69, v237
  v_lshlrev_b32 v60, 16, v238
  v_and_b32 v61, s69, v238
  v_lshlrev_b32 v62, 16, v239
  v_and_b32 v63, s69, v239
  v_pk_add_f32 v[64:65], v[64:65], v[32:33]
  v_pk_add_f32 v[66:67], v[66:67], v[34:35]
  v_pk_add_f32 v[68:69], v[68:69], v[36:37]
  v_pk_add_f32 v[70:71], v[70:71], v[38:39]
  v_pk_add_f32 v[72:73], v[72:73], v[40:41]
  v_pk_add_f32 v[74:75], v[74:75], v[42:43]
  v_pk_add_f32 v[76:77], v[76:77], v[44:45]
  v_pk_add_f32 v[78:79], v[78:79], v[46:47]
  v_pk_add_f32 v[80:81], v[80:81], v[48:49]
  v_pk_add_f32 v[82:83], v[82:83], v[50:51]
  v_pk_add_f32 v[84:85], v[84:85], v[52:53]
  v_pk_add_f32 v[86:87], v[86:87], v[54:55]
  v_pk_add_f32 v[88:89], v[88:89], v[56:57]
  v_pk_add_f32 v[90:91], v[90:91], v[58:59]
  v_pk_add_f32 v[92:93], v[92:93], v[60:61]
  v_pk_add_f32 v[94:95], v[94:95], v[62:63]
  s_waitcnt vmcnt(0)
  v_lshlrev_b32 v32, 16, v208
  v_and_b32 v33, s69, v208
  v_lshlrev_b32 v34, 16, v209
  v_and_b32 v35, s69, v209
  v_lshlrev_b32 v36, 16, v210
  v_and_b32 v37, s69, v210
  v_lshlrev_b32 v38, 16, v211
  v_and_b32 v39, s69, v211
  v_lshlrev_b32 v40, 16, v212
  v_and_b32 v41, s69, v212
  v_lshlrev_b32 v42, 16, v213
  v_and_b32 v43, s69, v213
  v_lshlrev_b32 v44, 16, v214
  v_and_b32 v45, s69, v214
  v_lshlrev_b32 v46, 16, v215
  v_and_b32 v47, s69, v215
  v_lshlrev_b32 v48, 16, v216
  v_and_b32 v49, s69, v216
  v_lshlrev_b32 v50, 16, v217
  v_and_b32 v51, s69, v217
  v_lshlrev_b32 v52, 16, v218
  v_and_b32 v53, s69, v218
  v_lshlrev_b32 v54, 16, v219
  v_and_b32 v55, s69, v219
  v_lshlrev_b32 v56, 16, v220
  v_and_b32 v57, s69, v220
  v_lshlrev_b32 v58, 16, v221
  v_and_b32 v59, s69, v221
  v_lshlrev_b32 v60, 16, v222
  v_and_b32 v61, s69, v222
  v_lshlrev_b32 v62, 16, v223
  v_and_b32 v63, s69, v223
  v_pk_add_f32 v[64:65], v[64:65], v[32:33]
  v_pk_add_f32 v[66:67], v[66:67], v[34:35]
  v_pk_add_f32 v[68:69], v[68:69], v[36:37]
  v_pk_add_f32 v[70:71], v[70:71], v[38:39]
  v_pk_add_f32 v[72:73], v[72:73], v[40:41]
  v_pk_add_f32 v[74:75], v[74:75], v[42:43]
  v_pk_add_f32 v[76:77], v[76:77], v[44:45]
  v_pk_add_f32 v[78:79], v[78:79], v[46:47]
  v_pk_add_f32 v[80:81], v[80:81], v[48:49]
  v_pk_add_f32 v[82:83], v[82:83], v[50:51]
  v_pk_add_f32 v[84:85], v[84:85], v[52:53]
  v_pk_add_f32 v[86:87], v[86:87], v[54:55]
  v_pk_add_f32 v[88:89], v[88:89], v[56:57]
  v_pk_add_f32 v[90:91], v[90:91], v[58:59]
  v_pk_add_f32 v[92:93], v[92:93], v[60:61]
  v_pk_add_f32 v[94:95], v[94:95], v[62:63]
  v_pk_fma_f32 v[160:161], v[64:65], v[128:129], v[160:161]
  v_pk_fma_f32 v[162:163], v[66:67], v[130:131], v[162:163]
  v_pk_fma_f32 v[176:177], v[80:81], v[144:145], v[176:177]
  v_pk_fma_f32 v[178:179], v[82:83], v[146:147], v[178:179]
  v_cvt_pk_bf16_f32 v96, v160, v161
  v_cvt_pk_bf16_f32 v97, v162, v163
  v_cvt_pk_bf16_f32 v98, v176, v177
  v_cvt_pk_bf16_f32 v99, v178, v179
  s_mov_b64 exec, s[56:57]
  v_swap_b32 v96, v98
  v_swap_b32 v97, v99
  s_mov_b64 exec, -1
  ds_write_b128 v24, v[96:99] offset:0
  ds_read_b128 v[112:115], v31 offset:0
  v_pk_fma_f32 v[164:165], v[68:69], v[132:133], v[164:165]
  v_pk_fma_f32 v[166:167], v[70:71], v[134:135], v[166:167]
  v_pk_fma_f32 v[180:181], v[84:85], v[148:149], v[180:181]
  v_pk_fma_f32 v[182:183], v[86:87], v[150:151], v[182:183]
  v_cvt_pk_bf16_f32 v100, v164, v165
  v_cvt_pk_bf16_f32 v101, v166, v167
  v_cvt_pk_bf16_f32 v102, v180, v181
  v_cvt_pk_bf16_f32 v103, v182, v183
  s_mov_b64 exec, s[56:57]
  v_swap_b32 v100, v102
  v_swap_b32 v101, v103
  s_mov_b64 exec, -1
  ds_write_b128 v24, v[100:103] offset:1024
  ds_read_b128 v[116:119], v31 offset:1024
  v_pk_fma_f32 v[168:169], v[72:73], v[136:137], v[168:169]
  v_pk_fma_f32 v[170:171], v[74:75], v[138:139], v[170:171]
  v_pk_fma_f32 v[184:185], v[88:89], v[152:153], v[184:185]
  v_pk_fma_f32 v[186:187], v[90:91], v[154:155], v[186:187]
  v_cvt_pk_bf16_f32 v104, v168, v169
  v_cvt_pk_bf16_f32 v105, v170, v171
  v_cvt_pk_bf16_f32 v106, v184, v185
  v_cvt_pk_bf16_f32 v107, v186, v187
  s_mov_b64 exec, s[56:57]
  v_swap_b32 v104, v106
  v_swap_b32 v105, v107
  s_mov_b64 exec, -1
  ds_write_b128 v24, v[104:107] offset:2048
  ds_read_b128 v[120:123], v31 offset:2048
  v_pk_fma_f32 v[172:173], v[76:77], v[140:141], v[172:173]
  v_pk_fma_f32 v[174:175], v[78:79], v[142:143], v[174:175]
  v_pk_fma_f32 v[188:189], v[92:93], v[156:157], v[188:189]
  v_pk_fma_f32 v[190:191], v[94:95], v[158:159], v[190:191]
  v_cvt_pk_bf16_f32 v108, v172, v173
  v_cvt_pk_bf16_f32 v109, v174, v175
  v_cvt_pk_bf16_f32 v110, v188, v189
  v_cvt_pk_bf16_f32 v111, v190, v191
  s_mov_b64 exec, s[56:57]
  v_swap_b32 v108, v110
  v_swap_b32 v109, v111
  s_mov_b64 exec, -1
  ds_write_b128 v24, v[108:111] offset:3072
  ds_read_b128 v[124:127], v31 offset:3072
  s_waitcnt lgkmcnt(6)
  buffer_store_dwordx4 v[112:115], v21, s[96:99], s52 offen
  s_waitcnt lgkmcnt(4)
  buffer_store_dwordx4 v[116:119], v21, s[96:99], s53 offen
  s_waitcnt lgkmcnt(2)
  buffer_store_dwordx4 v[120:123], v21, s[96:99], s54 offen
  s_waitcnt lgkmcnt(0)
  buffer_store_dwordx4 v[124:127], v21, s[96:99], s55 offen
L_end:
  s_endpgm
L_spin0:
  s_mov_b32 s70, 0x40000
L_spin0_l:
  buffer_load_ubyte v125, v28, s[64:67], 0 offen sc1
  s_waitcnt vmcnt(0)
  s_sub_u32 s70, s70, 1
  s_cbranch_scc1 L_spin0_ret
  v_cmp_gt_u32 vcc, 2, v125
  s_and_b32 s62, vcc_lo, -1
  s_cbranch_scc0 L_spin0_ret
  s_sleep 1
  s_branch L_spin0_l
L_spin1:
  s_mov_b32 s70, 0x40000
L_spin1_l:
  buffer_load_ubyte v125, v28, s[64:67], 0 offen sc1
  s_waitcnt vmcnt(0)
  s_sub_u32 s70, s70, 1
  s_cbranch_scc1 L_spin1_ret
  v_cmp_gt_u32 vcc, 3, v125
  s_and_b32 s62, vcc_lo, -1
  s_cbranch_scc0 L_spin1_ret
  s_sleep 1
  s_branch L_spin1_l
L_spin2:
  s_mov_b32 s70, 0x40000
L_spin2_l:
  buffer_load_dword v125, v22, s[64:67], 0 offen sc1
  s_waitcnt vmcnt(0)
  s_sub_u32 s70, s70, 1
  s_cbranch_scc1 L_spin2_ret
  v_readfirstlane_b32 s62, v125
  s_and_b32 s62, s62, 0x1010100
  s_cmp_lg_u32 s62, 0x1010100
  s_cbranch_scc0 L_spin2_ret
  s_sleep 1
  s_branch L_spin2_l
L_spin3:
  s_mov_b32 s70, 0x40000
L_spin3_l:
  buffer_load_dword v125, v22, s[64:67], 0 offen sc1
  s_waitcnt vmcnt(0)
  s_sub_u32 s70, s70, 1
  s_cbranch_scc1 L_spin3_ret
  v_readfirstlane_b32 s62, v125
  s_and_b32 s62, s62, 0x20200
  s_cmp_lg_u32 s62, 0x20200
  s_cbranch_scc0 L_spin3_ret
  s_sleep 1
  s_branch L_spin3_l
L_spin4:
  s_mov_b32 s70, 0x40000
L_spin4_l:
  buffer_load_dword v125, v22, s[64:67], 0 offen sc1
  s_waitcnt vmcnt(0)
  s_sub_u32 s70, s70, 1
  s_cbranch_scc1 L_spin4_ret
  v_readfirstlane_b32 s62, v125
  s_and_b32 s62, s62, 0x2000000
  s_cmp_lg_u32 s62, 0x2000000
  s_cbranch_scc0 L_spin4_ret
  s_sleep 1
  s_branch L_spin4_l
L_fallback:
  s_waitcnt vmcnt(0) lgkmcnt(0)
  s_nop 7
  s_add_u32 s88, s5, 0x18000
  s_and_b32 s62, s33, 1
  s_lshl_b32 s62, s62, 13
  s_lshr_b32 s63, s33, 1
  s_lshl_b32 s63, s63, 7
  s_add_u32 s62, s62, s63
  v_subrev_u32 v17, s5, v17
  v_subrev_u32 v21, s62, v21
  v_subrev_u32 v18, s5, v18
  v_subrev_u32 v22, s62, v22
  v_subrev_u32 v19, s5, v19
  v_subrev_u32 v23, s62, v23
  v_subrev_u32 v20, s5, v20
  v_subrev_u32 v24, s62, v24
  s_sub_u32 s62, s88, 0x10000
  v_add_u32 v11, s62, v11
  v_add_u32 v12, s62, v12
  v_add_u32 v13, s62, v13
  v_add_u32 v14, s62, v14
  s_sub_u32 s62, s88, 0x14000
  v_add_u32 v116, s62, v15
  v_add_u32 v117, s62, v16
  v_mov_b32 v120, 0xff800000
  v_mov_b32 v121, 0xff800000
  v_mov_b32 v122, 0xff800000
  v_mov_b32 v123, 0xff800000
  s_mov_b32 s55, 0
L_fb1:
  s_add_u32 m0, s88, 0
  s_add_u32 s89, s55, 0
  buffer_load_dwordx4 v17, s[28:31], s89 offen offset:0 lds
  buffer_load_dwordx4 v18, s[28:31], s89 offen offset:1024 lds
  buffer_load_dwordx4 v19, s[28:31], s89 offen offset:2048 lds
  buffer_load_dwordx4 v20, s[28:31], s89 offen offset:3072 lds
  s_add_u32 m0, s88, 16384
  s_add_u32 s89, s55, 4096
  buffer_load_dwordx4 v17, s[28:31], s89 offen offset:0 lds
  buffer_load_dwordx4 v18, s[28:31], s89 offen offset:1024 lds
  buffer_load_dwordx4 v19, s[28:31], s89 offen offset:2048 lds
  buffer_load_dwordx4 v20, s[28:31], s89 offen offset:3072 lds
  s_waitcnt vmcnt(0)
  ds_read_b128 v[64:67], v11 offset:0
  ds_read_b128 v[68:71], v12 offset:0
  ds_read_b128 v[72:75], v13 offset:0
  ds_read_b128 v[76:79], v14 offset:0
  ds_read_b128 v[80:83], v11 offset:16384
  ds_read_b128 v[84:87], v12 offset:16384
  ds_read_b128 v[88:91], v13 offset:16384
  ds_read_b128 v[92:95], v14 offset:16384
  s_waitcnt lgkmcnt(0)
  v_mfma_f32_16x16x32_bf16 v[208:211], v[64:67], v[128:131], 0
  v_mfma_f32_16x16x32_bf16 v[208:211], v[68:71], v[160:163], v[208:211]
  v_mfma_f32_16x16x32_bf16 v[208:211], v[72:75], v[192:195], v[208:211]
  v_mfma_f32_16x16x32_bf16 v[208:211], v[76:79], v[224:227], v[208:211]
  v_mfma_f32_16x16x32_bf16 v[240:243], v[80:83], v[128:131], 0
  v_mfma_f32_16x16x32_bf16 v[240:243], v[84:87], v[160:163], v[240:243]
  v_mfma_f32_16x16x32_bf16 v[240:243], v[88:91], v[192:195], v[240:243]
  v_mfma_f32_16x16x32_bf16 v[240:243], v[92:95], v[224:227], v[240:243]
  v_mfma_f32_16x16x32_bf16 v[212:215], v[64:67], v[132:135], 0
  v_mfma_f32_16x16x32_bf16 v[212:215], v[68:71], v[164:167], v[212:215]
  v_mfma_f32_16x16x32_bf16 v[212:215], v[72:75], v[196:199], v[212:215]
  v_mfma_f32_16x16x32_bf16 v[212:215], v[76:79], v[228:231], v[212:215]
  v_mfma_f32_16x16x32_bf16 v[244:247], v[80:83], v[132:135], 0
  v_mfma_f32_16x16x32_bf16 v[244:247], v[84:87], v[164:167], v[244:247]
  v_mfma_f32_16x16x32_bf16 v[244:247], v[88:91], v[196:199], v[244:247]
  v_mfma_f32_16x16x32_bf16 v[244:247], v[92:95], v[228:231], v[244:247]
  v_mfma_f32_16x16x32_bf16 v[216:219], v[64:67], v[136:139], 0
  v_mfma_f32_16x16x32_bf16 v[216:219], v[68:71], v[168:171], v[216:219]
  v_mfma_f32_16x16x32_bf16 v[216:219], v[72:75], v[200:203], v[216:219]
  v_mfma_f32_16x16x32_bf16 v[216:219], v[76:79], v[232:235], v[216:219]
  v_mfma_f32_16x16x32_bf16 v[248:251], v[80:83], v[136:139], 0
  v_mfma_f32_16x16x32_bf16 v[248:251], v[84:87], v[168:171], v[248:251]
  v_mfma_f32_16x16x32_bf16 v[248:251], v[88:91], v[200:203], v[248:251]
  v_mfma_f32_16x16x32_bf16 v[248:251], v[92:95], v[232:235], v[248:251]
  v_mfma_f32_16x16x32_bf16 v[220:223], v[64:67], v[140:143], 0
  v_mfma_f32_16x16x32_bf16 v[220:223], v[68:71], v[172:175], v[220:223]
  v_mfma_f32_16x16x32_bf16 v[220:223], v[72:75], v[204:207], v[220:223]
  v_mfma_f32_16x16x32_bf16 v[220:223], v[76:79], v[236:239], v[220:223]
  v_mfma_f32_16x16x32_bf16 v[252:255], v[80:83], v[140:143], 0
  v_mfma_f32_16x16x32_bf16 v[252:255], v[84:87], v[172:175], v[252:255]
  v_mfma_f32_16x16x32_bf16 v[252:255], v[88:91], v[204:207], v[252:255]
  v_mfma_f32_16x16x32_bf16 v[252:255], v[92:95], v[236:239], v[252:255]
  s_nop 7
  v_max3_f32 v118, v208, v209, v210
  v_max3_f32 v119, v211, v240, v241
  v_max3_f32 v118, v118, v242, v243
  v_max_f32 v118, v118, v119
  v_max_f32 v120, v120, v118
  v_max3_f32 v118, v212, v213, v214
  v_max3_f32 v119, v215, v244, v245
  v_max3_f32 v118, v118, v246, v247
  v_max_f32 v118, v118, v119
  v_max_f32 v121, v121, v118
  v_max3_f32 v118, v216, v217, v218
  v_max3_f32 v119, v219, v248, v249
  v_max3_f32 v118, v118, v250, v251
  v_max_f32 v118, v118, v119
  v_max_f32 v122, v122, v118
  v_max3_f32 v118, v220, v221, v222
  v_max3_f32 v119, v223, v252, v253
  v_max3_f32 v118, v118, v254, v255
  v_max_f32 v118, v118, v119
  v_max_f32 v123, v123, v118
  s_add_u32 s55, s55, 0x2000
  s_cmp_lt_u32 s55, 0x20000
  s_cbranch_scc1 L_fb1
  v_mov_b32 v118, v120
  s_nop 1
  v_permlane16_swap_b32 v120, v118
  v_max_f32 v120, v120, v118
  v_mov_b32 v118, v120
  s_nop 1
  v_permlane32_swap_b32 v120, v118
  v_max_f32 v120, v120, v118
  v_sub_f32 v96, 0, v120
  v_sub_f32 v97, 0, v120
  v_sub_f32 v98, 0, v120
  v_sub_f32 v99, 0, v120
  v_mov_b32 v118, v121
  s_nop 1
  v_permlane16_swap_b32 v121, v118
  v_max_f32 v121, v121, v118
  v_mov_b32 v118, v121
  s_nop 1
  v_permlane32_swap_b32 v121, v118
  v_max_f32 v121, v121, v118
  v_sub_f32 v100, 0, v121
  v_sub_f32 v101, 0, v121
  v_sub_f32 v102, 0, v121
  v_sub_f32 v103, 0, v121
  v_mov_b32 v118, v122
  s_nop 1
  v_permlane16_swap_b32 v122, v118
  v_max_f32 v122, v122, v118
  v_mov_b32 v118, v122
  s_nop 1
  v_permlane32_swap_b32 v122, v118
  v_max_f32 v122, v122, v118
  v_sub_f32 v104, 0, v122
  v_sub_f32 v105, 0, v122
  v_sub_f32 v106, 0, v122
  v_sub_f32 v107, 0, v122
  v_mov_b32 v118, v123
  s_nop 1
  v_permlane16_swap_b32 v123, v118
  v_max_f32 v123, v123, v118
  v_mov_b32 v118, v123
  s_nop 1
  v_permlane32_swap_b32 v123, v118
  v_max_f32 v123, v123, v118
  v_sub_f32 v108, 0, v123
  v_sub_f32 v109, 0, v123
  v_sub_f32 v110, 0, v123
  v_sub_f32 v111, 0, v123
  v_accvgpr_write_b32 a0, 0
  v_accvgpr_write_b32 a1, 0
  v_accvgpr_write_b32 a2, 0
  v_accvgpr_write_b32 a3, 0
  v_accvgpr_write_b32 a4, 0
  v_accvgpr_write_b32 a5, 0
  v_accvgpr_write_b32 a6, 0
  v_accvgpr_write_b32 a7, 0
  v_accvgpr_write_b32 a8, 0
  v_accvgpr_write_b32 a9, 0
  v_accvgpr_write_b32 a10, 0
  v_accvgpr_write_b32 a11, 0
  v_accvgpr_write_b32 a12, 0
  v_accvgpr_write_b32 a13, 0
  v_accvgpr_write_b32 a14, 0
  v_accvgpr_write_b32 a15, 0
  v_accvgpr_write_b32 a16, 0
  v_accvgpr_write_b32 a17, 0
  v_accvgpr_write_b32 a18, 0
  v_accvgpr_write_b32 a19, 0
  v_accvgpr_write_b32 a20, 0
  v_accvgpr_write_b32 a21, 0
  v_accvgpr_write_b32 a22, 0
  v_accvgpr_write_b32 a23, 0
  v_accvgpr_write_b32 a24, 0
  v_accvgpr_write_b32 a25, 0
  v_accvgpr_write_b32 a26, 0
  v_accvgpr_write_b32 a27, 0
  v_accvgpr_write_b32 a28, 0
  v_accvgpr_write_b32 a29, 0
  v_accvgpr_write_b32 a30, 0
  v_accvgpr_write_b32 a31, 0
  v_accvgpr_write_b32 a32, 0
  v_accvgpr_write_b32 a33, 0
  v_accvgpr_write_b32 a34, 0
  v_accvgpr_write_b32 a35, 0
  v_accvgpr_write_b32 a36, 0
  v_accvgpr_write_b32 a37, 0
  v_accvgpr_write_b32 a38, 0
  v_accvgpr_write_b32 a39, 0
  v_accvgpr_write_b32 a40, 0
  v_accvgpr_write_b32 a41, 0
  v_accvgpr_write_b32 a42, 0
  v_accvgpr_write_b32 a43, 0
  v_accvgpr_write_b32 a44, 0
  v_accvgpr_write_b32 a45, 0
  v_accvgpr_write_b32 a46, 0
  v_accvgpr_write_b32 a47, 0
  v_accvgpr_write_b32 a48, 0
  v_accvgpr_write_b32 a49, 0
  v_accvgpr_write_b32 a50, 0
  v_accvgpr_write_b32 a51, 0
  v_accvgpr_write_b32 a52, 0
  v_accvgpr_write_b32 a53, 0
  v_accvgpr_write_b32 a54, 0
  v_accvgpr_write_b32 a55, 0
  v_accvgpr_write_b32 a56, 0
  v_accvgpr_write_b32 a57, 0
  v_accvgpr_write_b32 a58, 0
  v_accvgpr_write_b32 a59, 0
  v_accvgpr_write_b32 a60, 0
  v_accvgpr_write_b32 a61, 0
  v_accvgpr_write_b32 a62, 0
  v_accvgpr_write_b32 a63, 0
  v_accvgpr_write_b32 a64, 0
  v_accvgpr_write_b32 a65, 0
  v_accvgpr_write_b32 a66, 0
  v_accvgpr_write_b32 a67, 0
  v_accvgpr_write_b32 a68, 0
  v_accvgpr_write_b32 a69, 0
  v_accvgpr_write_b32 a70, 0
  v_accvgpr_write_b32 a71, 0
  v_accvgpr_write_b32 a72, 0
  v_accvgpr_write_b32 a73, 0
  v_accvgpr_write_b32 a74, 0
  v_accvgpr_write_b32 a75, 0
  v_accvgpr_write_b32 a76, 0
  v_accvgpr_write_b32 a77, 0
  v_accvgpr_write_b32 a78, 0
  v_accvgpr_write_b32 a79, 0
  v_accvgpr_write_b32 a80, 0
  v_accvgpr_write_b32 a81, 0
  v_accvgpr_write_b32 a82, 0
  v_accvgpr_write_b32 a83, 0
  v_accvgpr_write_b32 a84, 0
  v_accvgpr_write_b32 a85, 0
  v_accvgpr_write_b32 a86, 0
  v_accvgpr_write_b32 a87, 0
  v_accvgpr_write_b32 a88, 0
  v_accvgpr_write_b32 a89, 0
  v_accvgpr_write_b32 a90, 0
  v_accvgpr_write_b32 a91, 0
  v_accvgpr_write_b32 a92, 0
  v_accvgpr_write_b32 a93, 0
  v_accvgpr_write_b32 a94, 0
  v_accvgpr_write_b32 a95, 0
  v_accvgpr_write_b32 a96, 0
  v_accvgpr_write_b32 a97, 0
  v_accvgpr_write_b32 a98, 0
  v_accvgpr_write_b32 a99, 0
  v_accvgpr_write_b32 a100, 0
  v_accvgpr_write_b32 a101, 0
  v_accvgpr_write_b32 a102, 0
  v_accvgpr_write_b32 a103, 0
  v_accvgpr_write_b32 a104, 0
  v_accvgpr_write_b32 a105, 0
  v_accvgpr_write_b32 a106, 0
  v_accvgpr_write_b32 a107, 0
  v_accvgpr_write_b32 a108, 0
  v_accvgpr_write_b32 a109, 0
  v_accvgpr_write_b32 a110, 0
  v_accvgpr_write_b32 a111, 0
  v_accvgpr_write_b32 a112, 0
  v_accvgpr_write_b32 a113, 0
  v_accvgpr_write_b32 a114, 0
  v_accvgpr_write_b32 a115, 0
  v_accvgpr_write_b32 a116, 0
  v_accvgpr_write_b32 a117, 0
  v_accvgpr_write_b32 a118, 0
  v_accvgpr_write_b32 a119, 0
  v_accvgpr_write_b32 a120, 0
  v_accvgpr_write_b32 a121, 0
  v_accvgpr_write_b32 a122, 0
  v_accvgpr_write_b32 a123, 0
  v_accvgpr_write_b32 a124, 0
  v_accvgpr_write_b32 a125, 0
  v_accvgpr_write_b32 a126, 0
  v_accvgpr_write_b32 a127, 0
  v_accvgpr_write_b32 a128, 0
  v_accvgpr_write_b32 a129, 0
  v_accvgpr_write_b32 a130, 0
  v_accvgpr_write_b32 a131, 0
  v_accvgpr_write_b32 a132, 0
  v_accvgpr_write_b32 a133, 0
  v_accvgpr_write_b32 a134, 0
  v_accvgpr_write_b32 a135, 0
  v_accvgpr_write_b32 a136, 0
  v_accvgpr_write_b32 a137, 0
  v_accvgpr_write_b32 a138, 0
  v_accvgpr_write_b32 a139, 0
  v_accvgpr_write_b32 a140, 0
  v_accvgpr_write_b32 a141, 0
  v_accvgpr_write_b32 a142, 0
  v_accvgpr_write_b32 a143, 0
  s_mov_b32 s55, 0
L_fb2:
  s_add_u32 m0, s88, 0
  s_add_u32 s89, s55, 0
  buffer_load_dwordx4 v17, s[28:31], s89 offen offset:0 lds
  buffer_load_dwordx4 v18, s[28:31], s89 offen offset:1024 lds
  buffer_load_dwordx4 v19, s[28:31], s89 offen offset:2048 lds
  buffer_load_dwordx4 v20, s[28:31], s89 offen offset:3072 lds
  s_add_u32 m0, s88, 16384
  s_add_u32 s89, s55, 4096
  buffer_load_dwordx4 v17, s[28:31], s89 offen offset:0 lds
  buffer_load_dwordx4 v18, s[28:31], s89 offen offset:1024 lds
  buffer_load_dwordx4 v19, s[28:31], s89 offen offset:2048 lds
  buffer_load_dwordx4 v20, s[28:31], s89 offen offset:3072 lds
  s_waitcnt vmcnt(0)
  ds_read_b128 v[64:67], v11 offset:0
  ds_read_b128 v[68:71], v12 offset:0
  ds_read_b128 v[72:75], v13 offset:0
  ds_read_b128 v[76:79], v14 offset:0
  ds_read_b128 v[80:83], v11 offset:16384
  ds_read_b128 v[84:87], v12 offset:16384
  ds_read_b128 v[88:91], v13 offset:16384
  ds_read_b128 v[92:95], v14 offset:16384
  s_waitcnt lgkmcnt(0)
  v_mfma_f32_16x16x32_bf16 v[208:211], v[64:67], v[128:131], v[96:99]
  v_mfma_f32_16x16x32_bf16 v[208:211], v[68:71], v[160:163], v[208:211]
  v_mfma_f32_16x16x32_bf16 v[208:211], v[72:75], v[192:195], v[208:211]
  v_mfma_f32_16x16x32_bf16 v[208:211], v[76:79], v[224:227], v[208:211]
  v_mfma_f32_16x16x32_bf16 v[240:243], v[80:83], v[128:131], v[96:99]
  v_mfma_f32_16x16x32_bf16 v[240:243], v[84:87], v[160:163], v[240:243]
  v_mfma_f32_16x16x32_bf16 v[240:243], v[88:91], v[192:195], v[240:243]
  v_mfma_f32_16x16x32_bf16 v[240:243], v[92:95], v[224:227], v[240:243]
  v_mfma_f32_16x16x32_bf16 v[212:215], v[64:67], v[132:135], v[100:103]
  v_mfma_f32_16x16x32_bf16 v[212:215], v[68:71], v[164:167], v[212:215]
  v_mfma_f32_16x16x32_bf16 v[212:215], v[72:75], v[196:199], v[212:215]
  v_mfma_f32_16x16x32_bf16 v[212:215], v[76:79], v[228:231], v[212:215]
  v_mfma_f32_16x16x32_bf16 v[244:247], v[80:83], v[132:135], v[100:103]
  v_mfma_f32_16x16x32_bf16 v[244:247], v[84:87], v[164:167], v[244:247]
  v_mfma_f32_16x16x32_bf16 v[244:247], v[88:91], v[196:199], v[244:247]
  v_mfma_f32_16x16x32_bf16 v[244:247], v[92:95], v[228:231], v[244:247]
  v_mfma_f32_16x16x32_bf16 v[216:219], v[64:67], v[136:139], v[104:107]
  v_mfma_f32_16x16x32_bf16 v[216:219], v[68:71], v[168:171], v[216:219]
  v_mfma_f32_16x16x32_bf16 v[216:219], v[72:75], v[200:203], v[216:219]
  v_mfma_f32_16x16x32_bf16 v[216:219], v[76:79], v[232:235], v[216:219]
  v_mfma_f32_16x16x32_bf16 v[248:251], v[80:83], v[136:139], v[104:107]
  v_mfma_f32_16x16x32_bf16 v[248:251], v[84:87], v[168:171], v[248:251]
  v_mfma_f32_16x16x32_bf16 v[248:251], v[88:91], v[200:203], v[248:251]
  v_mfma_f32_16x16x32_bf16 v[248:251], v[92:95], v[232:235], v[248:251]
  v_mfma_f32_16x16x32_bf16 v[220:223], v[64:67], v[140:143], v[108:111]
  v_mfma_f32_16x16x32_bf16 v[220:223], v[68:71], v[172:175], v[220:223]
  v_mfma_f32_16x16x32_bf16 v[220:223], v[72:75], v[204:207], v[220:223]
  v_mfma_f32_16x16x32_bf16 v[220:223], v[76:79], v[236:239], v[220:223]
  v_mfma_f32_16x16x32_bf16 v[252:255], v[80:83], v[140:143], v[108:111]
  v_mfma_f32_16x16x32_bf16 v[252:255], v[84:87], v[172:175], v[252:255]
  v_mfma_f32_16x16x32_bf16 v[252:255], v[88:91], v[204:207], v[252:255]
  v_mfma_f32_16x16x32_bf16 v[252:255], v[92:95], v[236:239], v[252:255]
  s_nop 7
  s_add_u32 m0, s88, 0
  s_add_u32 s89, s55, 0
  buffer_load_dwordx4 v21, s[36:39], s89 offen offset:0 lds
  buffer_load_dwordx4 v22, s[36:39], s89 offen offset:1024 lds
  buffer_load_dwordx4 v23, s[36:39], s89 offen offset:2048 lds
  buffer_load_dwordx4 v24, s[36:39], s89 offen offset:3072 lds
  s_add_u32 m0, s88, 16384
  s_add_u32 s89, s55, 128
  buffer_load_dwordx4 v21, s[36:39], s89 offen offset:0 lds
  buffer_load_dwordx4 v22, s[36:39], s89 offen offset:1024 lds
  buffer_load_dwordx4 v23, s[36:39], s89 offen offset:2048 lds
  buffer_load_dwordx4 v24, s[36:39], s89 offen offset:3072 lds
  s_waitcnt vmcnt(0)
  ds_read_b64_tr_b16 a[144:145], v116 offset:0
  ds_read_b64_tr_b16 a[146:147], v116 offset:2048
  ds_read_b64_tr_b16 a[148:149], v117 offset:0
  ds_read_b64_tr_b16 a[150:151], v117 offset:2048
  ds_read_b64_tr_b16 a[152:153], v116 offset:512
  ds_read_b64_tr_b16 a[154:155], v116 offset:2560
  ds_read_b64_tr_b16 a[156:157], v117 offset:512
  ds_read_b64_tr_b16 a[158:159], v117 offset:2560
  ds_read_b64_tr_b16 a[160:161], v116 offset:16384
  ds_read_b64_tr_b16 a[162:163], v116 offset:18432
  ds_read_b64_tr_b16 a[164:165], v117 offset:16384
  ds_read_b64_tr_b16 a[166:167], v117 offset:18432
  ds_read_b64_tr_b16 a[168:169], v116 offset:16896
  ds_read_b64_tr_b16 a[170:171], v116 offset:18944
  ds_read_b64_tr_b16 a[172:173], v117 offset:16896
  ds_read_b64_tr_b16 a[174:175], v117 offset:18944
  v_exp_f32 v208, v208
  v_exp_f32 v209, v209
  v_exp_f32 v210, v210
  v_exp_f32 v211, v211
  v_exp_f32 v240, v240
  v_exp_f32 v241, v241
  v_exp_f32 v242, v242
  v_exp_f32 v243, v243
  v_exp_f32 v212, v212
  v_exp_f32 v213, v213
  v_exp_f32 v214, v214
  v_exp_f32 v215, v215
  v_exp_f32 v244, v244
  v_exp_f32 v245, v245
  v_exp_f32 v246, v246
  v_exp_f32 v247, v247
  v_exp_f32 v216, v216
  v_exp_f32 v217, v217
  v_exp_f32 v218, v218
  v_exp_f32 v219, v219
  v_exp_f32 v248, v248
  v_exp_f32 v249, v249
  v_exp_f32 v250, v250
  v_exp_f32 v251, v251
  v_exp_f32 v220, v220
  v_exp_f32 v221, v221
  v_exp_f32 v222, v222
  v_exp_f32 v223, v223
  v_exp_f32 v252, v252
  v_exp_f32 v253, v253
  v_exp_f32 v254, v254
  v_exp_f32 v255, v255
  v_cvt_pk_bf16_f32 v208, v208, v209
  v_cvt_pk_bf16_f32 v209, v210, v211
  v_cvt_pk_bf16_f32 v210, v240, v241
  v_cvt_pk_bf16_f32 v211, v242, v243
  v_cvt_pk_bf16_f32 v212, v212, v213
  v_cvt_pk_bf16_f32 v213, v214, v215
  v_cvt_pk_bf16_f32 v214, v244, v245
  v_cvt_pk_bf16_f32 v215, v246, v247
  v_cvt_pk_bf16_f32 v216, v216, v217
  v_cvt_pk_bf16_f32 v217, v218, v219
  v_cvt_pk_bf16_f32 v218, v248, v249
  v_cvt_pk_bf16_f32 v219, v250, v251
  v_cvt_pk_bf16_f32 v220, v220, v221
  v_cvt_pk_bf16_f32 v221, v222, v223
  v_cvt_pk_bf16_f32 v222, v252, v253
  v_cvt_pk_bf16_f32 v223, v254, v255
  s_waitcnt lgkmcnt(0)
  v_mfma_f32_16x16x32_bf16 a[128:131], v[112:115], v[208:211], a[128:131]
  v_mfma_f32_16x16x32_bf16 a[132:135], v[112:115], v[212:215], a[132:135]
  v_mfma_f32_16x16x32_bf16 a[136:139], v[112:115], v[216:219], a[136:139]
  v_mfma_f32_16x16x32_bf16 a[140:143], v[112:115], v[220:223], a[140:143]
  v_mfma_f32_16x16x32_bf16 a[0:3], a[144:147], v[208:211], a[0:3]
  v_mfma_f32_16x16x32_bf16 a[4:7], a[144:147], v[212:215], a[4:7]
  v_mfma_f32_16x16x32_bf16 a[8:11], a[144:147], v[216:219], a[8:11]
  v_mfma_f32_16x16x32_bf16 a[12:15], a[144:147], v[220:223], a[12:15]
  v_mfma_f32_16x16x32_bf16 a[16:19], a[148:151], v[208:211], a[16:19]
  v_mfma_f32_16x16x32_bf16 a[20:23], a[148:151], v[212:215], a[20:23]
  v_mfma_f32_16x16x32_bf16 a[24:27], a[148:151], v[216:219], a[24:27]
  v_mfma_f32_16x16x32_bf16 a[28:31], a[148:151], v[220:223], a[28:31]
  s_add_u32 s55, s55, 0x2000
  s_cmp_lt_u32 s55, 0x20000
  s_cbranch_scc0 L_fb_done
  v_mfma_f32_16x16x32_bf16 a[32:35], a[152:155], v[208:211], a[32:35]
  v_mfma_f32_16x16x32_bf16 a[36:39], a[152:155], v[212:215], a[36:39]
  v_mfma_f32_16x16x32_bf16 a[40:43], a[152:155], v[216:219], a[40:43]
  v_mfma_f32_16x16x32_bf16 a[44:47], a[152:155], v[220:223], a[44:47]
  v_mfma_f32_16x16x32_bf16 a[48:51], a[156:159], v[208:211], a[48:51]
  v_mfma_f32_16x16x32_bf16 a[52:55], a[156:159], v[212:215], a[52:55]
  v_mfma_f32_16x16x32_bf16 a[56:59], a[156:159], v[216:219], a[56:59]
  v_mfma_f32_16x16x32_bf16 a[60:63], a[156:159], v[220:223], a[60:63]
  v_mfma_f32_16x16x32_bf16 a[64:67], a[160:163], v[208:211], a[64:67]
  v_mfma_f32_16x16x32_bf16 a[68:71], a[160:163], v[212:215], a[68:71]
  v_mfma_f32_16x16x32_bf16 a[72:75], a[160:163], v[216:219], a[72:75]
  v_mfma_f32_16x16x32_bf16 a[76:79], a[160:163], v[220:223], a[76:79]
  v_mfma_f32_16x16x32_bf16 a[80:83], a[164:167], v[208:211], a[80:83]
  v_mfma_f32_16x16x32_bf16 a[84:87], a[164:167], v[212:215], a[84:87]
  v_mfma_f32_16x16x32_bf16 a[88:91], a[164:167], v[216:219], a[88:91]
  v_mfma_f32_16x16x32_bf16 a[92:95], a[164:167], v[220:223], a[92:95]
  v_mfma_f32_16x16x32_bf16 a[96:99], a[168:171], v[208:211], a[96:99]
  v_mfma_f32_16x16x32_bf16 a[100:103], a[168:171], v[212:215], a[100:103]
  v_mfma_f32_16x16x32_bf16 a[104:107], a[168:171], v[216:219], a[104:107]
  v_mfma_f32_16x16x32_bf16 a[108:111], a[168:171], v[220:223], a[108:111]
  v_mfma_f32_16x16x32_bf16 a[112:115], a[172:175], v[208:211], a[112:115]
  v_mfma_f32_16x16x32_bf16 a[116:119], a[172:175], v[212:215], a[116:119]
  v_mfma_f32_16x16x32_bf16 a[120:123], a[172:175], v[216:219], a[120:123]
  v_mfma_f32_16x16x32_bf16 a[124:127], a[172:175], v[220:223], a[124:127]
  s_branch L_fb2
L_fb_done:
  s_nop 7
  v_accvgpr_read_b32 v116, a128
  v_accvgpr_read_b32 v117, a132
  v_accvgpr_read_b32 v118, a136
  v_accvgpr_read_b32 v119, a140
  s_sub_u32 s71, s71, 0x40000
  s_add_u32 m0, s5, 0x18000
  s_nop 0
  buffer_load_dwordx4 v7, s[80:83], s71 offen offset:0 lds
  buffer_load_dwordx4 v8, s[80:83], s71 offen offset:1024 lds
  buffer_load_dwordx4 v9, s[80:83], s71 offen offset:2048 lds
  buffer_load_dwordx4 v10, s[80:83], s71 offen offset:3072 lds
  s_add_u32 s71, s71, 0x20000
  s_add_u32 m0, s5, 0x1c000
  s_nop 0
  buffer_load_dwordx4 v7, s[80:83], s71 offen offset:0 lds
  buffer_load_dwordx4 v8, s[80:83], s71 offen offset:1024 lds
  buffer_load_dwordx4 v9, s[80:83], s71 offen offset:2048 lds
  buffer_load_dwordx4 v10, s[80:83], s71 offen offset:3072 lds
  s_add_u32 s71, s71, 0x20000
  s_waitcnt vmcnt(0)
  s_branch L_fb_ret
L_code_end:

.section .rodata,"a"
.p2align 6
.amdhsa_kernel recurrent_scan__sliding_block_cached__glu_gated_bilinear__prompt_kernel
  .amdhsa_next_free_vgpr 512
  .amdhsa_next_free_sgpr 102
  .amdhsa_accum_offset 256
  .amdhsa_group_segment_fixed_size 0
  .amdhsa_kernarg_size 96
  .amdhsa_user_sgpr_count 2
  .amdhsa_user_sgpr_kernarg_segment_ptr 1
  .amdhsa_system_sgpr_workgroup_id_x 1
  .amdhsa_float_denorm_mode_32 3
.end_amdhsa_kernel
```
